```python
import torch

def _softmax(x, axis=-1):
    return torch.softmax(x, dim=axis)
def _gelu(x):
    return torch.nn.functional.gelu(x, approximate="tanh")
def _silu(x):
    return torch.nn.functional.silu(x)
def _sigmoid(x):
    return torch.sigmoid(x)
def _layernorm(x, axis=-1, eps=1e-5):
    m = x.mean(dim=axis, keepdim=True)
    v = x.var(dim=axis, keepdim=True, unbiased=False)
    return (x - m) / torch.sqrt(v + eps)
def _scatter_add(tgt, idx, src, axis=0):
    return tgt.clone().index_add_(axis, idx, src)
def _segment_sum(src, seg, n):
    out = torch.zeros((n,) + src.shape[1:], dtype=src.dtype)
    return out.index_add_(0, seg, src)
def _pad(x, pw):
    flat = tuple(v for pair in reversed(pw) for v in pair)
    return torch.nn.functional.pad(x, flat)

kernel_name = 'recurrent_scan__compressed_kv_cla__dense_activation_mish__prompt'

def setup_inputs():

    _w = (lambda a: (lambda t: t.to(torch.bfloat16) if t.is_floating_point() else t)(torch.as_tensor(a)))
    def _A_setup():
        B, H, Sq, Sk, D, M = 1, 32, 2048, 2048, 128, 640
        Dc = 4 * D
        return {
            "x": _w((lambda *s: torch.randn(*s, dtype=torch.bfloat16) * 0.05)(B, Sq, M)),
            "c_kv": _w((lambda *s: torch.randn(*s, dtype=torch.bfloat16) * 0.8)(B, Sk, Dc)),
            "w_q": _w((lambda *s: torch.randn(*s, dtype=torch.bfloat16) * 1.6)(M, H, D) * (M ** -0.5)),
            "w_uk": _w((lambda *s: torch.randn(*s, dtype=torch.bfloat16) * 1.6)(Dc, H, D) * (Dc ** -0.5)),
            "w_uv": _w((lambda *s: torch.randn(*s, dtype=torch.bfloat16) * 0.8)(Dc, H, D) * (Dc ** -0.5)),
            "w_o": _w((lambda *s: torch.randn(*s, dtype=torch.bfloat16) * 0.8)(H, D, M) * ((H * D) ** -0.5)),
        }
    _A_in = _A_setup()

    def _B_setup():
        B, S, D, F = 1, 2048, 640, 1728
        return {
            "x": _w((lambda *s: torch.randn(*s, dtype=torch.bfloat16) * 0.05)(B, S, D)),
            "w1": _w((lambda *s: torch.randn(*s, dtype=torch.bfloat16) * 0.8)(D, F) * (D ** -0.5)),
            "b1": _w((lambda *s: torch.randn(*s, dtype=torch.bfloat16) * 0.8)(F)),
            "w2": _w((lambda *s: torch.randn(*s, dtype=torch.bfloat16) * 0.2)(F, D) * (F ** -0.5)),
        }
    _B_in = _B_setup()

    return {
        "A_x": _A_in["x"],
        "A_c_kv": _A_in["c_kv"],
        "A_w_q": _A_in["w_q"],
        "A_w_uk": _A_in["w_uk"],
        "A_w_uv": _A_in["w_uv"],
        "A_w_o": _A_in["w_o"],
        "B_x": _B_in["x"],
        "B_w1": _B_in["w1"],
        "B_b1": _B_in["b1"],
        "B_w2": _B_in["w2"],
    }

def reference(A_x, A_c_kv, A_w_q, A_w_uk, A_w_uv, A_w_o, B_x, B_w1, B_b1, B_w2):
    def _A_ref(x, c_kv, w_q, w_uk, w_uv, w_o):
        B, Sq, M = x.shape[0], x.shape[1], x.shape[2]
        Sk = c_kv.shape[1]
        H, D = w_q.shape[1], w_q.shape[2]
        q = torch.einsum("bqm,mhd->bhqd", x, w_q)
        k = torch.einsum("bkc,chd->bhkd", c_kv, w_uk)
        v = torch.einsum("bkc,chd->bhkd", c_kv, w_uv)
        scores = torch.einsum("bhqd,bhkd->bhqk", q, k) * (D ** -0.5)
        off = Sk - Sq
        qi = torch.arange(Sq)[:, None]
        kj = torch.arange(Sk)[None, :]
        cmask = kj <= (qi + off)
        scores = torch.where(cmask[None, None], scores, -1e9)
        p = _softmax(scores, axis=-1)
        ctx = torch.einsum("bhqk,bhkd->bhqd", p, v)
        return torch.einsum("bhqd,hdm->bqm", ctx, w_o)

    def _B_ref(x, w1, b1, w2):
        h = torch.einsum("bsd,df->bsf", x, w1) + b1
        sp = torch.log1p(torch.exp(-torch.abs(h))) + torch.where(h > 0, h, torch.zeros_like(h))
        act = h * torch.tanh(sp)
        return torch.einsum("bsf,fd->bsd", act, w2)

    x = A_x
    xn = _layernorm(x, axis=-1)
    s = _A_ref(xn, A_c_kv, A_w_q, A_w_uk, A_w_uv, A_w_o)
    g = _silu(_B_ref(xn, B_w1, B_b1, B_w2))
    return x + s * g
```

```asm
; @launch grid=(256,1,1) block=(512,1,1) lds=163840
.amdgcn_target "amdgcn-amd-amdhsa--gfx950"
.text
.globl recurrent_scan__compressed_kv_cla__dense_activation_mish__prompt_kernel
.p2align 8
.type recurrent_scan__compressed_kv_cla__dense_activation_mish__prompt_kernel,@function
recurrent_scan__compressed_kv_cla__dense_activation_mish__prompt_kernel:
    s_cmp_lt_u32 s2, 256
    s_cbranch_scc1 recurrent_scan__compressed_kv_cla__dense_activation_mish__prompt_kernel_go
    s_endpgm
recurrent_scan__compressed_kv_cla__dense_activation_mish__prompt_kernel_go:
    s_load_dwordx2 s[4:5], s[0:1], 8
    s_load_dwordx2 s[8:9], s[0:1], 24
    s_load_dwordx2 s[16:17], s[0:1], 32
    s_load_dwordx2 s[84:85], s[0:1], 40
    s_load_dwordx2 s[86:87], s[0:1], 72
    s_load_dwordx2 s[54:55], s[0:1], 96
    s_load_dwordx2 s[60:61], s[0:1], 16
    s_load_dwordx4 s[64:67], s[0:1], 56
    s_load_dwordx2 s[70:71], s[0:1], 0
    s_load_dwordx2 s[72:73], s[0:1], 80
    v_lshrrev_b32 v16, 6, v0
    v_and_b32 v17, 63, v0
    v_readfirstlane_b32 s22, v16
    v_lshlrev_b32 v1, 4, v17
    s_getpc_b64 s[94:95]
recurrent_scan__compressed_kv_cla__dense_activation_mish__prompt_kernel_pc:
    s_lshr_b32 s38, s2, 3
    s_lshl_b32 s38, s38, 3
    v_add_u32 v2, s38, v16
    v_mad_u32_u24 v2, v2, 4, v17
    v_lshlrev_b32 v2, 7, v2
    v_min_u32 v2, recurrent_scan__compressed_kv_cla__dense_activation_mish__prompt_kernel_codeend-recurrent_scan__compressed_kv_cla__dense_activation_mish__prompt_kernel_pc-4, v2
    s_bfm_b64 exec, 4, 0
    global_load_dword v3, v2, s[94:95]
    s_mov_b64 exec, -1
    s_and_b32 s38, s2, 7
    s_lshl_b32 s38, s38, 2
    s_lshr_b32 s39, s2, 6
    s_add_u32 s20, s38, s39
    s_bfe_u32 s21, s2, 0x30003
    s_sub_u32 s35, 15, s21
    s_and_b32 s23, s22, 3
    s_lshr_b32 s24, s22, 2
    s_lshl_b32 s74, s21, 5
    s_add_u32 s74, s74, s20
    s_lshl_b32 s74, s74, 2
    s_add_u32 s74, s74, 73400320
    s_mov_b32 s3, 0
    s_lshr_b32 s25, s2, 6
    s_mul_i32 s25, s25, 0
    s_mul_i32 s38, s21, 1
    s_add_u32 s25, s25, s38
    s_and_b32 s25, s25, 7
    v_lshrrev_b32 v14, 3, v17
    v_lshrrev_b32 v15, 4, v17
    v_and_b32 v16, 7, v17
    v_xor_b32 v16, v16, v15
    v_lshlrev_b32 v16, 4, v16
    v_lshl_add_u32 v4, v14, 10, v16
    v_xor_b32 v14, 64, v4
    v_add_u32 v5, 7168, v14
    v_add_u32 v6, 14336, v4
    v_add_u32 v7, 21504, v14
    v_bfe_u32 v14, v17, 4, 1
    v_bfe_u32 v15, v17, 1, 1
    v_xor_b32 v15, v15, v14
    v_and_b32 v16, 1, v17
    v_lshl_add_u32 v15, v15, 1, v16
    v_lshrrev_b32 v16, 5, v17
    v_lshl_add_u32 v15, v16, 2, v15
    v_lshlrev_b32 v44, 4, v15
    v_bfe_u32 v16, v17, 2, 2
    v_lshl_add_u32 v45, v14, 3, v16
    v_lshl_add_u32 v46, v14, 2, v16
    v_lshl_add_u32 v10, v45, 13, v44
    v_add_u32 v11, 130048, v10
    s_lshr_b32 s38, s22, 1
    s_lshl_b32 s39, s25, 1
    s_add_u32 s26, s38, s39
    s_and_b32 s45, s22, 1
    s_lshl_b32 s45, s45, 15
    s_lshl_b32 s28, s20, 8
    s_add_u32 s28, s28, s45
    s_lshl_b32 s30, s22, 11
    s_lshl_b32 s31, s22, 12
    s_add_u32 s37, s31, 65536
    s_add_u32 s31, s31, 98304
    s_lshl_b32 s32, s21, 3
    s_add_u32 s32, s32, s22
    s_lshl_b32 s75, s32, 13
    s_lshl_b32 s32, s32, 15
    s_waitcnt lgkmcnt(0)
    s_and_b32 s5, s5, 0xffff
    s_mov_b32 s6, 2097152
    s_mov_b32 s7, 0x20000
    s_add_u32 s38, s25, 0
    s_and_b32 s38, s38, 7
    s_lshl_b32 s38, s38, 7
    s_add_u32 m0, s31, 0
    s_add_u32 s38, s38, s32
    buffer_load_dwordx4 v4, s[4:7], s38 offen offset:0 lds
    buffer_load_dwordx4 v5, s[4:7], s38 offen offset:1024 lds
    buffer_load_dwordx4 v6, s[4:7], s38 offen offset:2048 lds
    buffer_load_dwordx4 v7, s[4:7], s38 offen offset:3072 lds
    s_and_b32 s9, s9, 0xffff
    s_mov_b32 s10, 4194304
    s_mov_b32 s11, 0x20000
    s_add_u32 s38, s26, 0
    s_and_b32 s38, s38, 15
    s_lshl_b32 s38, s38, 18
    s_add_u32 s38, s38, s28
    s_add_u32 m0, s30, 0
    s_add_u32 s38, s38, 0
    buffer_load_dwordx4 v10, s[8:11], s38 offen lds
    buffer_load_dwordx4 v11, s[8:11], s38 offen offset:1024 lds
    s_barrier
    s_mov_b32 s12, s54
    s_mov_b32 s13, s55
    s_and_b32 s13, s13, 0xffff
    s_mov_b32 s14, 103809024
    s_mov_b32 s15, 0x20000
    v_mov_b32 v14, s21
    v_mov_b32 v15, s22
    v_cmp_gt_u32 vcc, 32, v17
    v_bfe_u32 v16, v1, 2, 7
    s_lshr_b32 s40, s22, 2
    v_cndmask_b32 v14, v15, v14, vcc
    v_lshl_add_u32 v2, v14, 7, v16
    v_add_u32 v2, 73400320, v2
    buffer_load_dword v13, v2, s[12:15], 0 offen sc1
    s_add_u32 s27, s40, s39
    s_bfe_u32 s40, s22, 0x10001
    s_mul_i32 s45, s40, 12
    s_add_u32 s27, s27, s45
    s_lshl_b32 s40, s40, 7
    s_add_u32 s29, s28, s40
    s_add_u32 s38, s25, 1
    s_and_b32 s38, s38, 7
    s_lshl_b32 s38, s38, 7
    s_add_u32 m0, s31, 32768
    s_add_u32 s38, s38, s32
    buffer_load_dwordx4 v4, s[4:7], s38 offen offset:0 lds
    buffer_load_dwordx4 v5, s[4:7], s38 offen offset:1024 lds
    buffer_load_dwordx4 v6, s[4:7], s38 offen offset:2048 lds
    buffer_load_dwordx4 v7, s[4:7], s38 offen offset:3072 lds
    s_barrier
    v_and_b32 v14, 15, v17
    v_lshrrev_b32 v15, 4, v17
    v_lshlrev_b32 v26, 3, v15
    v_lshrrev_b32 v16, 1, v14
    v_xor_b32 v15, v15, v16
    v_lshlrev_b32 v15, 4, v15
    v_lshl_add_u32 v14, v14, 7, v15
    v_add_u32 v8, s31, v14
    v_xor_b32 v9, 64, v8
    v_add_u32 v40, s37, v14
    v_xor_b32 v41, 64, v40
    v_lshrrev_b32 v14, 5, v17
    v_bfe_u32 v15, v17, 2, 3
    v_lshlrev_b32 v15, 6, v15
    v_lshl_add_u32 v14, v14, 10, v15
    v_bfe_u32 v15, v17, 4, 1
    v_lshl_add_u32 v14, v15, 5, v14
    v_and_b32 v15, 3, v17
    v_lshl_add_u32 v20, v15, 3, v14
    v_xor_b32 v21, 32, v20
    v_add_u32 v22, 49152, v20
    v_add_u32 v23, 49152, v21
    v_add_u32 v24, 98304, v20
    v_add_u32 v25, 98304, v21
    v_mul_u32_u24 v12, 3456, v45
    v_add_u32 v12, v12, v44
    s_add_u32 s38, s27, 4
    s_and_b32 s38, s38, 15
    s_lshl_b32 s38, s38, 18
    s_add_u32 s38, s38, s29
    s_add_u32 m0, s30, 16384
    s_add_u32 s38, s38, 0
    buffer_load_dwordx4 v10, s[8:11], s38 offen lds
    buffer_load_dwordx4 v11, s[8:11], s38 offen offset:1024 lds
    s_lshr_b32 s45, s16, 8
    s_add_u32 s45, s45, s20
    s_and_b32 s45, s45, 3
    s_andn2_b32 s39, s20, 3
    s_add_u32 s39, s39, s45
    s_or_b32 s39, s39, 4
    s_cmp_eq_u32 s39, 31
    s_cselect_b32 s45, 1, s45
    s_cmp_eq_u32 s45, 1
    s_cbranch_scc1 recurrent_scan__compressed_kv_cla__dense_activation_mish__prompt_kernel_no1
    s_waitcnt vmcnt(9)
    ds_read_b128 v[64:67], v8 offset:0
    ds_read_b128 v[68:71], v8 offset:2048
    ds_read_b128 v[72:75], v9 offset:0
    ds_read_b128 v[76:79], v9 offset:2048
    s_waitcnt vmcnt(7)
    s_barrier
    ds_read_b64_tr_b16 v[44:45], v20 offset:0
    ds_read_b64_tr_b16 v[46:47], v20 offset:2048
    ds_read_b64_tr_b16 v[48:49], v21 offset:0
    ds_read_b64_tr_b16 v[50:51], v21 offset:2048
    ds_read_b64_tr_b16 v[52:53], v20 offset:512
    ds_read_b64_tr_b16 v[54:55], v20 offset:2560
    ds_read_b64_tr_b16 v[56:57], v21 offset:512
    ds_read_b64_tr_b16 v[58:59], v21 offset:2560
    ds_read_b64_tr_b16 v[60:61], v20 offset:4096
    ds_read_b64_tr_b16 v[62:63], v20 offset:6144
    s_waitcnt lgkmcnt(12)
    s_waitcnt lgkmcnt(10)
    s_waitcnt lgkmcnt(8)
    v_mfma_f32_16x16x32_bf16 v[192:195], v[44:47], v[64:67], 0
    s_cmp_lt_u32 s20, 16
    s_cselect_b32 s47, s35, s21
    s_lshl_b32 s47, s47, 4
    s_and_b32 s48, s20, 15
    s_add_u32 s47, s47, s48
    v_mfma_f32_16x16x32_bf16 v[208:211], v[44:47], v[68:71], 0
    s_lshl_b32 s48, s47, 3
    s_add_u32 s48, s48, s22
    s_mul_i32 s41, s48, 1280
    s_mov_b32 s80, s70
    s_mov_b32 s81, s71
    s_add_u32 s38, s25, 2
    s_and_b32 s38, s38, 7
    s_lshl_b32 s38, s38, 7
    s_mov_b32 m0, s37
    s_add_u32 s38, s38, s32
    buffer_load_dwordx4 v4, s[4:7], s38 offen offset:0 lds
    s_waitcnt lgkmcnt(6)
    v_mfma_f32_16x16x32_bf16 v[196:199], v[48:51], v[64:67], 0
    ds_read_b64_tr_b16 v[44:45], v21 offset:4096
    s_and_b32 s81, s81, 0xffff
    s_mov_b32 s82, 2621440
    s_mov_b32 s83, 0x20000
    s_lshr_b32 s44, s47, 1
    s_mul_i32 s44, s44, 20480
    v_mfma_f32_16x16x32_bf16 v[212:215], v[48:51], v[68:71], 0
    ds_read_b64_tr_b16 v[46:47], v21 offset:6144
    s_and_b32 s47, s47, 1
    s_lshl_b32 s47, s47, 7
    s_add_u32 s44, s44, s47
    s_lshl_b32 s47, s22, 11
    s_add_u32 s44, s44, s47
    buffer_load_dwordx4 v5, s[4:7], s38 offen offset:1024 lds
    s_waitcnt vmcnt(4)
    ds_read_b128 v[80:83], v8 offset:32768
    ds_read_b128 v[84:87], v8 offset:34816
    s_waitcnt lgkmcnt(8)
    v_mfma_f32_16x16x32_bf16 v[200:203], v[52:55], v[64:67], 0
    ds_read_b64_tr_b16 v[48:49], v20 offset:4608
    s_add_u32 s44, s44, 50331648
    v_and_b32 v15, 7, v17
    v_xor_b32 v16, s22, v15
    v_lshlrev_b32 v14, 7, v17
    v_lshl_add_u32 v14, v16, 4, v14
    v_mfma_f32_16x16x32_bf16 v[216:219], v[52:55], v[68:71], 0
    ds_read_b64_tr_b16 v[50:51], v20 offset:6656
    v_add_u32 v42, 49152, v14
    v_lshrrev_b32 v14, 3, v17
    v_xor_b32 v15, v15, v14
    v_lshlrev_b32 v15, 4, v15
    v_lshl_add_u32 v43, v14, 8, v15
    buffer_load_dwordx4 v6, s[4:7], s38 offen offset:2048 lds
    ds_read_b128 v[88:91], v9 offset:32768
    ds_read_b128 v[92:95], v9 offset:34816
    s_waitcnt lgkmcnt(10)
    v_mfma_f32_16x16x32_bf16 v[204:207], v[56:59], v[64:67], 0
    ds_read_b64_tr_b16 v[52:53], v21 offset:4608
    s_and_b32 s17, s17, 0xffff
    s_mov_b32 s18, 4194304
    s_mov_b32 s19, 0x20000
    s_xor_b32 s46, s20, 0
    s_lshl_b32 s46, s46, 19
    v_mfma_f32_16x16x32_bf16 v[220:223], v[56:59], v[68:71], 0
    ds_read_b64_tr_b16 v[54:55], v21 offset:6656
    s_add_u32 s75, s75, s46
    s_xor_b32 s46, s2, 0
    s_lshl_b32 s46, s46, 3
    s_add_u32 s46, s46, s22
    s_mul_i32 s47, s46, 6554
    buffer_load_dwordx4 v7, s[4:7], s38 offen offset:3072 lds
    s_waitcnt lgkmcnt(10)
    v_mfma_f32_16x16x32_bf16 v[192:195], v[60:63], v[72:75], v[192:195]
    ds_read_b64_tr_b16 v[56:57], v20 offset:8192
    s_lshr_b32 s47, s47, 16
    s_mul_i32 s48, s47, 10
    s_sub_u32 s46, s46, s48
    s_cmp_lt_u32 s47, 128
    s_cselect_b32 s84, s84, s86
    s_cselect_b32 s85, s85, s87
    s_mov_b32 s48, 5242880
    s_cselect_b32 s86, s48, 2211840
    s_mov_b32 s92, 131072
    s_cselect_b32 s92, s92, 55296
    s_mov_b32 s49, 62914560
    s_cselect_b32 s49, s49, 69206016
    v_mfma_f32_16x16x32_bf16 v[208:211], v[60:63], v[76:79], v[208:211]
    ds_read_b64_tr_b16 v[58:59], v20 offset:10240
    s_and_b32 s85, s85, 0xffff
    s_mov_b32 s87, 0x20000
    s_cmp_lt_u32 s47, 182
    s_cselect_b32 s49, s49, 0x40000000
    s_and_b32 s47, s47, 127
    buffer_load_dwordx4 v[28:31], v1, s[80:83], s41 offen offset:0
    s_waitcnt lgkmcnt(10)
    v_mfma_f32_16x16x32_bf16 v[196:199], v[44:47], v[72:75], v[196:199]
    ds_read_b64_tr_b16 v[60:61], v21 offset:8192
    s_mul_i32 s90, s47, 40960
    s_lshl_b32 s48, s46, 7
    s_add_u32 s90, s90, s48
    s_mul_i32 s91, s46, s92
    s_lshl_b32 s91, s91, 2
    v_mfma_f32_16x16x32_bf16 v[212:215], v[44:47], v[76:79], v[212:215]
    ds_read_b64_tr_b16 v[62:63], v21 offset:10240
    s_lshl_b32 s47, s47, 10
    s_add_u32 s91, s91, s47
    s_add_u32 s91, s91, s49
    s_lshr_b32 s49, s16, 8
    s_add_u32 s49, s49, s20
    buffer_load_dwordx4 v[32:35], v1, s[80:83], s41 offen offset:1024
    s_waitcnt lgkmcnt(8)
    v_mfma_f32_16x16x32_bf16 v[200:203], v[48:51], v[72:75], v[200:203]
    ds_read_b64_tr_b16 v[44:45], v20 offset:8704
    s_and_b32 s49, s49, 3
    s_lshr_b32 s47, s20, 2
    s_mul_i32 s56, s47, 3
    s_max_u32 s46, s49, 1
    s_add_u32 s56, s56, s46
    v_mfma_f32_16x16x32_bf16 v[216:219], v[48:51], v[76:79], v[216:219]
    ds_read_b64_tr_b16 v[46:47], v20 offset:10752
    s_cmp_eq_u32 s47, 7
    s_cselect_b32 s46, 2, 1
    s_sub_u32 s56, s56, s46
    s_lshl_b32 s56, s56, 1
    s_add_u32 s46, s47, 44
    s_add_u32 s38, s27, 6
    s_and_b32 s38, s38, 15
    s_lshl_b32 s38, s38, 18
    s_add_u32 s38, s38, s29
    s_add_u32 m0, s30, 32768
    s_add_u32 s38, s38, 0
    buffer_load_dwordx4 v10, s[8:11], s38 offen lds
    s_waitcnt lgkmcnt(6)
    v_mfma_f32_16x16x32_bf16 v[204:207], v[52:55], v[72:75], v[204:207]
    ds_read_b64_tr_b16 v[48:49], v21 offset:8704
    s_cmp_eq_u32 s49, 1
    s_cselect_b32 s56, s46, s56
    s_add_u32 s46, s47, 46
    s_lshl_b32 s47, s47, 2
    s_add_u32 s47, s47, s49
    v_mfma_f32_16x16x32_bf16 v[220:223], v[52:55], v[76:79], v[220:223]
    ds_read_b64_tr_b16 v[50:51], v21 offset:10752
    s_or_b32 s47, s47, 4
    s_cmp_eq_u32 s47, 31
    s_cselect_b32 s56, s46, s56
    s_cmp_eq_u32 s24, 0
    s_cselect_b32 s47, s35, s21
    buffer_load_dwordx4 v11, s[8:11], s38 offen offset:1024 lds
    s_waitcnt lgkmcnt(6)
    v_mfma_f32_16x16x32_bf16 v[192:195], v[56:59], v[80:83], v[192:195]
    ds_read_b64_tr_b16 v[52:53], v20 offset:12288
    s_lshl_b32 s47, s47, 2
    s_add_u32 s42, s47, s23
    s_mul_i32 s33, s42, 40960
    s_add_u32 s33, s33, 50331648
    s_add_u32 s34, s33, 20480
    v_mfma_f32_16x16x32_bf16 v[208:211], v[56:59], v[84:87], v[208:211]
    ds_read_b64_tr_b16 v[54:55], v20 offset:14336
    s_mul_i32 s42, s42, 110592
    s_lshl_b32 s47, s56, 10
    s_add_u32 s42, s42, s47
    s_add_u32 s42, s42, 54525952
    s_lshl_b32 s58, s24, 18
    s_add_u32 s38, s25, 3
    s_and_b32 s38, s38, 7
    s_lshl_b32 s38, s38, 7
    s_add_u32 m0, s31, 0
    s_add_u32 s38, s38, s32
    buffer_load_dwordx4 v4, s[4:7], s38 offen offset:0 lds
    s_waitcnt lgkmcnt(6)
    v_mfma_f32_16x16x32_bf16 v[196:199], v[60:63], v[80:83], v[196:199]
    ds_read_b64_tr_b16 v[56:57], v21 offset:12288
    s_add_u32 s58, s58, s29
    s_mul_i32 s69, s24, 12288
    s_lshl_b32 s49, s23, 11
    s_add_u32 s59, s69, s49
    s_lshl_b32 s49, s23, 10
    v_mfma_f32_16x16x32_bf16 v[212:215], v[60:63], v[84:87], v[212:215]
    ds_read_b64_tr_b16 v[58:59], v21 offset:14336
    s_add_u32 s69, s69, s49
    s_lshl_b32 s68, s24, 5
    s_and_b32 s47, s22, 1
    s_lshl_b32 s47, s47, 4
    s_add_u32 s68, s68, s47
    buffer_load_dwordx4 v5, s[4:7], s38 offen offset:1024 lds
    s_waitcnt vmcnt(6)
    ds_read_b128 v[96:99], v40 offset:0
    ds_read_b128 v[100:103], v40 offset:2048
    s_waitcnt lgkmcnt(8)
    v_mfma_f32_16x16x32_bf16 v[200:203], v[44:47], v[80:83], v[200:203]
    ds_read_b64_tr_b16 v[60:61], v20 offset:12800
    s_lshr_b32 s47, s23, 1
    s_lshl_b32 s47, s47, 2
    s_add_u32 s68, s68, s47
    s_mul_i32 s68, s68, 3456
    s_lshl_b32 s49, s56, 6
    v_mfma_f32_16x16x32_bf16 v[216:219], v[44:47], v[84:87], v[216:219]
    ds_read_b64_tr_b16 v[62:63], v20 offset:14848
    s_add_u32 s68, s68, s49
    s_add_u32 s100, s66, s49
    s_addc_u32 s101, s67, 0
    s_and_b32 s61, s61, 0xffff
    s_mov_b32 s62, 5242880
    buffer_load_dwordx4 v6, s[4:7], s38 offen offset:2048 lds
    ds_read_b128 v[104:107], v41 offset:0
    ds_read_b128 v[108:111], v41 offset:2048
    s_waitcnt lgkmcnt(10)
    v_mfma_f32_16x16x32_bf16 v[204:207], v[48:51], v[80:83], v[204:207]
    ds_read_b64_tr_b16 v[44:45], v21 offset:12800
    s_mov_b32 s63, 0x20000
    s_and_b32 s65, s65, 0xffff
    s_mov_b32 s66, 2211840
    s_mov_b32 s67, 0x20000
    v_cmp_gt_u32 vcc, 16, v17
    v_mfma_f32_16x16x32_bf16 v[220:223], v[48:51], v[84:87], v[220:223]
    ds_read_b64_tr_b16 v[46:47], v21 offset:14848
    buffer_load_dwordx4 v7, s[4:7], s38 offen offset:3072 lds
    s_barrier
    s_waitcnt lgkmcnt(10)
    v_mfma_f32_16x16x32_bf16 v[192:195], v[52:55], v[88:91], v[192:195]
    ds_read_b64_tr_b16 v[48:49], v20 offset:16384
    v_mfma_f32_16x16x32_bf16 v[208:211], v[52:55], v[92:95], v[208:211]
    ds_read_b64_tr_b16 v[50:51], v20 offset:18432
    v_readlane_b32 s3, v13, s20
    s_andn2_b32 s3, s3, 7
    s_add_u32 s3, s3, 8
    s_add_u32 s38, s27, 8
    s_and_b32 s38, s38, 15
    s_lshl_b32 s38, s38, 18
    s_add_u32 s38, s38, s29
    s_add_u32 m0, s30, 49152
    s_add_u32 s38, s38, 0
    buffer_load_dwordx4 v10, s[8:11], s38 offen lds
    s_waitcnt lgkmcnt(10)
    v_mfma_f32_16x16x32_bf16 v[196:199], v[56:59], v[88:91], v[196:199]
    ds_read_b64_tr_b16 v[52:53], v21 offset:16384
    v_mfma_f32_16x16x32_bf16 v[212:215], v[56:59], v[92:95], v[212:215]
    ds_read_b64_tr_b16 v[54:55], v21 offset:18432
    buffer_load_dwordx4 v11, s[8:11], s38 offen offset:1024 lds
    s_waitcnt lgkmcnt(8)
    v_mfma_f32_16x16x32_bf16 v[200:203], v[60:63], v[88:91], v[200:203]
    ds_read_b64_tr_b16 v[56:57], v20 offset:16896
    v_mfma_f32_16x16x32_bf16 v[216:219], v[60:63], v[92:95], v[216:219]
    ds_read_b64_tr_b16 v[58:59], v20 offset:18944
    s_add_u32 s38, s25, 4
    s_and_b32 s38, s38, 7
    s_lshl_b32 s38, s38, 7
    s_add_u32 m0, s31, 32768
    s_add_u32 s38, s38, s32
    buffer_load_dwordx4 v4, s[4:7], s38 offen offset:0 lds
    s_waitcnt lgkmcnt(6)
    v_mfma_f32_16x16x32_bf16 v[204:207], v[44:47], v[88:91], v[204:207]
    ds_read_b64_tr_b16 v[60:61], v21 offset:16896
    v_mfma_f32_16x16x32_bf16 v[220:223], v[44:47], v[92:95], v[220:223]
    ds_read_b64_tr_b16 v[62:63], v21 offset:18944
    buffer_load_dwordx4 v5, s[4:7], s38 offen offset:1024 lds
    s_waitcnt lgkmcnt(6)
    v_mfma_f32_16x16x32_bf16 v[192:195], v[48:51], v[96:99], v[192:195]
    ds_read_b64_tr_b16 v[44:45], v20 offset:20480
    v_mfma_f32_16x16x32_bf16 v[208:211], v[48:51], v[100:103], v[208:211]
    ds_read_b64_tr_b16 v[46:47], v20 offset:22528
    buffer_load_dwordx4 v6, s[4:7], s38 offen offset:2048 lds
    s_waitcnt lgkmcnt(6)
    v_mfma_f32_16x16x32_bf16 v[196:199], v[52:55], v[96:99], v[196:199]
    ds_read_b64_tr_b16 v[48:49], v21 offset:20480
    v_mfma_f32_16x16x32_bf16 v[212:215], v[52:55], v[100:103], v[212:215]
    ds_read_b64_tr_b16 v[50:51], v21 offset:22528
    buffer_load_dwordx4 v7, s[4:7], s38 offen offset:3072 lds
    s_waitcnt lgkmcnt(6)
    v_mfma_f32_16x16x32_bf16 v[200:203], v[56:59], v[96:99], v[200:203]
    ds_read_b64_tr_b16 v[52:53], v20 offset:20992
    v_mfma_f32_16x16x32_bf16 v[216:219], v[56:59], v[100:103], v[216:219]
    ds_read_b64_tr_b16 v[54:55], v20 offset:23040
    s_waitcnt lgkmcnt(6)
    v_mfma_f32_16x16x32_bf16 v[204:207], v[60:63], v[96:99], v[204:207]
    ds_read_b64_tr_b16 v[56:57], v21 offset:20992
    v_mfma_f32_16x16x32_bf16 v[220:223], v[60:63], v[100:103], v[220:223]
    ds_read_b64_tr_b16 v[58:59], v21 offset:23040
    s_waitcnt lgkmcnt(6)
    v_mfma_f32_16x16x32_bf16 v[224:227], v[44:47], v[64:67], 0
    ds_read_b64_tr_b16 v[60:61], v20 offset:24576
    v_mfma_f32_16x16x32_bf16 v[240:243], v[44:47], v[68:71], 0
    ds_read_b64_tr_b16 v[62:63], v20 offset:26624
    s_waitcnt vmcnt(12)
    v_cndmask_b32 v32, 0, v32, vcc
    v_cndmask_b32 v33, 0, v33, vcc
    v_cndmask_b32 v34, 0, v34, vcc
    v_cndmask_b32 v35, 0, v35, vcc
    s_waitcnt lgkmcnt(6)
    v_mfma_f32_16x16x32_bf16 v[228:231], v[48:51], v[64:67], 0
    ds_read_b64_tr_b16 v[44:45], v21 offset:24576
    v_mfma_f32_16x16x32_bf16 v[244:247], v[48:51], v[68:71], 0
    ds_read_b64_tr_b16 v[46:47], v21 offset:26624
    v_lshlrev_b32 v17, 16, v28
    v_and_b32 v18, 0xffff0000, v28
    v_add_f32 v14, v17, v18
    v_lshlrev_b32 v17, 16, v29
    s_waitcnt lgkmcnt(6)
    v_mfma_f32_16x16x32_bf16 v[232:235], v[52:55], v[64:67], 0
    ds_read_b64_tr_b16 v[48:49], v20 offset:25088
    v_mfma_f32_16x16x32_bf16 v[248:251], v[52:55], v[68:71], 0
    ds_read_b64_tr_b16 v[50:51], v20 offset:27136
    v_and_b32 v18, 0xffff0000, v29
    v_add_f32 v14, v14, v17
    v_add_f32 v14, v14, v18
    v_lshlrev_b32 v17, 16, v30
    s_waitcnt lgkmcnt(6)
    v_mfma_f32_16x16x32_bf16 v[236:239], v[56:59], v[64:67], 0
    ds_read_b64_tr_b16 v[52:53], v21 offset:25088
    v_mfma_f32_16x16x32_bf16 v[252:255], v[56:59], v[68:71], 0
    ds_read_b64_tr_b16 v[54:55], v21 offset:27136
    v_and_b32 v18, 0xffff0000, v30
    v_add_f32 v14, v14, v17
    v_add_f32 v14, v14, v18
    v_lshlrev_b32 v17, 16, v31
    s_waitcnt lgkmcnt(6)
    v_mfma_f32_16x16x32_bf16 v[192:195], v[60:63], v[104:107], v[192:195]
    ds_read_b64_tr_b16 v[56:57], v20 offset:28672
    v_mfma_f32_16x16x32_bf16 v[208:211], v[60:63], v[108:111], v[208:211]
    ds_read_b64_tr_b16 v[58:59], v20 offset:30720
    v_and_b32 v18, 0xffff0000, v31
    v_add_f32 v14, v14, v17
    v_add_f32 v14, v14, v18
    v_lshlrev_b32 v17, 16, v32
    s_waitcnt lgkmcnt(6)
    v_mfma_f32_16x16x32_bf16 v[196:199], v[44:47], v[104:107], v[196:199]
    ds_read_b64_tr_b16 v[60:61], v21 offset:28672
    v_mfma_f32_16x16x32_bf16 v[212:215], v[44:47], v[108:111], v[212:215]
    ds_read_b64_tr_b16 v[62:63], v21 offset:30720
    v_and_b32 v18, 0xffff0000, v32
    v_add_f32 v14, v14, v17
    v_add_f32 v14, v14, v18
    v_lshlrev_b32 v17, 16, v33
    s_waitcnt vmcnt(6)
    ds_read_b128 v[112:115], v8 offset:0
    ds_read_b128 v[116:119], v8 offset:2048
    s_waitcnt lgkmcnt(8)
    v_mfma_f32_16x16x32_bf16 v[200:203], v[48:51], v[104:107], v[200:203]
    ds_read_b64_tr_b16 v[44:45], v20 offset:29184
    v_mfma_f32_16x16x32_bf16 v[216:219], v[48:51], v[108:111], v[216:219]
    ds_read_b64_tr_b16 v[46:47], v20 offset:31232
    v_and_b32 v18, 0xffff0000, v33
    v_add_f32 v14, v14, v17
    v_add_f32 v14, v14, v18
    v_lshlrev_b32 v17, 16, v34
    ds_read_b128 v[120:123], v9 offset:0
    ds_read_b128 v[124:127], v9 offset:2048
    s_waitcnt lgkmcnt(10)
    v_mfma_f32_16x16x32_bf16 v[204:207], v[52:55], v[104:107], v[204:207]
    ds_read_b64_tr_b16 v[48:49], v21 offset:29184
    v_mfma_f32_16x16x32_bf16 v[220:223], v[52:55], v[108:111], v[220:223]
    ds_read_b64_tr_b16 v[50:51], v21 offset:31232
    v_and_b32 v18, 0xffff0000, v34
    v_add_f32 v14, v14, v17
    v_add_f32 v14, v14, v18
    v_lshlrev_b32 v17, 16, v35
    s_barrier
    s_waitcnt lgkmcnt(10)
    v_mfma_f32_16x16x32_bf16 v[224:227], v[56:59], v[72:75], v[224:227]
    ds_read_b64_tr_b16 v[52:53], v20 offset:32768
    v_mfma_f32_16x16x32_bf16 v[240:243], v[56:59], v[76:79], v[240:243]
    ds_read_b64_tr_b16 v[54:55], v20 offset:34816
    v_and_b32 v18, 0xffff0000, v35
    v_add_f32 v14, v14, v17
    v_add_f32 v14, v14, v18
    s_add_u32 s38, s27, 10
    s_and_b32 s38, s38, 15
    s_lshl_b32 s38, s38, 18
    s_add_u32 s38, s38, s29
    s_add_u32 m0, s30, 65536
    s_add_u32 s38, s38, 0
    buffer_load_dwordx4 v10, s[8:11], s38 offen lds
    s_waitcnt lgkmcnt(10)
    v_mfma_f32_16x16x32_bf16 v[228:231], v[60:63], v[72:75], v[228:231]
    ds_read_b64_tr_b16 v[56:57], v21 offset:32768
    v_mfma_f32_16x16x32_bf16 v[244:247], v[60:63], v[76:79], v[244:247]
    ds_read_b64_tr_b16 v[58:59], v21 offset:34816
    v_add_f32_dpp v14, v14, v14 quad_perm:[1,0,3,2] row_mask:0xf bank_mask:0xf
    buffer_load_dwordx4 v11, s[8:11], s38 offen offset:1024 lds
    s_waitcnt lgkmcnt(8)
    v_mfma_f32_16x16x32_bf16 v[232:235], v[44:47], v[72:75], v[232:235]
    ds_read_b64_tr_b16 v[60:61], v20 offset:33280
    v_mfma_f32_16x16x32_bf16 v[248:251], v[44:47], v[76:79], v[248:251]
    ds_read_b64_tr_b16 v[62:63], v20 offset:35328
    v_add_f32_dpp v14, v14, v14 quad_perm:[2,3,0,1] row_mask:0xf bank_mask:0xf
    s_add_u32 s38, s27, 12
    s_and_b32 s38, s38, 15
    s_lshl_b32 s38, s38, 18
    s_add_u32 s38, s38, s29
    s_add_u32 m0, s30, 81920
    s_add_u32 s38, s38, 0
    buffer_load_dwordx4 v10, s[8:11], s38 offen lds
    s_waitcnt lgkmcnt(6)
    v_mfma_f32_16x16x32_bf16 v[236:239], v[48:51], v[72:75], v[236:239]
    ds_read_b64_tr_b16 v[44:45], v21 offset:33280
    v_mfma_f32_16x16x32_bf16 v[252:255], v[48:51], v[76:79], v[252:255]
    ds_read_b64_tr_b16 v[46:47], v21 offset:35328
    v_add_f32_dpp v14, v14, v14 row_half_mirror row_mask:0xf bank_mask:0xf
    buffer_load_dwordx4 v11, s[8:11], s38 offen offset:1024 lds
    s_waitcnt lgkmcnt(6)
    v_mfma_f32_16x16x32_bf16 v[192:195], v[52:55], v[112:115], v[192:195]
    ds_read_b64_tr_b16 v[48:49], v20 offset:36864
    v_mfma_f32_16x16x32_bf16 v[208:211], v[52:55], v[116:119], v[208:211]
    ds_read_b64_tr_b16 v[50:51], v20 offset:38912
    v_add_f32_dpp v14, v14, v14 row_mirror row_mask:0xf bank_mask:0xf
    v_mov_b32 v15, v14
    s_add_u32 s38, s25, 5
    s_and_b32 s38, s38, 7
    s_lshl_b32 s38, s38, 7
    s_add_u32 m0, s31, 0
    s_add_u32 s38, s38, s32
    buffer_load_dwordx4 v4, s[4:7], s38 offen offset:0 lds
    s_waitcnt lgkmcnt(6)
    v_mfma_f32_16x16x32_bf16 v[196:199], v[56:59], v[112:115], v[196:199]
    ds_read_b64_tr_b16 v[52:53], v21 offset:36864
    v_mfma_f32_16x16x32_bf16 v[212:215], v[56:59], v[116:119], v[212:215]
    ds_read_b64_tr_b16 v[54:55], v21 offset:38912
    v_permlane16_swap_b32 v14, v15
    buffer_load_dwordx4 v5, s[4:7], s38 offen offset:1024 lds
    s_waitcnt lgkmcnt(6)
    v_mfma_f32_16x16x32_bf16 v[200:203], v[60:63], v[112:115], v[200:203]
    ds_read_b64_tr_b16 v[56:57], v20 offset:37376
    v_mfma_f32_16x16x32_bf16 v[216:219], v[60:63], v[116:119], v[216:219]
    ds_read_b64_tr_b16 v[58:59], v20 offset:39424
    v_add_f32 v14, v14, v15
    v_mov_b32 v15, v14
    buffer_load_dwordx4 v6, s[4:7], s38 offen offset:2048 lds
    s_waitcnt lgkmcnt(6)
    v_mfma_f32_16x16x32_bf16 v[204:207], v[44:47], v[112:115], v[204:207]
    ds_read_b64_tr_b16 v[60:61], v21 offset:37376
    v_mfma_f32_16x16x32_bf16 v[220:223], v[44:47], v[116:119], v[220:223]
    ds_read_b64_tr_b16 v[62:63], v21 offset:39424
    v_permlane32_swap_b32 v14, v15
    buffer_load_dwordx4 v7, s[4:7], s38 offen offset:3072 lds
    s_waitcnt lgkmcnt(6)
    v_mfma_f32_16x16x32_bf16 v[224:227], v[48:51], v[80:83], v[224:227]
    ds_read_b64_tr_b16 v[44:45], v20 offset:40960
    v_mfma_f32_16x16x32_bf16 v[240:243], v[48:51], v[84:87], v[240:243]
    ds_read_b64_tr_b16 v[46:47], v20 offset:43008
    v_add_f32 v14, v14, v15
    v_mul_f32 v16, 0.0015625, v14
    v_lshlrev_b32 v17, 16, v32
    v_and_b32 v18, 0xffff0000, v32
    s_add_u32 s38, s27, 14
    s_and_b32 s38, s38, 15
    s_lshl_b32 s38, s38, 18
    s_add_u32 s38, s38, s29
    s_add_u32 m0, s30, 0
    s_add_u32 s38, s38, 0
    buffer_load_dwordx4 v10, s[8:11], s38 offen lds
    s_waitcnt lgkmcnt(6)
    v_mfma_f32_16x16x32_bf16 v[228:231], v[52:55], v[80:83], v[228:231]
    ds_read_b64_tr_b16 v[48:49], v21 offset:40960
    v_mfma_f32_16x16x32_bf16 v[244:247], v[52:55], v[84:87], v[244:247]
    ds_read_b64_tr_b16 v[50:51], v21 offset:43008
    v_sub_f32 v17, v17, v16
    v_sub_f32 v18, v18, v16
    v_mul_f32 v14, v17, v17
    v_fmac_f32 v14, v18, v18
    buffer_load_dwordx4 v11, s[8:11], s38 offen offset:1024 lds
    s_waitcnt lgkmcnt(6)
    v_mfma_f32_16x16x32_bf16 v[232:235], v[56:59], v[80:83], v[232:235]
    ds_read_b64_tr_b16 v[52:53], v20 offset:41472
    v_mfma_f32_16x16x32_bf16 v[248:251], v[56:59], v[84:87], v[248:251]
    ds_read_b64_tr_b16 v[54:55], v20 offset:43520
    v_lshlrev_b32 v17, 16, v33
    v_and_b32 v18, 0xffff0000, v33
    v_sub_f32 v17, v17, v16
    v_sub_f32 v18, v18, v16
    s_waitcnt lgkmcnt(6)
    v_mfma_f32_16x16x32_bf16 v[236:239], v[60:63], v[80:83], v[236:239]
    ds_read_b64_tr_b16 v[56:57], v21 offset:41472
    v_mfma_f32_16x16x32_bf16 v[252:255], v[60:63], v[84:87], v[252:255]
    ds_read_b64_tr_b16 v[58:59], v21 offset:43520
    v_fmac_f32 v14, v17, v17
    v_fmac_f32 v14, v18, v18
    v_lshlrev_b32 v17, 16, v34
    v_and_b32 v18, 0xffff0000, v34
    s_waitcnt lgkmcnt(6)
    v_mfma_f32_16x16x32_bf16 v[192:195], v[44:47], v[120:123], v[192:195]
    ds_read_b64_tr_b16 v[60:61], v20 offset:45056
    v_mfma_f32_16x16x32_bf16 v[208:211], v[44:47], v[124:127], v[208:211]
    ds_read_b64_tr_b16 v[62:63], v20 offset:47104
    v_sub_f32 v17, v17, v16
    v_sub_f32 v18, v18, v16
    v_fmac_f32 v14, v17, v17
    v_fmac_f32 v14, v18, v18
    s_lshl_b32 s39, s21, 3
    s_add_u32 s39, s39, s22
    v_bfe_u32 v19, v1, 4, 1
    v_lshrrev_b32 v27, 5, v1
    v_lshlrev_b32 v19, 7, v19
    v_lshl_add_u32 v19, v27, 13, v19
    s_mul_i32 s38, s39, 65536
    s_lshl_b32 s39, s20, 8
    s_add_u32 s38, s38, s39
    s_bfm_b64 exec, 16, 0
    buffer_load_dword v3, v19, s[16:19], s38 offen
    s_mov_b64 exec, -1
    s_waitcnt lgkmcnt(6)
    v_mfma_f32_16x16x32_bf16 v[196:199], v[48:51], v[120:123], v[196:199]
    ds_read_b64_tr_b16 v[44:45], v21 offset:45056
    v_mfma_f32_16x16x32_bf16 v[212:215], v[48:51], v[124:127], v[212:215]
    ds_read_b64_tr_b16 v[46:47], v21 offset:47104
    v_lshlrev_b32 v17, 16, v35
    v_and_b32 v18, 0xffff0000, v35
    v_sub_f32 v17, v17, v16
    v_sub_f32 v18, v18, v16
    s_waitcnt vmcnt(11)
    ds_read_b128 v[128:131], v8 offset:32768
    ds_read_b128 v[132:135], v8 offset:34816
    s_waitcnt lgkmcnt(8)
    v_mfma_f32_16x16x32_bf16 v[200:203], v[52:55], v[120:123], v[200:203]
    ds_read_b64_tr_b16 v[48:49], v20 offset:45568
    v_mfma_f32_16x16x32_bf16 v[216:219], v[52:55], v[124:127], v[216:219]
    ds_read_b64_tr_b16 v[50:51], v20 offset:47616
    v_fmac_f32 v14, v17, v17
    v_fmac_f32 v14, v18, v18
    v_cndmask_b32 v14, 0, v14, vcc
    v_lshlrev_b32 v17, 16, v28
    ds_read_b128 v[136:139], v9 offset:32768
    ds_read_b128 v[140:143], v9 offset:34816
    s_waitcnt lgkmcnt(10)
    v_mfma_f32_16x16x32_bf16 v[204:207], v[56:59], v[120:123], v[204:207]
    ds_read_b64_tr_b16 v[52:53], v21 offset:45568
    v_mfma_f32_16x16x32_bf16 v[220:223], v[56:59], v[124:127], v[220:223]
    ds_read_b64_tr_b16 v[54:55], v21 offset:47616
    v_and_b32 v18, 0xffff0000, v28
    v_sub_f32 v17, v17, v16
    v_sub_f32 v18, v18, v16
    v_fmac_f32 v14, v17, v17
    s_barrier
    s_waitcnt lgkmcnt(10)
    v_mfma_f32_16x16x32_bf16 v[224:227], v[60:63], v[88:91], v[224:227]
    ds_read_b64_tr_b16 v[56:57], v22 offset:0
    v_mfma_f32_16x16x32_bf16 v[240:243], v[60:63], v[92:95], v[240:243]
    ds_read_b64_tr_b16 v[58:59], v22 offset:2048
    v_fmac_f32 v14, v18, v18
    v_lshlrev_b32 v17, 16, v29
    v_and_b32 v18, 0xffff0000, v29
    v_sub_f32 v17, v17, v16
    s_add_u32 s38, s26, 12
    s_and_b32 s38, s38, 15
    s_lshl_b32 s38, s38, 18
    s_add_u32 s38, s38, s28
    s_add_u32 m0, s30, 16384
    s_add_u32 s38, s38, 128
    buffer_load_dwordx4 v10, s[8:11], s38 offen lds
    s_waitcnt lgkmcnt(10)
    v_mfma_f32_16x16x32_bf16 v[228:231], v[44:47], v[88:91], v[228:231]
    ds_read_b64_tr_b16 v[60:61], v23 offset:0
    v_mfma_f32_16x16x32_bf16 v[244:247], v[44:47], v[92:95], v[244:247]
    ds_read_b64_tr_b16 v[62:63], v23 offset:2048
    v_sub_f32 v18, v18, v16
    v_fmac_f32 v14, v17, v17
    v_fmac_f32 v14, v18, v18
    v_lshlrev_b32 v17, 16, v30
    buffer_load_dwordx4 v11, s[8:11], s38 offen offset:1024 lds
    s_waitcnt lgkmcnt(8)
    v_mfma_f32_16x16x32_bf16 v[232:235], v[48:51], v[88:91], v[232:235]
    ds_read_b64_tr_b16 v[44:45], v22 offset:512
    v_mfma_f32_16x16x32_bf16 v[248:251], v[48:51], v[92:95], v[248:251]
    ds_read_b64_tr_b16 v[46:47], v22 offset:2560
    v_and_b32 v18, 0xffff0000, v30
    v_sub_f32 v17, v17, v16
    v_sub_f32 v18, v18, v16
    v_fmac_f32 v14, v17, v17
    s_waitcnt lgkmcnt(6)
    v_mfma_f32_16x16x32_bf16 v[236:239], v[52:55], v[88:91], v[236:239]
    ds_read_b64_tr_b16 v[48:49], v23 offset:512
    v_mfma_f32_16x16x32_bf16 v[252:255], v[52:55], v[92:95], v[252:255]
    ds_read_b64_tr_b16 v[50:51], v23 offset:2560
    v_fmac_f32 v14, v18, v18
    v_lshlrev_b32 v17, 16, v31
    v_and_b32 v18, 0xffff0000, v31
    v_sub_f32 v17, v17, v16
    s_waitcnt lgkmcnt(6)
    v_mfma_f32_16x16x32_bf16 v[192:195], v[56:59], v[128:131], v[192:195]
    ds_read_b64_tr_b16 v[52:53], v22 offset:4096
    v_mfma_f32_16x16x32_bf16 v[208:211], v[56:59], v[132:135], v[208:211]
    ds_read_b64_tr_b16 v[54:55], v22 offset:6144
    v_sub_f32 v18, v18, v16
    v_fmac_f32 v14, v17, v17
    v_fmac_f32 v14, v18, v18
    s_add_u32 s38, s25, 6
    s_and_b32 s38, s38, 7
    s_lshl_b32 s38, s38, 7
    s_add_u32 m0, s31, 32768
    s_add_u32 s38, s38, s32
    buffer_load_dwordx4 v4, s[4:7], s38 offen offset:0 lds
    s_waitcnt lgkmcnt(6)
    v_mfma_f32_16x16x32_bf16 v[196:199], v[60:63], v[128:131], v[196:199]
    ds_read_b64_tr_b16 v[56:57], v23 offset:4096
    v_mfma_f32_16x16x32_bf16 v[212:215], v[60:63], v[132:135], v[212:215]
    ds_read_b64_tr_b16 v[58:59], v23 offset:6144
    v_add_f32_dpp v14, v14, v14 quad_perm:[1,0,3,2] row_mask:0xf bank_mask:0xf
    s_waitcnt lgkmcnt(6)
    v_mfma_f32_16x16x32_bf16 v[200:203], v[44:47], v[128:131], v[200:203]
    ds_read_b64_tr_b16 v[60:61], v22 offset:4608
    v_mfma_f32_16x16x32_bf16 v[216:219], v[44:47], v[132:135], v[216:219]
    ds_read_b64_tr_b16 v[62:63], v22 offset:6656
    v_add_f32_dpp v14, v14, v14 quad_perm:[2,3,0,1] row_mask:0xf bank_mask:0xf
    buffer_load_dwordx4 v5, s[4:7], s38 offen offset:1024 lds
    s_waitcnt lgkmcnt(6)
    v_mfma_f32_16x16x32_bf16 v[204:207], v[48:51], v[128:131], v[204:207]
    ds_read_b64_tr_b16 v[44:45], v23 offset:4608
    v_mfma_f32_16x16x32_bf16 v[220:223], v[48:51], v[132:135], v[220:223]
    ds_read_b64_tr_b16 v[46:47], v23 offset:6656
    v_add_f32_dpp v14, v14, v14 row_half_mirror row_mask:0xf bank_mask:0xf
    s_waitcnt lgkmcnt(6)
    v_mfma_f32_16x16x32_bf16 v[224:227], v[52:55], v[96:99], v[224:227]
    ds_read_b64_tr_b16 v[48:49], v22 offset:8192
    v_mfma_f32_16x16x32_bf16 v[240:243], v[52:55], v[100:103], v[240:243]
    ds_read_b64_tr_b16 v[50:51], v22 offset:10240
    v_add_f32_dpp v14, v14, v14 row_mirror row_mask:0xf bank_mask:0xf
    v_mov_b32 v15, v14
    buffer_load_dwordx4 v6, s[4:7], s38 offen offset:2048 lds
    s_waitcnt lgkmcnt(6)
    v_mfma_f32_16x16x32_bf16 v[228:231], v[56:59], v[96:99], v[228:231]
    ds_read_b64_tr_b16 v[52:53], v23 offset:8192
    v_mfma_f32_16x16x32_bf16 v[244:247], v[56:59], v[100:103], v[244:247]
    ds_read_b64_tr_b16 v[54:55], v23 offset:10240
    v_permlane16_swap_b32 v14, v15
    s_waitcnt lgkmcnt(6)
    v_mfma_f32_16x16x32_bf16 v[232:235], v[60:63], v[96:99], v[232:235]
    ds_read_b64_tr_b16 v[56:57], v22 offset:8704
    v_mfma_f32_16x16x32_bf16 v[248:251], v[60:63], v[100:103], v[248:251]
    ds_read_b64_tr_b16 v[58:59], v22 offset:10752
    v_add_f32 v14, v14, v15
    v_mov_b32 v15, v14
    buffer_load_dwordx4 v7, s[4:7], s38 offen offset:3072 lds
    s_waitcnt lgkmcnt(6)
    v_mfma_f32_16x16x32_bf16 v[236:239], v[44:47], v[96:99], v[236:239]
    ds_read_b64_tr_b16 v[60:61], v23 offset:8704
    v_mfma_f32_16x16x32_bf16 v[252:255], v[44:47], v[100:103], v[252:255]
    ds_read_b64_tr_b16 v[62:63], v23 offset:10752
    v_permlane32_swap_b32 v14, v15
    s_waitcnt lgkmcnt(6)
    v_mfma_f32_16x16x32_bf16 v[192:195], v[48:51], v[136:139], v[192:195]
    ds_read_b64_tr_b16 v[44:45], v22 offset:12288
    v_mfma_f32_16x16x32_bf16 v[208:211], v[48:51], v[140:143], v[208:211]
    ds_read_b64_tr_b16 v[46:47], v22 offset:14336
    v_add_f32 v14, v14, v15
    v_mul_f32 v14, 0.0015625, v14
    v_cvt_pk_bf16_f32 v14, v14, v14
    v_and_b32 v14, 0xffff0000, v14
    s_lshl_b32 s39, s21, 3
    s_add_u32 s39, s39, s22
    v_lshrrev_b32 v19, 4, v1
    v_mul_u32_u24 v19, 3456, v19
    s_mul_i32 s38, s39, 34560
    s_lshl_b32 s39, s56, 6
    s_add_u32 s38, s38, s39
    s_bfm_b64 exec, 10, 0
    buffer_load_dword v3, v19, s[64:67], s38 offen
    s_mov_b64 exec, -1
    s_mov_b64 exec, 129
    global_load_dword v3, v1, s[100:101]
    s_mov_b64 exec, -1
    s_waitcnt lgkmcnt(6)
    v_mfma_f32_16x16x32_bf16 v[196:199], v[52:55], v[136:139], v[196:199]
    ds_read_b64_tr_b16 v[48:49], v23 offset:12288
    v_mfma_f32_16x16x32_bf16 v[212:215], v[52:55], v[140:143], v[212:215]
    ds_read_b64_tr_b16 v[50:51], v23 offset:14336
    v_add_f32 v14, 1e-05, v14
    v_cvt_pk_bf16_f32 v14, v14, v14
    v_and_b32 v14, 0xffff0000, v14
    v_sqrt_f32 v14, v14
    s_waitcnt vmcnt(11)
    ds_read_b128 v[144:147], v8 offset:0
    ds_read_b128 v[148:151], v8 offset:2048
    s_waitcnt lgkmcnt(8)
    v_mfma_f32_16x16x32_bf16 v[200:203], v[56:59], v[136:139], v[200:203]
    ds_read_b64_tr_b16 v[52:53], v22 offset:12800
    v_mfma_f32_16x16x32_bf16 v[216:219], v[56:59], v[140:143], v[216:219]
    ds_read_b64_tr_b16 v[54:55], v22 offset:14848
    v_cvt_pk_bf16_f32 v14, v14, v14
    v_and_b32 v14, 0xffff0000, v14
    v_rcp_f32 v15, v14
    ds_read_b128 v[152:155], v9 offset:0
    ds_read_b128 v[156:159], v9 offset:2048
    s_waitcnt lgkmcnt(10)
    v_mfma_f32_16x16x32_bf16 v[204:207], v[60:63], v[136:139], v[204:207]
    ds_read_b64_tr_b16 v[56:57], v23 offset:12800
    v_mfma_f32_16x16x32_bf16 v[220:223], v[60:63], v[140:143], v[220:223]
    ds_read_b64_tr_b16 v[58:59], v23 offset:14848
    v_cvt_pk_bf16_f32 v16, v16, v16
    v_and_b32 v16, 0xffff0000, v16
    v_lshlrev_b32 v17, 16, v28
    v_and_b32 v18, 0xffff0000, v28
    s_barrier
    s_waitcnt lgkmcnt(10)
    v_mfma_f32_16x16x32_bf16 v[224:227], v[44:47], v[104:107], v[224:227]
    ds_read_b64_tr_b16 v[60:61], v22 offset:16384
    v_mfma_f32_16x16x32_bf16 v[240:243], v[44:47], v[108:111], v[240:243]
    ds_read_b64_tr_b16 v[62:63], v22 offset:18432
    v_sub_f32 v17, v17, v16
    v_sub_f32 v18, v18, v16
    v_cvt_pk_bf16_f32 v28, v17, v18
    v_lshlrev_b32 v17, 16, v28
    s_add_u32 s38, s26, 0
    s_and_b32 s38, s38, 15
    s_lshl_b32 s38, s38, 18
    s_add_u32 s38, s38, s28
    s_add_u32 m0, s30, 32768
    s_add_u32 s38, s38, 0
    buffer_load_dwordx4 v10, s[16:19], s38 offen lds
    s_waitcnt lgkmcnt(10)
    v_mfma_f32_16x16x32_bf16 v[228:231], v[48:51], v[104:107], v[228:231]
    ds_read_b64_tr_b16 v[44:45], v23 offset:16384
    v_mfma_f32_16x16x32_bf16 v[244:247], v[48:51], v[108:111], v[244:247]
    ds_read_b64_tr_b16 v[46:47], v23 offset:18432
    v_and_b32 v18, 0xffff0000, v28
    v_mul_f32 v17, v17, v15
    v_mul_f32 v18, v18, v15
    v_cvt_pk_bf16_f32 v28, v17, v18
    s_waitcnt lgkmcnt(8)
    v_mfma_f32_16x16x32_bf16 v[232:235], v[52:55], v[104:107], v[232:235]
    ds_read_b64_tr_b16 v[48:49], v22 offset:16896
    v_mfma_f32_16x16x32_bf16 v[248:251], v[52:55], v[108:111], v[248:251]
    ds_read_b64_tr_b16 v[50:51], v22 offset:18944
    v_lshlrev_b32 v17, 16, v29
    v_and_b32 v18, 0xffff0000, v29
    v_sub_f32 v17, v17, v16
    v_sub_f32 v18, v18, v16
    buffer_load_dwordx4 v11, s[16:19], s38 offen offset:1024 lds
    s_waitcnt lgkmcnt(6)
    v_mfma_f32_16x16x32_bf16 v[236:239], v[56:59], v[104:107], v[236:239]
    ds_read_b64_tr_b16 v[52:53], v23 offset:16896
    v_mfma_f32_16x16x32_bf16 v[252:255], v[56:59], v[108:111], v[252:255]
    ds_read_b64_tr_b16 v[54:55], v23 offset:18944
    v_cvt_pk_bf16_f32 v29, v17, v18
    v_lshlrev_b32 v17, 16, v29
    v_and_b32 v18, 0xffff0000, v29
    v_mul_f32 v17, v17, v15
    s_waitcnt lgkmcnt(6)
    v_mfma_f32_16x16x32_bf16 v[192:195], v[60:63], v[144:147], v[192:195]
    ds_read_b64_tr_b16 v[56:57], v22 offset:20480
    v_mfma_f32_16x16x32_bf16 v[208:211], v[60:63], v[148:151], v[208:211]
    ds_read_b64_tr_b16 v[58:59], v22 offset:22528
    v_mul_f32 v18, v18, v15
    v_cvt_pk_bf16_f32 v29, v17, v18
    v_lshlrev_b32 v17, 16, v30
    v_and_b32 v18, 0xffff0000, v30
    s_add_u32 s38, s25, 7
    s_and_b32 s38, s38, 7
    s_lshl_b32 s38, s38, 7
    s_add_u32 m0, s31, 0
    s_add_u32 s38, s38, s32
    buffer_load_dwordx4 v4, s[4:7], s38 offen offset:0 lds
    s_waitcnt lgkmcnt(6)
    v_mfma_f32_16x16x32_bf16 v[196:199], v[44:47], v[144:147], v[196:199]
    ds_read_b64_tr_b16 v[60:61], v23 offset:20480
    v_mfma_f32_16x16x32_bf16 v[212:215], v[44:47], v[148:151], v[212:215]
    ds_read_b64_tr_b16 v[62:63], v23 offset:22528
    v_sub_f32 v17, v17, v16
    v_sub_f32 v18, v18, v16
    v_cvt_pk_bf16_f32 v30, v17, v18
    v_lshlrev_b32 v17, 16, v30
    s_waitcnt lgkmcnt(6)
    v_mfma_f32_16x16x32_bf16 v[200:203], v[48:51], v[144:147], v[200:203]
    ds_read_b64_tr_b16 v[44:45], v22 offset:20992
    v_mfma_f32_16x16x32_bf16 v[216:219], v[48:51], v[148:151], v[216:219]
    ds_read_b64_tr_b16 v[46:47], v22 offset:23040
    v_and_b32 v18, 0xffff0000, v30
    v_mul_f32 v17, v17, v15
    v_mul_f32 v18, v18, v15
    v_cvt_pk_bf16_f32 v30, v17, v18
    buffer_load_dwordx4 v5, s[4:7], s38 offen offset:1024 lds
    s_waitcnt lgkmcnt(6)
    v_mfma_f32_16x16x32_bf16 v[204:207], v[52:55], v[144:147], v[204:207]
    ds_read_b64_tr_b16 v[48:49], v23 offset:20992
    v_mfma_f32_16x16x32_bf16 v[220:223], v[52:55], v[148:151], v[220:223]
    ds_read_b64_tr_b16 v[50:51], v23 offset:23040
    v_lshlrev_b32 v17, 16, v31
    v_and_b32 v18, 0xffff0000, v31
    v_sub_f32 v17, v17, v16
    v_sub_f32 v18, v18, v16
    s_waitcnt lgkmcnt(6)
    v_mfma_f32_16x16x32_bf16 v[224:227], v[56:59], v[112:115], v[224:227]
    ds_read_b64_tr_b16 v[52:53], v22 offset:24576
    v_mfma_f32_16x16x32_bf16 v[240:243], v[56:59], v[116:119], v[240:243]
    ds_read_b64_tr_b16 v[54:55], v22 offset:26624
    v_cvt_pk_bf16_f32 v31, v17, v18
    v_lshlrev_b32 v17, 16, v31
    v_and_b32 v18, 0xffff0000, v31
    v_mul_f32 v17, v17, v15
    buffer_load_dwordx4 v6, s[4:7], s38 offen offset:2048 lds
    s_waitcnt lgkmcnt(6)
    v_mfma_f32_16x16x32_bf16 v[228:231], v[60:63], v[112:115], v[228:231]
    ds_read_b64_tr_b16 v[56:57], v23 offset:24576
    v_mfma_f32_16x16x32_bf16 v[244:247], v[60:63], v[116:119], v[244:247]
    ds_read_b64_tr_b16 v[58:59], v23 offset:26624
    v_mul_f32 v18, v18, v15
    v_cvt_pk_bf16_f32 v31, v17, v18
    v_lshlrev_b32 v17, 16, v32
    v_and_b32 v18, 0xffff0000, v32
    s_waitcnt lgkmcnt(6)
    v_mfma_f32_16x16x32_bf16 v[232:235], v[44:47], v[112:115], v[232:235]
    ds_read_b64_tr_b16 v[60:61], v22 offset:25088
    v_mfma_f32_16x16x32_bf16 v[248:251], v[44:47], v[116:119], v[248:251]
    ds_read_b64_tr_b16 v[62:63], v22 offset:27136
    v_sub_f32 v17, v17, v16
    v_sub_f32 v18, v18, v16
    v_cvt_pk_bf16_f32 v32, v17, v18
    v_lshlrev_b32 v17, 16, v32
    buffer_load_dwordx4 v7, s[4:7], s38 offen offset:3072 lds
    s_waitcnt lgkmcnt(6)
    v_mfma_f32_16x16x32_bf16 v[236:239], v[48:51], v[112:115], v[236:239]
    ds_read_b64_tr_b16 v[44:45], v23 offset:25088
    v_mfma_f32_16x16x32_bf16 v[252:255], v[48:51], v[116:119], v[252:255]
    ds_read_b64_tr_b16 v[46:47], v23 offset:27136
    v_and_b32 v18, 0xffff0000, v32
    v_mul_f32 v17, v17, v15
    v_mul_f32 v18, v18, v15
    v_cvt_pk_bf16_f32 v32, v17, v18
    s_waitcnt lgkmcnt(6)
    v_mfma_f32_16x16x32_bf16 v[192:195], v[52:55], v[152:155], v[192:195]
    ds_read_b64_tr_b16 v[48:49], v22 offset:28672
    v_mfma_f32_16x16x32_bf16 v[208:211], v[52:55], v[156:159], v[208:211]
    ds_read_b64_tr_b16 v[50:51], v22 offset:30720
    v_lshlrev_b32 v17, 16, v33
    v_and_b32 v18, 0xffff0000, v33
    v_sub_f32 v17, v17, v16
    v_sub_f32 v18, v18, v16
    s_waitcnt lgkmcnt(6)
    v_mfma_f32_16x16x32_bf16 v[196:199], v[56:59], v[152:155], v[196:199]
    ds_read_b64_tr_b16 v[52:53], v23 offset:28672
    v_mfma_f32_16x16x32_bf16 v[212:215], v[56:59], v[156:159], v[212:215]
    ds_read_b64_tr_b16 v[54:55], v23 offset:30720
    v_cvt_pk_bf16_f32 v33, v17, v18
    v_lshlrev_b32 v17, 16, v33
    v_and_b32 v18, 0xffff0000, v33
    v_mul_f32 v17, v17, v15
    s_waitcnt vmcnt(8)
    ds_read_b128 v[160:163], v8 offset:32768
    ds_read_b128 v[164:167], v8 offset:34816
    s_waitcnt lgkmcnt(8)
    v_mfma_f32_16x16x32_bf16 v[200:203], v[60:63], v[152:155], v[200:203]
    ds_read_b64_tr_b16 v[56:57], v22 offset:29184
    v_mfma_f32_16x16x32_bf16 v[216:219], v[60:63], v[156:159], v[216:219]
    ds_read_b64_tr_b16 v[58:59], v22 offset:31232
    v_mul_f32 v18, v18, v15
    v_cvt_pk_bf16_f32 v33, v17, v18
    v_lshlrev_b32 v17, 16, v34
    v_and_b32 v18, 0xffff0000, v34
    ds_read_b128 v[168:171], v9 offset:32768
    ds_read_b128 v[172:175], v9 offset:34816
    s_waitcnt lgkmcnt(10)
    v_mfma_f32_16x16x32_bf16 v[204:207], v[44:47], v[152:155], v[204:207]
    ds_read_b64_tr_b16 v[60:61], v23 offset:29184
    v_mfma_f32_16x16x32_bf16 v[220:223], v[44:47], v[156:159], v[220:223]
    ds_read_b64_tr_b16 v[62:63], v23 offset:31232
    v_sub_f32 v17, v17, v16
    v_sub_f32 v18, v18, v16
    v_cvt_pk_bf16_f32 v34, v17, v18
    v_lshlrev_b32 v17, 16, v34
    s_barrier
    s_waitcnt lgkmcnt(10)
    v_mfma_f32_16x16x32_bf16 v[224:227], v[48:51], v[120:123], v[224:227]
    ds_read_b64_tr_b16 v[44:45], v22 offset:32768
    v_mfma_f32_16x16x32_bf16 v[240:243], v[48:51], v[124:127], v[240:243]
    ds_read_b64_tr_b16 v[46:47], v22 offset:34816
    v_and_b32 v18, 0xffff0000, v34
    v_mul_f32 v17, v17, v15
    v_mul_f32 v18, v18, v15
    v_cvt_pk_bf16_f32 v34, v17, v18
    s_lshl_b32 s39, s21, 3
    s_add_u32 s39, s39, s22
    v_bfe_u32 v19, v1, 4, 1
    v_lshrrev_b32 v27, 5, v1
    v_lshlrev_b32 v19, 7, v19
    v_lshl_add_u32 v19, v27, 13, v19
    s_mul_i32 s38, s39, 81920
    s_lshl_b32 s39, s20, 8
    s_add_u32 s38, s38, s39
    s_bfm_b64 exec, 20, 0
    buffer_load_dword v3, v19, s[60:63], s38 offen
    s_mov_b64 exec, -1
    s_waitcnt lgkmcnt(10)
    v_mfma_f32_16x16x32_bf16 v[228:231], v[52:55], v[120:123], v[228:231]
    ds_read_b64_tr_b16 v[48:49], v23 offset:32768
    v_mfma_f32_16x16x32_bf16 v[244:247], v[52:55], v[124:127], v[244:247]
    ds_read_b64_tr_b16 v[50:51], v23 offset:34816
    v_lshlrev_b32 v17, 16, v35
    v_and_b32 v18, 0xffff0000, v35
    v_sub_f32 v17, v17, v16
    v_sub_f32 v18, v18, v16
    s_waitcnt lgkmcnt(8)
    v_mfma_f32_16x16x32_bf16 v[232:235], v[56:59], v[120:123], v[232:235]
    ds_read_b64_tr_b16 v[52:53], v22 offset:33280
    v_mfma_f32_16x16x32_bf16 v[248:251], v[56:59], v[124:127], v[248:251]
    ds_read_b64_tr_b16 v[54:55], v22 offset:35328
    v_cvt_pk_bf16_f32 v35, v17, v18
    v_lshlrev_b32 v17, 16, v35
    v_and_b32 v18, 0xffff0000, v35
    v_mul_f32 v17, v17, v15
    s_waitcnt lgkmcnt(6)
    v_mfma_f32_16x16x32_bf16 v[236:239], v[60:63], v[120:123], v[236:239]
    ds_read_b64_tr_b16 v[56:57], v23 offset:33280
    v_mfma_f32_16x16x32_bf16 v[252:255], v[60:63], v[124:127], v[252:255]
    ds_read_b64_tr_b16 v[58:59], v23 offset:35328
    v_mul_f32 v18, v18, v15
    v_cvt_pk_bf16_f32 v35, v17, v18
    s_waitcnt lgkmcnt(6)
    v_mfma_f32_16x16x32_bf16 v[192:195], v[44:47], v[160:163], v[192:195]
    ds_read_b64_tr_b16 v[60:61], v22 offset:36864
    v_mfma_f32_16x16x32_bf16 v[208:211], v[44:47], v[164:167], v[208:211]
    ds_read_b64_tr_b16 v[62:63], v22 offset:38912
    ds_write_b128 v42, v[28:31] offset:0
    ds_write_b128 v42, v[32:35] offset:8192
    s_waitcnt lgkmcnt(8)
    v_mfma_f32_16x16x32_bf16 v[196:199], v[48:51], v[160:163], v[196:199]
    ds_read_b64_tr_b16 v[44:45], v23 offset:36864
    v_mfma_f32_16x16x32_bf16 v[212:215], v[48:51], v[164:167], v[212:215]
    ds_read_b64_tr_b16 v[46:47], v23 offset:38912
    s_waitcnt lgkmcnt(8)
    v_mfma_f32_16x16x32_bf16 v[200:203], v[52:55], v[160:163], v[200:203]
    ds_read_b64_tr_b16 v[48:49], v22 offset:37376
    v_mfma_f32_16x16x32_bf16 v[216:219], v[52:55], v[164:167], v[216:219]
    ds_read_b64_tr_b16 v[50:51], v22 offset:39424
    s_waitcnt lgkmcnt(8)
    v_mfma_f32_16x16x32_bf16 v[204:207], v[56:59], v[160:163], v[204:207]
    ds_read_b64_tr_b16 v[52:53], v23 offset:37376
    v_mfma_f32_16x16x32_bf16 v[220:223], v[56:59], v[164:167], v[220:223]
    ds_read_b64_tr_b16 v[54:55], v23 offset:39424
    s_waitcnt lgkmcnt(8)
    v_mfma_f32_16x16x32_bf16 v[224:227], v[60:63], v[128:131], v[224:227]
    ds_read_b64_tr_b16 v[56:57], v22 offset:40960
    v_mfma_f32_16x16x32_bf16 v[240:243], v[60:63], v[132:135], v[240:243]
    ds_read_b64_tr_b16 v[58:59], v22 offset:43008
    s_waitcnt lgkmcnt(6)
    v_mfma_f32_16x16x32_bf16 v[228:231], v[44:47], v[128:131], v[228:231]
    ds_read_b64_tr_b16 v[60:61], v23 offset:40960
    v_mfma_f32_16x16x32_bf16 v[244:247], v[44:47], v[132:135], v[244:247]
    ds_read_b64_tr_b16 v[62:63], v23 offset:43008
    s_waitcnt lgkmcnt(6)
    v_mfma_f32_16x16x32_bf16 v[232:235], v[48:51], v[128:131], v[232:235]
    ds_read_b64_tr_b16 v[44:45], v22 offset:41472
    v_mfma_f32_16x16x32_bf16 v[248:251], v[48:51], v[132:135], v[248:251]
    ds_read_b64_tr_b16 v[46:47], v22 offset:43520
    s_waitcnt lgkmcnt(6)
    v_mfma_f32_16x16x32_bf16 v[236:239], v[52:55], v[128:131], v[236:239]
    ds_read_b64_tr_b16 v[48:49], v23 offset:41472
    v_mfma_f32_16x16x32_bf16 v[252:255], v[52:55], v[132:135], v[252:255]
    ds_read_b64_tr_b16 v[50:51], v23 offset:43520
    s_waitcnt lgkmcnt(6)
    v_mfma_f32_16x16x32_bf16 v[192:195], v[56:59], v[168:171], v[192:195]
    ds_read_b64_tr_b16 v[52:53], v22 offset:45056
    v_mfma_f32_16x16x32_bf16 v[208:211], v[56:59], v[172:175], v[208:211]
    ds_read_b64_tr_b16 v[54:55], v22 offset:47104
    s_waitcnt lgkmcnt(6)
    v_mfma_f32_16x16x32_bf16 v[196:199], v[60:63], v[168:171], v[196:199]
    ds_read_b64_tr_b16 v[56:57], v23 offset:45056
    v_mfma_f32_16x16x32_bf16 v[212:215], v[60:63], v[172:175], v[212:215]
    ds_read_b64_tr_b16 v[58:59], v23 offset:47104
    s_waitcnt vmcnt(1)
    ds_read_b128 v[176:179], v8 offset:0
    ds_read_b128 v[180:183], v8 offset:2048
    s_waitcnt lgkmcnt(8)
    v_mfma_f32_16x16x32_bf16 v[200:203], v[44:47], v[168:171], v[200:203]
    ds_read_b64_tr_b16 v[60:61], v22 offset:45568
    v_mfma_f32_16x16x32_bf16 v[216:219], v[44:47], v[172:175], v[216:219]
    ds_read_b64_tr_b16 v[62:63], v22 offset:47616
    ds_read_b128 v[184:187], v9 offset:0
    ds_read_b128 v[188:191], v9 offset:2048
    s_waitcnt lgkmcnt(10)
    v_mfma_f32_16x16x32_bf16 v[204:207], v[48:51], v[168:171], v[204:207]
    ds_read_b64_tr_b16 v[44:45], v23 offset:45568
    v_mfma_f32_16x16x32_bf16 v[220:223], v[48:51], v[172:175], v[220:223]
    ds_read_b64_tr_b16 v[46:47], v23 offset:47616
    s_waitcnt lgkmcnt(0)
    s_barrier
    s_lshl_b32 s39, s22, 10
    s_add_u32 s39, s39, 49152
    v_add_u32 v42, s39, v1
    ds_read_b128 v[28:31], v42 offset:0
    ds_read_b128 v[32:35], v42 offset:8192
    v_mfma_f32_16x16x32_bf16 v[224:227], v[52:55], v[136:139], v[224:227]
    ds_read_b64_tr_b16 v[48:49], v20 offset:0
    v_mfma_f32_16x16x32_bf16 v[240:243], v[52:55], v[140:143], v[240:243]
    ds_read_b64_tr_b16 v[50:51], v20 offset:2048
    s_add_u32 s38, s26, 8
    s_and_b32 s38, s38, 15
    s_lshl_b32 s38, s38, 18
    s_add_u32 s38, s38, s28
    s_add_u32 m0, s30, 65536
    s_add_u32 s38, s38, 0
    buffer_load_dwordx4 v10, s[16:19], s38 offen lds
    v_mfma_f32_16x16x32_bf16 v[228:231], v[56:59], v[136:139], v[228:231]
    ds_read_b64_tr_b16 v[52:53], v21 offset:0
    v_mfma_f32_16x16x32_bf16 v[244:247], v[56:59], v[140:143], v[244:247]
    ds_read_b64_tr_b16 v[54:55], v21 offset:2048
    v_mfma_f32_16x16x32_bf16 v[232:235], v[60:63], v[136:139], v[232:235]
    ds_read_b64_tr_b16 v[56:57], v20 offset:512
    v_mfma_f32_16x16x32_bf16 v[248:251], v[60:63], v[140:143], v[248:251]
    ds_read_b64_tr_b16 v[58:59], v20 offset:2560
    buffer_load_dwordx4 v11, s[16:19], s38 offen offset:1024 lds
    s_waitcnt lgkmcnt(6)
    buffer_store_dwordx4 v[28:31], v43, s[12:15], s44 offen sc1
    v_mfma_f32_16x16x32_bf16 v[236:239], v[44:47], v[136:139], v[236:239]
    ds_read_b64_tr_b16 v[60:61], v21 offset:512
    v_mfma_f32_16x16x32_bf16 v[252:255], v[44:47], v[140:143], v[252:255]
    ds_read_b64_tr_b16 v[62:63], v21 offset:2560
    s_waitcnt lgkmcnt(6)
    v_mfma_f32_16x16x32_bf16 v[192:195], v[48:51], v[176:179], v[192:195]
    ds_read_b64_tr_b16 v[44:45], v20 offset:4096
    v_mfma_f32_16x16x32_bf16 v[208:211], v[48:51], v[180:183], v[208:211]
    ds_read_b64_tr_b16 v[46:47], v20 offset:6144
    s_waitcnt lgkmcnt(6)
    v_mfma_f32_16x16x32_bf16 v[196:199], v[52:55], v[176:179], v[196:199]
    ds_read_b64_tr_b16 v[48:49], v21 offset:4096
    v_mfma_f32_16x16x32_bf16 v[212:215], v[52:55], v[180:183], v[212:215]
    ds_read_b64_tr_b16 v[50:51], v21 offset:6144
    s_waitcnt lgkmcnt(6)
    v_mfma_f32_16x16x32_bf16 v[200:203], v[56:59], v[176:179], v[200:203]
    ds_read_b64_tr_b16 v[52:53], v20 offset:4608
    v_mfma_f32_16x16x32_bf16 v[216:219], v[56:59], v[180:183], v[216:219]
    ds_read_b64_tr_b16 v[54:55], v20 offset:6656
    s_cmp_lt_u32 s22, 2
    s_cselect_b32 s45, 16384, 0x40000000
    s_add_u32 s45, s45, s44
    buffer_store_dwordx4 v[32:35], v43, s[12:15], s45 offen sc1
    s_waitcnt lgkmcnt(6)
    v_mfma_f32_16x16x32_bf16 v[204:207], v[60:63], v[176:179], v[204:207]
    ds_read_b64_tr_b16 v[56:57], v21 offset:4608
    v_mfma_f32_16x16x32_bf16 v[220:223], v[60:63], v[180:183], v[220:223]
    ds_read_b64_tr_b16 v[58:59], v21 offset:6656
    s_waitcnt lgkmcnt(6)
    v_mfma_f32_16x16x32_bf16 v[224:227], v[44:47], v[144:147], v[224:227]
    ds_read_b64_tr_b16 v[60:61], v20 offset:8192
    v_mfma_f32_16x16x32_bf16 v[240:243], v[44:47], v[148:151], v[240:243]
    ds_read_b64_tr_b16 v[62:63], v20 offset:10240
    s_waitcnt lgkmcnt(6)
    v_mfma_f32_16x16x32_bf16 v[228:231], v[48:51], v[144:147], v[228:231]
    ds_read_b64_tr_b16 v[44:45], v21 offset:8192
    v_mfma_f32_16x16x32_bf16 v[244:247], v[48:51], v[148:151], v[244:247]
    ds_read_b64_tr_b16 v[46:47], v21 offset:10240
    s_waitcnt lgkmcnt(6)
    v_mfma_f32_16x16x32_bf16 v[232:235], v[52:55], v[144:147], v[232:235]
    ds_read_b64_tr_b16 v[48:49], v20 offset:8704
    v_mfma_f32_16x16x32_bf16 v[248:251], v[52:55], v[148:151], v[248:251]
    ds_read_b64_tr_b16 v[50:51], v20 offset:10752
    s_waitcnt lgkmcnt(6)
    v_mfma_f32_16x16x32_bf16 v[236:239], v[56:59], v[144:147], v[236:239]
    ds_read_b64_tr_b16 v[52:53], v21 offset:8704
    v_mfma_f32_16x16x32_bf16 v[252:255], v[56:59], v[148:151], v[252:255]
    ds_read_b64_tr_b16 v[54:55], v21 offset:10752
    s_waitcnt lgkmcnt(6)
    v_mfma_f32_16x16x32_bf16 v[192:195], v[60:63], v[184:187], v[192:195]
    ds_read_b64_tr_b16 v[56:57], v20 offset:12288
    v_mfma_f32_16x16x32_bf16 v[208:211], v[60:63], v[188:191], v[208:211]
    ds_read_b64_tr_b16 v[58:59], v20 offset:14336
    s_waitcnt lgkmcnt(6)
    v_mfma_f32_16x16x32_bf16 v[196:199], v[44:47], v[184:187], v[196:199]
    ds_read_b64_tr_b16 v[60:61], v21 offset:12288
    v_mfma_f32_16x16x32_bf16 v[212:215], v[44:47], v[188:191], v[212:215]
    ds_read_b64_tr_b16 v[62:63], v21 offset:14336
    s_waitcnt lgkmcnt(6)
    v_mfma_f32_16x16x32_bf16 v[200:203], v[48:51], v[184:187], v[200:203]
    ds_read_b64_tr_b16 v[44:45], v20 offset:12800
    v_mfma_f32_16x16x32_bf16 v[216:219], v[48:51], v[188:191], v[216:219]
    ds_read_b64_tr_b16 v[46:47], v20 offset:14848
    s_waitcnt lgkmcnt(6)
    v_mfma_f32_16x16x32_bf16 v[204:207], v[52:55], v[184:187], v[204:207]
    ds_read_b64_tr_b16 v[48:49], v21 offset:12800
    v_mul_f32 v192, 0.12751743082459868, v192
    v_mul_f32 v193, 0.12751743082459868, v193
    v_mul_f32 v194, 0.12751743082459868, v194
    v_mul_f32 v195, 0.12751743082459868, v195
    v_mfma_f32_16x16x32_bf16 v[220:223], v[52:55], v[188:191], v[220:223]
    ds_read_b64_tr_b16 v[50:51], v21 offset:14848
    s_barrier
    s_waitcnt lgkmcnt(6)
    v_mfma_f32_16x16x32_bf16 v[224:227], v[56:59], v[152:155], v[224:227]
    ds_read_b64_tr_b16 v[52:53], v20 offset:16384
    v_mul_f32 v196, 0.12751743082459868, v196
    v_mul_f32 v197, 0.12751743082459868, v197
    v_mul_f32 v198, 0.12751743082459868, v198
    v_mul_f32 v199, 0.12751743082459868, v199
    v_mfma_f32_16x16x32_bf16 v[240:243], v[56:59], v[156:159], v[240:243]
    ds_read_b64_tr_b16 v[54:55], v20 offset:18432
    s_add_u32 s38, s26, 4
    s_and_b32 s38, s38, 15
    s_lshl_b32 s38, s38, 18
    s_add_u32 s38, s38, s28
    s_add_u32 m0, s30, 49152
    s_add_u32 s38, s38, 0
    buffer_load_dwordx4 v10, s[16:19], s38 offen lds
    s_waitcnt lgkmcnt(6)
    v_mfma_f32_16x16x32_bf16 v[228:231], v[60:63], v[152:155], v[228:231]
    ds_read_b64_tr_b16 v[56:57], v21 offset:16384
    v_cvt_pk_bf16_f32 v28, v192, v193
    v_cvt_pk_bf16_f32 v29, v194, v195
    v_cvt_pk_bf16_f32 v30, v196, v197
    v_cvt_pk_bf16_f32 v31, v198, v199
    v_mfma_f32_16x16x32_bf16 v[244:247], v[60:63], v[156:159], v[244:247]
    ds_read_b64_tr_b16 v[58:59], v21 offset:18432
    s_waitcnt lgkmcnt(6)
    v_mfma_f32_16x16x32_bf16 v[232:235], v[44:47], v[152:155], v[232:235]
    ds_read_b64_tr_b16 v[60:61], v20 offset:16896
    v_mul_f32 v208, 0.12751743082459868, v208
    v_mul_f32 v209, 0.12751743082459868, v209
    v_mul_f32 v210, 0.12751743082459868, v210
    v_mul_f32 v211, 0.12751743082459868, v211
    v_mfma_f32_16x16x32_bf16 v[248:251], v[44:47], v[156:159], v[248:251]
    ds_read_b64_tr_b16 v[62:63], v20 offset:18944
    buffer_load_dwordx4 v11, s[16:19], s38 offen offset:1024 lds
    s_waitcnt lgkmcnt(6)
    v_mfma_f32_16x16x32_bf16 v[236:239], v[48:51], v[152:155], v[236:239]
    ds_read_b64_tr_b16 v[44:45], v21 offset:16896
    v_mul_f32 v212, 0.12751743082459868, v212
    v_mul_f32 v213, 0.12751743082459868, v213
    v_mul_f32 v214, 0.12751743082459868, v214
    v_mul_f32 v215, 0.12751743082459868, v215
    v_mfma_f32_16x16x32_bf16 v[252:255], v[48:51], v[156:159], v[252:255]
    ds_read_b64_tr_b16 v[46:47], v21 offset:18944
    s_add_u32 s45, s75, 0
    buffer_store_dwordx4 v[28:31], v1, s[12:15], s45 offen sc1
    s_waitcnt lgkmcnt(6)
    v_mfma_f32_16x16x32_bf16 v[224:227], v[52:55], v[160:163], v[224:227]
    ds_read_b64_tr_b16 v[48:49], v20 offset:20480
    v_cvt_pk_bf16_f32 v32, v208, v209
    v_cvt_pk_bf16_f32 v33, v210, v211
    v_cvt_pk_bf16_f32 v34, v212, v213
    v_cvt_pk_bf16_f32 v35, v214, v215
    v_mfma_f32_16x16x32_bf16 v[240:243], v[52:55], v[164:167], v[240:243]
    ds_read_b64_tr_b16 v[50:51], v20 offset:22528
    s_add_u32 s38, s26, 12
    s_and_b32 s38, s38, 15
    s_lshl_b32 s38, s38, 18
    s_add_u32 s38, s38, s28
    s_add_u32 m0, s30, 81920
    s_add_u32 s38, s38, 0
    buffer_load_dwordx4 v10, s[16:19], s38 offen lds
    s_waitcnt lgkmcnt(6)
    v_mfma_f32_16x16x32_bf16 v[228:231], v[56:59], v[160:163], v[228:231]
    ds_read_b64_tr_b16 v[52:53], v21 offset:20480
    v_mul_f32 v200, 0.12751743082459868, v200
    v_mul_f32 v201, 0.12751743082459868, v201
    v_mul_f32 v202, 0.12751743082459868, v202
    v_mul_f32 v203, 0.12751743082459868, v203
    v_mfma_f32_16x16x32_bf16 v[244:247], v[56:59], v[164:167], v[244:247]
    ds_read_b64_tr_b16 v[54:55], v21 offset:22528
    s_waitcnt lgkmcnt(6)
    v_mfma_f32_16x16x32_bf16 v[232:235], v[60:63], v[160:163], v[232:235]
    ds_read_b64_tr_b16 v[56:57], v20 offset:20992
    v_mul_f32 v204, 0.12751743082459868, v204
    v_mul_f32 v205, 0.12751743082459868, v205
    v_mul_f32 v206, 0.12751743082459868, v206
    v_mul_f32 v207, 0.12751743082459868, v207
    v_mfma_f32_16x16x32_bf16 v[248:251], v[60:63], v[164:167], v[248:251]
    ds_read_b64_tr_b16 v[58:59], v20 offset:23040
    buffer_load_dwordx4 v11, s[16:19], s38 offen offset:1024 lds
    s_waitcnt lgkmcnt(6)
    v_mfma_f32_16x16x32_bf16 v[236:239], v[44:47], v[160:163], v[236:239]
    ds_read_b64_tr_b16 v[60:61], v21 offset:20992
    v_cvt_pk_bf16_f32 v36, v200, v201
    v_cvt_pk_bf16_f32 v37, v202, v203
    v_cvt_pk_bf16_f32 v38, v204, v205
    v_cvt_pk_bf16_f32 v39, v206, v207
    v_mfma_f32_16x16x32_bf16 v[252:255], v[44:47], v[164:167], v[252:255]
    ds_read_b64_tr_b16 v[62:63], v21 offset:23040
    s_waitcnt lgkmcnt(6)
    v_mfma_f32_16x16x32_bf16 v[224:227], v[48:51], v[168:171], v[224:227]
    ds_read_b64_tr_b16 v[44:45], v20 offset:24576
    v_mul_f32 v216, 0.12751743082459868, v216
    v_mul_f32 v217, 0.12751743082459868, v217
    v_mul_f32 v218, 0.12751743082459868, v218
    v_mul_f32 v219, 0.12751743082459868, v219
    v_mfma_f32_16x16x32_bf16 v[240:243], v[48:51], v[172:175], v[240:243]
    ds_read_b64_tr_b16 v[46:47], v20 offset:26624
    s_add_u32 s38, s26, 0
    s_and_b32 s38, s38, 15
    s_lshl_b32 s38, s38, 18
    s_add_u32 s38, s38, s28
    s_add_u32 m0, s30, 98304
    s_add_u32 s38, s38, 128
    buffer_load_dwordx4 v10, s[16:19], s38 offen lds
    s_waitcnt lgkmcnt(6)
    v_mfma_f32_16x16x32_bf16 v[228:231], v[52:55], v[168:171], v[228:231]
    ds_read_b64_tr_b16 v[48:49], v21 offset:24576
    v_mul_f32 v220, 0.12751743082459868, v220
    v_mul_f32 v221, 0.12751743082459868, v221
    v_mul_f32 v222, 0.12751743082459868, v222
    v_mul_f32 v223, 0.12751743082459868, v223
    v_mfma_f32_16x16x32_bf16 v[244:247], v[52:55], v[172:175], v[244:247]
    ds_read_b64_tr_b16 v[50:51], v21 offset:26624
    s_waitcnt lgkmcnt(6)
    v_mfma_f32_16x16x32_bf16 v[232:235], v[56:59], v[168:171], v[232:235]
    ds_read_b64_tr_b16 v[52:53], v20 offset:25088
    v_cvt_pk_bf16_f32 v40, v216, v217
    v_cvt_pk_bf16_f32 v41, v218, v219
    v_cvt_pk_bf16_f32 v42, v220, v221
    v_cvt_pk_bf16_f32 v43, v222, v223
    v_mfma_f32_16x16x32_bf16 v[248:251], v[56:59], v[172:175], v[248:251]
    ds_read_b64_tr_b16 v[54:55], v20 offset:27136
    buffer_load_dwordx4 v11, s[16:19], s38 offen offset:1024 lds
    s_waitcnt lgkmcnt(6)
    v_mfma_f32_16x16x32_bf16 v[236:239], v[60:63], v[168:171], v[236:239]
    ds_read_b64_tr_b16 v[56:57], v21 offset:25088
    v_mfma_f32_16x16x32_bf16 v[252:255], v[60:63], v[172:175], v[252:255]
    ds_read_b64_tr_b16 v[58:59], v21 offset:27136
    s_waitcnt lgkmcnt(6)
    v_mfma_f32_16x16x32_bf16 v[224:227], v[44:47], v[176:179], v[224:227]
    ds_read_b64_tr_b16 v[60:61], v20 offset:28672
    v_mfma_f32_16x16x32_bf16 v[240:243], v[44:47], v[180:183], v[240:243]
    ds_read_b64_tr_b16 v[62:63], v20 offset:30720
    s_add_u32 s38, s26, 4
    s_and_b32 s38, s38, 15
    s_lshl_b32 s38, s38, 18
    s_add_u32 s38, s38, s28
    s_add_u32 m0, s30, 114688
    s_add_u32 s38, s38, 128
    buffer_load_dwordx4 v10, s[16:19], s38 offen lds
    s_waitcnt lgkmcnt(6)
    v_mfma_f32_16x16x32_bf16 v[228:231], v[48:51], v[176:179], v[228:231]
    ds_read_b64_tr_b16 v[44:45], v21 offset:28672
    v_mfma_f32_16x16x32_bf16 v[244:247], v[48:51], v[180:183], v[244:247]
    ds_read_b64_tr_b16 v[46:47], v21 offset:30720
    s_waitcnt lgkmcnt(6)
    v_mfma_f32_16x16x32_bf16 v[232:235], v[52:55], v[176:179], v[232:235]
    ds_read_b64_tr_b16 v[48:49], v20 offset:29184
    v_mfma_f32_16x16x32_bf16 v[248:251], v[52:55], v[180:183], v[248:251]
    ds_read_b64_tr_b16 v[50:51], v20 offset:31232
    buffer_load_dwordx4 v11, s[16:19], s38 offen offset:1024 lds
    s_waitcnt lgkmcnt(6)
    v_mfma_f32_16x16x32_bf16 v[236:239], v[56:59], v[176:179], v[236:239]
    ds_read_b64_tr_b16 v[52:53], v21 offset:29184
    v_mfma_f32_16x16x32_bf16 v[252:255], v[56:59], v[180:183], v[252:255]
    ds_read_b64_tr_b16 v[54:55], v21 offset:31232
    s_barrier
    s_waitcnt lgkmcnt(6)
    v_mfma_f32_16x16x32_bf16 v[224:227], v[60:63], v[184:187], v[224:227]
    ds_read_b64_tr_b16 v[56:57], v20 offset:32768
    v_mfma_f32_16x16x32_bf16 v[240:243], v[60:63], v[188:191], v[240:243]
    ds_read_b64_tr_b16 v[58:59], v20 offset:34816
    s_add_u32 s45, s75, 4096
    buffer_store_dwordx4 v[32:35], v1, s[12:15], s45 offen sc1
    s_waitcnt lgkmcnt(6)
    v_mfma_f32_16x16x32_bf16 v[228:231], v[44:47], v[184:187], v[228:231]
    ds_read_b64_tr_b16 v[60:61], v21 offset:32768
    v_mfma_f32_16x16x32_bf16 v[244:247], v[44:47], v[188:191], v[244:247]
    ds_read_b64_tr_b16 v[62:63], v21 offset:34816
    s_waitcnt lgkmcnt(6)
    v_mfma_f32_16x16x32_bf16 v[232:235], v[48:51], v[184:187], v[232:235]
    ds_read_b64_tr_b16 v[44:45], v20 offset:33280
    v_mfma_f32_16x16x32_bf16 v[248:251], v[48:51], v[188:191], v[248:251]
    ds_read_b64_tr_b16 v[46:47], v20 offset:35328
    s_waitcnt lgkmcnt(6)
    v_mfma_f32_16x16x32_bf16 v[236:239], v[52:55], v[184:187], v[236:239]
    ds_read_b64_tr_b16 v[48:49], v21 offset:33280
    v_mul_f32 v224, 0.12751743082459868, v224
    v_mul_f32 v225, 0.12751743082459868, v225
    v_mul_f32 v226, 0.12751743082459868, v226
    v_mul_f32 v227, 0.12751743082459868, v227
    v_mfma_f32_16x16x32_bf16 v[252:255], v[52:55], v[188:191], v[252:255]
    ds_read_b64_tr_b16 v[50:51], v21 offset:35328
    s_waitcnt lgkmcnt(6)
    v_mfma_f32_16x16x32_bf16 v[192:195], v[64:67], v[56:59], 0
    ds_read_b64_tr_b16 v[52:53], v20 offset:36864
    v_mul_f32 v228, 0.12751743082459868, v228
    v_mul_f32 v229, 0.12751743082459868, v229
    v_mul_f32 v230, 0.12751743082459868, v230
    v_mul_f32 v231, 0.12751743082459868, v231
    v_mfma_f32_16x16x32_bf16 v[208:211], v[68:71], v[56:59], 0
    ds_read_b64_tr_b16 v[54:55], v20 offset:38912
    s_waitcnt lgkmcnt(6)
    v_mfma_f32_16x16x32_bf16 v[196:199], v[64:67], v[60:63], 0
    ds_read_b64_tr_b16 v[56:57], v21 offset:36864
    v_cvt_pk_bf16_f32 v224, v224, v225
    v_cvt_pk_bf16_f32 v225, v226, v227
    v_cvt_pk_bf16_f32 v226, v228, v229
    v_cvt_pk_bf16_f32 v227, v230, v231
    v_mfma_f32_16x16x32_bf16 v[212:215], v[68:71], v[60:63], 0
    ds_read_b64_tr_b16 v[58:59], v21 offset:38912
    s_waitcnt lgkmcnt(6)
    v_mfma_f32_16x16x32_bf16 v[200:203], v[64:67], v[44:47], 0
    ds_read_b64_tr_b16 v[60:61], v20 offset:37376
    v_mul_f32 v240, 0.12751743082459868, v240
    v_mul_f32 v241, 0.12751743082459868, v241
    v_mul_f32 v242, 0.12751743082459868, v242
    v_mul_f32 v243, 0.12751743082459868, v243
    v_mfma_f32_16x16x32_bf16 v[216:219], v[68:71], v[44:47], 0
    ds_read_b64_tr_b16 v[62:63], v20 offset:39424
    s_waitcnt lgkmcnt(6)
    v_mfma_f32_16x16x32_bf16 v[204:207], v[64:67], v[48:51], 0
    ds_read_b64_tr_b16 v[44:45], v21 offset:37376
    v_mul_f32 v244, 0.12751743082459868, v244
    v_mul_f32 v245, 0.12751743082459868, v245
    v_mul_f32 v246, 0.12751743082459868, v246
    v_mul_f32 v247, 0.12751743082459868, v247
    v_mfma_f32_16x16x32_bf16 v[220:223], v[68:71], v[48:51], 0
    ds_read_b64_tr_b16 v[46:47], v21 offset:39424
    s_waitcnt lgkmcnt(6)
    v_mfma_f32_16x16x32_bf16 v[192:195], v[72:75], v[52:55], v[192:195]
    ds_read_b64_tr_b16 v[48:49], v20 offset:40960
    v_cvt_pk_bf16_f32 v240, v240, v241
    v_cvt_pk_bf16_f32 v241, v242, v243
    v_cvt_pk_bf16_f32 v242, v244, v245
    v_cvt_pk_bf16_f32 v243, v246, v247
    v_mfma_f32_16x16x32_bf16 v[208:211], v[76:79], v[52:55], v[208:211]
    ds_read_b64_tr_b16 v[50:51], v20 offset:43008
    s_waitcnt lgkmcnt(6)
    v_mfma_f32_16x16x32_bf16 v[196:199], v[72:75], v[56:59], v[196:199]
    ds_read_b64_tr_b16 v[52:53], v21 offset:40960
    v_mul_f32 v232, 0.12751743082459868, v232
    v_mul_f32 v233, 0.12751743082459868, v233
    v_mul_f32 v234, 0.12751743082459868, v234
    v_mul_f32 v235, 0.12751743082459868, v235
    v_mfma_f32_16x16x32_bf16 v[212:215], v[76:79], v[56:59], v[212:215]
    ds_read_b64_tr_b16 v[54:55], v21 offset:43008
    s_waitcnt lgkmcnt(6)
    v_mfma_f32_16x16x32_bf16 v[200:203], v[72:75], v[60:63], v[200:203]
    ds_read_b64_tr_b16 v[56:57], v20 offset:41472
    v_mul_f32 v236, 0.12751743082459868, v236
    v_mul_f32 v237, 0.12751743082459868, v237
    v_mul_f32 v238, 0.12751743082459868, v238
    v_mul_f32 v239, 0.12751743082459868, v239
    v_mfma_f32_16x16x32_bf16 v[216:219], v[76:79], v[60:63], v[216:219]
    ds_read_b64_tr_b16 v[58:59], v20 offset:43520
    s_waitcnt lgkmcnt(6)
    v_mfma_f32_16x16x32_bf16 v[204:207], v[72:75], v[44:47], v[204:207]
    ds_read_b64_tr_b16 v[60:61], v21 offset:41472
    v_cvt_pk_bf16_f32 v232, v232, v233
    v_cvt_pk_bf16_f32 v233, v234, v235
    v_cvt_pk_bf16_f32 v234, v236, v237
    v_cvt_pk_bf16_f32 v235, v238, v239
    v_mfma_f32_16x16x32_bf16 v[220:223], v[76:79], v[44:47], v[220:223]
    ds_read_b64_tr_b16 v[62:63], v21 offset:43520
    s_waitcnt lgkmcnt(6)
    v_mfma_f32_16x16x32_bf16 v[192:195], v[80:83], v[48:51], v[192:195]
    ds_read_b64_tr_b16 v[44:45], v20 offset:45056
    v_mul_f32 v248, 0.12751743082459868, v248
    v_mul_f32 v249, 0.12751743082459868, v249
    v_mul_f32 v250, 0.12751743082459868, v250
    v_mul_f32 v251, 0.12751743082459868, v251
    v_mfma_f32_16x16x32_bf16 v[208:211], v[84:87], v[48:51], v[208:211]
    ds_read_b64_tr_b16 v[46:47], v20 offset:47104
    s_waitcnt lgkmcnt(6)
    v_mfma_f32_16x16x32_bf16 v[196:199], v[80:83], v[52:55], v[196:199]
    ds_read_b64_tr_b16 v[48:49], v21 offset:45056
    v_mul_f32 v252, 0.12751743082459868, v252
    v_mul_f32 v253, 0.12751743082459868, v253
    v_mul_f32 v254, 0.12751743082459868, v254
    v_mul_f32 v255, 0.12751743082459868, v255
    v_mfma_f32_16x16x32_bf16 v[212:215], v[84:87], v[52:55], v[212:215]
    ds_read_b64_tr_b16 v[50:51], v21 offset:47104
    s_add_u32 s45, s75, 2048
    buffer_store_dwordx4 v[224:227], v1, s[12:15], s45 offen sc1
    s_waitcnt lgkmcnt(6)
    v_mfma_f32_16x16x32_bf16 v[200:203], v[80:83], v[56:59], v[200:203]
    ds_read_b64_tr_b16 v[52:53], v20 offset:45568
    v_cvt_pk_bf16_f32 v248, v248, v249
    v_cvt_pk_bf16_f32 v249, v250, v251
    v_cvt_pk_bf16_f32 v250, v252, v253
    v_cvt_pk_bf16_f32 v251, v254, v255
    v_mfma_f32_16x16x32_bf16 v[216:219], v[84:87], v[56:59], v[216:219]
    ds_read_b64_tr_b16 v[54:55], v20 offset:47616
    s_waitcnt lgkmcnt(6)
    v_mfma_f32_16x16x32_bf16 v[204:207], v[80:83], v[60:63], v[204:207]
    ds_read_b64_tr_b16 v[56:57], v21 offset:45568
    v_mfma_f32_16x16x32_bf16 v[220:223], v[84:87], v[60:63], v[220:223]
    ds_read_b64_tr_b16 v[58:59], v21 offset:47616
    s_waitcnt vmcnt(9)
    s_barrier
    s_cmp_eq_u32 s22, 0
    s_cbranch_scc0 L_fl_1
    s_add_u32 s45, s3, 1
    s_mov_b64 exec, 1
    v_mov_b32 v19, s45
    buffer_store_dword v19, off, s[12:15], s74 sc1
    s_mov_b64 exec, -1
L_fl_1:
    s_waitcnt lgkmcnt(6)
    v_mfma_f32_16x16x32_bf16 v[192:195], v[88:91], v[44:47], v[192:195]
    ds_read_b64_tr_b16 v[60:61], v22 offset:0
    v_mfma_f32_16x16x32_bf16 v[208:211], v[92:95], v[44:47], v[208:211]
    ds_read_b64_tr_b16 v[62:63], v22 offset:2048
    s_waitcnt lgkmcnt(6)
    v_mfma_f32_16x16x32_bf16 v[196:199], v[88:91], v[48:51], v[196:199]
    ds_read_b64_tr_b16 v[44:45], v23 offset:0
    v_mfma_f32_16x16x32_bf16 v[212:215], v[92:95], v[48:51], v[212:215]
    ds_read_b64_tr_b16 v[46:47], v23 offset:2048
    s_waitcnt lgkmcnt(6)
    v_mfma_f32_16x16x32_bf16 v[200:203], v[88:91], v[52:55], v[200:203]
    ds_read_b64_tr_b16 v[48:49], v22 offset:512
    v_mfma_f32_16x16x32_bf16 v[216:219], v[92:95], v[52:55], v[216:219]
    ds_read_b64_tr_b16 v[50:51], v22 offset:2560
    s_waitcnt lgkmcnt(6)
    v_mfma_f32_16x16x32_bf16 v[204:207], v[88:91], v[56:59], v[204:207]
    ds_read_b64_tr_b16 v[52:53], v23 offset:512
    v_mfma_f32_16x16x32_bf16 v[220:223], v[92:95], v[56:59], v[220:223]
    ds_read_b64_tr_b16 v[54:55], v23 offset:2560
    s_waitcnt lgkmcnt(6)
    v_mfma_f32_16x16x32_bf16 v[192:195], v[96:99], v[60:63], v[192:195]
    ds_read_b64_tr_b16 v[56:57], v22 offset:4096
    v_mfma_f32_16x16x32_bf16 v[208:211], v[100:103], v[60:63], v[208:211]
    ds_read_b64_tr_b16 v[58:59], v22 offset:6144
    s_waitcnt lgkmcnt(6)
    v_mfma_f32_16x16x32_bf16 v[196:199], v[96:99], v[44:47], v[196:199]
    ds_read_b64_tr_b16 v[60:61], v23 offset:4096
    v_mfma_f32_16x16x32_bf16 v[212:215], v[100:103], v[44:47], v[212:215]
    ds_read_b64_tr_b16 v[62:63], v23 offset:6144
    s_waitcnt lgkmcnt(6)
    v_mfma_f32_16x16x32_bf16 v[200:203], v[96:99], v[48:51], v[200:203]
    ds_read_b64_tr_b16 v[44:45], v22 offset:4608
    v_mfma_f32_16x16x32_bf16 v[216:219], v[100:103], v[48:51], v[216:219]
    ds_read_b64_tr_b16 v[46:47], v22 offset:6656
    s_waitcnt lgkmcnt(6)
    v_mfma_f32_16x16x32_bf16 v[204:207], v[96:99], v[52:55], v[204:207]
    ds_read_b64_tr_b16 v[48:49], v23 offset:4608
    v_mfma_f32_16x16x32_bf16 v[220:223], v[100:103], v[52:55], v[220:223]
    ds_read_b64_tr_b16 v[50:51], v23 offset:6656
    s_waitcnt lgkmcnt(6)
    v_mfma_f32_16x16x32_bf16 v[192:195], v[104:107], v[56:59], v[192:195]
    ds_read_b64_tr_b16 v[52:53], v22 offset:8192
    v_mfma_f32_16x16x32_bf16 v[208:211], v[108:111], v[56:59], v[208:211]
    ds_read_b64_tr_b16 v[54:55], v22 offset:10240
    s_waitcnt lgkmcnt(6)
    v_mfma_f32_16x16x32_bf16 v[196:199], v[104:107], v[60:63], v[196:199]
    ds_read_b64_tr_b16 v[56:57], v23 offset:8192
    v_mfma_f32_16x16x32_bf16 v[212:215], v[108:111], v[60:63], v[212:215]
    ds_read_b64_tr_b16 v[58:59], v23 offset:10240
    s_waitcnt lgkmcnt(6)
    v_mfma_f32_16x16x32_bf16 v[200:203], v[104:107], v[44:47], v[200:203]
    ds_read_b64_tr_b16 v[60:61], v22 offset:8704
    v_mfma_f32_16x16x32_bf16 v[216:219], v[108:111], v[44:47], v[216:219]
    ds_read_b64_tr_b16 v[62:63], v22 offset:10752
    s_add_u32 s45, s75, 6144
    buffer_store_dwordx4 v[240:243], v1, s[12:15], s45 offen sc1
    s_waitcnt lgkmcnt(6)
    v_mfma_f32_16x16x32_bf16 v[204:207], v[104:107], v[48:51], v[204:207]
    ds_read_b64_tr_b16 v[44:45], v23 offset:8704
    v_mfma_f32_16x16x32_bf16 v[220:223], v[108:111], v[48:51], v[220:223]
    ds_read_b64_tr_b16 v[46:47], v23 offset:10752
    s_waitcnt lgkmcnt(6)
    v_mfma_f32_16x16x32_bf16 v[192:195], v[112:115], v[52:55], v[192:195]
    ds_read_b64_tr_b16 v[48:49], v22 offset:12288
    v_mfma_f32_16x16x32_bf16 v[208:211], v[116:119], v[52:55], v[208:211]
    ds_read_b64_tr_b16 v[50:51], v22 offset:14336
    s_waitcnt lgkmcnt(6)
    v_mfma_f32_16x16x32_bf16 v[196:199], v[112:115], v[56:59], v[196:199]
    ds_read_b64_tr_b16 v[52:53], v23 offset:12288
    v_mfma_f32_16x16x32_bf16 v[212:215], v[116:119], v[56:59], v[212:215]
    ds_read_b64_tr_b16 v[54:55], v23 offset:14336
    s_waitcnt lgkmcnt(6)
    v_mfma_f32_16x16x32_bf16 v[200:203], v[112:115], v[60:63], v[200:203]
    ds_read_b64_tr_b16 v[56:57], v22 offset:12800
    v_mfma_f32_16x16x32_bf16 v[216:219], v[116:119], v[60:63], v[216:219]
    ds_read_b64_tr_b16 v[58:59], v22 offset:14848
    s_waitcnt lgkmcnt(6)
    v_mfma_f32_16x16x32_bf16 v[204:207], v[112:115], v[44:47], v[204:207]
    ds_read_b64_tr_b16 v[60:61], v23 offset:12800
    v_mfma_f32_16x16x32_bf16 v[220:223], v[116:119], v[44:47], v[220:223]
    ds_read_b64_tr_b16 v[62:63], v23 offset:14848
    s_barrier
    s_waitcnt lgkmcnt(6)
    v_mfma_f32_16x16x32_bf16 v[192:195], v[120:123], v[48:51], v[192:195]
    ds_read_b64_tr_b16 v[44:45], v22 offset:16384
    v_mfma_f32_16x16x32_bf16 v[208:211], v[124:127], v[48:51], v[208:211]
    ds_read_b64_tr_b16 v[46:47], v22 offset:18432
    s_waitcnt lgkmcnt(6)
    v_mfma_f32_16x16x32_bf16 v[196:199], v[120:123], v[52:55], v[196:199]
    ds_read_b64_tr_b16 v[48:49], v23 offset:16384
    v_mfma_f32_16x16x32_bf16 v[212:215], v[124:127], v[52:55], v[212:215]
    ds_read_b64_tr_b16 v[50:51], v23 offset:18432
    s_waitcnt lgkmcnt(6)
    v_mfma_f32_16x16x32_bf16 v[200:203], v[120:123], v[56:59], v[200:203]
    ds_read_b64_tr_b16 v[52:53], v22 offset:16896
    v_mfma_f32_16x16x32_bf16 v[216:219], v[124:127], v[56:59], v[216:219]
    ds_read_b64_tr_b16 v[54:55], v22 offset:18944
    s_waitcnt lgkmcnt(6)
    v_mfma_f32_16x16x32_bf16 v[204:207], v[120:123], v[60:63], v[204:207]
    ds_read_b64_tr_b16 v[56:57], v23 offset:16896
    v_mfma_f32_16x16x32_bf16 v[220:223], v[124:127], v[60:63], v[220:223]
    ds_read_b64_tr_b16 v[58:59], v23 offset:18944
    s_waitcnt lgkmcnt(6)
    v_mfma_f32_16x16x32_bf16 v[192:195], v[128:131], v[44:47], v[192:195]
    ds_read_b64_tr_b16 v[60:61], v22 offset:20480
    v_mfma_f32_16x16x32_bf16 v[208:211], v[132:135], v[44:47], v[208:211]
    ds_read_b64_tr_b16 v[62:63], v22 offset:22528
    s_add_u32 m0, s59, 0
    s_add_u32 s38, s58, 0
    buffer_load_dwordx4 v10, s[60:63], s38 offen lds
    s_waitcnt lgkmcnt(6)
    v_mfma_f32_16x16x32_bf16 v[196:199], v[128:131], v[48:51], v[196:199]
    ds_read_b64_tr_b16 v[44:45], v23 offset:20480
    v_mfma_f32_16x16x32_bf16 v[212:215], v[132:135], v[48:51], v[212:215]
    ds_read_b64_tr_b16 v[46:47], v23 offset:22528
    s_waitcnt lgkmcnt(6)
    v_mfma_f32_16x16x32_bf16 v[200:203], v[128:131], v[52:55], v[200:203]
    ds_read_b64_tr_b16 v[48:49], v22 offset:20992
    v_mfma_f32_16x16x32_bf16 v[216:219], v[132:135], v[52:55], v[216:219]
    ds_read_b64_tr_b16 v[50:51], v22 offset:23040
    buffer_load_dwordx4 v11, s[60:63], s38 offen offset:1024 lds
    s_waitcnt lgkmcnt(6)
    v_mfma_f32_16x16x32_bf16 v[204:207], v[128:131], v[56:59], v[204:207]
    ds_read_b64_tr_b16 v[52:53], v23 offset:20992
    v_mfma_f32_16x16x32_bf16 v[220:223], v[132:135], v[56:59], v[220:223]
    ds_read_b64_tr_b16 v[54:55], v23 offset:23040
    s_add_u32 s45, s75, 3072
    buffer_store_dwordx4 v[232:235], v1, s[12:15], s45 offen sc1
    s_waitcnt lgkmcnt(6)
    v_mfma_f32_16x16x32_bf16 v[192:195], v[136:139], v[60:63], v[192:195]
    ds_read_b64_tr_b16 v[56:57], v22 offset:24576
    v_mfma_f32_16x16x32_bf16 v[208:211], v[140:143], v[60:63], v[208:211]
    ds_read_b64_tr_b16 v[58:59], v22 offset:26624
    s_add_u32 m0, s69, 8192
    s_add_u32 s38, s68, 0
    buffer_load_dwordx4 v12, s[64:67], s38 offen lds
    s_waitcnt lgkmcnt(6)
    v_mfma_f32_16x16x32_bf16 v[196:199], v[136:139], v[44:47], v[196:199]
    ds_read_b64_tr_b16 v[60:61], v23 offset:24576
    v_mfma_f32_16x16x32_bf16 v[212:215], v[140:143], v[44:47], v[212:215]
    ds_read_b64_tr_b16 v[62:63], v23 offset:26624
    s_waitcnt lgkmcnt(6)
    v_mfma_f32_16x16x32_bf16 v[200:203], v[136:139], v[48:51], v[200:203]
    ds_read_b64_tr_b16 v[44:45], v22 offset:25088
    v_mfma_f32_16x16x32_bf16 v[216:219], v[140:143], v[48:51], v[216:219]
    ds_read_b64_tr_b16 v[46:47], v22 offset:27136
    s_add_u32 m0, s59, 24576
    s_add_u32 s38, s58, 524288
    buffer_load_dwordx4 v10, s[60:63], s38 offen lds
    s_waitcnt lgkmcnt(6)
    v_mfma_f32_16x16x32_bf16 v[204:207], v[136:139], v[52:55], v[204:207]
    ds_read_b64_tr_b16 v[48:49], v23 offset:25088
    v_mfma_f32_16x16x32_bf16 v[220:223], v[140:143], v[52:55], v[220:223]
    ds_read_b64_tr_b16 v[50:51], v23 offset:27136
    s_waitcnt lgkmcnt(6)
    v_mfma_f32_16x16x32_bf16 v[192:195], v[144:147], v[56:59], v[192:195]
    ds_read_b64_tr_b16 v[52:53], v22 offset:28672
    v_mfma_f32_16x16x32_bf16 v[208:211], v[148:151], v[56:59], v[208:211]
    ds_read_b64_tr_b16 v[54:55], v22 offset:30720
    buffer_load_dwordx4 v11, s[60:63], s38 offen offset:1024 lds
    s_waitcnt lgkmcnt(6)
    v_mfma_f32_16x16x32_bf16 v[196:199], v[144:147], v[60:63], v[196:199]
    ds_read_b64_tr_b16 v[56:57], v23 offset:28672
    v_mfma_f32_16x16x32_bf16 v[212:215], v[148:151], v[60:63], v[212:215]
    ds_read_b64_tr_b16 v[58:59], v23 offset:30720
    s_waitcnt lgkmcnt(6)
    v_mfma_f32_16x16x32_bf16 v[200:203], v[144:147], v[44:47], v[200:203]
    ds_read_b64_tr_b16 v[60:61], v22 offset:29184
    v_mfma_f32_16x16x32_bf16 v[216:219], v[148:151], v[44:47], v[216:219]
    ds_read_b64_tr_b16 v[62:63], v22 offset:31232
    s_add_u32 m0, s69, 32768
    s_add_u32 s38, s68, 221184
    buffer_load_dwordx4 v12, s[64:67], s38 offen lds
    s_waitcnt lgkmcnt(6)
    v_mfma_f32_16x16x32_bf16 v[204:207], v[144:147], v[48:51], v[204:207]
    ds_read_b64_tr_b16 v[44:45], v23 offset:29184
    v_mfma_f32_16x16x32_bf16 v[220:223], v[148:151], v[48:51], v[220:223]
    ds_read_b64_tr_b16 v[46:47], v23 offset:31232
    s_waitcnt vmcnt(14)
    s_barrier
    s_waitcnt lgkmcnt(6)
    v_mfma_f32_16x16x32_bf16 v[192:195], v[152:155], v[52:55], v[192:195]
    ds_read_b64_tr_b16 v[48:49], v22 offset:32768
    v_mfma_f32_16x16x32_bf16 v[208:211], v[156:159], v[52:55], v[208:211]
    ds_read_b64_tr_b16 v[50:51], v22 offset:34816
    s_add_u32 s38, s26, 8
    s_and_b32 s38, s38, 15
    s_lshl_b32 s38, s38, 18
    s_add_u32 s38, s38, s28
    s_add_u32 m0, s30, 131072
    s_add_u32 s38, s38, 128
    buffer_load_dwordx4 v10, s[16:19], s38 offen lds
    s_waitcnt lgkmcnt(6)
    v_mfma_f32_16x16x32_bf16 v[196:199], v[152:155], v[56:59], v[196:199]
    ds_read_b64_tr_b16 v[52:53], v23 offset:32768
    v_mfma_f32_16x16x32_bf16 v[212:215], v[156:159], v[56:59], v[212:215]
    ds_read_b64_tr_b16 v[54:55], v23 offset:34816
    s_waitcnt lgkmcnt(6)
    v_mfma_f32_16x16x32_bf16 v[200:203], v[152:155], v[60:63], v[200:203]
    ds_read_b64_tr_b16 v[56:57], v22 offset:33280
    v_mfma_f32_16x16x32_bf16 v[216:219], v[156:159], v[60:63], v[216:219]
    ds_read_b64_tr_b16 v[58:59], v22 offset:35328
    buffer_load_dwordx4 v11, s[16:19], s38 offen offset:1024 lds
    s_waitcnt lgkmcnt(6)
    v_mfma_f32_16x16x32_bf16 v[204:207], v[152:155], v[44:47], v[204:207]
    ds_read_b64_tr_b16 v[60:61], v23 offset:33280
    v_mfma_f32_16x16x32_bf16 v[220:223], v[156:159], v[44:47], v[220:223]
    ds_read_b64_tr_b16 v[62:63], v23 offset:35328
    s_waitcnt lgkmcnt(6)
    v_mfma_f32_16x16x32_bf16 v[192:195], v[160:163], v[48:51], v[192:195]
    ds_read_b64_tr_b16 v[44:45], v22 offset:36864
    v_mfma_f32_16x16x32_bf16 v[208:211], v[164:167], v[48:51], v[208:211]
    ds_read_b64_tr_b16 v[46:47], v22 offset:38912
    s_add_u32 s38, s26, 12
    s_and_b32 s38, s38, 15
    s_lshl_b32 s38, s38, 18
    s_add_u32 s38, s38, s28
    s_add_u32 m0, s30, 147456
    s_add_u32 s38, s38, 128
    buffer_load_dwordx4 v10, s[16:19], s38 offen lds
    s_add_u32 s45, s75, 7168
    buffer_store_dwordx4 v[248:251], v1, s[12:15], s45 offen sc1
    s_waitcnt lgkmcnt(6)
    v_mfma_f32_16x16x32_bf16 v[196:199], v[160:163], v[52:55], v[196:199]
    ds_read_b64_tr_b16 v[48:49], v23 offset:36864
    v_mfma_f32_16x16x32_bf16 v[212:215], v[164:167], v[52:55], v[212:215]
    ds_read_b64_tr_b16 v[50:51], v23 offset:38912
    s_waitcnt lgkmcnt(6)
    v_mfma_f32_16x16x32_bf16 v[200:203], v[160:163], v[56:59], v[200:203]
    ds_read_b64_tr_b16 v[52:53], v22 offset:37376
    v_mfma_f32_16x16x32_bf16 v[216:219], v[164:167], v[56:59], v[216:219]
    ds_read_b64_tr_b16 v[54:55], v22 offset:39424
    buffer_load_dwordx4 v11, s[16:19], s38 offen offset:1024 lds
    s_waitcnt lgkmcnt(6)
    v_mfma_f32_16x16x32_bf16 v[204:207], v[160:163], v[60:63], v[204:207]
    ds_read_b64_tr_b16 v[56:57], v23 offset:37376
    v_mfma_f32_16x16x32_bf16 v[220:223], v[164:167], v[60:63], v[220:223]
    ds_read_b64_tr_b16 v[58:59], v23 offset:39424
    s_waitcnt lgkmcnt(6)
    v_mfma_f32_16x16x32_bf16 v[192:195], v[168:171], v[44:47], v[192:195]
    ds_read_b64_tr_b16 v[60:61], v22 offset:40960
    v_mfma_f32_16x16x32_bf16 v[208:211], v[172:175], v[44:47], v[208:211]
    ds_read_b64_tr_b16 v[62:63], v22 offset:43008
    s_waitcnt lgkmcnt(6)
    v_mfma_f32_16x16x32_bf16 v[196:199], v[168:171], v[48:51], v[196:199]
    ds_read_b64_tr_b16 v[44:45], v23 offset:40960
    v_mfma_f32_16x16x32_bf16 v[212:215], v[172:175], v[48:51], v[212:215]
    ds_read_b64_tr_b16 v[46:47], v23 offset:43008
    s_waitcnt lgkmcnt(6)
    v_mfma_f32_16x16x32_bf16 v[200:203], v[168:171], v[52:55], v[200:203]
    ds_read_b64_tr_b16 v[48:49], v22 offset:41472
    v_mfma_f32_16x16x32_bf16 v[216:219], v[172:175], v[52:55], v[216:219]
    ds_read_b64_tr_b16 v[50:51], v22 offset:43520
    s_waitcnt lgkmcnt(6)
    v_mfma_f32_16x16x32_bf16 v[204:207], v[168:171], v[56:59], v[204:207]
    ds_read_b64_tr_b16 v[52:53], v23 offset:41472
    v_mfma_f32_16x16x32_bf16 v[220:223], v[172:175], v[56:59], v[220:223]
    ds_read_b64_tr_b16 v[54:55], v23 offset:43520
    s_waitcnt lgkmcnt(6)
    v_mfma_f32_16x16x32_bf16 v[192:195], v[176:179], v[60:63], v[192:195]
    ds_read_b64_tr_b16 v[56:57], v22 offset:45056
    v_mfma_f32_16x16x32_bf16 v[208:211], v[180:183], v[60:63], v[208:211]
    ds_read_b64_tr_b16 v[58:59], v22 offset:47104
    s_waitcnt lgkmcnt(6)
    v_mfma_f32_16x16x32_bf16 v[196:199], v[176:179], v[44:47], v[196:199]
    ds_read_b64_tr_b16 v[60:61], v23 offset:45056
    v_mfma_f32_16x16x32_bf16 v[212:215], v[180:183], v[44:47], v[212:215]
    ds_read_b64_tr_b16 v[62:63], v23 offset:47104
    s_waitcnt lgkmcnt(6)
    v_mfma_f32_16x16x32_bf16 v[200:203], v[176:179], v[48:51], v[200:203]
    ds_read_b64_tr_b16 v[44:45], v22 offset:45568
    v_mfma_f32_16x16x32_bf16 v[216:219], v[180:183], v[48:51], v[216:219]
    ds_read_b64_tr_b16 v[46:47], v22 offset:47616
    s_waitcnt lgkmcnt(6)
    v_mfma_f32_16x16x32_bf16 v[204:207], v[176:179], v[52:55], v[204:207]
    ds_read_b64_tr_b16 v[48:49], v23 offset:45568
    v_mfma_f32_16x16x32_bf16 v[220:223], v[180:183], v[52:55], v[220:223]
    ds_read_b64_tr_b16 v[50:51], v23 offset:47616
    s_waitcnt vmcnt(17)
    s_barrier
    s_waitcnt lgkmcnt(6)
    v_mfma_f32_16x16x32_bf16 v[192:195], v[184:187], v[56:59], v[192:195]
    ds_read_b64_tr_b16 v[52:53], v24 offset:0
    v_mfma_f32_16x16x32_bf16 v[208:211], v[188:191], v[56:59], v[208:211]
    ds_read_b64_tr_b16 v[54:55], v24 offset:2048
    buffer_load_dword v3, v2, s[12:15], 0 offen sc1
    s_waitcnt lgkmcnt(6)
    v_mfma_f32_16x16x32_bf16 v[196:199], v[184:187], v[60:63], v[196:199]
    ds_read_b64_tr_b16 v[56:57], v25 offset:0
    v_mfma_f32_16x16x32_bf16 v[212:215], v[188:191], v[60:63], v[212:215]
    ds_read_b64_tr_b16 v[58:59], v25 offset:2048
    s_add_u32 s45, s75, 1024
    buffer_store_dwordx4 v[36:39], v1, s[12:15], s45 offen sc1
    s_waitcnt lgkmcnt(6)
    v_mfma_f32_16x16x32_bf16 v[200:203], v[184:187], v[44:47], v[200:203]
    ds_read_b64_tr_b16 v[60:61], v24 offset:512
    v_cvt_pk_bf16_f32 v211, v210, v211
    v_cvt_pk_bf16_f32 v210, v208, v209
    v_cvt_pk_bf16_f32 v208, v192, v193
    v_cvt_pk_bf16_f32 v209, v194, v195
    v_mfma_f32_16x16x32_bf16 v[216:219], v[188:191], v[44:47], v[216:219]
    ds_read_b64_tr_b16 v[62:63], v24 offset:2560
    s_add_u32 m0, s59, 49152
    s_add_u32 s38, s58, 1048576
    buffer_load_dwordx4 v10, s[60:63], s38 offen lds
    s_waitcnt lgkmcnt(6)
    v_mfma_f32_16x16x32_bf16 v[204:207], v[184:187], v[48:51], v[204:207]
    ds_read_b64_tr_b16 v[44:45], v25 offset:512
    v_cvt_pk_bf16_f32 v215, v214, v215
    v_cvt_pk_bf16_f32 v214, v212, v213
    v_cvt_pk_bf16_f32 v212, v196, v197
    v_cvt_pk_bf16_f32 v213, v198, v199
    v_mfma_f32_16x16x32_bf16 v[220:223], v[188:191], v[48:51], v[220:223]
    ds_read_b64_tr_b16 v[46:47], v25 offset:2560
    s_waitcnt lgkmcnt(6)
    v_mfma_f32_16x16x32_bf16 v[224:227], v[64:67], v[52:55], 0
    ds_read_b64_tr_b16 v[48:49], v24 offset:4096
    v_cvt_pk_bf16_f32 v219, v218, v219
    v_cvt_pk_bf16_f32 v218, v216, v217
    v_cvt_pk_bf16_f32 v216, v200, v201
    v_cvt_pk_bf16_f32 v217, v202, v203
    v_mfma_f32_16x16x32_bf16 v[240:243], v[68:71], v[52:55], 0
    ds_read_b64_tr_b16 v[50:51], v24 offset:6144
    buffer_load_dwordx4 v11, s[60:63], s38 offen offset:1024 lds
    s_waitcnt lgkmcnt(6)
    v_mfma_f32_16x16x32_bf16 v[228:231], v[64:67], v[56:59], 0
    ds_read_b64_tr_b16 v[52:53], v25 offset:4096
    v_cvt_pk_bf16_f32 v223, v222, v223
    v_cvt_pk_bf16_f32 v222, v220, v221
    v_cvt_pk_bf16_f32 v220, v204, v205
    v_cvt_pk_bf16_f32 v221, v206, v207
    v_mfma_f32_16x16x32_bf16 v[244:247], v[68:71], v[56:59], 0
    ds_read_b64_tr_b16 v[54:55], v25 offset:6144
    s_waitcnt lgkmcnt(6)
    v_mfma_f32_16x16x32_bf16 v[232:235], v[64:67], v[60:63], 0
    ds_read_b64_tr_b16 v[56:57], v24 offset:4608
    v_mfma_f32_16x16x32_bf16 v[248:251], v[68:71], v[60:63], 0
    ds_read_b64_tr_b16 v[58:59], v24 offset:6656
    s_add_u32 m0, s69, 57344
    s_add_u32 s38, s68, 442368
    buffer_load_dwordx4 v12, s[64:67], s38 offen lds
    s_waitcnt lgkmcnt(6)
    v_mfma_f32_16x16x32_bf16 v[236:239], v[64:67], v[44:47], 0
    ds_read_b64_tr_b16 v[60:61], v25 offset:4608
    v_mfma_f32_16x16x32_bf16 v[252:255], v[68:71], v[44:47], 0
    ds_read_b64_tr_b16 v[62:63], v25 offset:6656
    s_waitcnt lgkmcnt(6)
    v_mfma_f32_16x16x32_bf16 v[224:227], v[72:75], v[48:51], v[224:227]
    ds_read_b64_tr_b16 v[44:45], v24 offset:8192
    v_mfma_f32_16x16x32_bf16 v[240:243], v[76:79], v[48:51], v[240:243]
    ds_read_b64_tr_b16 v[46:47], v24 offset:10240
    s_waitcnt lgkmcnt(6)
    v_mfma_f32_16x16x32_bf16 v[228:231], v[72:75], v[52:55], v[228:231]
    ds_read_b64_tr_b16 v[48:49], v25 offset:8192
    v_mfma_f32_16x16x32_bf16 v[244:247], v[76:79], v[52:55], v[244:247]
    ds_read_b64_tr_b16 v[50:51], v25 offset:10240
    s_waitcnt lgkmcnt(6)
    v_mfma_f32_16x16x32_bf16 v[232:235], v[72:75], v[56:59], v[232:235]
    ds_read_b64_tr_b16 v[52:53], v24 offset:8704
    v_mfma_f32_16x16x32_bf16 v[248:251], v[76:79], v[56:59], v[248:251]
    ds_read_b64_tr_b16 v[54:55], v24 offset:10752
    s_waitcnt lgkmcnt(6)
    v_mfma_f32_16x16x32_bf16 v[236:239], v[72:75], v[60:63], v[236:239]
    ds_read_b64_tr_b16 v[56:57], v25 offset:8704
    v_mfma_f32_16x16x32_bf16 v[252:255], v[76:79], v[60:63], v[252:255]
    ds_read_b64_tr_b16 v[58:59], v25 offset:10752
    s_waitcnt lgkmcnt(6)
    v_mfma_f32_16x16x32_bf16 v[224:227], v[80:83], v[44:47], v[224:227]
    ds_read_b64_tr_b16 v[60:61], v24 offset:12288
    v_mfma_f32_16x16x32_bf16 v[240:243], v[84:87], v[44:47], v[240:243]
    ds_read_b64_tr_b16 v[62:63], v24 offset:14336
    s_waitcnt lgkmcnt(6)
    v_mfma_f32_16x16x32_bf16 v[228:231], v[80:83], v[48:51], v[228:231]
    ds_read_b64_tr_b16 v[44:45], v25 offset:12288
    v_mfma_f32_16x16x32_bf16 v[244:247], v[84:87], v[48:51], v[244:247]
    ds_read_b64_tr_b16 v[46:47], v25 offset:14336
    s_waitcnt lgkmcnt(6)
    v_mfma_f32_16x16x32_bf16 v[232:235], v[80:83], v[52:55], v[232:235]
    ds_read_b64_tr_b16 v[48:49], v24 offset:12800
    v_mfma_f32_16x16x32_bf16 v[248:251], v[84:87], v[52:55], v[248:251]
    ds_read_b64_tr_b16 v[50:51], v24 offset:14848
    s_add_u32 s45, s75, 5120
    buffer_store_dwordx4 v[40:43], v1, s[12:15], s45 offen sc1
    s_waitcnt lgkmcnt(6)
    v_mfma_f32_16x16x32_bf16 v[236:239], v[80:83], v[56:59], v[236:239]
    ds_read_b64_tr_b16 v[52:53], v25 offset:12800
    v_mfma_f32_16x16x32_bf16 v[252:255], v[84:87], v[56:59], v[252:255]
    ds_read_b64_tr_b16 v[54:55], v25 offset:14848
    s_waitcnt vmcnt(21)
    s_barrier
    s_waitcnt lgkmcnt(6)
    v_mfma_f32_16x16x32_bf16 v[224:227], v[88:91], v[60:63], v[224:227]
    ds_read_b64_tr_b16 v[56:57], v24 offset:16384
    v_mfma_f32_16x16x32_bf16 v[240:243], v[92:95], v[60:63], v[240:243]
    ds_read_b64_tr_b16 v[58:59], v24 offset:18432
    s_add_u32 m0, s59, 73728
    s_add_u32 s38, s58, 1572864
    buffer_load_dwordx4 v10, s[60:63], s38 offen lds
    s_waitcnt lgkmcnt(6)
    v_mfma_f32_16x16x32_bf16 v[228:231], v[88:91], v[44:47], v[228:231]
    ds_read_b64_tr_b16 v[60:61], v25 offset:16384
    v_mfma_f32_16x16x32_bf16 v[244:247], v[92:95], v[44:47], v[244:247]
    ds_read_b64_tr_b16 v[62:63], v25 offset:18432
    buffer_load_dwordx4 v11, s[60:63], s38 offen offset:1024 lds
    s_waitcnt lgkmcnt(6)
    v_mfma_f32_16x16x32_bf16 v[232:235], v[88:91], v[48:51], v[232:235]
    ds_read_b64_tr_b16 v[44:45], v24 offset:16896
    v_mfma_f32_16x16x32_bf16 v[248:251], v[92:95], v[48:51], v[248:251]
    ds_read_b64_tr_b16 v[46:47], v24 offset:18944
    s_waitcnt vmcnt(7)
    v_cmp_eq_u32 s[46:47], v3, v13
    v_and_b32 v19, 7, v3
    v_cmp_gt_u32 vcc, 1, v19
    s_nop 1
    s_or_b64 vcc, vcc, s[46:47]
    s_cmp_lg_u32 vcc_lo, 0
    s_cbranch_scc1 L_spin_2
L_spinback_3:
    s_add_u32 m0, s69, 81920
    s_add_u32 s38, s68, 663552
    buffer_load_dwordx4 v12, s[64:67], s38 offen lds
    s_waitcnt lgkmcnt(6)
    v_mfma_f32_16x16x32_bf16 v[236:239], v[88:91], v[52:55], v[236:239]
    ds_read_b64_tr_b16 v[48:49], v25 offset:16896
    v_mfma_f32_16x16x32_bf16 v[252:255], v[92:95], v[52:55], v[252:255]
    ds_read_b64_tr_b16 v[50:51], v25 offset:18944
    s_waitcnt lgkmcnt(6)
    v_mfma_f32_16x16x32_bf16 v[224:227], v[96:99], v[56:59], v[224:227]
    ds_read_b64_tr_b16 v[52:53], v24 offset:20480
    v_mfma_f32_16x16x32_bf16 v[240:243], v[100:103], v[56:59], v[240:243]
    ds_read_b64_tr_b16 v[54:55], v24 offset:22528
    s_waitcnt lgkmcnt(6)
    v_mfma_f32_16x16x32_bf16 v[228:231], v[96:99], v[60:63], v[228:231]
    ds_read_b64_tr_b16 v[56:57], v25 offset:20480
    v_mfma_f32_16x16x32_bf16 v[244:247], v[100:103], v[60:63], v[244:247]
    ds_read_b64_tr_b16 v[58:59], v25 offset:22528
    buffer_load_dwordx4 v[64:67], v1, s[12:15], s33 offen offset:0 sc1
    s_waitcnt lgkmcnt(6)
    v_mfma_f32_16x16x32_bf16 v[232:235], v[96:99], v[44:47], v[232:235]
    ds_read_b64_tr_b16 v[60:61], v24 offset:20992
    v_mfma_f32_16x16x32_bf16 v[248:251], v[100:103], v[44:47], v[248:251]
    ds_read_b64_tr_b16 v[62:63], v24 offset:23040
    buffer_load_dwordx4 v[68:71], v1, s[12:15], s34 offen offset:0 sc1
    s_waitcnt lgkmcnt(6)
    v_mfma_f32_16x16x32_bf16 v[236:239], v[96:99], v[48:51], v[236:239]
    ds_read_b64_tr_b16 v[44:45], v25 offset:20992
    v_mfma_f32_16x16x32_bf16 v[252:255], v[100:103], v[48:51], v[252:255]
    ds_read_b64_tr_b16 v[46:47], v25 offset:23040
    buffer_load_dwordx4 v[72:75], v1, s[12:15], s33 offen offset:1024 sc1
    s_waitcnt lgkmcnt(6)
    v_mfma_f32_16x16x32_bf16 v[224:227], v[104:107], v[52:55], v[224:227]
    ds_read_b64_tr_b16 v[48:49], v24 offset:24576
    v_mfma_f32_16x16x32_bf16 v[240:243], v[108:111], v[52:55], v[240:243]
    ds_read_b64_tr_b16 v[50:51], v24 offset:26624
    buffer_load_dwordx4 v[76:79], v1, s[12:15], s34 offen offset:1024 sc1
    s_waitcnt lgkmcnt(6)
    v_mfma_f32_16x16x32_bf16 v[228:231], v[104:107], v[56:59], v[228:231]
    ds_read_b64_tr_b16 v[52:53], v25 offset:24576
    v_mfma_f32_16x16x32_bf16 v[244:247], v[108:111], v[56:59], v[244:247]
    ds_read_b64_tr_b16 v[54:55], v25 offset:26624
    s_waitcnt lgkmcnt(6)
    v_mfma_f32_16x16x32_bf16 v[232:235], v[104:107], v[60:63], v[232:235]
    ds_read_b64_tr_b16 v[56:57], v24 offset:25088
    v_mfma_f32_16x16x32_bf16 v[248:251], v[108:111], v[60:63], v[248:251]
    ds_read_b64_tr_b16 v[58:59], v24 offset:27136
    s_waitcnt lgkmcnt(6)
    v_mfma_f32_16x16x32_bf16 v[236:239], v[104:107], v[44:47], v[236:239]
    ds_read_b64_tr_b16 v[60:61], v25 offset:25088
    v_mfma_f32_16x16x32_bf16 v[252:255], v[108:111], v[44:47], v[252:255]
    ds_read_b64_tr_b16 v[62:63], v25 offset:27136
    s_add_u32 s45, s75, 16777216
    buffer_store_dwordx4 v[208:211], v1, s[12:15], s45 offen sc1
    s_waitcnt lgkmcnt(6)
    v_mfma_f32_16x16x32_bf16 v[224:227], v[112:115], v[48:51], v[224:227]
    ds_read_b64_tr_b16 v[44:45], v24 offset:28672
    v_mfma_f32_16x16x32_bf16 v[240:243], v[116:119], v[48:51], v[240:243]
    ds_read_b64_tr_b16 v[46:47], v24 offset:30720
    s_waitcnt lgkmcnt(6)
    v_mfma_f32_16x16x32_bf16 v[228:231], v[112:115], v[52:55], v[228:231]
    ds_read_b64_tr_b16 v[48:49], v25 offset:28672
    v_mfma_f32_16x16x32_bf16 v[244:247], v[116:119], v[52:55], v[244:247]
    ds_read_b64_tr_b16 v[50:51], v25 offset:30720
    s_waitcnt lgkmcnt(6)
    v_mfma_f32_16x16x32_bf16 v[232:235], v[112:115], v[56:59], v[232:235]
    ds_read_b64_tr_b16 v[52:53], v24 offset:29184
    v_mfma_f32_16x16x32_bf16 v[248:251], v[116:119], v[56:59], v[248:251]
    ds_read_b64_tr_b16 v[54:55], v24 offset:31232
    s_waitcnt lgkmcnt(6)
    v_mfma_f32_16x16x32_bf16 v[236:239], v[112:115], v[60:63], v[236:239]
    ds_read_b64_tr_b16 v[56:57], v25 offset:29184
    v_mfma_f32_16x16x32_bf16 v[252:255], v[116:119], v[60:63], v[252:255]
    ds_read_b64_tr_b16 v[58:59], v25 offset:31232
    s_barrier
    s_waitcnt lgkmcnt(6)
    v_mfma_f32_16x16x32_bf16 v[224:227], v[120:123], v[44:47], v[224:227]
    ds_read_b64_tr_b16 v[60:61], v24 offset:32768
    v_mfma_f32_16x16x32_bf16 v[240:243], v[124:127], v[44:47], v[240:243]
    ds_read_b64_tr_b16 v[62:63], v24 offset:34816
    buffer_load_dwordx4 v[80:83], v1, s[12:15], s33 offen offset:2048 sc1
    s_waitcnt lgkmcnt(6)
    v_mfma_f32_16x16x32_bf16 v[228:231], v[120:123], v[48:51], v[228:231]
    ds_read_b64_tr_b16 v[44:45], v24 offset:36864
    v_mfma_f32_16x16x32_bf16 v[244:247], v[124:127], v[48:51], v[244:247]
    ds_read_b64_tr_b16 v[46:47], v24 offset:38912
    buffer_load_dwordx4 v[84:87], v1, s[12:15], s34 offen offset:2048 sc1
    s_waitcnt lgkmcnt(6)
    v_mfma_f32_16x16x32_bf16 v[232:235], v[120:123], v[52:55], v[232:235]
    ds_read_b64_tr_b16 v[48:49], v24 offset:40960
    v_mfma_f32_16x16x32_bf16 v[248:251], v[124:127], v[52:55], v[248:251]
    ds_read_b64_tr_b16 v[50:51], v24 offset:43008
    s_waitcnt lgkmcnt(6)
    v_mfma_f32_16x16x32_bf16 v[236:239], v[120:123], v[56:59], v[236:239]
    ds_read_b64_tr_b16 v[52:53], v24 offset:45056
    v_mfma_f32_16x16x32_bf16 v[252:255], v[124:127], v[56:59], v[252:255]
    ds_read_b64_tr_b16 v[54:55], v24 offset:47104
    s_waitcnt lgkmcnt(6)
    v_mfma_f32_16x16x32_bf16 v[224:227], v[128:131], v[60:63], v[224:227]
    ds_read_b64_tr_b16 v[56:57], v24 offset:49152
    v_mfma_f32_16x16x32_bf16 v[240:243], v[132:135], v[60:63], v[240:243]
    ds_read_b64_tr_b16 v[58:59], v24 offset:51200
    s_waitcnt lgkmcnt(6)
    v_mfma_f32_16x16x32_bf16 v[224:227], v[136:139], v[44:47], v[224:227]
    ds_read_b64_tr_b16 v[60:61], v24 offset:53248
    v_mfma_f32_16x16x32_bf16 v[240:243], v[140:143], v[44:47], v[240:243]
    ds_read_b64_tr_b16 v[62:63], v24 offset:55296
    s_waitcnt lgkmcnt(6)
    v_mfma_f32_16x16x32_bf16 v[224:227], v[144:147], v[48:51], v[224:227]
    ds_read_b64_tr_b16 v[44:45], v24 offset:57344
    v_mfma_f32_16x16x32_bf16 v[240:243], v[148:151], v[48:51], v[240:243]
    ds_read_b64_tr_b16 v[46:47], v24 offset:59392
    s_mov_b32 s16, s100
    s_mov_b32 s17, s101
    s_and_b32 s17, s17, 0xffff
    s_mov_b32 s18, 128
    s_mov_b32 s19, 0x20000
    buffer_load_dwordx2 v[32:33], v26, s[16:19], 0 offen offset:0
    s_waitcnt lgkmcnt(6)
    v_mfma_f32_16x16x32_bf16 v[224:227], v[152:155], v[52:55], v[224:227]
    ds_read_b64_tr_b16 v[48:49], v24 offset:61440
    v_mfma_f32_16x16x32_bf16 v[240:243], v[156:159], v[52:55], v[240:243]
    ds_read_b64_tr_b16 v[50:51], v24 offset:63488
    buffer_load_dwordx2 v[34:35], v26, s[16:19], 0 offen offset:32
    s_waitcnt lgkmcnt(6)
    v_mfma_f32_16x16x32_bf16 v[224:227], v[160:163], v[56:59], v[224:227]
    ds_read_b64_tr_b16 v[52:53], v25 offset:32768
    v_mfma_f32_16x16x32_bf16 v[240:243], v[164:167], v[56:59], v[240:243]
    ds_read_b64_tr_b16 v[54:55], v25 offset:34816
    buffer_load_dwordx2 v[36:37], v26, s[16:19], 0 offen offset:64
    s_add_u32 s45, s75, 16778240
    buffer_store_dwordx4 v[212:215], v1, s[12:15], s45 offen sc1
    s_waitcnt lgkmcnt(6)
    v_mfma_f32_16x16x32_bf16 v[224:227], v[168:171], v[60:63], v[224:227]
    ds_read_b64_tr_b16 v[56:57], v25 offset:36864
    v_mfma_f32_16x16x32_bf16 v[240:243], v[172:175], v[60:63], v[240:243]
    ds_read_b64_tr_b16 v[58:59], v25 offset:38912
    buffer_load_dwordx2 v[38:39], v26, s[16:19], 0 offen offset:96
    s_waitcnt lgkmcnt(6)
    v_mfma_f32_16x16x32_bf16 v[224:227], v[176:179], v[44:47], v[224:227]
    ds_read_b64_tr_b16 v[60:61], v25 offset:40960
    v_mfma_f32_16x16x32_bf16 v[240:243], v[180:183], v[44:47], v[240:243]
    ds_read_b64_tr_b16 v[62:63], v25 offset:43008
    s_waitcnt lgkmcnt(6)
    v_mfma_f32_16x16x32_bf16 v[224:227], v[184:187], v[48:51], v[224:227]
    ds_read_b64_tr_b16 v[44:45], v25 offset:45056
    v_mfma_f32_16x16x32_bf16 v[240:243], v[188:191], v[48:51], v[240:243]
    ds_read_b64_tr_b16 v[46:47], v25 offset:47104
    s_waitcnt lgkmcnt(6)
    v_mfma_f32_16x16x32_bf16 v[228:231], v[128:131], v[52:55], v[228:231]
    ds_read_b64_tr_b16 v[48:49], v25 offset:49152
    v_mfma_f32_16x16x32_bf16 v[244:247], v[132:135], v[52:55], v[244:247]
    ds_read_b64_tr_b16 v[50:51], v25 offset:51200
    buffer_load_dwordx4 v[88:91], v1, s[12:15], s33 offen offset:3072 sc1
    s_add_u32 s33, s33, 4096
    s_waitcnt lgkmcnt(6)
    v_mfma_f32_16x16x32_bf16 v[228:231], v[136:139], v[56:59], v[228:231]
    ds_read_b64_tr_b16 v[52:53], v25 offset:53248
    v_cvt_pk_bf16_f32 v224, v224, v225
    v_cvt_pk_bf16_f32 v225, v226, v227
    v_cvt_pk_bf16_f32 v226, v240, v241
    v_cvt_pk_bf16_f32 v227, v242, v243
    v_mfma_f32_16x16x32_bf16 v[244:247], v[140:143], v[56:59], v[244:247]
    ds_read_b64_tr_b16 v[54:55], v25 offset:55296
    buffer_load_dwordx4 v[92:95], v1, s[12:15], s34 offen offset:3072 sc1
    s_add_u32 s34, s34, 4096
    s_waitcnt lgkmcnt(6)
    v_mfma_f32_16x16x32_bf16 v[228:231], v[144:147], v[60:63], v[228:231]
    ds_read_b64_tr_b16 v[56:57], v25 offset:57344
    v_mfma_f32_16x16x32_bf16 v[244:247], v[148:151], v[60:63], v[244:247]
    ds_read_b64_tr_b16 v[58:59], v25 offset:59392
    s_waitcnt lgkmcnt(6)
    v_mfma_f32_16x16x32_bf16 v[228:231], v[152:155], v[44:47], v[228:231]
    ds_read_b64_tr_b16 v[60:61], v25 offset:61440
    v_mfma_f32_16x16x32_bf16 v[244:247], v[156:159], v[44:47], v[244:247]
    ds_read_b64_tr_b16 v[62:63], v25 offset:63488
    s_waitcnt lgkmcnt(6)
    v_mfma_f32_16x16x32_bf16 v[228:231], v[160:163], v[48:51], v[228:231]
    ds_read_b64_tr_b16 v[44:45], v24 offset:33280
    v_mfma_f32_16x16x32_bf16 v[244:247], v[164:167], v[48:51], v[244:247]
    ds_read_b64_tr_b16 v[46:47], v24 offset:35328
    s_waitcnt lgkmcnt(6)
    v_mfma_f32_16x16x32_bf16 v[228:231], v[168:171], v[52:55], v[228:231]
    ds_read_b64_tr_b16 v[48:49], v24 offset:37376
    v_mfma_f32_16x16x32_bf16 v[244:247], v[172:175], v[52:55], v[244:247]
    ds_read_b64_tr_b16 v[50:51], v24 offset:39424
    s_waitcnt lgkmcnt(6)
    v_mfma_f32_16x16x32_bf16 v[228:231], v[176:179], v[56:59], v[228:231]
    ds_read_b64_tr_b16 v[52:53], v24 offset:41472
    v_mfma_f32_16x16x32_bf16 v[244:247], v[180:183], v[56:59], v[244:247]
    ds_read_b64_tr_b16 v[54:55], v24 offset:43520
    s_waitcnt lgkmcnt(6)
    v_mfma_f32_16x16x32_bf16 v[228:231], v[184:187], v[60:63], v[228:231]
    ds_read_b64_tr_b16 v[56:57], v24 offset:45568
    v_mfma_f32_16x16x32_bf16 v[244:247], v[188:191], v[60:63], v[244:247]
    ds_read_b64_tr_b16 v[58:59], v24 offset:47616
    s_waitcnt lgkmcnt(6)
    v_mfma_f32_16x16x32_bf16 v[232:235], v[128:131], v[44:47], v[232:235]
    ds_read_b64_tr_b16 v[60:61], v24 offset:49664
    v_mfma_f32_16x16x32_bf16 v[248:251], v[132:135], v[44:47], v[248:251]
    ds_read_b64_tr_b16 v[62:63], v24 offset:51712
    s_waitcnt lgkmcnt(6)
    v_mfma_f32_16x16x32_bf16 v[232:235], v[136:139], v[48:51], v[232:235]
    ds_read_b64_tr_b16 v[44:45], v24 offset:53760
    v_cvt_pk_bf16_f32 v228, v228, v229
    v_cvt_pk_bf16_f32 v229, v230, v231
    v_cvt_pk_bf16_f32 v230, v244, v245
    v_cvt_pk_bf16_f32 v231, v246, v247
    v_mfma_f32_16x16x32_bf16 v[248:251], v[140:143], v[48:51], v[248:251]
    ds_read_b64_tr_b16 v[46:47], v24 offset:55808
    s_add_u32 s45, s75, 16779264
    buffer_store_dwordx4 v[216:219], v1, s[12:15], s45 offen sc1
    s_waitcnt lgkmcnt(6)
    v_mfma_f32_16x16x32_bf16 v[232:235], v[144:147], v[52:55], v[232:235]
    ds_read_b64_tr_b16 v[48:49], v24 offset:57856
    v_mfma_f32_16x16x32_bf16 v[248:251], v[148:151], v[52:55], v[248:251]
    ds_read_b64_tr_b16 v[50:51], v24 offset:59904
    s_waitcnt lgkmcnt(6)
    v_mfma_f32_16x16x32_bf16 v[232:235], v[152:155], v[56:59], v[232:235]
    ds_read_b64_tr_b16 v[52:53], v24 offset:61952
    v_mfma_f32_16x16x32_bf16 v[248:251], v[156:159], v[56:59], v[248:251]
    ds_read_b64_tr_b16 v[54:55], v24 offset:64000
    s_waitcnt lgkmcnt(6)
    v_mfma_f32_16x16x32_bf16 v[232:235], v[160:163], v[60:63], v[232:235]
    ds_read_b64_tr_b16 v[56:57], v25 offset:33280
    v_mfma_f32_16x16x32_bf16 v[248:251], v[164:167], v[60:63], v[248:251]
    ds_read_b64_tr_b16 v[58:59], v25 offset:35328
    buffer_load_dwordx4 v[96:99], v1, s[12:15], s33 offen offset:0 sc1
    s_waitcnt lgkmcnt(6)
    v_mfma_f32_16x16x32_bf16 v[232:235], v[168:171], v[44:47], v[232:235]
    ds_read_b64_tr_b16 v[60:61], v25 offset:37376
    v_mfma_f32_16x16x32_bf16 v[248:251], v[172:175], v[44:47], v[248:251]
    ds_read_b64_tr_b16 v[62:63], v25 offset:39424
    buffer_load_dwordx4 v[100:103], v1, s[12:15], s34 offen offset:0 sc1
    s_waitcnt lgkmcnt(6)
    v_mfma_f32_16x16x32_bf16 v[232:235], v[176:179], v[48:51], v[232:235]
    ds_read_b64_tr_b16 v[44:45], v25 offset:41472
    v_mfma_f32_16x16x32_bf16 v[248:251], v[180:183], v[48:51], v[248:251]
    ds_read_b64_tr_b16 v[46:47], v25 offset:43520
    s_waitcnt lgkmcnt(6)
    v_mfma_f32_16x16x32_bf16 v[232:235], v[184:187], v[52:55], v[232:235]
    ds_read_b64_tr_b16 v[48:49], v25 offset:45568
    v_mfma_f32_16x16x32_bf16 v[248:251], v[188:191], v[52:55], v[248:251]
    ds_read_b64_tr_b16 v[50:51], v25 offset:47616
    s_add_u32 s45, s75, 16780288
    buffer_store_dwordx4 v[220:223], v1, s[12:15], s45 offen sc1
    s_waitcnt lgkmcnt(6)
    v_mfma_f32_16x16x32_bf16 v[236:239], v[128:131], v[56:59], v[236:239]
    ds_read_b64_tr_b16 v[52:53], v25 offset:49664
    v_mfma_f32_16x16x32_bf16 v[252:255], v[132:135], v[56:59], v[252:255]
    ds_read_b64_tr_b16 v[54:55], v25 offset:51712
    s_waitcnt lgkmcnt(6)
    v_mfma_f32_16x16x32_bf16 v[236:239], v[136:139], v[60:63], v[236:239]
    ds_read_b64_tr_b16 v[56:57], v25 offset:53760
    v_cvt_pk_bf16_f32 v232, v232, v233
    v_cvt_pk_bf16_f32 v233, v234, v235
    v_cvt_pk_bf16_f32 v234, v248, v249
    v_cvt_pk_bf16_f32 v235, v250, v251
    v_mfma_f32_16x16x32_bf16 v[252:255], v[140:143], v[60:63], v[252:255]
    ds_read_b64_tr_b16 v[58:59], v25 offset:55808
    s_waitcnt lgkmcnt(6)
    v_mfma_f32_16x16x32_bf16 v[236:239], v[144:147], v[44:47], v[236:239]
    ds_read_b64_tr_b16 v[60:61], v25 offset:57856
    v_mfma_f32_16x16x32_bf16 v[252:255], v[148:151], v[44:47], v[252:255]
    ds_read_b64_tr_b16 v[62:63], v25 offset:59904
    s_waitcnt vmcnt(6)
    v_lshlrev_b32 v192, 16, v32
    v_and_b32 v193, 0xffff0000, v32
    v_lshlrev_b32 v194, 16, v33
    v_and_b32 v195, 0xffff0000, v33
    v_lshlrev_b32 v196, 16, v34
    v_and_b32 v197, 0xffff0000, v34
    v_lshlrev_b32 v198, 16, v35
    v_and_b32 v199, 0xffff0000, v35
    v_lshlrev_b32 v200, 16, v36
    v_and_b32 v201, 0xffff0000, v36
    v_lshlrev_b32 v202, 16, v37
    v_and_b32 v203, 0xffff0000, v37
    v_lshlrev_b32 v204, 16, v38
    v_and_b32 v205, 0xffff0000, v38
    v_lshlrev_b32 v206, 16, v39
    v_and_b32 v207, 0xffff0000, v39
    s_waitcnt lgkmcnt(6)
    v_mfma_f32_16x16x32_bf16 v[236:239], v[152:155], v[48:51], v[236:239]
    ds_read_b64_tr_b16 v[44:45], v25 offset:61952
    v_mfma_f32_16x16x32_bf16 v[252:255], v[156:159], v[48:51], v[252:255]
    ds_read_b64_tr_b16 v[46:47], v25 offset:64000
    s_barrier
    s_waitcnt lgkmcnt(6)
    v_mfma_f32_16x16x32_bf16 v[236:239], v[160:163], v[52:55], v[236:239]
    ds_read_b64_tr_b16 v[48:49], v20 offset:8192
    v_mfma_f32_16x16x32_bf16 v[252:255], v[164:167], v[52:55], v[252:255]
    ds_read_b64_tr_b16 v[50:51], v20 offset:10240
    s_add_u32 m0, s59, 98304
    s_add_u32 s38, s58, 2097152
    buffer_load_dwordx4 v10, s[60:63], s38 offen lds
    s_waitcnt lgkmcnt(6)
    v_mfma_f32_16x16x32_bf16 v[236:239], v[168:171], v[56:59], v[236:239]
    ds_read_b64_tr_b16 v[52:53], v21 offset:8192
    v_mfma_f32_16x16x32_bf16 v[252:255], v[172:175], v[56:59], v[252:255]
    ds_read_b64_tr_b16 v[54:55], v21 offset:10240
    buffer_load_dwordx4 v11, s[60:63], s38 offen offset:1024 lds
    s_waitcnt lgkmcnt(6)
    v_mfma_f32_16x16x32_bf16 v[236:239], v[176:179], v[60:63], v[236:239]
    ds_read_b64_tr_b16 v[56:57], v20 offset:8704
    v_mfma_f32_16x16x32_bf16 v[252:255], v[180:183], v[60:63], v[252:255]
    ds_read_b64_tr_b16 v[58:59], v20 offset:10752
    s_add_u32 m0, s69, 106496
    s_add_u32 s38, s68, 884736
    buffer_load_dwordx4 v12, s[64:67], s38 offen lds
    s_waitcnt lgkmcnt(6)
    v_mfma_f32_16x16x32_bf16 v[236:239], v[184:187], v[44:47], v[236:239]
    ds_read_b64_tr_b16 v[60:61], v21 offset:8704
    v_mfma_f32_16x16x32_bf16 v[252:255], v[188:191], v[44:47], v[252:255]
    ds_read_b64_tr_b16 v[62:63], v21 offset:10752
    s_waitcnt lgkmcnt(6)
    v_mfma_f32_16x16x32_bf16 v[208:211], v[48:51], v[68:71], v[192:195]
    ds_read_b64_tr_b16 v[44:45], v20 offset:0
    v_mfma_f32_16x16x32_bf16 v[192:195], v[48:51], v[64:67], v[192:195]
    ds_read_b64_tr_b16 v[46:47], v20 offset:2048
    buffer_load_dwordx4 v[104:107], v1, s[12:15], s33 offen offset:1024 sc1
    s_waitcnt lgkmcnt(6)
    v_mfma_f32_16x16x32_bf16 v[212:215], v[52:55], v[68:71], v[196:199]
    ds_read_b64_tr_b16 v[48:49], v21 offset:0
    v_cvt_pk_bf16_f32 v236, v236, v237
    v_cvt_pk_bf16_f32 v237, v238, v239
    v_cvt_pk_bf16_f32 v238, v252, v253
    v_cvt_pk_bf16_f32 v239, v254, v255
    v_mfma_f32_16x16x32_bf16 v[196:199], v[52:55], v[64:67], v[196:199]
    ds_read_b64_tr_b16 v[50:51], v21 offset:2048
    buffer_load_dwordx4 v[108:111], v1, s[12:15], s34 offen offset:1024 sc1
    s_waitcnt lgkmcnt(6)
    v_mfma_f32_16x16x32_bf16 v[216:219], v[56:59], v[68:71], v[200:203]
    ds_read_b64_tr_b16 v[52:53], v20 offset:512
    v_mfma_f32_16x16x32_bf16 v[200:203], v[56:59], v[64:67], v[200:203]
    ds_read_b64_tr_b16 v[54:55], v20 offset:2560
    s_waitcnt lgkmcnt(6)
    v_mfma_f32_16x16x32_bf16 v[220:223], v[60:63], v[68:71], v[204:207]
    ds_read_b64_tr_b16 v[56:57], v21 offset:512
    v_mfma_f32_16x16x32_bf16 v[204:207], v[60:63], v[64:67], v[204:207]
    ds_read_b64_tr_b16 v[58:59], v21 offset:2560
    s_add_u32 s45, s75, 16781312
    buffer_store_dwordx4 v[224:227], v1, s[12:15], s45 offen sc1
    s_waitcnt lgkmcnt(6)
    v_mfma_f32_16x16x32_bf16 v[128:131], v[44:47], v[64:67], 0
    ds_read_b64_tr_b16 v[60:61], v20 offset:4096
    v_mfma_f32_16x16x32_bf16 v[160:163], v[44:47], v[68:71], 0
    ds_read_b64_tr_b16 v[62:63], v20 offset:6144
    s_waitcnt lgkmcnt(6)
    v_mfma_f32_16x16x32_bf16 v[132:135], v[48:51], v[64:67], 0
    ds_read_b64_tr_b16 v[44:45], v21 offset:4096
    v_mfma_f32_16x16x32_bf16 v[164:167], v[48:51], v[68:71], 0
    ds_read_b64_tr_b16 v[46:47], v21 offset:6144
    s_waitcnt lgkmcnt(6)
    v_mfma_f32_16x16x32_bf16 v[136:139], v[52:55], v[64:67], 0
    ds_read_b64_tr_b16 v[48:49], v20 offset:4608
    v_mfma_f32_16x16x32_bf16 v[168:171], v[52:55], v[68:71], 0
    ds_read_b64_tr_b16 v[50:51], v20 offset:6656
    s_waitcnt lgkmcnt(6)
    v_mfma_f32_16x16x32_bf16 v[140:143], v[56:59], v[64:67], 0
    ds_read_b64_tr_b16 v[52:53], v21 offset:4608
    v_mfma_f32_16x16x32_bf16 v[172:175], v[56:59], v[68:71], 0
    ds_read_b64_tr_b16 v[54:55], v21 offset:6656
    s_waitcnt lgkmcnt(6)
    v_mfma_f32_16x16x32_bf16 v[144:147], v[60:63], v[64:67], 0
    ds_read_b64_tr_b16 v[56:57], v20 offset:20480
    v_mfma_f32_16x16x32_bf16 v[176:179], v[60:63], v[68:71], 0
    ds_read_b64_tr_b16 v[58:59], v20 offset:22528
    s_waitcnt lgkmcnt(6)
    v_mfma_f32_16x16x32_bf16 v[148:151], v[44:47], v[64:67], 0
    ds_read_b64_tr_b16 v[60:61], v21 offset:20480
    v_mfma_f32_16x16x32_bf16 v[180:183], v[44:47], v[68:71], 0
    ds_read_b64_tr_b16 v[62:63], v21 offset:22528
    s_waitcnt lgkmcnt(6)
    v_mfma_f32_16x16x32_bf16 v[152:155], v[48:51], v[64:67], 0
    ds_read_b64_tr_b16 v[44:45], v20 offset:20992
    v_mfma_f32_16x16x32_bf16 v[184:187], v[48:51], v[68:71], 0
    ds_read_b64_tr_b16 v[46:47], v20 offset:23040
    s_waitcnt lgkmcnt(6)
    v_mfma_f32_16x16x32_bf16 v[156:159], v[52:55], v[64:67], 0
    ds_read_b64_tr_b16 v[48:49], v21 offset:20992
    v_mfma_f32_16x16x32_bf16 v[188:191], v[52:55], v[68:71], 0
    ds_read_b64_tr_b16 v[50:51], v21 offset:23040
    s_waitcnt lgkmcnt(6)
    v_mfma_f32_16x16x32_bf16 v[192:195], v[56:59], v[72:75], v[192:195]
    ds_read_b64_tr_b16 v[52:53], v20 offset:12288
    v_mfma_f32_16x16x32_bf16 v[208:211], v[56:59], v[76:79], v[208:211]
    ds_read_b64_tr_b16 v[54:55], v20 offset:14336
    buffer_load_dwordx4 v[112:115], v1, s[12:15], s33 offen offset:2048 sc1
    s_waitcnt lgkmcnt(6)
    v_mfma_f32_16x16x32_bf16 v[196:199], v[60:63], v[72:75], v[196:199]
    ds_read_b64_tr_b16 v[56:57], v21 offset:12288
    v_mfma_f32_16x16x32_bf16 v[212:215], v[60:63], v[76:79], v[212:215]
    ds_read_b64_tr_b16 v[58:59], v21 offset:14336
    buffer_load_dwordx4 v[116:119], v1, s[12:15], s34 offen offset:2048 sc1
    s_waitcnt lgkmcnt(6)
    v_mfma_f32_16x16x32_bf16 v[200:203], v[44:47], v[72:75], v[200:203]
    ds_read_b64_tr_b16 v[60:61], v20 offset:12800
    v_mfma_f32_16x16x32_bf16 v[216:219], v[44:47], v[76:79], v[216:219]
    ds_read_b64_tr_b16 v[62:63], v20 offset:14848
    s_waitcnt lgkmcnt(6)
    v_mfma_f32_16x16x32_bf16 v[204:207], v[48:51], v[72:75], v[204:207]
    ds_read_b64_tr_b16 v[44:45], v21 offset:12800
    v_mfma_f32_16x16x32_bf16 v[220:223], v[48:51], v[76:79], v[220:223]
    ds_read_b64_tr_b16 v[46:47], v21 offset:14848
    s_add_u32 s45, s75, 16782336
    buffer_store_dwordx4 v[228:231], v1, s[12:15], s45 offen sc1
    s_waitcnt lgkmcnt(6)
    v_mfma_f32_16x16x32_bf16 v[128:131], v[52:55], v[72:75], v[128:131]
    ds_read_b64_tr_b16 v[48:49], v20 offset:16384
    v_mfma_f32_16x16x32_bf16 v[160:163], v[52:55], v[76:79], v[160:163]
    ds_read_b64_tr_b16 v[50:51], v20 offset:18432
    s_waitcnt lgkmcnt(6)
    v_mfma_f32_16x16x32_bf16 v[132:135], v[56:59], v[72:75], v[132:135]
    ds_read_b64_tr_b16 v[52:53], v21 offset:16384
    v_mfma_f32_16x16x32_bf16 v[164:167], v[56:59], v[76:79], v[164:167]
    ds_read_b64_tr_b16 v[54:55], v21 offset:18432
    s_waitcnt lgkmcnt(6)
    v_mfma_f32_16x16x32_bf16 v[136:139], v[60:63], v[72:75], v[136:139]
    ds_read_b64_tr_b16 v[56:57], v20 offset:16896
    v_mfma_f32_16x16x32_bf16 v[168:171], v[60:63], v[76:79], v[168:171]
    ds_read_b64_tr_b16 v[58:59], v20 offset:18944
    s_waitcnt lgkmcnt(6)
    v_mfma_f32_16x16x32_bf16 v[140:143], v[44:47], v[72:75], v[140:143]
    ds_read_b64_tr_b16 v[60:61], v21 offset:16896
    v_mfma_f32_16x16x32_bf16 v[172:175], v[44:47], v[76:79], v[172:175]
    ds_read_b64_tr_b16 v[62:63], v21 offset:18944
    s_barrier
    s_waitcnt lgkmcnt(6)
    v_mfma_f32_16x16x32_bf16 v[144:147], v[48:51], v[72:75], v[144:147]
    ds_read_b64_tr_b16 v[44:45], v20 offset:32768
    v_mfma_f32_16x16x32_bf16 v[176:179], v[48:51], v[76:79], v[176:179]
    ds_read_b64_tr_b16 v[46:47], v20 offset:34816
    s_add_u32 m0, s59, 122880
    s_add_u32 s38, s58, 2621440
    buffer_load_dwordx4 v10, s[60:63], s38 offen lds
    s_waitcnt lgkmcnt(6)
    v_mfma_f32_16x16x32_bf16 v[148:151], v[52:55], v[72:75], v[148:151]
    ds_read_b64_tr_b16 v[48:49], v21 offset:32768
    v_mfma_f32_16x16x32_bf16 v[180:183], v[52:55], v[76:79], v[180:183]
    ds_read_b64_tr_b16 v[50:51], v21 offset:34816
    buffer_load_dwordx4 v11, s[60:63], s38 offen offset:1024 lds
    s_waitcnt lgkmcnt(6)
    v_mfma_f32_16x16x32_bf16 v[152:155], v[56:59], v[72:75], v[152:155]
    ds_read_b64_tr_b16 v[52:53], v20 offset:33280
    v_mfma_f32_16x16x32_bf16 v[184:187], v[56:59], v[76:79], v[184:187]
    ds_read_b64_tr_b16 v[54:55], v20 offset:35328
    s_add_u32 m0, s69, 131072
    s_add_u32 s38, s68, 1105920
    buffer_load_dwordx4 v12, s[64:67], s38 offen lds
    s_waitcnt lgkmcnt(6)
    v_mfma_f32_16x16x32_bf16 v[156:159], v[60:63], v[72:75], v[156:159]
    ds_read_b64_tr_b16 v[56:57], v21 offset:33280
    v_mfma_f32_16x16x32_bf16 v[188:191], v[60:63], v[76:79], v[188:191]
    ds_read_b64_tr_b16 v[58:59], v21 offset:35328
    s_waitcnt lgkmcnt(6)
    v_mfma_f32_16x16x32_bf16 v[192:195], v[44:47], v[80:83], v[192:195]
    ds_read_b64_tr_b16 v[60:61], v20 offset:24576
    v_mfma_f32_16x16x32_bf16 v[208:211], v[44:47], v[84:87], v[208:211]
    ds_read_b64_tr_b16 v[62:63], v20 offset:26624
    buffer_load_dwordx4 v[120:123], v1, s[12:15], s33 offen offset:3072 sc1
    s_add_u32 s33, s33, 4096
    s_waitcnt lgkmcnt(6)
    v_mfma_f32_16x16x32_bf16 v[196:199], v[48:51], v[80:83], v[196:199]
    ds_read_b64_tr_b16 v[44:45], v21 offset:24576
    v_mfma_f32_16x16x32_bf16 v[212:215], v[48:51], v[84:87], v[212:215]
    ds_read_b64_tr_b16 v[46:47], v21 offset:26624
    buffer_load_dwordx4 v[124:127], v1, s[12:15], s34 offen offset:3072 sc1
    s_add_u32 s34, s34, 4096
    s_waitcnt lgkmcnt(6)
    v_mfma_f32_16x16x32_bf16 v[200:203], v[52:55], v[80:83], v[200:203]
    ds_read_b64_tr_b16 v[48:49], v20 offset:25088
    v_mfma_f32_16x16x32_bf16 v[216:219], v[52:55], v[84:87], v[216:219]
    ds_read_b64_tr_b16 v[50:51], v20 offset:27136
    s_waitcnt lgkmcnt(6)
    v_mfma_f32_16x16x32_bf16 v[204:207], v[56:59], v[80:83], v[204:207]
    ds_read_b64_tr_b16 v[52:53], v21 offset:25088
    v_mfma_f32_16x16x32_bf16 v[220:223], v[56:59], v[84:87], v[220:223]
    ds_read_b64_tr_b16 v[54:55], v21 offset:27136
    s_add_u32 s45, s75, 16783360
    buffer_store_dwordx4 v[232:235], v1, s[12:15], s45 offen sc1
    s_waitcnt lgkmcnt(6)
    v_mfma_f32_16x16x32_bf16 v[128:131], v[60:63], v[80:83], v[128:131]
    ds_read_b64_tr_b16 v[56:57], v20 offset:28672
    v_mfma_f32_16x16x32_bf16 v[160:163], v[60:63], v[84:87], v[160:163]
    ds_read_b64_tr_b16 v[58:59], v20 offset:30720
    s_waitcnt lgkmcnt(6)
    v_mfma_f32_16x16x32_bf16 v[132:135], v[44:47], v[80:83], v[132:135]
    ds_read_b64_tr_b16 v[60:61], v21 offset:28672
    v_mfma_f32_16x16x32_bf16 v[164:167], v[44:47], v[84:87], v[164:167]
    ds_read_b64_tr_b16 v[62:63], v21 offset:30720
    s_waitcnt lgkmcnt(6)
    v_mfma_f32_16x16x32_bf16 v[136:139], v[48:51], v[80:83], v[136:139]
    ds_read_b64_tr_b16 v[44:45], v20 offset:29184
    v_mfma_f32_16x16x32_bf16 v[168:171], v[48:51], v[84:87], v[168:171]
    ds_read_b64_tr_b16 v[46:47], v20 offset:31232
    s_waitcnt lgkmcnt(6)
    v_mfma_f32_16x16x32_bf16 v[140:143], v[52:55], v[80:83], v[140:143]
    ds_read_b64_tr_b16 v[48:49], v21 offset:29184
    v_mfma_f32_16x16x32_bf16 v[172:175], v[52:55], v[84:87], v[172:175]
    ds_read_b64_tr_b16 v[50:51], v21 offset:31232
    s_waitcnt lgkmcnt(6)
    v_mfma_f32_16x16x32_bf16 v[144:147], v[56:59], v[80:83], v[144:147]
    ds_read_b64_tr_b16 v[52:53], v20 offset:45056
    v_mfma_f32_16x16x32_bf16 v[176:179], v[56:59], v[84:87], v[176:179]
    ds_read_b64_tr_b16 v[54:55], v20 offset:47104
    s_waitcnt lgkmcnt(6)
    v_mfma_f32_16x16x32_bf16 v[148:151], v[60:63], v[80:83], v[148:151]
    ds_read_b64_tr_b16 v[56:57], v21 offset:45056
    v_mfma_f32_16x16x32_bf16 v[180:183], v[60:63], v[84:87], v[180:183]
    ds_read_b64_tr_b16 v[58:59], v21 offset:47104
    s_waitcnt lgkmcnt(6)
    v_mfma_f32_16x16x32_bf16 v[152:155], v[44:47], v[80:83], v[152:155]
    ds_read_b64_tr_b16 v[60:61], v20 offset:45568
    v_mfma_f32_16x16x32_bf16 v[184:187], v[44:47], v[84:87], v[184:187]
    ds_read_b64_tr_b16 v[62:63], v20 offset:47616
    s_waitcnt lgkmcnt(6)
    v_mfma_f32_16x16x32_bf16 v[156:159], v[48:51], v[80:83], v[156:159]
    ds_read_b64_tr_b16 v[44:45], v21 offset:45568
    v_mfma_f32_16x16x32_bf16 v[188:191], v[48:51], v[84:87], v[188:191]
    ds_read_b64_tr_b16 v[46:47], v21 offset:47616
    s_waitcnt vmcnt(19)
    s_waitcnt lgkmcnt(6)
    v_mfma_f32_16x16x32_bf16 v[192:195], v[52:55], v[88:91], v[192:195]
    ds_read_b64_tr_b16 v[48:49], v20 offset:36864
    v_mfma_f32_16x16x32_bf16 v[208:211], v[52:55], v[92:95], v[208:211]
    ds_read_b64_tr_b16 v[50:51], v20 offset:38912
    buffer_load_dwordx4 v[64:67], v1, s[12:15], s33 offen offset:0 sc1
    s_waitcnt lgkmcnt(6)
    v_mfma_f32_16x16x32_bf16 v[196:199], v[56:59], v[88:91], v[196:199]
    ds_read_b64_tr_b16 v[52:53], v21 offset:36864
    v_mfma_f32_16x16x32_bf16 v[212:215], v[56:59], v[92:95], v[212:215]
    ds_read_b64_tr_b16 v[54:55], v21 offset:38912
    buffer_load_dwordx4 v[68:71], v1, s[12:15], s34 offen offset:0 sc1
    s_waitcnt lgkmcnt(6)
    v_mfma_f32_16x16x32_bf16 v[200:203], v[60:63], v[88:91], v[200:203]
    ds_read_b64_tr_b16 v[56:57], v20 offset:37376
    v_mfma_f32_16x16x32_bf16 v[216:219], v[60:63], v[92:95], v[216:219]
    ds_read_b64_tr_b16 v[58:59], v20 offset:39424
    s_waitcnt lgkmcnt(6)
    v_mfma_f32_16x16x32_bf16 v[204:207], v[44:47], v[88:91], v[204:207]
    ds_read_b64_tr_b16 v[60:61], v21 offset:37376
    v_mfma_f32_16x16x32_bf16 v[220:223], v[44:47], v[92:95], v[220:223]
    ds_read_b64_tr_b16 v[62:63], v21 offset:39424
    s_add_u32 s45, s75, 16784384
    buffer_store_dwordx4 v[236:239], v1, s[12:15], s45 offen sc1
    s_waitcnt lgkmcnt(6)
    v_mfma_f32_16x16x32_bf16 v[128:131], v[48:51], v[88:91], v[128:131]
    ds_read_b64_tr_b16 v[44:45], v20 offset:40960
    v_mfma_f32_16x16x32_bf16 v[160:163], v[48:51], v[92:95], v[160:163]
    ds_read_b64_tr_b16 v[46:47], v20 offset:43008
    s_waitcnt lgkmcnt(6)
    v_mfma_f32_16x16x32_bf16 v[132:135], v[52:55], v[88:91], v[132:135]
    ds_read_b64_tr_b16 v[48:49], v21 offset:40960
    v_mfma_f32_16x16x32_bf16 v[164:167], v[52:55], v[92:95], v[164:167]
    ds_read_b64_tr_b16 v[50:51], v21 offset:43008
    s_waitcnt lgkmcnt(6)
    v_mfma_f32_16x16x32_bf16 v[136:139], v[56:59], v[88:91], v[136:139]
    ds_read_b64_tr_b16 v[52:53], v20 offset:41472
    v_mfma_f32_16x16x32_bf16 v[168:171], v[56:59], v[92:95], v[168:171]
    ds_read_b64_tr_b16 v[54:55], v20 offset:43520
    s_waitcnt lgkmcnt(6)
    v_mfma_f32_16x16x32_bf16 v[140:143], v[60:63], v[88:91], v[140:143]
    ds_read_b64_tr_b16 v[56:57], v21 offset:41472
    v_mfma_f32_16x16x32_bf16 v[172:175], v[60:63], v[92:95], v[172:175]
    ds_read_b64_tr_b16 v[58:59], v21 offset:43520
    s_barrier
    s_waitcnt lgkmcnt(6)
    v_mfma_f32_16x16x32_bf16 v[144:147], v[44:47], v[88:91], v[144:147]
    ds_read_b64_tr_b16 v[60:61], v22 offset:8192
    v_mfma_f32_16x16x32_bf16 v[176:179], v[44:47], v[92:95], v[176:179]
    ds_read_b64_tr_b16 v[62:63], v22 offset:10240
    s_add_u32 m0, s59, 0
    s_add_u32 s38, s58, 3145728
    buffer_load_dwordx4 v10, s[60:63], s38 offen lds
    s_waitcnt lgkmcnt(6)
    v_mfma_f32_16x16x32_bf16 v[148:151], v[48:51], v[88:91], v[148:151]
    ds_read_b64_tr_b16 v[44:45], v23 offset:8192
    v_mfma_f32_16x16x32_bf16 v[180:183], v[48:51], v[92:95], v[180:183]
    ds_read_b64_tr_b16 v[46:47], v23 offset:10240
    buffer_load_dwordx4 v11, s[60:63], s38 offen offset:1024 lds
    s_waitcnt lgkmcnt(6)
    v_mfma_f32_16x16x32_bf16 v[152:155], v[52:55], v[88:91], v[152:155]
    ds_read_b64_tr_b16 v[48:49], v22 offset:8704
    v_mfma_f32_16x16x32_bf16 v[184:187], v[52:55], v[92:95], v[184:187]
    ds_read_b64_tr_b16 v[50:51], v22 offset:10752
    s_add_u32 m0, s69, 8192
    s_add_u32 s38, s68, 1327104
    buffer_load_dwordx4 v12, s[64:67], s38 offen lds
    s_waitcnt lgkmcnt(6)
    v_mfma_f32_16x16x32_bf16 v[156:159], v[56:59], v[88:91], v[156:159]
    ds_read_b64_tr_b16 v[52:53], v23 offset:8704
    v_mfma_f32_16x16x32_bf16 v[188:191], v[56:59], v[92:95], v[188:191]
    ds_read_b64_tr_b16 v[54:55], v23 offset:10752
    s_waitcnt vmcnt(22)
    s_waitcnt lgkmcnt(6)
    v_mfma_f32_16x16x32_bf16 v[192:195], v[60:63], v[96:99], v[192:195]
    ds_read_b64_tr_b16 v[56:57], v22 offset:0
    v_mfma_f32_16x16x32_bf16 v[208:211], v[60:63], v[100:103], v[208:211]
    ds_read_b64_tr_b16 v[58:59], v22 offset:2048
    buffer_load_dwordx4 v[72:75], v1, s[12:15], s33 offen offset:1024 sc1
    s_waitcnt lgkmcnt(6)
    v_mfma_f32_16x16x32_bf16 v[196:199], v[44:47], v[96:99], v[196:199]
    ds_read_b64_tr_b16 v[60:61], v23 offset:0
    v_mfma_f32_16x16x32_bf16 v[212:215], v[44:47], v[100:103], v[212:215]
    ds_read_b64_tr_b16 v[62:63], v23 offset:2048
    buffer_load_dwordx4 v[76:79], v1, s[12:15], s34 offen offset:1024 sc1
    s_waitcnt lgkmcnt(6)
    v_mfma_f32_16x16x32_bf16 v[200:203], v[48:51], v[96:99], v[200:203]
    ds_read_b64_tr_b16 v[44:45], v22 offset:512
    v_mfma_f32_16x16x32_bf16 v[216:219], v[48:51], v[100:103], v[216:219]
    ds_read_b64_tr_b16 v[46:47], v22 offset:2560
    s_waitcnt lgkmcnt(6)
    v_mfma_f32_16x16x32_bf16 v[204:207], v[52:55], v[96:99], v[204:207]
    ds_read_b64_tr_b16 v[48:49], v23 offset:512
    v_mfma_f32_16x16x32_bf16 v[220:223], v[52:55], v[100:103], v[220:223]
    ds_read_b64_tr_b16 v[50:51], v23 offset:2560
    s_waitcnt lgkmcnt(6)
    v_mfma_f32_16x16x32_bf16 v[128:131], v[56:59], v[96:99], v[128:131]
    ds_read_b64_tr_b16 v[52:53], v22 offset:4096
    v_mfma_f32_16x16x32_bf16 v[160:163], v[56:59], v[100:103], v[160:163]
    ds_read_b64_tr_b16 v[54:55], v22 offset:6144
    s_waitcnt lgkmcnt(6)
    v_mfma_f32_16x16x32_bf16 v[132:135], v[60:63], v[96:99], v[132:135]
    ds_read_b64_tr_b16 v[56:57], v23 offset:4096
    v_mfma_f32_16x16x32_bf16 v[164:167], v[60:63], v[100:103], v[164:167]
    ds_read_b64_tr_b16 v[58:59], v23 offset:6144
    s_waitcnt lgkmcnt(6)
    v_mfma_f32_16x16x32_bf16 v[136:139], v[44:47], v[96:99], v[136:139]
    ds_read_b64_tr_b16 v[60:61], v22 offset:4608
    v_mfma_f32_16x16x32_bf16 v[168:171], v[44:47], v[100:103], v[168:171]
    ds_read_b64_tr_b16 v[62:63], v22 offset:6656
    s_waitcnt lgkmcnt(6)
    v_mfma_f32_16x16x32_bf16 v[140:143], v[48:51], v[96:99], v[140:143]
    ds_read_b64_tr_b16 v[44:45], v23 offset:4608
    v_mfma_f32_16x16x32_bf16 v[172:175], v[48:51], v[100:103], v[172:175]
    ds_read_b64_tr_b16 v[46:47], v23 offset:6656
    s_waitcnt lgkmcnt(6)
    v_mfma_f32_16x16x32_bf16 v[144:147], v[52:55], v[96:99], v[144:147]
    ds_read_b64_tr_b16 v[48:49], v22 offset:20480
    v_mfma_f32_16x16x32_bf16 v[176:179], v[52:55], v[100:103], v[176:179]
    ds_read_b64_tr_b16 v[50:51], v22 offset:22528
    s_waitcnt lgkmcnt(6)
    v_mfma_f32_16x16x32_bf16 v[148:151], v[56:59], v[96:99], v[148:151]
    ds_read_b64_tr_b16 v[52:53], v23 offset:20480
    v_mfma_f32_16x16x32_bf16 v[180:183], v[56:59], v[100:103], v[180:183]
    ds_read_b64_tr_b16 v[54:55], v23 offset:22528
    s_waitcnt lgkmcnt(6)
    v_mfma_f32_16x16x32_bf16 v[152:155], v[60:63], v[96:99], v[152:155]
    ds_read_b64_tr_b16 v[56:57], v22 offset:20992
    v_mfma_f32_16x16x32_bf16 v[184:187], v[60:63], v[100:103], v[184:187]
    ds_read_b64_tr_b16 v[58:59], v22 offset:23040
    s_waitcnt lgkmcnt(6)
    v_mfma_f32_16x16x32_bf16 v[156:159], v[44:47], v[96:99], v[156:159]
    ds_read_b64_tr_b16 v[60:61], v23 offset:20992
    v_mfma_f32_16x16x32_bf16 v[188:191], v[44:47], v[100:103], v[188:191]
    ds_read_b64_tr_b16 v[62:63], v23 offset:23040
    s_waitcnt vmcnt(18)
    s_waitcnt lgkmcnt(6)
    v_mfma_f32_16x16x32_bf16 v[192:195], v[48:51], v[104:107], v[192:195]
    ds_read_b64_tr_b16 v[44:45], v22 offset:12288
    v_mfma_f32_16x16x32_bf16 v[208:211], v[48:51], v[108:111], v[208:211]
    ds_read_b64_tr_b16 v[46:47], v22 offset:14336
    buffer_load_dwordx4 v[80:83], v1, s[12:15], s33 offen offset:2048 sc1
    s_waitcnt lgkmcnt(6)
    v_mfma_f32_16x16x32_bf16 v[196:199], v[52:55], v[104:107], v[196:199]
    ds_read_b64_tr_b16 v[48:49], v23 offset:12288
    v_mfma_f32_16x16x32_bf16 v[212:215], v[52:55], v[108:111], v[212:215]
    ds_read_b64_tr_b16 v[50:51], v23 offset:14336
    buffer_load_dwordx4 v[84:87], v1, s[12:15], s34 offen offset:2048 sc1
    s_waitcnt lgkmcnt(6)
    v_mfma_f32_16x16x32_bf16 v[200:203], v[56:59], v[104:107], v[200:203]
    ds_read_b64_tr_b16 v[52:53], v22 offset:12800
    v_mfma_f32_16x16x32_bf16 v[216:219], v[56:59], v[108:111], v[216:219]
    ds_read_b64_tr_b16 v[54:55], v22 offset:14848
    s_waitcnt lgkmcnt(6)
    v_mfma_f32_16x16x32_bf16 v[204:207], v[60:63], v[104:107], v[204:207]
    ds_read_b64_tr_b16 v[56:57], v23 offset:12800
    v_mfma_f32_16x16x32_bf16 v[220:223], v[60:63], v[108:111], v[220:223]
    ds_read_b64_tr_b16 v[58:59], v23 offset:14848
    s_waitcnt lgkmcnt(6)
    v_mfma_f32_16x16x32_bf16 v[128:131], v[44:47], v[104:107], v[128:131]
    ds_read_b64_tr_b16 v[60:61], v22 offset:16384
    v_mfma_f32_16x16x32_bf16 v[160:163], v[44:47], v[108:111], v[160:163]
    ds_read_b64_tr_b16 v[62:63], v22 offset:18432
    s_waitcnt lgkmcnt(6)
    v_mfma_f32_16x16x32_bf16 v[132:135], v[48:51], v[104:107], v[132:135]
    ds_read_b64_tr_b16 v[44:45], v23 offset:16384
    v_mfma_f32_16x16x32_bf16 v[164:167], v[48:51], v[108:111], v[164:167]
    ds_read_b64_tr_b16 v[46:47], v23 offset:18432
    s_waitcnt lgkmcnt(6)
    v_mfma_f32_16x16x32_bf16 v[136:139], v[52:55], v[104:107], v[136:139]
    ds_read_b64_tr_b16 v[48:49], v22 offset:16896
    v_mfma_f32_16x16x32_bf16 v[168:171], v[52:55], v[108:111], v[168:171]
    ds_read_b64_tr_b16 v[50:51], v22 offset:18944
    s_waitcnt lgkmcnt(6)
    v_mfma_f32_16x16x32_bf16 v[140:143], v[56:59], v[104:107], v[140:143]
    ds_read_b64_tr_b16 v[52:53], v23 offset:16896
    v_mfma_f32_16x16x32_bf16 v[172:175], v[56:59], v[108:111], v[172:175]
    ds_read_b64_tr_b16 v[54:55], v23 offset:18944
    s_waitcnt vmcnt(7)
    s_barrier
    s_cmp_eq_u32 s22, 0
    s_cbranch_scc0 L_fl_4
    s_add_u32 s45, s3, 2
    s_mov_b64 exec, 1
    v_mov_b32 v19, s45
    buffer_store_dword v19, off, s[12:15], s74 sc1
    s_mov_b64 exec, -1
L_fl_4:
    s_waitcnt lgkmcnt(6)
    v_mfma_f32_16x16x32_bf16 v[144:147], v[60:63], v[104:107], v[144:147]
    ds_read_b64_tr_b16 v[56:57], v22 offset:32768
    v_mfma_f32_16x16x32_bf16 v[176:179], v[60:63], v[108:111], v[176:179]
    ds_read_b64_tr_b16 v[58:59], v22 offset:34816
    s_add_u32 m0, s59, 24576
    s_add_u32 s38, s58, 3670016
    buffer_load_dwordx4 v10, s[60:63], s38 offen lds
    s_waitcnt lgkmcnt(6)
    v_mfma_f32_16x16x32_bf16 v[148:151], v[44:47], v[104:107], v[148:151]
    ds_read_b64_tr_b16 v[60:61], v23 offset:32768
    v_mfma_f32_16x16x32_bf16 v[180:183], v[44:47], v[108:111], v[180:183]
    ds_read_b64_tr_b16 v[62:63], v23 offset:34816
    buffer_load_dwordx4 v11, s[60:63], s38 offen offset:1024 lds
    s_waitcnt lgkmcnt(6)
    v_mfma_f32_16x16x32_bf16 v[152:155], v[48:51], v[104:107], v[152:155]
    ds_read_b64_tr_b16 v[44:45], v22 offset:33280
    v_mfma_f32_16x16x32_bf16 v[184:187], v[48:51], v[108:111], v[184:187]
    ds_read_b64_tr_b16 v[46:47], v22 offset:35328
    s_add_u32 m0, s69, 32768
    s_add_u32 s38, s68, 1548288
    buffer_load_dwordx4 v12, s[64:67], s38 offen lds
    s_waitcnt lgkmcnt(6)
    v_mfma_f32_16x16x32_bf16 v[156:159], v[52:55], v[104:107], v[156:159]
    ds_read_b64_tr_b16 v[48:49], v23 offset:33280
    v_mfma_f32_16x16x32_bf16 v[188:191], v[52:55], v[108:111], v[188:191]
    ds_read_b64_tr_b16 v[50:51], v23 offset:35328
    s_waitcnt lgkmcnt(6)
    v_mfma_f32_16x16x32_bf16 v[192:195], v[56:59], v[112:115], v[192:195]
    ds_read_b64_tr_b16 v[52:53], v22 offset:24576
    v_mfma_f32_16x16x32_bf16 v[208:211], v[56:59], v[116:119], v[208:211]
    ds_read_b64_tr_b16 v[54:55], v22 offset:26624
    buffer_load_dwordx4 v[88:91], v1, s[12:15], s33 offen offset:3072 sc1
    s_add_u32 s33, s33, 4096
    s_waitcnt lgkmcnt(6)
    v_mfma_f32_16x16x32_bf16 v[196:199], v[60:63], v[112:115], v[196:199]
    ds_read_b64_tr_b16 v[56:57], v23 offset:24576
    v_mfma_f32_16x16x32_bf16 v[212:215], v[60:63], v[116:119], v[212:215]
    ds_read_b64_tr_b16 v[58:59], v23 offset:26624
    buffer_load_dwordx4 v[92:95], v1, s[12:15], s34 offen offset:3072 sc1
    s_add_u32 s34, s34, 4096
    s_waitcnt lgkmcnt(6)
    v_mfma_f32_16x16x32_bf16 v[200:203], v[44:47], v[112:115], v[200:203]
    ds_read_b64_tr_b16 v[60:61], v22 offset:25088
    v_mfma_f32_16x16x32_bf16 v[216:219], v[44:47], v[116:119], v[216:219]
    ds_read_b64_tr_b16 v[62:63], v22 offset:27136
    s_waitcnt lgkmcnt(6)
    v_mfma_f32_16x16x32_bf16 v[204:207], v[48:51], v[112:115], v[204:207]
    ds_read_b64_tr_b16 v[44:45], v23 offset:25088
    v_mfma_f32_16x16x32_bf16 v[220:223], v[48:51], v[116:119], v[220:223]
    ds_read_b64_tr_b16 v[46:47], v23 offset:27136
    s_waitcnt lgkmcnt(6)
    v_mfma_f32_16x16x32_bf16 v[128:131], v[52:55], v[112:115], v[128:131]
    ds_read_b64_tr_b16 v[48:49], v22 offset:28672
    v_mfma_f32_16x16x32_bf16 v[160:163], v[52:55], v[116:119], v[160:163]
    ds_read_b64_tr_b16 v[50:51], v22 offset:30720
    s_waitcnt lgkmcnt(6)
    v_mfma_f32_16x16x32_bf16 v[132:135], v[56:59], v[112:115], v[132:135]
    ds_read_b64_tr_b16 v[52:53], v23 offset:28672
    v_mfma_f32_16x16x32_bf16 v[164:167], v[56:59], v[116:119], v[164:167]
    ds_read_b64_tr_b16 v[54:55], v23 offset:30720
    s_waitcnt lgkmcnt(6)
    v_mfma_f32_16x16x32_bf16 v[136:139], v[60:63], v[112:115], v[136:139]
    ds_read_b64_tr_b16 v[56:57], v22 offset:29184
    v_mfma_f32_16x16x32_bf16 v[168:171], v[60:63], v[116:119], v[168:171]
    ds_read_b64_tr_b16 v[58:59], v22 offset:31232
    s_waitcnt lgkmcnt(6)
    v_mfma_f32_16x16x32_bf16 v[140:143], v[44:47], v[112:115], v[140:143]
    ds_read_b64_tr_b16 v[60:61], v23 offset:29184
    v_mfma_f32_16x16x32_bf16 v[172:175], v[44:47], v[116:119], v[172:175]
    ds_read_b64_tr_b16 v[62:63], v23 offset:31232
    s_waitcnt lgkmcnt(6)
    v_mfma_f32_16x16x32_bf16 v[144:147], v[48:51], v[112:115], v[144:147]
    ds_read_b64_tr_b16 v[44:45], v22 offset:45056
    v_mfma_f32_16x16x32_bf16 v[176:179], v[48:51], v[116:119], v[176:179]
    ds_read_b64_tr_b16 v[46:47], v22 offset:47104
    s_waitcnt lgkmcnt(6)
    v_mfma_f32_16x16x32_bf16 v[148:151], v[52:55], v[112:115], v[148:151]
    ds_read_b64_tr_b16 v[48:49], v23 offset:45056
    v_mfma_f32_16x16x32_bf16 v[180:183], v[52:55], v[116:119], v[180:183]
    ds_read_b64_tr_b16 v[50:51], v23 offset:47104
    s_waitcnt lgkmcnt(6)
    v_mfma_f32_16x16x32_bf16 v[152:155], v[56:59], v[112:115], v[152:155]
    ds_read_b64_tr_b16 v[52:53], v22 offset:45568
    v_mfma_f32_16x16x32_bf16 v[184:187], v[56:59], v[116:119], v[184:187]
    ds_read_b64_tr_b16 v[54:55], v22 offset:47616
    s_waitcnt lgkmcnt(6)
    v_mfma_f32_16x16x32_bf16 v[156:159], v[60:63], v[112:115], v[156:159]
    ds_read_b64_tr_b16 v[56:57], v23 offset:45568
    v_mfma_f32_16x16x32_bf16 v[188:191], v[60:63], v[116:119], v[188:191]
    ds_read_b64_tr_b16 v[58:59], v23 offset:47616
    s_waitcnt lgkmcnt(6)
    v_mfma_f32_16x16x32_bf16 v[192:195], v[44:47], v[120:123], v[192:195]
    ds_read_b64_tr_b16 v[60:61], v22 offset:36864
    v_mfma_f32_16x16x32_bf16 v[208:211], v[44:47], v[124:127], v[208:211]
    ds_read_b64_tr_b16 v[62:63], v22 offset:38912
    buffer_load_dwordx4 v[96:99], v1, s[12:15], s33 offen offset:0 sc1
    s_waitcnt lgkmcnt(6)
    v_mfma_f32_16x16x32_bf16 v[196:199], v[48:51], v[120:123], v[196:199]
    ds_read_b64_tr_b16 v[44:45], v23 offset:36864
    v_mfma_f32_16x16x32_bf16 v[212:215], v[48:51], v[124:127], v[212:215]
    ds_read_b64_tr_b16 v[46:47], v23 offset:38912
    buffer_load_dwordx4 v[100:103], v1, s[12:15], s34 offen offset:0 sc1
    s_waitcnt lgkmcnt(6)
    v_mfma_f32_16x16x32_bf16 v[200:203], v[52:55], v[120:123], v[200:203]
    ds_read_b64_tr_b16 v[48:49], v22 offset:37376
    v_mfma_f32_16x16x32_bf16 v[216:219], v[52:55], v[124:127], v[216:219]
    ds_read_b64_tr_b16 v[50:51], v22 offset:39424
    s_waitcnt lgkmcnt(6)
    v_mfma_f32_16x16x32_bf16 v[204:207], v[56:59], v[120:123], v[204:207]
    ds_read_b64_tr_b16 v[52:53], v23 offset:37376
    v_mfma_f32_16x16x32_bf16 v[220:223], v[56:59], v[124:127], v[220:223]
    ds_read_b64_tr_b16 v[54:55], v23 offset:39424
    s_waitcnt lgkmcnt(6)
    v_mfma_f32_16x16x32_bf16 v[128:131], v[60:63], v[120:123], v[128:131]
    ds_read_b64_tr_b16 v[56:57], v22 offset:40960
    v_mfma_f32_16x16x32_bf16 v[160:163], v[60:63], v[124:127], v[160:163]
    ds_read_b64_tr_b16 v[58:59], v22 offset:43008
    s_waitcnt lgkmcnt(6)
    v_mfma_f32_16x16x32_bf16 v[132:135], v[44:47], v[120:123], v[132:135]
    ds_read_b64_tr_b16 v[60:61], v23 offset:40960
    v_mfma_f32_16x16x32_bf16 v[164:167], v[44:47], v[124:127], v[164:167]
    ds_read_b64_tr_b16 v[62:63], v23 offset:43008
    s_waitcnt lgkmcnt(6)
    v_mfma_f32_16x16x32_bf16 v[136:139], v[48:51], v[120:123], v[136:139]
    ds_read_b64_tr_b16 v[44:45], v22 offset:41472
    v_mfma_f32_16x16x32_bf16 v[168:171], v[48:51], v[124:127], v[168:171]
    ds_read_b64_tr_b16 v[46:47], v22 offset:43520
    s_lshl_b32 s39, s21, 3
    s_add_u32 s39, s39, s22
    v_lshrrev_b32 v19, 4, v1
    v_mul_u32_u24 v19, 1280, v19
    s_mov_b32 s38, s90
    s_bfm_b64 exec, 16, 0
    buffer_load_dword v3, v19, s[84:87], s38 offen
    s_mov_b64 exec, -1
    s_waitcnt lgkmcnt(6)
    v_mfma_f32_16x16x32_bf16 v[140:143], v[52:55], v[120:123], v[140:143]
    ds_read_b64_tr_b16 v[48:49], v23 offset:41472
    v_mfma_f32_16x16x32_bf16 v[172:175], v[52:55], v[124:127], v[172:175]
    ds_read_b64_tr_b16 v[50:51], v23 offset:43520
    s_barrier
    s_waitcnt lgkmcnt(6)
    v_mfma_f32_16x16x32_bf16 v[144:147], v[56:59], v[120:123], v[144:147]
    ds_read_b64_tr_b16 v[52:53], v24 offset:8192
    v_mfma_f32_16x16x32_bf16 v[176:179], v[56:59], v[124:127], v[176:179]
    ds_read_b64_tr_b16 v[54:55], v24 offset:10240
    s_add_u32 m0, s59, 49152
    s_add_u32 s38, s58, 4194304
    buffer_load_dwordx4 v10, s[60:63], s38 offen lds
    s_waitcnt lgkmcnt(6)
    v_mfma_f32_16x16x32_bf16 v[148:151], v[60:63], v[120:123], v[148:151]
    ds_read_b64_tr_b16 v[56:57], v25 offset:8192
    v_mfma_f32_16x16x32_bf16 v[180:183], v[60:63], v[124:127], v[180:183]
    ds_read_b64_tr_b16 v[58:59], v25 offset:10240
    buffer_load_dwordx4 v11, s[60:63], s38 offen offset:1024 lds
    s_waitcnt lgkmcnt(6)
    v_mfma_f32_16x16x32_bf16 v[152:155], v[44:47], v[120:123], v[152:155]
    ds_read_b64_tr_b16 v[60:61], v24 offset:8704
    v_mfma_f32_16x16x32_bf16 v[184:187], v[44:47], v[124:127], v[184:187]
    ds_read_b64_tr_b16 v[62:63], v24 offset:10752
    s_add_u32 m0, s69, 57344
    s_add_u32 s38, s68, 1769472
    buffer_load_dwordx4 v12, s[64:67], s38 offen lds
    s_waitcnt lgkmcnt(6)
    v_mfma_f32_16x16x32_bf16 v[156:159], v[48:51], v[120:123], v[156:159]
    ds_read_b64_tr_b16 v[44:45], v25 offset:8704
    v_mfma_f32_16x16x32_bf16 v[188:191], v[48:51], v[124:127], v[188:191]
    ds_read_b64_tr_b16 v[46:47], v25 offset:10752
    s_waitcnt lgkmcnt(6)
    v_mfma_f32_16x16x32_bf16 v[192:195], v[52:55], v[64:67], v[192:195]
    ds_read_b64_tr_b16 v[48:49], v24 offset:0
    v_mfma_f32_16x16x32_bf16 v[208:211], v[52:55], v[68:71], v[208:211]
    ds_read_b64_tr_b16 v[50:51], v24 offset:2048
    buffer_load_dwordx4 v[104:107], v1, s[12:15], s33 offen offset:1024 sc1
    s_waitcnt lgkmcnt(6)
    v_mfma_f32_16x16x32_bf16 v[196:199], v[56:59], v[64:67], v[196:199]
    ds_read_b64_tr_b16 v[52:53], v25 offset:0
    v_mfma_f32_16x16x32_bf16 v[212:215], v[56:59], v[68:71], v[212:215]
    ds_read_b64_tr_b16 v[54:55], v25 offset:2048
    buffer_load_dwordx4 v[108:111], v1, s[12:15], s34 offen offset:1024 sc1
    s_waitcnt lgkmcnt(6)
    v_mfma_f32_16x16x32_bf16 v[200:203], v[60:63], v[64:67], v[200:203]
    ds_read_b64_tr_b16 v[56:57], v24 offset:512
    v_mfma_f32_16x16x32_bf16 v[216:219], v[60:63], v[68:71], v[216:219]
    ds_read_b64_tr_b16 v[58:59], v24 offset:2560
    s_waitcnt lgkmcnt(6)
    v_mfma_f32_16x16x32_bf16 v[204:207], v[44:47], v[64:67], v[204:207]
    ds_read_b64_tr_b16 v[60:61], v25 offset:512
    v_mfma_f32_16x16x32_bf16 v[220:223], v[44:47], v[68:71], v[220:223]
    ds_read_b64_tr_b16 v[62:63], v25 offset:2560
    s_waitcnt lgkmcnt(6)
    v_mfma_f32_16x16x32_bf16 v[128:131], v[48:51], v[64:67], v[128:131]
    ds_read_b64_tr_b16 v[44:45], v24 offset:4096
    v_mfma_f32_16x16x32_bf16 v[160:163], v[48:51], v[68:71], v[160:163]
    ds_read_b64_tr_b16 v[46:47], v24 offset:6144
    s_waitcnt lgkmcnt(6)
    v_mfma_f32_16x16x32_bf16 v[132:135], v[52:55], v[64:67], v[132:135]
    ds_read_b64_tr_b16 v[48:49], v25 offset:4096
    v_mfma_f32_16x16x32_bf16 v[164:167], v[52:55], v[68:71], v[164:167]
    ds_read_b64_tr_b16 v[50:51], v25 offset:6144
    s_waitcnt lgkmcnt(6)
    v_mfma_f32_16x16x32_bf16 v[136:139], v[56:59], v[64:67], v[136:139]
    ds_read_b64_tr_b16 v[52:53], v24 offset:4608
    v_mfma_f32_16x16x32_bf16 v[168:171], v[56:59], v[68:71], v[168:171]
    ds_read_b64_tr_b16 v[54:55], v24 offset:6656
    s_waitcnt lgkmcnt(6)
    v_mfma_f32_16x16x32_bf16 v[140:143], v[60:63], v[64:67], v[140:143]
    ds_read_b64_tr_b16 v[56:57], v25 offset:4608
    v_mfma_f32_16x16x32_bf16 v[172:175], v[60:63], v[68:71], v[172:175]
    ds_read_b64_tr_b16 v[58:59], v25 offset:6656
    s_waitcnt lgkmcnt(6)
    v_mfma_f32_16x16x32_bf16 v[144:147], v[44:47], v[64:67], v[144:147]
    ds_read_b64_tr_b16 v[60:61], v24 offset:20480
    v_mfma_f32_16x16x32_bf16 v[176:179], v[44:47], v[68:71], v[176:179]
    ds_read_b64_tr_b16 v[62:63], v24 offset:22528
    s_waitcnt lgkmcnt(6)
    v_mfma_f32_16x16x32_bf16 v[148:151], v[48:51], v[64:67], v[148:151]
    ds_read_b64_tr_b16 v[44:45], v25 offset:20480
    v_mfma_f32_16x16x32_bf16 v[180:183], v[48:51], v[68:71], v[180:183]
    ds_read_b64_tr_b16 v[46:47], v25 offset:22528
    s_waitcnt lgkmcnt(6)
    v_mfma_f32_16x16x32_bf16 v[152:155], v[52:55], v[64:67], v[152:155]
    ds_read_b64_tr_b16 v[48:49], v24 offset:20992
    v_mfma_f32_16x16x32_bf16 v[184:187], v[52:55], v[68:71], v[184:187]
    ds_read_b64_tr_b16 v[50:51], v24 offset:23040
    s_waitcnt lgkmcnt(6)
    v_mfma_f32_16x16x32_bf16 v[156:159], v[56:59], v[64:67], v[156:159]
    ds_read_b64_tr_b16 v[52:53], v25 offset:20992
    v_mfma_f32_16x16x32_bf16 v[188:191], v[56:59], v[68:71], v[188:191]
    ds_read_b64_tr_b16 v[54:55], v25 offset:23040
    s_waitcnt vmcnt(15)
    s_waitcnt lgkmcnt(6)
    v_mfma_f32_16x16x32_bf16 v[192:195], v[60:63], v[72:75], v[192:195]
    ds_read_b64_tr_b16 v[56:57], v24 offset:12288
    v_mfma_f32_16x16x32_bf16 v[208:211], v[60:63], v[76:79], v[208:211]
    ds_read_b64_tr_b16 v[58:59], v24 offset:14336
    buffer_load_dwordx4 v[112:115], v1, s[12:15], s33 offen offset:2048 sc1
    s_waitcnt lgkmcnt(6)
    v_mfma_f32_16x16x32_bf16 v[196:199], v[44:47], v[72:75], v[196:199]
    ds_read_b64_tr_b16 v[60:61], v25 offset:12288
    v_mfma_f32_16x16x32_bf16 v[212:215], v[44:47], v[76:79], v[212:215]
    ds_read_b64_tr_b16 v[62:63], v25 offset:14336
    buffer_load_dwordx4 v[116:119], v1, s[12:15], s34 offen offset:2048 sc1
    s_waitcnt lgkmcnt(6)
    v_mfma_f32_16x16x32_bf16 v[200:203], v[48:51], v[72:75], v[200:203]
    ds_read_b64_tr_b16 v[44:45], v24 offset:12800
    v_mfma_f32_16x16x32_bf16 v[216:219], v[48:51], v[76:79], v[216:219]
    ds_read_b64_tr_b16 v[46:47], v24 offset:14848
    s_waitcnt lgkmcnt(6)
    v_mfma_f32_16x16x32_bf16 v[204:207], v[52:55], v[72:75], v[204:207]
    ds_read_b64_tr_b16 v[48:49], v25 offset:12800
    v_mfma_f32_16x16x32_bf16 v[220:223], v[52:55], v[76:79], v[220:223]
    ds_read_b64_tr_b16 v[50:51], v25 offset:14848
    s_waitcnt lgkmcnt(6)
    v_mfma_f32_16x16x32_bf16 v[128:131], v[56:59], v[72:75], v[128:131]
    ds_read_b64_tr_b16 v[52:53], v24 offset:16384
    v_mfma_f32_16x16x32_bf16 v[160:163], v[56:59], v[76:79], v[160:163]
    ds_read_b64_tr_b16 v[54:55], v24 offset:18432
    s_waitcnt lgkmcnt(6)
    v_mfma_f32_16x16x32_bf16 v[132:135], v[60:63], v[72:75], v[132:135]
    ds_read_b64_tr_b16 v[56:57], v25 offset:16384
    v_mfma_f32_16x16x32_bf16 v[164:167], v[60:63], v[76:79], v[164:167]
    ds_read_b64_tr_b16 v[58:59], v25 offset:18432
    s_waitcnt lgkmcnt(6)
    v_mfma_f32_16x16x32_bf16 v[136:139], v[44:47], v[72:75], v[136:139]
    ds_read_b64_tr_b16 v[60:61], v24 offset:16896
    v_mfma_f32_16x16x32_bf16 v[168:171], v[44:47], v[76:79], v[168:171]
    ds_read_b64_tr_b16 v[62:63], v24 offset:18944
    s_waitcnt lgkmcnt(6)
    v_mfma_f32_16x16x32_bf16 v[140:143], v[48:51], v[72:75], v[140:143]
    ds_read_b64_tr_b16 v[44:45], v25 offset:16896
    v_mfma_f32_16x16x32_bf16 v[172:175], v[48:51], v[76:79], v[172:175]
    ds_read_b64_tr_b16 v[46:47], v25 offset:18944
    s_barrier
    s_waitcnt lgkmcnt(6)
    v_mfma_f32_16x16x32_bf16 v[144:147], v[52:55], v[72:75], v[144:147]
    ds_read_b64_tr_b16 v[48:49], v24 offset:32768
    v_mfma_f32_16x16x32_bf16 v[176:179], v[52:55], v[76:79], v[176:179]
    ds_read_b64_tr_b16 v[50:51], v24 offset:34816
    s_add_u32 m0, s59, 73728
    s_add_u32 s38, s58, 4718592
    buffer_load_dwordx4 v10, s[60:63], s38 offen lds
    s_waitcnt lgkmcnt(6)
    v_mfma_f32_16x16x32_bf16 v[148:151], v[56:59], v[72:75], v[148:151]
    ds_read_b64_tr_b16 v[52:53], v25 offset:32768
    v_mfma_f32_16x16x32_bf16 v[180:183], v[56:59], v[76:79], v[180:183]
    ds_read_b64_tr_b16 v[54:55], v25 offset:34816
    buffer_load_dwordx4 v11, s[60:63], s38 offen offset:1024 lds
    s_waitcnt lgkmcnt(6)
    v_mfma_f32_16x16x32_bf16 v[152:155], v[60:63], v[72:75], v[152:155]
    ds_read_b64_tr_b16 v[56:57], v24 offset:33280
    v_mfma_f32_16x16x32_bf16 v[184:187], v[60:63], v[76:79], v[184:187]
    ds_read_b64_tr_b16 v[58:59], v24 offset:35328
    s_add_u32 m0, s69, 81920
    s_add_u32 s38, s68, 1990656
    buffer_load_dwordx4 v12, s[64:67], s38 offen lds
    s_waitcnt lgkmcnt(6)
    v_mfma_f32_16x16x32_bf16 v[156:159], v[44:47], v[72:75], v[156:159]
    ds_read_b64_tr_b16 v[60:61], v25 offset:33280
    v_mfma_f32_16x16x32_bf16 v[188:191], v[44:47], v[76:79], v[188:191]
    ds_read_b64_tr_b16 v[62:63], v25 offset:35328
    s_waitcnt vmcnt(18)
    s_waitcnt lgkmcnt(6)
    v_mfma_f32_16x16x32_bf16 v[192:195], v[48:51], v[80:83], v[192:195]
    ds_read_b64_tr_b16 v[44:45], v24 offset:24576
    v_mfma_f32_16x16x32_bf16 v[208:211], v[48:51], v[84:87], v[208:211]
    ds_read_b64_tr_b16 v[46:47], v24 offset:26624
    s_lshl_b32 s39, s21, 3
    s_add_u32 s39, s39, s22
    v_lshrrev_b32 v19, 4, v1
    v_mul_u32_u24 v19, 1280, v19
    s_mov_b32 s38, s90
    s_bfm_b64 exec, 16, 16
    buffer_load_dword v3, v19, s[84:87], s38 offen
    s_mov_b64 exec, -1
    buffer_load_dwordx4 v[120:123], v1, s[12:15], s33 offen offset:3072 sc1
    s_add_u32 s33, s33, 4096
    s_waitcnt lgkmcnt(6)
    v_mfma_f32_16x16x32_bf16 v[196:199], v[52:55], v[80:83], v[196:199]
    ds_read_b64_tr_b16 v[48:49], v25 offset:24576
    v_mfma_f32_16x16x32_bf16 v[212:215], v[52:55], v[84:87], v[212:215]
    ds_read_b64_tr_b16 v[50:51], v25 offset:26624
    buffer_load_dwordx4 v[124:127], v1, s[12:15], s34 offen offset:3072 sc1
    s_add_u32 s34, s34, 4096
    s_waitcnt lgkmcnt(6)
    v_mfma_f32_16x16x32_bf16 v[200:203], v[56:59], v[80:83], v[200:203]
    ds_read_b64_tr_b16 v[52:53], v24 offset:25088
    v_mfma_f32_16x16x32_bf16 v[216:219], v[56:59], v[84:87], v[216:219]
    ds_read_b64_tr_b16 v[54:55], v24 offset:27136
    s_waitcnt lgkmcnt(6)
    v_mfma_f32_16x16x32_bf16 v[204:207], v[60:63], v[80:83], v[204:207]
    ds_read_b64_tr_b16 v[56:57], v25 offset:25088
    v_mfma_f32_16x16x32_bf16 v[220:223], v[60:63], v[84:87], v[220:223]
    ds_read_b64_tr_b16 v[58:59], v25 offset:27136
    s_waitcnt lgkmcnt(6)
    v_mfma_f32_16x16x32_bf16 v[128:131], v[44:47], v[80:83], v[128:131]
    ds_read_b64_tr_b16 v[60:61], v24 offset:28672
    v_mfma_f32_16x16x32_bf16 v[160:163], v[44:47], v[84:87], v[160:163]
    ds_read_b64_tr_b16 v[62:63], v24 offset:30720
    s_waitcnt lgkmcnt(6)
    v_mfma_f32_16x16x32_bf16 v[132:135], v[48:51], v[80:83], v[132:135]
    ds_read_b64_tr_b16 v[44:45], v25 offset:28672
    v_mfma_f32_16x16x32_bf16 v[164:167], v[48:51], v[84:87], v[164:167]
    ds_read_b64_tr_b16 v[46:47], v25 offset:30720
    s_waitcnt lgkmcnt(6)
    v_mfma_f32_16x16x32_bf16 v[136:139], v[52:55], v[80:83], v[136:139]
    ds_read_b64_tr_b16 v[48:49], v24 offset:29184
    v_mfma_f32_16x16x32_bf16 v[168:171], v[52:55], v[84:87], v[168:171]
    ds_read_b64_tr_b16 v[50:51], v24 offset:31232
    s_waitcnt lgkmcnt(6)
    v_mfma_f32_16x16x32_bf16 v[140:143], v[56:59], v[80:83], v[140:143]
    ds_read_b64_tr_b16 v[52:53], v25 offset:29184
    v_mfma_f32_16x16x32_bf16 v[172:175], v[56:59], v[84:87], v[172:175]
    ds_read_b64_tr_b16 v[54:55], v25 offset:31232
    s_waitcnt lgkmcnt(6)
    v_mfma_f32_16x16x32_bf16 v[144:147], v[60:63], v[80:83], v[144:147]
    ds_read_b64_tr_b16 v[56:57], v24 offset:45056
    v_mfma_f32_16x16x32_bf16 v[176:179], v[60:63], v[84:87], v[176:179]
    ds_read_b64_tr_b16 v[58:59], v24 offset:47104
    s_waitcnt lgkmcnt(6)
    v_mfma_f32_16x16x32_bf16 v[148:151], v[44:47], v[80:83], v[148:151]
    ds_read_b64_tr_b16 v[60:61], v25 offset:45056
    v_mfma_f32_16x16x32_bf16 v[180:183], v[44:47], v[84:87], v[180:183]
    ds_read_b64_tr_b16 v[62:63], v25 offset:47104
    s_waitcnt lgkmcnt(6)
    v_mfma_f32_16x16x32_bf16 v[152:155], v[48:51], v[80:83], v[152:155]
    ds_read_b64_tr_b16 v[44:45], v24 offset:45568
    v_mfma_f32_16x16x32_bf16 v[184:187], v[48:51], v[84:87], v[184:187]
    ds_read_b64_tr_b16 v[46:47], v24 offset:47616
    s_waitcnt lgkmcnt(6)
    v_mfma_f32_16x16x32_bf16 v[156:159], v[52:55], v[80:83], v[156:159]
    ds_read_b64_tr_b16 v[48:49], v25 offset:45568
    v_mfma_f32_16x16x32_bf16 v[188:191], v[52:55], v[84:87], v[188:191]
    ds_read_b64_tr_b16 v[50:51], v25 offset:47616
    s_waitcnt vmcnt(16)
    s_waitcnt lgkmcnt(6)
    v_mfma_f32_16x16x32_bf16 v[192:195], v[56:59], v[88:91], v[192:195]
    ds_read_b64_tr_b16 v[52:53], v24 offset:36864
    v_mfma_f32_16x16x32_bf16 v[208:211], v[56:59], v[92:95], v[208:211]
    ds_read_b64_tr_b16 v[54:55], v24 offset:38912
    buffer_load_dwordx4 v[64:67], v1, s[12:15], s33 offen offset:0 sc1
    s_waitcnt lgkmcnt(6)
    v_mfma_f32_16x16x32_bf16 v[196:199], v[60:63], v[88:91], v[196:199]
    ds_read_b64_tr_b16 v[56:57], v25 offset:36864
    v_mfma_f32_16x16x32_bf16 v[212:215], v[60:63], v[92:95], v[212:215]
    ds_read_b64_tr_b16 v[58:59], v25 offset:38912
    buffer_load_dwordx4 v[68:71], v1, s[12:15], s34 offen offset:0 sc1
    s_waitcnt lgkmcnt(6)
    v_mfma_f32_16x16x32_bf16 v[200:203], v[44:47], v[88:91], v[200:203]
    ds_read_b64_tr_b16 v[60:61], v24 offset:37376
    v_mfma_f32_16x16x32_bf16 v[216:219], v[44:47], v[92:95], v[216:219]
    ds_read_b64_tr_b16 v[62:63], v24 offset:39424
    s_waitcnt lgkmcnt(6)
    v_mfma_f32_16x16x32_bf16 v[204:207], v[48:51], v[88:91], v[204:207]
    ds_read_b64_tr_b16 v[44:45], v25 offset:37376
    v_mfma_f32_16x16x32_bf16 v[220:223], v[48:51], v[92:95], v[220:223]
    ds_read_b64_tr_b16 v[46:47], v25 offset:39424
    s_waitcnt lgkmcnt(6)
    v_mfma_f32_16x16x32_bf16 v[128:131], v[52:55], v[88:91], v[128:131]
    ds_read_b64_tr_b16 v[48:49], v24 offset:40960
    v_mfma_f32_16x16x32_bf16 v[160:163], v[52:55], v[92:95], v[160:163]
    ds_read_b64_tr_b16 v[50:51], v24 offset:43008
    s_waitcnt lgkmcnt(6)
    v_mfma_f32_16x16x32_bf16 v[132:135], v[56:59], v[88:91], v[132:135]
    ds_read_b64_tr_b16 v[52:53], v25 offset:40960
    v_mfma_f32_16x16x32_bf16 v[164:167], v[56:59], v[92:95], v[164:167]
    ds_read_b64_tr_b16 v[54:55], v25 offset:43008
    s_waitcnt lgkmcnt(6)
    v_mfma_f32_16x16x32_bf16 v[136:139], v[60:63], v[88:91], v[136:139]
    ds_read_b64_tr_b16 v[56:57], v24 offset:41472
    v_mfma_f32_16x16x32_bf16 v[168:171], v[60:63], v[92:95], v[168:171]
    ds_read_b64_tr_b16 v[58:59], v24 offset:43520
    s_waitcnt lgkmcnt(6)
    v_mfma_f32_16x16x32_bf16 v[140:143], v[44:47], v[88:91], v[140:143]
    ds_read_b64_tr_b16 v[60:61], v25 offset:41472
    v_mfma_f32_16x16x32_bf16 v[172:175], v[44:47], v[92:95], v[172:175]
    ds_read_b64_tr_b16 v[62:63], v25 offset:43520
    s_barrier
    s_waitcnt lgkmcnt(6)
    v_mfma_f32_16x16x32_bf16 v[144:147], v[48:51], v[88:91], v[144:147]
    ds_read_b64_tr_b16 v[44:45], v20 offset:8192
    v_mfma_f32_16x16x32_bf16 v[176:179], v[48:51], v[92:95], v[176:179]
    ds_read_b64_tr_b16 v[46:47], v20 offset:10240
    s_waitcnt lgkmcnt(6)
    v_mfma_f32_16x16x32_bf16 v[148:151], v[52:55], v[88:91], v[148:151]
    ds_read_b64_tr_b16 v[48:49], v21 offset:8192
    v_mfma_f32_16x16x32_bf16 v[180:183], v[52:55], v[92:95], v[180:183]
    ds_read_b64_tr_b16 v[50:51], v21 offset:10240
    s_waitcnt lgkmcnt(6)
    v_mfma_f32_16x16x32_bf16 v[152:155], v[56:59], v[88:91], v[152:155]
    ds_read_b64_tr_b16 v[52:53], v20 offset:8704
    v_mfma_f32_16x16x32_bf16 v[184:187], v[56:59], v[92:95], v[184:187]
    ds_read_b64_tr_b16 v[54:55], v20 offset:10752
    s_waitcnt lgkmcnt(6)
    v_mfma_f32_16x16x32_bf16 v[156:159], v[60:63], v[88:91], v[156:159]
    ds_read_b64_tr_b16 v[56:57], v21 offset:8704
    v_mfma_f32_16x16x32_bf16 v[188:191], v[60:63], v[92:95], v[188:191]
    ds_read_b64_tr_b16 v[58:59], v21 offset:10752
    s_waitcnt vmcnt(16)
    s_waitcnt lgkmcnt(6)
    v_mfma_f32_16x16x32_bf16 v[192:195], v[44:47], v[96:99], v[192:195]
    ds_read_b64_tr_b16 v[60:61], v20 offset:0
    v_mfma_f32_16x16x32_bf16 v[208:211], v[44:47], v[100:103], v[208:211]
    ds_read_b64_tr_b16 v[62:63], v20 offset:2048
    buffer_load_dwordx4 v[72:75], v1, s[12:15], s33 offen offset:1024 sc1
    s_waitcnt lgkmcnt(6)
    v_mfma_f32_16x16x32_bf16 v[196:199], v[48:51], v[96:99], v[196:199]
    ds_read_b64_tr_b16 v[44:45], v21 offset:0
    v_mfma_f32_16x16x32_bf16 v[212:215], v[48:51], v[100:103], v[212:215]
    ds_read_b64_tr_b16 v[46:47], v21 offset:2048
    buffer_load_dwordx4 v[76:79], v1, s[12:15], s34 offen offset:1024 sc1
    s_waitcnt lgkmcnt(6)
    v_mfma_f32_16x16x32_bf16 v[200:203], v[52:55], v[96:99], v[200:203]
    ds_read_b64_tr_b16 v[48:49], v20 offset:512
    v_mfma_f32_16x16x32_bf16 v[216:219], v[52:55], v[100:103], v[216:219]
    ds_read_b64_tr_b16 v[50:51], v20 offset:2560
    s_waitcnt lgkmcnt(6)
    v_mfma_f32_16x16x32_bf16 v[204:207], v[56:59], v[96:99], v[204:207]
    ds_read_b64_tr_b16 v[52:53], v21 offset:512
    v_mfma_f32_16x16x32_bf16 v[220:223], v[56:59], v[100:103], v[220:223]
    ds_read_b64_tr_b16 v[54:55], v21 offset:2560
    s_waitcnt lgkmcnt(6)
    v_mfma_f32_16x16x32_bf16 v[128:131], v[60:63], v[96:99], v[128:131]
    ds_read_b64_tr_b16 v[56:57], v20 offset:4096
    v_mfma_f32_16x16x32_bf16 v[160:163], v[60:63], v[100:103], v[160:163]
    ds_read_b64_tr_b16 v[58:59], v20 offset:6144
    s_waitcnt lgkmcnt(6)
    v_mfma_f32_16x16x32_bf16 v[132:135], v[44:47], v[96:99], v[132:135]
    ds_read_b64_tr_b16 v[60:61], v21 offset:4096
    v_mfma_f32_16x16x32_bf16 v[164:167], v[44:47], v[100:103], v[164:167]
    ds_read_b64_tr_b16 v[62:63], v21 offset:6144
    s_waitcnt lgkmcnt(6)
    v_mfma_f32_16x16x32_bf16 v[136:139], v[48:51], v[96:99], v[136:139]
    ds_read_b64_tr_b16 v[44:45], v20 offset:4608
    v_mfma_f32_16x16x32_bf16 v[168:171], v[48:51], v[100:103], v[168:171]
    ds_read_b64_tr_b16 v[46:47], v20 offset:6656
    s_waitcnt lgkmcnt(6)
    v_mfma_f32_16x16x32_bf16 v[140:143], v[52:55], v[96:99], v[140:143]
    ds_read_b64_tr_b16 v[48:49], v21 offset:4608
    v_mfma_f32_16x16x32_bf16 v[172:175], v[52:55], v[100:103], v[172:175]
    ds_read_b64_tr_b16 v[50:51], v21 offset:6656
    s_waitcnt lgkmcnt(6)
    v_mfma_f32_16x16x32_bf16 v[144:147], v[56:59], v[96:99], v[144:147]
    ds_read_b64_tr_b16 v[52:53], v20 offset:20480
    v_mfma_f32_16x16x32_bf16 v[176:179], v[56:59], v[100:103], v[176:179]
    ds_read_b64_tr_b16 v[54:55], v20 offset:22528
    s_waitcnt lgkmcnt(6)
    v_mfma_f32_16x16x32_bf16 v[148:151], v[60:63], v[96:99], v[148:151]
    ds_read_b64_tr_b16 v[56:57], v21 offset:20480
    v_mfma_f32_16x16x32_bf16 v[180:183], v[60:63], v[100:103], v[180:183]
    ds_read_b64_tr_b16 v[58:59], v21 offset:22528
    s_waitcnt lgkmcnt(6)
    v_mfma_f32_16x16x32_bf16 v[152:155], v[44:47], v[96:99], v[152:155]
    ds_read_b64_tr_b16 v[60:61], v20 offset:20992
    v_mfma_f32_16x16x32_bf16 v[184:187], v[44:47], v[100:103], v[184:187]
    ds_read_b64_tr_b16 v[62:63], v20 offset:23040
    s_waitcnt lgkmcnt(6)
    v_mfma_f32_16x16x32_bf16 v[156:159], v[48:51], v[96:99], v[156:159]
    ds_read_b64_tr_b16 v[44:45], v21 offset:20992
    v_mfma_f32_16x16x32_bf16 v[188:191], v[48:51], v[100:103], v[188:191]
    ds_read_b64_tr_b16 v[46:47], v21 offset:23040
    s_waitcnt vmcnt(12)
    s_waitcnt lgkmcnt(6)
    v_mfma_f32_16x16x32_bf16 v[192:195], v[52:55], v[104:107], v[192:195]
    ds_read_b64_tr_b16 v[48:49], v20 offset:12288
    v_mfma_f32_16x16x32_bf16 v[208:211], v[52:55], v[108:111], v[208:211]
    ds_read_b64_tr_b16 v[50:51], v20 offset:14336
    buffer_load_dwordx4 v[80:83], v1, s[12:15], s33 offen offset:2048 sc1
    s_waitcnt lgkmcnt(6)
    v_mfma_f32_16x16x32_bf16 v[196:199], v[56:59], v[104:107], v[196:199]
    ds_read_b64_tr_b16 v[52:53], v21 offset:12288
    v_mfma_f32_16x16x32_bf16 v[212:215], v[56:59], v[108:111], v[212:215]
    ds_read_b64_tr_b16 v[54:55], v21 offset:14336
    buffer_load_dwordx4 v[84:87], v1, s[12:15], s34 offen offset:2048 sc1
    s_waitcnt lgkmcnt(6)
    v_mfma_f32_16x16x32_bf16 v[200:203], v[60:63], v[104:107], v[200:203]
    ds_read_b64_tr_b16 v[56:57], v20 offset:12800
    v_mfma_f32_16x16x32_bf16 v[216:219], v[60:63], v[108:111], v[216:219]
    ds_read_b64_tr_b16 v[58:59], v20 offset:14848
    s_waitcnt lgkmcnt(6)
    v_mfma_f32_16x16x32_bf16 v[204:207], v[44:47], v[104:107], v[204:207]
    ds_read_b64_tr_b16 v[60:61], v21 offset:12800
    v_mfma_f32_16x16x32_bf16 v[220:223], v[44:47], v[108:111], v[220:223]
    ds_read_b64_tr_b16 v[62:63], v21 offset:14848
    s_waitcnt lgkmcnt(6)
    v_mfma_f32_16x16x32_bf16 v[128:131], v[48:51], v[104:107], v[128:131]
    ds_read_b64_tr_b16 v[44:45], v20 offset:16384
    v_mfma_f32_16x16x32_bf16 v[160:163], v[48:51], v[108:111], v[160:163]
    ds_read_b64_tr_b16 v[46:47], v20 offset:18432
    s_waitcnt lgkmcnt(6)
    v_mfma_f32_16x16x32_bf16 v[132:135], v[52:55], v[104:107], v[132:135]
    ds_read_b64_tr_b16 v[48:49], v21 offset:16384
    v_mfma_f32_16x16x32_bf16 v[164:167], v[52:55], v[108:111], v[164:167]
    ds_read_b64_tr_b16 v[50:51], v21 offset:18432
    s_waitcnt lgkmcnt(6)
    v_mfma_f32_16x16x32_bf16 v[136:139], v[56:59], v[104:107], v[136:139]
    ds_read_b64_tr_b16 v[52:53], v20 offset:16896
    v_mfma_f32_16x16x32_bf16 v[168:171], v[56:59], v[108:111], v[168:171]
    ds_read_b64_tr_b16 v[54:55], v20 offset:18944
    s_waitcnt lgkmcnt(6)
    v_mfma_f32_16x16x32_bf16 v[140:143], v[60:63], v[104:107], v[140:143]
    ds_read_b64_tr_b16 v[56:57], v21 offset:16896
    v_mfma_f32_16x16x32_bf16 v[172:175], v[60:63], v[108:111], v[172:175]
    ds_read_b64_tr_b16 v[58:59], v21 offset:18944
    s_barrier
    s_waitcnt lgkmcnt(6)
    v_mfma_f32_16x16x32_bf16 v[144:147], v[44:47], v[104:107], v[144:147]
    ds_read_b64_tr_b16 v[60:61], v20 offset:32768
    v_mfma_f32_16x16x32_bf16 v[176:179], v[44:47], v[108:111], v[176:179]
    ds_read_b64_tr_b16 v[62:63], v20 offset:34816
    s_waitcnt lgkmcnt(6)
    v_mfma_f32_16x16x32_bf16 v[148:151], v[48:51], v[104:107], v[148:151]
    ds_read_b64_tr_b16 v[44:45], v21 offset:32768
    v_mfma_f32_16x16x32_bf16 v[180:183], v[48:51], v[108:111], v[180:183]
    ds_read_b64_tr_b16 v[46:47], v21 offset:34816
    s_waitcnt lgkmcnt(6)
    v_mfma_f32_16x16x32_bf16 v[152:155], v[52:55], v[104:107], v[152:155]
    ds_read_b64_tr_b16 v[48:49], v20 offset:33280
    v_mfma_f32_16x16x32_bf16 v[184:187], v[52:55], v[108:111], v[184:187]
    ds_read_b64_tr_b16 v[50:51], v20 offset:35328
    s_waitcnt lgkmcnt(6)
    v_mfma_f32_16x16x32_bf16 v[156:159], v[56:59], v[104:107], v[156:159]
    ds_read_b64_tr_b16 v[52:53], v21 offset:33280
    v_mfma_f32_16x16x32_bf16 v[188:191], v[56:59], v[108:111], v[188:191]
    ds_read_b64_tr_b16 v[54:55], v21 offset:35328
    s_waitcnt vmcnt(12)
    s_waitcnt lgkmcnt(6)
    v_mfma_f32_16x16x32_bf16 v[192:195], v[60:63], v[112:115], v[192:195]
    ds_read_b64_tr_b16 v[56:57], v20 offset:24576
    v_mfma_f32_16x16x32_bf16 v[208:211], v[60:63], v[116:119], v[208:211]
    ds_read_b64_tr_b16 v[58:59], v20 offset:26624
    buffer_load_dwordx4 v[88:91], v1, s[12:15], s33 offen offset:3072 sc1
    s_add_u32 s33, s33, 4096
    s_waitcnt lgkmcnt(6)
    v_mfma_f32_16x16x32_bf16 v[196:199], v[44:47], v[112:115], v[196:199]
    ds_read_b64_tr_b16 v[60:61], v21 offset:24576
    v_mfma_f32_16x16x32_bf16 v[212:215], v[44:47], v[116:119], v[212:215]
    ds_read_b64_tr_b16 v[62:63], v21 offset:26624
    buffer_load_dwordx4 v[92:95], v1, s[12:15], s34 offen offset:3072 sc1
    s_add_u32 s34, s34, 4096
    s_waitcnt lgkmcnt(6)
    v_mfma_f32_16x16x32_bf16 v[200:203], v[48:51], v[112:115], v[200:203]
    ds_read_b64_tr_b16 v[44:45], v20 offset:25088
    v_mfma_f32_16x16x32_bf16 v[216:219], v[48:51], v[116:119], v[216:219]
    ds_read_b64_tr_b16 v[46:47], v20 offset:27136
    s_waitcnt lgkmcnt(6)
    v_mfma_f32_16x16x32_bf16 v[204:207], v[52:55], v[112:115], v[204:207]
    ds_read_b64_tr_b16 v[48:49], v21 offset:25088
    v_mfma_f32_16x16x32_bf16 v[220:223], v[52:55], v[116:119], v[220:223]
    ds_read_b64_tr_b16 v[50:51], v21 offset:27136
    s_waitcnt lgkmcnt(6)
    v_mfma_f32_16x16x32_bf16 v[128:131], v[56:59], v[112:115], v[128:131]
    ds_read_b64_tr_b16 v[52:53], v20 offset:28672
    v_mfma_f32_16x16x32_bf16 v[160:163], v[56:59], v[116:119], v[160:163]
    ds_read_b64_tr_b16 v[54:55], v20 offset:30720
    buffer_load_dword v3, v2, s[12:15], 0 offen sc1
    s_waitcnt lgkmcnt(6)
    v_mfma_f32_16x16x32_bf16 v[132:135], v[60:63], v[112:115], v[132:135]
    ds_read_b64_tr_b16 v[56:57], v21 offset:28672
    v_mfma_f32_16x16x32_bf16 v[164:167], v[60:63], v[116:119], v[164:167]
    ds_read_b64_tr_b16 v[58:59], v21 offset:30720
    s_waitcnt lgkmcnt(6)
    v_mfma_f32_16x16x32_bf16 v[136:139], v[44:47], v[112:115], v[136:139]
    ds_read_b64_tr_b16 v[60:61], v20 offset:29184
    v_mfma_f32_16x16x32_bf16 v[168:171], v[44:47], v[116:119], v[168:171]
    ds_read_b64_tr_b16 v[62:63], v20 offset:31232
    s_waitcnt lgkmcnt(6)
    v_mfma_f32_16x16x32_bf16 v[140:143], v[48:51], v[112:115], v[140:143]
    ds_read_b64_tr_b16 v[44:45], v21 offset:29184
    v_mfma_f32_16x16x32_bf16 v[172:175], v[48:51], v[116:119], v[172:175]
    ds_read_b64_tr_b16 v[46:47], v21 offset:31232
    s_waitcnt lgkmcnt(6)
    v_mfma_f32_16x16x32_bf16 v[144:147], v[52:55], v[112:115], v[144:147]
    ds_read_b64_tr_b16 v[48:49], v20 offset:45056
    v_mfma_f32_16x16x32_bf16 v[176:179], v[52:55], v[116:119], v[176:179]
    ds_read_b64_tr_b16 v[50:51], v20 offset:47104
    s_waitcnt lgkmcnt(6)
    v_mfma_f32_16x16x32_bf16 v[148:151], v[56:59], v[112:115], v[148:151]
    ds_read_b64_tr_b16 v[52:53], v21 offset:45056
    v_mfma_f32_16x16x32_bf16 v[180:183], v[56:59], v[116:119], v[180:183]
    ds_read_b64_tr_b16 v[54:55], v21 offset:47104
    s_waitcnt lgkmcnt(6)
    v_mfma_f32_16x16x32_bf16 v[152:155], v[60:63], v[112:115], v[152:155]
    ds_read_b64_tr_b16 v[56:57], v20 offset:45568
    v_mfma_f32_16x16x32_bf16 v[184:187], v[60:63], v[116:119], v[184:187]
    ds_read_b64_tr_b16 v[58:59], v20 offset:47616
    s_waitcnt lgkmcnt(6)
    v_mfma_f32_16x16x32_bf16 v[156:159], v[44:47], v[112:115], v[156:159]
    ds_read_b64_tr_b16 v[60:61], v21 offset:45568
    v_mfma_f32_16x16x32_bf16 v[188:191], v[44:47], v[116:119], v[188:191]
    ds_read_b64_tr_b16 v[62:63], v21 offset:47616
    s_waitcnt vmcnt(9)
    s_waitcnt lgkmcnt(6)
    v_mfma_f32_16x16x32_bf16 v[192:195], v[48:51], v[120:123], v[192:195]
    ds_read_b64_tr_b16 v[44:45], v20 offset:36864
    v_mfma_f32_16x16x32_bf16 v[208:211], v[48:51], v[124:127], v[208:211]
    ds_read_b64_tr_b16 v[46:47], v20 offset:38912
    s_waitcnt lgkmcnt(6)
    v_mfma_f32_16x16x32_bf16 v[196:199], v[52:55], v[120:123], v[196:199]
    ds_read_b64_tr_b16 v[48:49], v21 offset:36864
    v_mfma_f32_16x16x32_bf16 v[212:215], v[52:55], v[124:127], v[212:215]
    ds_read_b64_tr_b16 v[50:51], v21 offset:38912
    s_waitcnt lgkmcnt(6)
    v_mfma_f32_16x16x32_bf16 v[200:203], v[56:59], v[120:123], v[200:203]
    ds_read_b64_tr_b16 v[52:53], v20 offset:37376
    v_mfma_f32_16x16x32_bf16 v[216:219], v[56:59], v[124:127], v[216:219]
    ds_read_b64_tr_b16 v[54:55], v20 offset:39424
    s_waitcnt lgkmcnt(6)
    v_mfma_f32_16x16x32_bf16 v[204:207], v[60:63], v[120:123], v[204:207]
    ds_read_b64_tr_b16 v[56:57], v21 offset:37376
    v_mfma_f32_16x16x32_bf16 v[220:223], v[60:63], v[124:127], v[220:223]
    ds_read_b64_tr_b16 v[58:59], v21 offset:39424
    s_waitcnt lgkmcnt(6)
    v_mfma_f32_16x16x32_bf16 v[128:131], v[44:47], v[120:123], v[128:131]
    ds_read_b64_tr_b16 v[60:61], v20 offset:40960
    v_mfma_f32_16x16x32_bf16 v[160:163], v[44:47], v[124:127], v[160:163]
    ds_read_b64_tr_b16 v[62:63], v20 offset:43008
    s_waitcnt lgkmcnt(6)
    v_mfma_f32_16x16x32_bf16 v[132:135], v[48:51], v[120:123], v[132:135]
    ds_read_b64_tr_b16 v[44:45], v21 offset:40960
    v_mfma_f32_16x16x32_bf16 v[164:167], v[48:51], v[124:127], v[164:167]
    ds_read_b64_tr_b16 v[46:47], v21 offset:43008
    s_waitcnt lgkmcnt(6)
    v_mfma_f32_16x16x32_bf16 v[136:139], v[52:55], v[120:123], v[136:139]
    ds_read_b64_tr_b16 v[48:49], v20 offset:41472
    v_mfma_f32_16x16x32_bf16 v[168:171], v[52:55], v[124:127], v[168:171]
    ds_read_b64_tr_b16 v[50:51], v20 offset:43520
    s_waitcnt lgkmcnt(6)
    v_mfma_f32_16x16x32_bf16 v[140:143], v[56:59], v[120:123], v[140:143]
    ds_read_b64_tr_b16 v[52:53], v21 offset:41472
    v_mfma_f32_16x16x32_bf16 v[172:175], v[56:59], v[124:127], v[172:175]
    ds_read_b64_tr_b16 v[54:55], v21 offset:43520
    v_mov_b32 v18, 1
    s_add_u32 s39, s20, 32
    s_lshr_b32 s45, s35, 1
    s_cmp_le_u32 s22, s45
    s_cselect_b32 s39, s39, 0
    v_writelane_b32 v18, 2, s39
    s_waitcnt vmcnt(0)
    v_cmp_eq_u32 s[46:47], v3, v13
    v_and_b32 v19, 7, v3
    v_cmp_gt_u32 vcc, v18, v19
    s_nop 1
    s_or_b64 vcc, vcc, s[46:47]
    s_cmp_lg_u32 vcc_hi, 0
    s_cbranch_scc1 L_spin_5
L_spinback_6:
    s_barrier
    s_waitcnt lgkmcnt(6)
    v_mfma_f32_16x16x32_bf16 v[144:147], v[60:63], v[120:123], v[144:147]
    ds_read_b64_tr_b16 v[56:57], v22 offset:8192
    s_xor_b32 s38, s20, 0
    s_lshl_b32 s38, s38, 19
    v_mfma_f32_16x16x32_bf16 v[176:179], v[60:63], v[124:127], v[176:179]
    ds_read_b64_tr_b16 v[58:59], v22 offset:10240
    s_mov_b32 s4, s54
    s_mov_b32 s5, s55
    s_waitcnt lgkmcnt(6)
    v_mfma_f32_16x16x32_bf16 v[148:151], v[44:47], v[120:123], v[148:151]
    ds_read_b64_tr_b16 v[60:61], v23 offset:8192
    s_add_u32 s4, s4, s38
    s_addc_u32 s5, s5, 0
    v_mfma_f32_16x16x32_bf16 v[180:183], v[44:47], v[124:127], v[180:183]
    ds_read_b64_tr_b16 v[62:63], v23 offset:10240
    s_and_b32 s5, s5, 0xffff
    s_mov_b32 s6, 524288
    s_waitcnt lgkmcnt(6)
    v_mfma_f32_16x16x32_bf16 v[152:155], v[48:51], v[120:123], v[152:155]
    ds_read_b64_tr_b16 v[44:45], v22 offset:8704
    s_mov_b32 s7, 0x20000
    s_add_u32 s8, s54, 16777216
    s_addc_u32 s9, s55, 0
    v_mfma_f32_16x16x32_bf16 v[184:187], v[48:51], v[124:127], v[184:187]
    ds_read_b64_tr_b16 v[46:47], v22 offset:10752
    s_add_u32 s8, s8, s38
    s_addc_u32 s9, s9, 0
    s_waitcnt lgkmcnt(6)
    v_mfma_f32_16x16x32_bf16 v[156:159], v[52:55], v[120:123], v[156:159]
    ds_read_b64_tr_b16 v[48:49], v23 offset:8704
    s_and_b32 s9, s9, 0xffff
    s_mov_b32 s10, 524288
    v_mfma_f32_16x16x32_bf16 v[188:191], v[52:55], v[124:127], v[188:191]
    ds_read_b64_tr_b16 v[50:51], v23 offset:10752
    s_mov_b32 s11, 0x20000
    s_lshl_b32 s38, s24, 13
    s_waitcnt lgkmcnt(6)
    v_mfma_f32_16x16x32_bf16 v[192:195], v[56:59], v[64:67], v[192:195]
    ds_read_b64_tr_b16 v[52:53], v22 offset:0
    v_add_u32 v5, s38, v1
    s_mul_i32 s39, s24, 12288
    v_mfma_f32_16x16x32_bf16 v[208:211], v[56:59], v[68:71], v[208:211]
    ds_read_b64_tr_b16 v[54:55], v22 offset:2048
    s_add_u32 s39, s39, 49152
    v_add_u32 v6, s39, v1
    s_waitcnt lgkmcnt(6)
    v_mfma_f32_16x16x32_bf16 v[196:199], v[60:63], v[64:67], v[196:199]
    ds_read_b64_tr_b16 v[56:57], v23 offset:0
    s_lshl_b32 s39, s24, 12
    s_add_u32 s39, s39, 49152
    v_mfma_f32_16x16x32_bf16 v[212:215], v[60:63], v[68:71], v[212:215]
    ds_read_b64_tr_b16 v[58:59], v23 offset:2048
    v_add_u32 v7, s39, v1
    v_bfe_u32 v16, v1, 4, 4
    s_waitcnt lgkmcnt(6)
    v_mfma_f32_16x16x32_bf16 v[200:203], v[44:47], v[64:67], v[200:203]
    ds_read_b64_tr_b16 v[60:61], v22 offset:512
    v_lshrrev_b32 v18, 8, v1
    v_lshlrev_b32 v19, 2, v18
    v_mfma_f32_16x16x32_bf16 v[216:219], v[44:47], v[68:71], v[216:219]
    ds_read_b64_tr_b16 v[62:63], v22 offset:2560
    v_sub_u32 v8, v16, v19
    v_mov_b32 v9, 0xff800000
    s_waitcnt lgkmcnt(6)
    v_mfma_f32_16x16x32_bf16 v[204:207], v[48:51], v[64:67], v[204:207]
    ds_read_b64_tr_b16 v[44:45], v23 offset:512
    s_lshl_b32 s44, s23, 18
    s_add_u32 s44, s44, 33554432
    v_mfma_f32_16x16x32_bf16 v[220:223], v[48:51], v[68:71], v[220:223]
    ds_read_b64_tr_b16 v[46:47], v23 offset:2560
    s_lshl_b32 s38, s20, 12
    s_add_u32 s44, s44, s38
    s_waitcnt lgkmcnt(6)
    v_mfma_f32_16x16x32_bf16 v[128:131], v[52:55], v[64:67], v[128:131]
    ds_read_b64_tr_b16 v[48:49], v22 offset:4096
    s_lshl_b32 s38, s24, 11
    s_add_u32 s44, s44, s38
    v_mfma_f32_16x16x32_bf16 v[160:163], v[52:55], v[68:71], v[160:163]
    ds_read_b64_tr_b16 v[50:51], v22 offset:6144
    s_mov_b32 s37, 0x40004000
    s_lshl_b32 s40, s22, 11
    s_waitcnt lgkmcnt(6)
    v_mfma_f32_16x16x32_bf16 v[132:135], v[56:59], v[64:67], v[132:135]
    ds_read_b64_tr_b16 v[52:53], v23 offset:4096
    s_mov_b32 s25, s40
    s_mov_b32 s26, s40
    v_mfma_f32_16x16x32_bf16 v[164:167], v[56:59], v[68:71], v[164:167]
    ds_read_b64_tr_b16 v[54:55], v23 offset:6144
    s_lshl_b32 s38, s35, 15
    s_add_u32 s38, s38, 32768
    s_waitcnt lgkmcnt(6)
    v_mfma_f32_16x16x32_bf16 v[136:139], v[60:63], v[64:67], v[136:139]
    ds_read_b64_tr_b16 v[56:57], v22 offset:4608
    s_add_u32 s27, s38, s40
    s_mov_b32 s28, s27
    v_mfma_f32_16x16x32_bf16 v[168:171], v[60:63], v[68:71], v[168:171]
    ds_read_b64_tr_b16 v[58:59], v22 offset:6656
    s_add_u32 s56, s40, 0
    s_mov_b32 s29, s56
    s_waitcnt lgkmcnt(6)
    v_mfma_f32_16x16x32_bf16 v[140:143], v[44:47], v[64:67], v[140:143]
    ds_read_b64_tr_b16 v[60:61], v23 offset:4608
    s_add_u32 s41, s56, 49152
    s_add_u32 s57, s40, 49152
    v_mfma_f32_16x16x32_bf16 v[172:175], v[44:47], v[68:71], v[172:175]
    ds_read_b64_tr_b16 v[62:63], v23 offset:6656
    s_mov_b32 s30, 0
    s_mov_b32 s31, 32768
    s_waitcnt lgkmcnt(6)
    v_mfma_f32_16x16x32_bf16 v[144:147], v[48:51], v[64:67], v[144:147]
    ds_read_b64_tr_b16 v[44:45], v22 offset:20480
    s_mov_b32 s32, 49152
    s_mov_b32 s36, 0
    v_mfma_f32_16x16x32_bf16 v[176:179], v[48:51], v[68:71], v[176:179]
    ds_read_b64_tr_b16 v[46:47], v22 offset:22528
    s_lshl_b32 s43, s23, 13
    s_add_u32 s39, s43, 131072
    s_waitcnt lgkmcnt(6)
    v_mfma_f32_16x16x32_bf16 v[148:151], v[52:55], v[64:67], v[148:151]
    ds_read_b64_tr_b16 v[48:49], v23 offset:20480
    v_add_u32 v30, s39, v1
    s_add_u32 s43, s43, 98304
    v_mfma_f32_16x16x32_bf16 v[180:183], v[52:55], v[68:71], v[180:183]
    ds_read_b64_tr_b16 v[50:51], v23 offset:22528
    v_add_u32 v29, s43, v1
    s_cmp_eq_u32 s24, 0
    s_cselect_b32 s39, s43, s39
    s_waitcnt lgkmcnt(6)
    v_mfma_f32_16x16x32_bf16 v[152:155], v[56:59], v[64:67], v[152:155]
    ds_read_b64_tr_b16 v[52:53], v22 offset:20992
    v_add_u32 v27, s39, v1
    v_mfma_f32_16x16x32_bf16 v[184:187], v[56:59], v[68:71], v[184:187]
    ds_read_b64_tr_b16 v[54:55], v22 offset:23040
    s_waitcnt lgkmcnt(6)
    v_mfma_f32_16x16x32_bf16 v[156:159], v[60:63], v[64:67], v[156:159]
    ds_read_b64_tr_b16 v[56:57], v23 offset:20992
    v_mfma_f32_16x16x32_bf16 v[188:191], v[60:63], v[68:71], v[188:191]
    ds_read_b64_tr_b16 v[58:59], v23 offset:23040
    s_waitcnt lgkmcnt(6)
    v_mfma_f32_16x16x32_bf16 v[192:195], v[44:47], v[72:75], v[192:195]
    ds_read_b64_tr_b16 v[60:61], v22 offset:12288
    v_mfma_f32_16x16x32_bf16 v[208:211], v[44:47], v[76:79], v[208:211]
    ds_read_b64_tr_b16 v[62:63], v22 offset:14336
    s_waitcnt lgkmcnt(6)
    v_mfma_f32_16x16x32_bf16 v[196:199], v[48:51], v[72:75], v[196:199]
    ds_read_b64_tr_b16 v[44:45], v23 offset:12288
    v_mfma_f32_16x16x32_bf16 v[212:215], v[48:51], v[76:79], v[212:215]
    ds_read_b64_tr_b16 v[46:47], v23 offset:14336
    s_waitcnt lgkmcnt(6)
    v_mfma_f32_16x16x32_bf16 v[200:203], v[52:55], v[72:75], v[200:203]
    ds_read_b64_tr_b16 v[48:49], v22 offset:12800
    v_mfma_f32_16x16x32_bf16 v[216:219], v[52:55], v[76:79], v[216:219]
    ds_read_b64_tr_b16 v[50:51], v22 offset:14848
    s_waitcnt lgkmcnt(6)
    v_mfma_f32_16x16x32_bf16 v[204:207], v[56:59], v[72:75], v[204:207]
    ds_read_b64_tr_b16 v[52:53], v23 offset:12800
    v_mfma_f32_16x16x32_bf16 v[220:223], v[56:59], v[76:79], v[220:223]
    ds_read_b64_tr_b16 v[54:55], v23 offset:14848
    s_waitcnt lgkmcnt(6)
    v_mfma_f32_16x16x32_bf16 v[128:131], v[60:63], v[72:75], v[128:131]
    ds_read_b64_tr_b16 v[56:57], v22 offset:16384
    v_mfma_f32_16x16x32_bf16 v[160:163], v[60:63], v[76:79], v[160:163]
    ds_read_b64_tr_b16 v[58:59], v22 offset:18432
    s_waitcnt lgkmcnt(6)
    v_mfma_f32_16x16x32_bf16 v[132:135], v[44:47], v[72:75], v[132:135]
    ds_read_b64_tr_b16 v[60:61], v23 offset:16384
    v_mfma_f32_16x16x32_bf16 v[164:167], v[44:47], v[76:79], v[164:167]
    ds_read_b64_tr_b16 v[62:63], v23 offset:18432
    s_waitcnt lgkmcnt(6)
    v_mfma_f32_16x16x32_bf16 v[136:139], v[48:51], v[72:75], v[136:139]
    ds_read_b64_tr_b16 v[44:45], v22 offset:16896
    v_mfma_f32_16x16x32_bf16 v[168:171], v[48:51], v[76:79], v[168:171]
    ds_read_b64_tr_b16 v[46:47], v22 offset:18944
    s_waitcnt lgkmcnt(6)
    v_mfma_f32_16x16x32_bf16 v[140:143], v[52:55], v[72:75], v[140:143]
    ds_read_b64_tr_b16 v[48:49], v23 offset:16896
    v_mfma_f32_16x16x32_bf16 v[172:175], v[52:55], v[76:79], v[172:175]
    ds_read_b64_tr_b16 v[50:51], v23 offset:18944
    s_barrier
    s_waitcnt lgkmcnt(6)
    v_mfma_f32_16x16x32_bf16 v[144:147], v[56:59], v[72:75], v[144:147]
    ds_read_b64_tr_b16 v[52:53], v22 offset:32768
    v_mfma_f32_16x16x32_bf16 v[176:179], v[56:59], v[76:79], v[176:179]
    ds_read_b64_tr_b16 v[54:55], v22 offset:34816
    s_mov_b32 m0, s29
    s_add_u32 s29, s29, 16384
    buffer_load_dwordx4 v1, s[4:7], s25 offen sc1 lds
    s_waitcnt lgkmcnt(6)
    v_mfma_f32_16x16x32_bf16 v[148:151], v[60:63], v[72:75], v[148:151]
    ds_read_b64_tr_b16 v[56:57], v23 offset:32768
    v_mfma_f32_16x16x32_bf16 v[180:183], v[60:63], v[76:79], v[180:183]
    ds_read_b64_tr_b16 v[58:59], v23 offset:34816
    buffer_load_dwordx4 v1, s[4:7], s25 offen offset:1024 sc1 lds
    s_cmp_eq_u32 s29, s41
    s_cselect_b32 s29, s56, s29
    s_add_u32 s25, s25, 16384
    s_cmp_eq_u32 s25, s27
    s_cselect_b32 s25, s40, s25
    s_waitcnt lgkmcnt(6)
    v_mfma_f32_16x16x32_bf16 v[152:155], v[44:47], v[72:75], v[152:155]
    ds_read_b64_tr_b16 v[60:61], v22 offset:33280
    v_mfma_f32_16x16x32_bf16 v[184:187], v[44:47], v[76:79], v[184:187]
    ds_read_b64_tr_b16 v[62:63], v22 offset:35328
    s_mov_b32 m0, s29
    s_add_u32 s29, s29, 16384
    buffer_load_dwordx4 v1, s[4:7], s25 offen sc1 lds
    s_waitcnt lgkmcnt(6)
    v_mfma_f32_16x16x32_bf16 v[156:159], v[48:51], v[72:75], v[156:159]
    ds_read_b64_tr_b16 v[44:45], v23 offset:33280
    v_mfma_f32_16x16x32_bf16 v[188:191], v[48:51], v[76:79], v[188:191]
    ds_read_b64_tr_b16 v[46:47], v23 offset:35328
    buffer_load_dwordx4 v1, s[4:7], s25 offen offset:1024 sc1 lds
    s_cmp_eq_u32 s29, s41
    s_cselect_b32 s29, s56, s29
    s_add_u32 s25, s25, 16384
    s_cmp_eq_u32 s25, s27
    s_cselect_b32 s25, s40, s25
    s_waitcnt lgkmcnt(6)
    v_mfma_f32_16x16x32_bf16 v[192:195], v[52:55], v[80:83], v[192:195]
    ds_read_b64_tr_b16 v[48:49], v22 offset:24576
    v_mfma_f32_16x16x32_bf16 v[208:211], v[52:55], v[84:87], v[208:211]
    ds_read_b64_tr_b16 v[50:51], v22 offset:26624
    s_mov_b32 m0, s29
    s_add_u32 s29, s29, 16384
    buffer_load_dwordx4 v1, s[4:7], s25 offen sc1 lds
    s_waitcnt lgkmcnt(6)
    v_mfma_f32_16x16x32_bf16 v[196:199], v[56:59], v[80:83], v[196:199]
    ds_read_b64_tr_b16 v[52:53], v23 offset:24576
    v_mfma_f32_16x16x32_bf16 v[212:215], v[56:59], v[84:87], v[212:215]
    ds_read_b64_tr_b16 v[54:55], v23 offset:26624
    buffer_load_dwordx4 v1, s[4:7], s25 offen offset:1024 sc1 lds
    s_cmp_eq_u32 s29, s41
    s_cselect_b32 s29, s56, s29
    s_add_u32 s25, s25, 16384
    s_cmp_eq_u32 s25, s27
    s_cselect_b32 s25, s40, s25
    s_waitcnt lgkmcnt(6)
    v_mfma_f32_16x16x32_bf16 v[200:203], v[60:63], v[80:83], v[200:203]
    ds_read_b64_tr_b16 v[56:57], v22 offset:25088
    v_mfma_f32_16x16x32_bf16 v[216:219], v[60:63], v[84:87], v[216:219]
    ds_read_b64_tr_b16 v[58:59], v22 offset:27136
    s_waitcnt lgkmcnt(6)
    v_mfma_f32_16x16x32_bf16 v[204:207], v[44:47], v[80:83], v[204:207]
    ds_read_b64_tr_b16 v[60:61], v23 offset:25088
    v_mfma_f32_16x16x32_bf16 v[220:223], v[44:47], v[84:87], v[220:223]
    ds_read_b64_tr_b16 v[62:63], v23 offset:27136
    s_waitcnt lgkmcnt(6)
    v_mfma_f32_16x16x32_bf16 v[128:131], v[48:51], v[80:83], v[128:131]
    ds_read_b64_tr_b16 v[44:45], v22 offset:28672
    v_mfma_f32_16x16x32_bf16 v[160:163], v[48:51], v[84:87], v[160:163]
    ds_read_b64_tr_b16 v[46:47], v22 offset:30720
    s_waitcnt lgkmcnt(6)
    v_mfma_f32_16x16x32_bf16 v[132:135], v[52:55], v[80:83], v[132:135]
    ds_read_b64_tr_b16 v[48:49], v23 offset:28672
    v_mfma_f32_16x16x32_bf16 v[164:167], v[52:55], v[84:87], v[164:167]
    ds_read_b64_tr_b16 v[50:51], v23 offset:30720
    s_waitcnt lgkmcnt(6)
    v_mfma_f32_16x16x32_bf16 v[136:139], v[56:59], v[80:83], v[136:139]
    ds_read_b64_tr_b16 v[52:53], v22 offset:29184
    v_mfma_f32_16x16x32_bf16 v[168:171], v[56:59], v[84:87], v[168:171]
    ds_read_b64_tr_b16 v[54:55], v22 offset:31232
    s_waitcnt lgkmcnt(6)
    v_mfma_f32_16x16x32_bf16 v[140:143], v[60:63], v[80:83], v[140:143]
    ds_read_b64_tr_b16 v[56:57], v23 offset:29184
    v_mfma_f32_16x16x32_bf16 v[172:175], v[60:63], v[84:87], v[172:175]
    ds_read_b64_tr_b16 v[58:59], v23 offset:31232
    s_waitcnt lgkmcnt(6)
    v_mfma_f32_16x16x32_bf16 v[144:147], v[44:47], v[80:83], v[144:147]
    ds_read_b64_tr_b16 v[60:61], v22 offset:45056
    v_mfma_f32_16x16x32_bf16 v[176:179], v[44:47], v[84:87], v[176:179]
    ds_read_b64_tr_b16 v[62:63], v22 offset:47104
    s_waitcnt lgkmcnt(6)
    v_mfma_f32_16x16x32_bf16 v[148:151], v[48:51], v[80:83], v[148:151]
    ds_read_b64_tr_b16 v[44:45], v23 offset:45056
    v_mfma_f32_16x16x32_bf16 v[180:183], v[48:51], v[84:87], v[180:183]
    ds_read_b64_tr_b16 v[46:47], v23 offset:47104
    s_waitcnt lgkmcnt(6)
    v_mfma_f32_16x16x32_bf16 v[152:155], v[52:55], v[80:83], v[152:155]
    ds_read_b64_tr_b16 v[48:49], v22 offset:45568
    v_mfma_f32_16x16x32_bf16 v[184:187], v[52:55], v[84:87], v[184:187]
    ds_read_b64_tr_b16 v[50:51], v22 offset:47616
    s_waitcnt lgkmcnt(6)
    v_mfma_f32_16x16x32_bf16 v[156:159], v[56:59], v[80:83], v[156:159]
    ds_read_b64_tr_b16 v[52:53], v23 offset:45568
    v_mfma_f32_16x16x32_bf16 v[188:191], v[56:59], v[84:87], v[188:191]
    ds_read_b64_tr_b16 v[54:55], v23 offset:47616
    s_waitcnt lgkmcnt(6)
    v_mfma_f32_16x16x32_bf16 v[192:195], v[60:63], v[88:91], v[192:195]
    ds_read_b64_tr_b16 v[56:57], v22 offset:36864
    v_mfma_f32_16x16x32_bf16 v[208:211], v[60:63], v[92:95], v[208:211]
    ds_read_b64_tr_b16 v[58:59], v22 offset:38912
    s_waitcnt lgkmcnt(6)
    v_mfma_f32_16x16x32_bf16 v[196:199], v[44:47], v[88:91], v[196:199]
    ds_read_b64_tr_b16 v[60:61], v23 offset:36864
    v_mfma_f32_16x16x32_bf16 v[212:215], v[44:47], v[92:95], v[212:215]
    ds_read_b64_tr_b16 v[62:63], v23 offset:38912
    s_waitcnt lgkmcnt(6)
    v_mfma_f32_16x16x32_bf16 v[200:203], v[48:51], v[88:91], v[200:203]
    ds_read_b64_tr_b16 v[44:45], v22 offset:37376
    v_mfma_f32_16x16x32_bf16 v[216:219], v[48:51], v[92:95], v[216:219]
    ds_read_b64_tr_b16 v[46:47], v22 offset:39424
    s_waitcnt lgkmcnt(6)
    v_mfma_f32_16x16x32_bf16 v[204:207], v[52:55], v[88:91], v[204:207]
    ds_read_b64_tr_b16 v[48:49], v23 offset:37376
    v_mfma_f32_16x16x32_bf16 v[220:223], v[52:55], v[92:95], v[220:223]
    ds_read_b64_tr_b16 v[50:51], v23 offset:39424
    s_waitcnt lgkmcnt(6)
    v_mfma_f32_16x16x32_bf16 v[128:131], v[56:59], v[88:91], v[128:131]
    ds_read_b64_tr_b16 v[52:53], v22 offset:40960
    v_mfma_f32_16x16x32_bf16 v[160:163], v[56:59], v[92:95], v[160:163]
    ds_read_b64_tr_b16 v[54:55], v22 offset:43008
    s_waitcnt lgkmcnt(6)
    v_mfma_f32_16x16x32_bf16 v[132:135], v[60:63], v[88:91], v[132:135]
    ds_read_b64_tr_b16 v[56:57], v23 offset:40960
    v_mfma_f32_16x16x32_bf16 v[164:167], v[60:63], v[92:95], v[164:167]
    ds_read_b64_tr_b16 v[58:59], v23 offset:43008
    s_waitcnt lgkmcnt(6)
    v_mfma_f32_16x16x32_bf16 v[136:139], v[44:47], v[88:91], v[136:139]
    ds_read_b64_tr_b16 v[60:61], v22 offset:41472
    s_mov_b32 s52, 1.4426950408889634
    v_fma_f32 v96, v192, s52, -0.5
    v_fma_f32 v97, v193, s52, -0.5
    v_mfma_f32_16x16x32_bf16 v[168:171], v[44:47], v[92:95], v[168:171]
    ds_read_b64_tr_b16 v[62:63], v22 offset:43520
    v_fma_f32 v98, v194, s52, -0.5
    v_fma_f32 v99, v195, s52, -0.5
    v_fma_f32 v100, v196, s52, -0.5
    s_waitcnt lgkmcnt(6)
    v_mfma_f32_16x16x32_bf16 v[140:143], v[48:51], v[88:91], v[140:143]
    ds_read_b64_tr_b16 v[44:45], v23 offset:41472
    v_fma_f32 v101, v197, s52, -0.5
    v_fma_f32 v102, v198, s52, -0.5
    v_fma_f32 v103, v199, s52, -0.5
    v_mfma_f32_16x16x32_bf16 v[172:175], v[48:51], v[92:95], v[172:175]
    ds_read_b64_tr_b16 v[46:47], v23 offset:43520
    v_exp_f32 v96, v96
    v_exp_f32 v97, v97
    v_exp_f32 v98, v98
    s_waitcnt lgkmcnt(6)
    v_mfma_f32_16x16x32_bf16 v[144:147], v[52:55], v[88:91], v[144:147]
    v_cvt_pk_bf16_f32 v128, v128, v129
    v_cvt_pk_bf16_f32 v129, v130, v131
    v_cvt_pk_bf16_f32 v130, v132, v133
    v_cvt_pk_bf16_f32 v131, v134, v135
    ds_write_b128 v27, v[128:131] offset:0
    v_mfma_f32_16x16x32_bf16 v[176:179], v[52:55], v[92:95], v[176:179]
    v_cvt_pk_bf16_f32 v160, v160, v161
    v_cvt_pk_bf16_f32 v161, v162, v163
    v_cvt_pk_bf16_f32 v162, v164, v165
    v_cvt_pk_bf16_f32 v163, v166, v167
    ds_write_b128 v27, v[160:163] offset:4096
    s_waitcnt lgkmcnt(6)
    v_mfma_f32_16x16x32_bf16 v[148:151], v[56:59], v[88:91], v[148:151]
    v_exp_f32 v99, v99
    v_exp_f32 v100, v100
    v_exp_f32 v101, v101
    v_mfma_f32_16x16x32_bf16 v[180:183], v[56:59], v[92:95], v[180:183]
    v_exp_f32 v102, v102
    v_exp_f32 v103, v103
    v_add_f32 v96, 0.7071067811865476, v96
    s_waitcnt lgkmcnt(4)
    v_mfma_f32_16x16x32_bf16 v[152:155], v[60:63], v[88:91], v[152:155]
    v_cvt_pk_bf16_f32 v136, v136, v137
    v_cvt_pk_bf16_f32 v137, v138, v139
    v_cvt_pk_bf16_f32 v138, v140, v141
    v_cvt_pk_bf16_f32 v139, v142, v143
    ds_write_b128 v27, v[136:139] offset:1024
    v_mfma_f32_16x16x32_bf16 v[184:187], v[60:63], v[92:95], v[184:187]
    v_cvt_pk_bf16_f32 v168, v168, v169
    v_cvt_pk_bf16_f32 v169, v170, v171
    v_cvt_pk_bf16_f32 v170, v172, v173
    v_cvt_pk_bf16_f32 v171, v174, v175
    ds_write_b128 v27, v[168:171] offset:5120
    s_waitcnt lgkmcnt(4)
    v_mfma_f32_16x16x32_bf16 v[156:159], v[44:47], v[88:91], v[156:159]
    v_add_f32 v97, 0.7071067811865476, v97
    v_add_f32 v98, 0.7071067811865476, v98
    v_add_f32 v99, 0.7071067811865476, v99
    v_mfma_f32_16x16x32_bf16 v[188:191], v[44:47], v[92:95], v[188:191]
    v_add_f32 v100, 0.7071067811865476, v100
    v_add_f32 v101, 0.7071067811865476, v101
    v_add_f32 v102, 0.7071067811865476, v102
    v_cvt_pk_bf16_f32 v144, v144, v145
    v_cvt_pk_bf16_f32 v145, v146, v147
    v_cvt_pk_bf16_f32 v146, v148, v149
    v_cvt_pk_bf16_f32 v147, v150, v151
    ds_write_b128 v27, v[144:147] offset:2048
    v_cvt_pk_bf16_f32 v176, v176, v177
    v_cvt_pk_bf16_f32 v177, v178, v179
    v_cvt_pk_bf16_f32 v178, v180, v181
    v_cvt_pk_bf16_f32 v179, v182, v183
    ds_write_b128 v27, v[176:179] offset:6144
    v_add_f32 v103, 0.7071067811865476, v103
    v_fma_f32 v96, v96, v96, 0.5
    v_fma_f32 v97, v97, v97, 0.5
    v_fma_f32 v98, v98, v98, 0.5
    v_fma_f32 v99, v99, v99, 0.5
    v_fma_f32 v100, v100, v100, 0.5
    v_fma_f32 v101, v101, v101, 0.5
    v_fma_f32 v102, v102, v102, 0.5
    v_cvt_pk_bf16_f32 v152, v152, v153
    v_cvt_pk_bf16_f32 v153, v154, v155
    v_cvt_pk_bf16_f32 v154, v156, v157
    v_cvt_pk_bf16_f32 v155, v158, v159
    ds_write_b128 v27, v[152:155] offset:3072
    v_cvt_pk_bf16_f32 v184, v184, v185
    v_cvt_pk_bf16_f32 v185, v186, v187
    v_cvt_pk_bf16_f32 v186, v188, v189
    v_cvt_pk_bf16_f32 v187, v190, v191
    ds_write_b128 v27, v[184:187] offset:7168
    v_fma_f32 v103, v103, v103, 0.5
    v_rcp_f32 v96, v96
    v_rcp_f32 v97, v97
    v_rcp_f32 v98, v98
    v_rcp_f32 v99, v99
    v_rcp_f32 v100, v100
    v_rcp_f32 v101, v101
    v_rcp_f32 v102, v102
    s_mov_b32 s46, 1.4426950408889634
    s_mov_b32 s47, 0.7071067811865476
    s_waitcnt vmcnt(4) lgkmcnt(0)
    s_barrier
    ds_read_b128 v[128:131], v29 offset:0
    ds_read_b128 v[132:135], v29 offset:1024
    ds_read_b128 v[136:139], v29 offset:2048
    ds_read_b128 v[140:143], v29 offset:3072
    ds_read_b128 v[144:147], v29 offset:4096
    ds_read_b128 v[148:151], v29 offset:5120
    ds_read_b128 v[152:155], v29 offset:6144
    ds_read_b128 v[156:159], v29 offset:7168
    s_add_u32 m0, s30, s57
    s_add_u32 s30, s30, 16384
    buffer_load_dwordx4 v1, s[8:11], s26 offen sc1 lds
    buffer_load_dwordx4 v1, s[8:11], s26 offen offset:1024 sc1 lds
    s_and_b32 s30, s30, 0xffff
    s_add_u32 s26, s26, 16384
    s_cmp_eq_u32 s26, s28
    s_cselect_b32 s26, s40, s26
    s_add_u32 m0, s30, s57
    s_add_u32 s30, s30, 16384
    buffer_load_dwordx4 v1, s[8:11], s26 offen sc1 lds
    buffer_load_dwordx4 v1, s[8:11], s26 offen offset:1024 sc1 lds
    s_and_b32 s30, s30, 0xffff
    s_add_u32 s26, s26, 16384
    s_cmp_eq_u32 s26, s28
    s_cselect_b32 s26, s40, s26
    v_mov_b32 v12, 0x3f803f80
    v_mov_b32 v13, 0x3f803f80
    v_mov_b32 v14, 0x3f803f80
    v_mov_b32 v15, 0x3f803f80
    v_mov_b32 v160, -20.0
    v_mov_b32 v161, -20.0
    v_mov_b32 v162, -20.0
    v_mov_b32 v163, -20.0
    v_mov_b32 v164, -20.0
    v_mov_b32 v165, -20.0
    v_mov_b32 v166, -20.0
    v_mov_b32 v167, -20.0
    s_lshl_b32 s34, s35, 2
    s_add_u32 s34, s34, s23
    s_sub_u32 s34, s34, s24
    s_lshl_b32 s34, s34, 5
    s_mov_b32 s33, s35
    s_add_u32 s31, s31, 16384
    s_cmp_eq_u32 s31, 49152
    s_cselect_b32 s31, 0, s31
    v_add_u32 v2, s31, v5
    ds_read_b128 v[32:35], v2 offset:0
    ds_read_b128 v[36:39], v2 offset:1024
    ds_read_b128 v[40:43], v2 offset:2048
    ds_read_b128 v[44:47], v2 offset:3072
    v_rcp_f32 v103, v103
    v_fma_f32 v192, -v96, v192, v192
    v_fma_f32 v193, -v97, v193, v193
    v_fma_f32 v194, -v98, v194, v194
    v_fma_f32 v195, -v99, v195, v195
    v_fma_f32 v196, -v100, v196, v196
    v_fma_f32 v197, -v101, v197, v197
    v_fma_f32 v198, -v102, v198, v198
    v_fma_f32 v199, -v103, v199, v199
    v_cvt_pk_bf16_f32 v192, v192, v193
    v_cvt_pk_bf16_f32 v193, v194, v195
    v_cvt_pk_bf16_f32 v194, v196, v197
    v_cvt_pk_bf16_f32 v195, v198, v199
    s_add_u32 s39, s42, 0
    buffer_store_dwordx4 v[192:195], v1, s[12:15], s39 offen offset:0 sc1
    v_pk_fma_f32 v[104:105], v[200:201], s[46:47], -0.5 op_sel_hi:[1,0,0]
    v_pk_fma_f32 v[106:107], v[202:203], s[46:47], -0.5 op_sel_hi:[1,0,0]
    v_pk_fma_f32 v[108:109], v[204:205], s[46:47], -0.5 op_sel_hi:[1,0,0]
    v_pk_fma_f32 v[110:111], v[206:207], s[46:47], -0.5 op_sel_hi:[1,0,0]
    v_exp_f32 v104, v104
    v_exp_f32 v105, v105
    v_exp_f32 v106, v106
    v_exp_f32 v107, v107
    v_exp_f32 v108, v108
    v_exp_f32 v109, v109
    v_exp_f32 v110, v110
    v_exp_f32 v111, v111
    v_pk_add_f32 v[104:105], v[104:105], s[46:47] op_sel:[0,1] op_sel_hi:[1,1]
    v_pk_add_f32 v[106:107], v[106:107], s[46:47] op_sel:[0,1] op_sel_hi:[1,1]
    v_pk_add_f32 v[108:109], v[108:109], s[46:47] op_sel:[0,1] op_sel_hi:[1,1]
    v_pk_add_f32 v[110:111], v[110:111], s[46:47] op_sel:[0,1] op_sel_hi:[1,1]
    v_pk_fma_f32 v[104:105], v[104:105], v[104:105], 0.5 op_sel_hi:[1,1,0]
    v_pk_fma_f32 v[106:107], v[106:107], v[106:107], 0.5 op_sel_hi:[1,1,0]
    v_pk_fma_f32 v[108:109], v[108:109], v[108:109], 0.5 op_sel_hi:[1,1,0]
    v_pk_fma_f32 v[110:111], v[110:111], v[110:111], 0.5 op_sel_hi:[1,1,0]
    v_rcp_f32 v104, v104
    v_rcp_f32 v105, v105
    v_rcp_f32 v106, v106
    v_rcp_f32 v107, v107
    v_rcp_f32 v108, v108
    v_rcp_f32 v109, v109
    v_rcp_f32 v110, v110
    v_rcp_f32 v111, v111
    v_pk_fma_f32 v[200:201], v[104:105], v[200:201], v[200:201] neg_lo:[1,0,0] neg_hi:[1,0,0]
    v_pk_fma_f32 v[202:203], v[106:107], v[202:203], v[202:203] neg_lo:[1,0,0] neg_hi:[1,0,0]
    v_pk_fma_f32 v[204:205], v[108:109], v[204:205], v[204:205] neg_lo:[1,0,0] neg_hi:[1,0,0]
    v_pk_fma_f32 v[206:207], v[110:111], v[206:207], v[206:207] neg_lo:[1,0,0] neg_hi:[1,0,0]
    v_cvt_pk_bf16_f32 v200, v200, v201
    v_cvt_pk_bf16_f32 v201, v202, v203
    v_cvt_pk_bf16_f32 v202, v204, v205
    v_cvt_pk_bf16_f32 v203, v206, v207
    s_add_u32 s39, s42, 0
    buffer_store_dwordx4 v[200:203], v1, s[12:15], s39 offen offset:1024 sc1
    s_waitcnt lgkmcnt(3)
    v_mfma_f32_16x16x32_bf16 v[176:179], v[32:35], v[128:131], v[160:163]
    v_fma_f32 v112, v208, s52, -0.5
    v_fma_f32 v113, v209, s52, -0.5
    v_fma_f32 v114, v210, s52, -0.5
    v_fma_f32 v115, v211, s52, -0.5
    v_mfma_f32_16x16x32_bf16 v[180:183], v[32:35], v[144:147], v[164:167]
    ds_read_b128 v[32:35], v2 offset:4096
    ds_read_b128 v[224:227], v30 offset:0
    ds_read_b128 v[228:231], v30 offset:1024
    ds_read_b128 v[232:235], v30 offset:2048
    ds_read_b128 v[236:239], v30 offset:3072
    v_fma_f32 v116, v212, s52, -0.5
    v_fma_f32 v117, v213, s52, -0.5
    v_fma_f32 v118, v214, s52, -0.5
    s_waitcnt lgkmcnt(7)
    v_mfma_f32_16x16x32_bf16 v[176:179], v[36:39], v[132:135], v[176:179]
    v_fma_f32 v119, v215, s52, -0.5
    v_exp_f32 v112, v112
    v_exp_f32 v113, v113
    v_exp_f32 v114, v114
    v_mfma_f32_16x16x32_bf16 v[180:183], v[36:39], v[148:151], v[180:183]
    ds_read_b128 v[36:39], v2 offset:5120
    ds_read_b128 v[240:243], v30 offset:4096
    ds_read_b128 v[244:247], v30 offset:5120
    ds_read_b128 v[248:251], v30 offset:6144
    ds_read_b128 v[252:255], v30 offset:7168
    v_exp_f32 v115, v115
    v_exp_f32 v116, v116
    v_exp_f32 v117, v117
    s_waitcnt lgkmcnt(11)
    v_mfma_f32_16x16x32_bf16 v[176:179], v[40:43], v[136:139], v[176:179]
    v_exp_f32 v118, v118
    v_exp_f32 v119, v119
    v_add_f32 v112, 0.7071067811865476, v112
    v_mfma_f32_16x16x32_bf16 v[180:183], v[40:43], v[152:155], v[180:183]
    ds_read_b128 v[40:43], v2 offset:6144
    v_add_f32 v113, 0.7071067811865476, v113
    v_add_f32 v114, 0.7071067811865476, v114
    v_add_f32 v115, 0.7071067811865476, v115
    v_add_f32 v116, 0.7071067811865476, v116
    s_waitcnt lgkmcnt(11)
    v_mfma_f32_16x16x32_bf16 v[176:179], v[44:47], v[140:143], v[176:179]
    v_add_f32 v117, 0.7071067811865476, v117
    v_add_f32 v118, 0.7071067811865476, v118
    v_add_f32 v119, 0.7071067811865476, v119
    v_mfma_f32_16x16x32_bf16 v[180:183], v[44:47], v[156:159], v[180:183]
    ds_read_b128 v[44:47], v2 offset:7168
    v_fma_f32 v112, v112, v112, 0.5
    v_fma_f32 v113, v113, v113, 0.5
    v_fma_f32 v114, v114, v114, 0.5
    s_waitcnt lgkmcnt(0)
    s_waitcnt vmcnt(8)
    s_barrier
    v_mfma_f32_16x16x32_bf16 v[184:187], v[32:35], v[128:131], v[160:163]
    v_fma_f32 v115, v115, v115, 0.5
    v_fma_f32 v116, v116, v116, 0.5
    v_fma_f32 v117, v117, v117, 0.5
    v_fma_f32 v118, v118, v118, 0.5
    v_lshrrev_b32 v49, 13, v10
    v_and_b32 v50, 3, v49
    v_mfma_f32_16x16x32_bf16 v[188:191], v[32:35], v[144:147], v[164:167]
    s_add_u32 s31, s31, 16384
    s_cmp_eq_u32 s31, 49152
    s_cselect_b32 s31, 0, s31
    v_add_u32 v2, s31, v5
    ds_read_b128 v[32:35], v2 offset:0
    s_mov_b32 m0, s29
    s_add_u32 s29, s29, 16384
    buffer_load_dwordx4 v1, s[4:7], s25 offen sc1 lds
    v_fma_f32 v119, v119, v119, 0.5
    v_rcp_f32 v112, v112
    v_rcp_f32 v113, v113
    v_lshrrev_b32 v49, 3, v49
    v_lshl_add_u32 v49, v49, 2, v50
    v_mfma_f32_16x16x32_bf16 v[184:187], v[36:39], v[132:135], v[184:187]
    v_rcp_f32 v114, v114
    v_rcp_f32 v115, v115
    v_rcp_f32 v116, v116
    v_rcp_f32 v117, v117
    v_and_b32 v48, 0x7f, v10
    v_mfma_f32_16x16x32_bf16 v[188:191], v[36:39], v[148:151], v[188:191]
    ds_read_b128 v[36:39], v2 offset:1024
    v_rcp_f32 v118, v118
    v_rcp_f32 v119, v119
    v_fma_f32 v208, -v112, v208, v208
    v_mul_u32_u24 v49, 1280, v49
    v_add_u32 v48, v48, v49
    v_mfma_f32_16x16x32_bf16 v[184:187], v[40:43], v[136:139], v[184:187]
    v_fma_f32 v209, -v113, v209, v209
    v_fma_f32 v210, -v114, v210, v210
    v_fma_f32 v211, -v115, v211, v211
    s_lshl_b32 s93, s22, 12
    s_add_u32 s93, s93, 114688
    v_mfma_f32_16x16x32_bf16 v[188:191], v[40:43], v[152:155], v[188:191]
    ds_read_b128 v[40:43], v2 offset:2048
    v_fma_f32 v212, -v116, v212, v212
    v_fma_f32 v213, -v117, v213, v213
    v_fma_f32 v214, -v118, v214, v214
    v_fma_f32 v215, -v119, v215, v215
    v_add_u32 v52, s93, v20
    v_mfma_f32_16x16x32_bf16 v[184:187], v[44:47], v[140:143], v[184:187]
    v_cvt_pk_bf16_f32 v208, v208, v209
    v_cvt_pk_bf16_f32 v209, v210, v211
    v_cvt_pk_bf16_f32 v210, v212, v213
    v_add_u32 v53, s93, v21
    v_mov_b32 v10, 20.0
    v_mfma_f32_16x16x32_bf16 v[188:191], v[44:47], v[156:159], v[188:191]
    ds_read_b128 v[44:47], v2 offset:3072
    v_cvt_pk_bf16_f32 v211, v214, v215
    s_add_u32 s39, s42, 55296
    buffer_store_dwordx4 v[208:211], v1, s[12:15], s39 offen offset:0 sc1
    v_mov_b32 v11, 20.0
    v_pk_fma_f32 v[120:121], v[216:217], s[46:47], -0.5 op_sel_hi:[1,0,0]
    v_pk_fma_f32 v[122:123], v[218:219], s[46:47], -0.5 op_sel_hi:[1,0,0]
    v_pk_fma_f32 v[124:125], v[220:221], s[46:47], -0.5 op_sel_hi:[1,0,0]
    v_pk_fma_f32 v[126:127], v[222:223], s[46:47], -0.5 op_sel_hi:[1,0,0]
    v_exp_f32 v120, v120
    v_exp_f32 v121, v121
    v_exp_f32 v122, v122
    v_exp_f32 v123, v123
    v_exp_f32 v124, v124
    v_exp_f32 v125, v125
    v_exp_f32 v126, v126
    v_exp_f32 v127, v127
    v_pk_add_f32 v[120:121], v[120:121], s[46:47] op_sel:[0,1] op_sel_hi:[1,1]
    v_pk_add_f32 v[122:123], v[122:123], s[46:47] op_sel:[0,1] op_sel_hi:[1,1]
    v_pk_add_f32 v[124:125], v[124:125], s[46:47] op_sel:[0,1] op_sel_hi:[1,1]
    v_pk_add_f32 v[126:127], v[126:127], s[46:47] op_sel:[0,1] op_sel_hi:[1,1]
    v_pk_fma_f32 v[120:121], v[120:121], v[120:121], 0.5 op_sel_hi:[1,1,0]
    v_pk_fma_f32 v[122:123], v[122:123], v[122:123], 0.5 op_sel_hi:[1,1,0]
    v_pk_fma_f32 v[124:125], v[124:125], v[124:125], 0.5 op_sel_hi:[1,1,0]
    v_pk_fma_f32 v[126:127], v[126:127], v[126:127], 0.5 op_sel_hi:[1,1,0]
    v_rcp_f32 v120, v120
    v_rcp_f32 v121, v121
    v_rcp_f32 v122, v122
    v_rcp_f32 v123, v123
    v_rcp_f32 v124, v124
    v_rcp_f32 v125, v125
    v_rcp_f32 v126, v126
    v_rcp_f32 v127, v127
    v_pk_fma_f32 v[216:217], v[120:121], v[216:217], v[216:217] neg_lo:[1,0,0] neg_hi:[1,0,0]
    v_pk_fma_f32 v[218:219], v[122:123], v[218:219], v[218:219] neg_lo:[1,0,0] neg_hi:[1,0,0]
    v_pk_fma_f32 v[220:221], v[124:125], v[220:221], v[220:221] neg_lo:[1,0,0] neg_hi:[1,0,0]
    v_pk_fma_f32 v[222:223], v[126:127], v[222:223], v[222:223] neg_lo:[1,0,0] neg_hi:[1,0,0]
    v_cvt_pk_bf16_f32 v216, v216, v217
    v_cvt_pk_bf16_f32 v217, v218, v219
    v_cvt_pk_bf16_f32 v218, v220, v221
    v_cvt_pk_bf16_f32 v219, v222, v223
    s_add_u32 s39, s42, 55296
    buffer_store_dwordx4 v[216:219], v1, s[12:15], s39 offen offset:1024 sc1
    s_branch recurrent_scan__compressed_kv_cla__dense_activation_mish__prompt_kernel_pj
recurrent_scan__compressed_kv_cla__dense_activation_mish__prompt_kernel_no1:
    s_waitcnt vmcnt(9)
    ds_read_b128 v[64:67], v8 offset:0
    ds_read_b128 v[68:71], v8 offset:2048
    ds_read_b128 v[72:75], v9 offset:0
    ds_read_b128 v[76:79], v9 offset:2048
    s_waitcnt vmcnt(7)
    s_barrier
    ds_read_b64_tr_b16 v[44:45], v20 offset:0
    ds_read_b64_tr_b16 v[46:47], v20 offset:2048
    ds_read_b64_tr_b16 v[48:49], v21 offset:0
    ds_read_b64_tr_b16 v[50:51], v21 offset:2048
    ds_read_b64_tr_b16 v[52:53], v20 offset:512
    ds_read_b64_tr_b16 v[54:55], v20 offset:2560
    ds_read_b64_tr_b16 v[56:57], v21 offset:512
    ds_read_b64_tr_b16 v[58:59], v21 offset:2560
    ds_read_b64_tr_b16 v[60:61], v20 offset:4096
    ds_read_b64_tr_b16 v[62:63], v20 offset:6144
    s_waitcnt lgkmcnt(12)
    s_waitcnt lgkmcnt(10)
    s_waitcnt lgkmcnt(8)
    v_mfma_f32_16x16x32_bf16 v[192:195], v[44:47], v[64:67], 0
    s_cmp_lt_u32 s20, 16
    s_cselect_b32 s47, s35, s21
    s_lshl_b32 s47, s47, 4
    s_and_b32 s48, s20, 15
    s_add_u32 s47, s47, s48
    v_mfma_f32_16x16x32_bf16 v[208:211], v[44:47], v[68:71], 0
    s_lshl_b32 s48, s47, 3
    s_add_u32 s48, s48, s22
    s_mul_i32 s41, s48, 1280
    s_mov_b32 s80, s70
    s_mov_b32 s81, s71
    s_add_u32 s38, s25, 2
    s_and_b32 s38, s38, 7
    s_lshl_b32 s38, s38, 7
    s_mov_b32 m0, s37
    s_add_u32 s38, s38, s32
    buffer_load_dwordx4 v4, s[4:7], s38 offen offset:0 lds
    s_waitcnt lgkmcnt(6)
    v_mfma_f32_16x16x32_bf16 v[196:199], v[48:51], v[64:67], 0
    ds_read_b64_tr_b16 v[44:45], v21 offset:4096
    s_and_b32 s81, s81, 0xffff
    s_mov_b32 s82, 2621440
    s_mov_b32 s83, 0x20000
    s_lshr_b32 s44, s47, 1
    s_mul_i32 s44, s44, 20480
    v_mfma_f32_16x16x32_bf16 v[212:215], v[48:51], v[68:71], 0
    ds_read_b64_tr_b16 v[46:47], v21 offset:6144
    s_and_b32 s47, s47, 1
    s_lshl_b32 s47, s47, 7
    s_add_u32 s44, s44, s47
    s_lshl_b32 s47, s22, 11
    s_add_u32 s44, s44, s47
    buffer_load_dwordx4 v5, s[4:7], s38 offen offset:1024 lds
    s_waitcnt vmcnt(4)
    ds_read_b128 v[80:83], v8 offset:32768
    ds_read_b128 v[84:87], v8 offset:34816
    s_waitcnt lgkmcnt(8)
    v_mfma_f32_16x16x32_bf16 v[200:203], v[52:55], v[64:67], 0
    ds_read_b64_tr_b16 v[48:49], v20 offset:4608
    s_add_u32 s44, s44, 50331648
    v_and_b32 v15, 7, v17
    v_xor_b32 v16, s22, v15
    v_lshlrev_b32 v14, 7, v17
    v_lshl_add_u32 v14, v16, 4, v14
    v_mfma_f32_16x16x32_bf16 v[216:219], v[52:55], v[68:71], 0
    ds_read_b64_tr_b16 v[50:51], v20 offset:6656
    v_add_u32 v42, 49152, v14
    v_lshrrev_b32 v14, 3, v17
    v_xor_b32 v15, v15, v14
    v_lshlrev_b32 v15, 4, v15
    v_lshl_add_u32 v43, v14, 8, v15
    buffer_load_dwordx4 v6, s[4:7], s38 offen offset:2048 lds
    ds_read_b128 v[88:91], v9 offset:32768
    ds_read_b128 v[92:95], v9 offset:34816
    s_waitcnt lgkmcnt(10)
    v_mfma_f32_16x16x32_bf16 v[204:207], v[56:59], v[64:67], 0
    ds_read_b64_tr_b16 v[52:53], v21 offset:4608
    s_and_b32 s17, s17, 0xffff
    s_mov_b32 s18, 4194304
    s_mov_b32 s19, 0x20000
    s_xor_b32 s46, s20, 0
    s_lshl_b32 s46, s46, 19
    v_mfma_f32_16x16x32_bf16 v[220:223], v[56:59], v[68:71], 0
    ds_read_b64_tr_b16 v[54:55], v21 offset:6656
    s_add_u32 s75, s75, s46
    s_xor_b32 s46, s2, 0
    s_lshl_b32 s46, s46, 3
    s_add_u32 s46, s46, s22
    s_mul_i32 s47, s46, 6554
    buffer_load_dwordx4 v7, s[4:7], s38 offen offset:3072 lds
    s_waitcnt lgkmcnt(10)
    v_mfma_f32_16x16x32_bf16 v[192:195], v[60:63], v[72:75], v[192:195]
    ds_read_b64_tr_b16 v[56:57], v20 offset:8192
    s_lshr_b32 s47, s47, 16
    s_mul_i32 s48, s47, 10
    s_sub_u32 s46, s46, s48
    s_cmp_lt_u32 s47, 128
    s_cselect_b32 s84, s84, s86
    s_cselect_b32 s85, s85, s87
    s_mov_b32 s48, 5242880
    s_cselect_b32 s86, s48, 2211840
    s_mov_b32 s92, 131072
    s_cselect_b32 s92, s92, 55296
    s_mov_b32 s49, 62914560
    s_cselect_b32 s49, s49, 69206016
    v_mfma_f32_16x16x32_bf16 v[208:211], v[60:63], v[76:79], v[208:211]
    ds_read_b64_tr_b16 v[58:59], v20 offset:10240
    s_and_b32 s85, s85, 0xffff
    s_mov_b32 s87, 0x20000
    s_cmp_lt_u32 s47, 182
    s_cselect_b32 s49, s49, 0x40000000
    s_and_b32 s47, s47, 127
    buffer_load_dwordx4 v[28:31], v1, s[80:83], s41 offen offset:0
    s_waitcnt lgkmcnt(10)
    v_mfma_f32_16x16x32_bf16 v[196:199], v[44:47], v[72:75], v[196:199]
    ds_read_b64_tr_b16 v[60:61], v21 offset:8192
    s_mul_i32 s90, s47, 40960
    s_lshl_b32 s48, s46, 7
    s_add_u32 s90, s90, s48
    s_mul_i32 s91, s46, s92
    s_lshl_b32 s91, s91, 2
    v_mfma_f32_16x16x32_bf16 v[212:215], v[44:47], v[76:79], v[212:215]
    ds_read_b64_tr_b16 v[62:63], v21 offset:10240
    s_lshl_b32 s47, s47, 10
    s_add_u32 s91, s91, s47
    s_add_u32 s91, s91, s49
    s_lshr_b32 s49, s16, 8
    s_add_u32 s49, s49, s20
    buffer_load_dwordx4 v[32:35], v1, s[80:83], s41 offen offset:1024
    s_waitcnt lgkmcnt(8)
    v_mfma_f32_16x16x32_bf16 v[200:203], v[48:51], v[72:75], v[200:203]
    ds_read_b64_tr_b16 v[44:45], v20 offset:8704
    s_and_b32 s49, s49, 3
    s_lshr_b32 s47, s20, 2
    s_mul_i32 s56, s47, 3
    s_max_u32 s46, s49, 1
    s_add_u32 s56, s56, s46
    v_mfma_f32_16x16x32_bf16 v[216:219], v[48:51], v[76:79], v[216:219]
    ds_read_b64_tr_b16 v[46:47], v20 offset:10752
    s_cmp_eq_u32 s47, 7
    s_cselect_b32 s46, 2, 1
    s_sub_u32 s56, s56, s46
    s_lshl_b32 s56, s56, 1
    s_add_u32 s46, s47, 44
    s_add_u32 s38, s27, 6
    s_and_b32 s38, s38, 15
    s_lshl_b32 s38, s38, 18
    s_add_u32 s38, s38, s29
    s_add_u32 m0, s30, 32768
    s_add_u32 s38, s38, 0
    buffer_load_dwordx4 v10, s[8:11], s38 offen lds
    s_waitcnt lgkmcnt(6)
    v_mfma_f32_16x16x32_bf16 v[204:207], v[52:55], v[72:75], v[204:207]
    ds_read_b64_tr_b16 v[48:49], v21 offset:8704
    s_cmp_eq_u32 s49, 1
    s_cselect_b32 s56, s46, s56
    s_add_u32 s46, s47, 46
    s_lshl_b32 s47, s47, 2
    s_add_u32 s47, s47, s49
    v_mfma_f32_16x16x32_bf16 v[220:223], v[52:55], v[76:79], v[220:223]
    ds_read_b64_tr_b16 v[50:51], v21 offset:10752
    s_or_b32 s47, s47, 4
    s_cmp_eq_u32 s47, 31
    s_cselect_b32 s56, s46, s56
    s_cmp_eq_u32 s24, 0
    s_cselect_b32 s47, s35, s21
    buffer_load_dwordx4 v11, s[8:11], s38 offen offset:1024 lds
    s_waitcnt lgkmcnt(6)
    v_mfma_f32_16x16x32_bf16 v[192:195], v[56:59], v[80:83], v[192:195]
    ds_read_b64_tr_b16 v[52:53], v20 offset:12288
    s_lshl_b32 s47, s47, 2
    s_add_u32 s42, s47, s23
    s_mul_i32 s33, s42, 40960
    s_add_u32 s33, s33, 50331648
    s_add_u32 s34, s33, 20480
    v_mfma_f32_16x16x32_bf16 v[208:211], v[56:59], v[84:87], v[208:211]
    ds_read_b64_tr_b16 v[54:55], v20 offset:14336
    s_mul_i32 s42, s42, 110592
    s_lshl_b32 s47, s56, 10
    s_add_u32 s42, s42, s47
    s_add_u32 s42, s42, 54525952
    s_lshl_b32 s58, s24, 18
    s_add_u32 s38, s25, 3
    s_and_b32 s38, s38, 7
    s_lshl_b32 s38, s38, 7
    s_add_u32 m0, s31, 0
    s_add_u32 s38, s38, s32
    buffer_load_dwordx4 v4, s[4:7], s38 offen offset:0 lds
    s_waitcnt lgkmcnt(6)
    v_mfma_f32_16x16x32_bf16 v[196:199], v[60:63], v[80:83], v[196:199]
    ds_read_b64_tr_b16 v[56:57], v21 offset:12288
    s_add_u32 s58, s58, s29
    s_mul_i32 s69, s24, 12288
    s_lshl_b32 s49, s23, 11
    s_add_u32 s59, s69, s49
    s_lshl_b32 s49, s23, 10
    v_mfma_f32_16x16x32_bf16 v[212:215], v[60:63], v[84:87], v[212:215]
    ds_read_b64_tr_b16 v[58:59], v21 offset:14336
    s_add_u32 s69, s69, s49
    s_lshl_b32 s68, s24, 5
    s_and_b32 s47, s22, 1
    s_lshl_b32 s47, s47, 4
    s_add_u32 s68, s68, s47
    buffer_load_dwordx4 v5, s[4:7], s38 offen offset:1024 lds
    s_waitcnt vmcnt(6)
    ds_read_b128 v[96:99], v40 offset:0
    ds_read_b128 v[100:103], v40 offset:2048
    s_waitcnt lgkmcnt(8)
    v_mfma_f32_16x16x32_bf16 v[200:203], v[44:47], v[80:83], v[200:203]
    ds_read_b64_tr_b16 v[60:61], v20 offset:12800
    s_lshr_b32 s47, s23, 1
    s_lshl_b32 s47, s47, 2
    s_add_u32 s68, s68, s47
    s_mul_i32 s68, s68, 3456
    s_lshl_b32 s49, s56, 6
    v_mfma_f32_16x16x32_bf16 v[216:219], v[44:47], v[84:87], v[216:219]
    ds_read_b64_tr_b16 v[62:63], v20 offset:14848
    s_add_u32 s68, s68, s49
    s_add_u32 s100, s66, s49
    s_addc_u32 s101, s67, 0
    s_and_b32 s61, s61, 0xffff
    s_mov_b32 s62, 5242880
    buffer_load_dwordx4 v6, s[4:7], s38 offen offset:2048 lds
    ds_read_b128 v[104:107], v41 offset:0
    ds_read_b128 v[108:111], v41 offset:2048
    s_waitcnt lgkmcnt(10)
    v_mfma_f32_16x16x32_bf16 v[204:207], v[48:51], v[80:83], v[204:207]
    ds_read_b64_tr_b16 v[44:45], v21 offset:12800
    s_mov_b32 s63, 0x20000
    s_and_b32 s65, s65, 0xffff
    s_mov_b32 s66, 2211840
    s_mov_b32 s67, 0x20000
    v_cmp_gt_u32 vcc, 16, v17
    v_mfma_f32_16x16x32_bf16 v[220:223], v[48:51], v[84:87], v[220:223]
    ds_read_b64_tr_b16 v[46:47], v21 offset:14848
    buffer_load_dwordx4 v7, s[4:7], s38 offen offset:3072 lds
    s_barrier
    s_waitcnt lgkmcnt(10)
    v_mfma_f32_16x16x32_bf16 v[192:195], v[52:55], v[88:91], v[192:195]
    ds_read_b64_tr_b16 v[48:49], v20 offset:16384
    v_mfma_f32_16x16x32_bf16 v[208:211], v[52:55], v[92:95], v[208:211]
    ds_read_b64_tr_b16 v[50:51], v20 offset:18432
    v_readlane_b32 s3, v13, s20
    s_andn2_b32 s3, s3, 7
    s_add_u32 s3, s3, 8
    s_add_u32 s38, s27, 8
    s_and_b32 s38, s38, 15
    s_lshl_b32 s38, s38, 18
    s_add_u32 s38, s38, s29
    s_add_u32 m0, s30, 49152
    s_add_u32 s38, s38, 0
    buffer_load_dwordx4 v10, s[8:11], s38 offen lds
    s_waitcnt lgkmcnt(10)
    v_mfma_f32_16x16x32_bf16 v[196:199], v[56:59], v[88:91], v[196:199]
    ds_read_b64_tr_b16 v[52:53], v21 offset:16384
    v_mfma_f32_16x16x32_bf16 v[212:215], v[56:59], v[92:95], v[212:215]
    ds_read_b64_tr_b16 v[54:55], v21 offset:18432
    buffer_load_dwordx4 v11, s[8:11], s38 offen offset:1024 lds
    s_waitcnt lgkmcnt(8)
    v_mfma_f32_16x16x32_bf16 v[200:203], v[60:63], v[88:91], v[200:203]
    ds_read_b64_tr_b16 v[56:57], v20 offset:16896
    v_mfma_f32_16x16x32_bf16 v[216:219], v[60:63], v[92:95], v[216:219]
    ds_read_b64_tr_b16 v[58:59], v20 offset:18944
    s_add_u32 s38, s25, 4
    s_and_b32 s38, s38, 7
    s_lshl_b32 s38, s38, 7
    s_add_u32 m0, s31, 32768
    s_add_u32 s38, s38, s32
    buffer_load_dwordx4 v4, s[4:7], s38 offen offset:0 lds
    s_waitcnt lgkmcnt(6)
    v_mfma_f32_16x16x32_bf16 v[204:207], v[44:47], v[88:91], v[204:207]
    ds_read_b64_tr_b16 v[60:61], v21 offset:16896
    v_mfma_f32_16x16x32_bf16 v[220:223], v[44:47], v[92:95], v[220:223]
    ds_read_b64_tr_b16 v[62:63], v21 offset:18944
    buffer_load_dwordx4 v5, s[4:7], s38 offen offset:1024 lds
    s_waitcnt lgkmcnt(6)
    v_mfma_f32_16x16x32_bf16 v[192:195], v[48:51], v[96:99], v[192:195]
    ds_read_b64_tr_b16 v[44:45], v20 offset:20480
    v_mfma_f32_16x16x32_bf16 v[208:211], v[48:51], v[100:103], v[208:211]
    ds_read_b64_tr_b16 v[46:47], v20 offset:22528
    buffer_load_dwordx4 v6, s[4:7], s38 offen offset:2048 lds
    s_waitcnt lgkmcnt(6)
    v_mfma_f32_16x16x32_bf16 v[196:199], v[52:55], v[96:99], v[196:199]
    ds_read_b64_tr_b16 v[48:49], v21 offset:20480
    v_mfma_f32_16x16x32_bf16 v[212:215], v[52:55], v[100:103], v[212:215]
    ds_read_b64_tr_b16 v[50:51], v21 offset:22528
    buffer_load_dwordx4 v7, s[4:7], s38 offen offset:3072 lds
    s_waitcnt lgkmcnt(6)
    v_mfma_f32_16x16x32_bf16 v[200:203], v[56:59], v[96:99], v[200:203]
    ds_read_b64_tr_b16 v[52:53], v20 offset:20992
    v_mfma_f32_16x16x32_bf16 v[216:219], v[56:59], v[100:103], v[216:219]
    ds_read_b64_tr_b16 v[54:55], v20 offset:23040
    s_waitcnt lgkmcnt(6)
    v_mfma_f32_16x16x32_bf16 v[204:207], v[60:63], v[96:99], v[204:207]
    ds_read_b64_tr_b16 v[56:57], v21 offset:20992
    v_mfma_f32_16x16x32_bf16 v[220:223], v[60:63], v[100:103], v[220:223]
    ds_read_b64_tr_b16 v[58:59], v21 offset:23040
    s_waitcnt lgkmcnt(6)
    v_mfma_f32_16x16x32_bf16 v[224:227], v[44:47], v[64:67], 0
    ds_read_b64_tr_b16 v[60:61], v20 offset:24576
    v_mfma_f32_16x16x32_bf16 v[240:243], v[44:47], v[68:71], 0
    ds_read_b64_tr_b16 v[62:63], v20 offset:26624
    s_waitcnt vmcnt(12)
    v_cndmask_b32 v32, 0, v32, vcc
    v_cndmask_b32 v33, 0, v33, vcc
    v_cndmask_b32 v34, 0, v34, vcc
    v_cndmask_b32 v35, 0, v35, vcc
    s_waitcnt lgkmcnt(6)
    v_mfma_f32_16x16x32_bf16 v[228:231], v[48:51], v[64:67], 0
    ds_read_b64_tr_b16 v[44:45], v21 offset:24576
    v_mfma_f32_16x16x32_bf16 v[244:247], v[48:51], v[68:71], 0
    ds_read_b64_tr_b16 v[46:47], v21 offset:26624
    v_lshlrev_b32 v17, 16, v28
    v_and_b32 v18, 0xffff0000, v28
    v_add_f32 v14, v17, v18
    v_lshlrev_b32 v17, 16, v29
    s_waitcnt lgkmcnt(6)
    v_mfma_f32_16x16x32_bf16 v[232:235], v[52:55], v[64:67], 0
    ds_read_b64_tr_b16 v[48:49], v20 offset:25088
    v_mfma_f32_16x16x32_bf16 v[248:251], v[52:55], v[68:71], 0
    ds_read_b64_tr_b16 v[50:51], v20 offset:27136
    v_and_b32 v18, 0xffff0000, v29
    v_add_f32 v14, v14, v17
    v_add_f32 v14, v14, v18
    v_lshlrev_b32 v17, 16, v30
    s_waitcnt lgkmcnt(6)
    v_mfma_f32_16x16x32_bf16 v[236:239], v[56:59], v[64:67], 0
    ds_read_b64_tr_b16 v[52:53], v21 offset:25088
    v_mfma_f32_16x16x32_bf16 v[252:255], v[56:59], v[68:71], 0
    ds_read_b64_tr_b16 v[54:55], v21 offset:27136
    v_and_b32 v18, 0xffff0000, v30
    v_add_f32 v14, v14, v17
    v_add_f32 v14, v14, v18
    v_lshlrev_b32 v17, 16, v31
    s_waitcnt lgkmcnt(6)
    v_mfma_f32_16x16x32_bf16 v[192:195], v[60:63], v[104:107], v[192:195]
    ds_read_b64_tr_b16 v[56:57], v20 offset:28672
    v_mfma_f32_16x16x32_bf16 v[208:211], v[60:63], v[108:111], v[208:211]
    ds_read_b64_tr_b16 v[58:59], v20 offset:30720
    v_and_b32 v18, 0xffff0000, v31
    v_add_f32 v14, v14, v17
    v_add_f32 v14, v14, v18
    v_lshlrev_b32 v17, 16, v32
    s_waitcnt lgkmcnt(6)
    v_mfma_f32_16x16x32_bf16 v[196:199], v[44:47], v[104:107], v[196:199]
    ds_read_b64_tr_b16 v[60:61], v21 offset:28672
    v_mfma_f32_16x16x32_bf16 v[212:215], v[44:47], v[108:111], v[212:215]
    ds_read_b64_tr_b16 v[62:63], v21 offset:30720
    v_and_b32 v18, 0xffff0000, v32
    v_add_f32 v14, v14, v17
    v_add_f32 v14, v14, v18
    v_lshlrev_b32 v17, 16, v33
    s_waitcnt vmcnt(6)
    ds_read_b128 v[112:115], v8 offset:0
    ds_read_b128 v[116:119], v8 offset:2048
    s_waitcnt lgkmcnt(8)
    v_mfma_f32_16x16x32_bf16 v[200:203], v[48:51], v[104:107], v[200:203]
    ds_read_b64_tr_b16 v[44:45], v20 offset:29184
    v_mfma_f32_16x16x32_bf16 v[216:219], v[48:51], v[108:111], v[216:219]
    ds_read_b64_tr_b16 v[46:47], v20 offset:31232
    v_and_b32 v18, 0xffff0000, v33
    v_add_f32 v14, v14, v17
    v_add_f32 v14, v14, v18
    v_lshlrev_b32 v17, 16, v34
    ds_read_b128 v[120:123], v9 offset:0
    ds_read_b128 v[124:127], v9 offset:2048
    s_waitcnt lgkmcnt(10)
    v_mfma_f32_16x16x32_bf16 v[204:207], v[52:55], v[104:107], v[204:207]
    ds_read_b64_tr_b16 v[48:49], v21 offset:29184
    v_mfma_f32_16x16x32_bf16 v[220:223], v[52:55], v[108:111], v[220:223]
    ds_read_b64_tr_b16 v[50:51], v21 offset:31232
    v_and_b32 v18, 0xffff0000, v34
    v_add_f32 v14, v14, v17
    v_add_f32 v14, v14, v18
    v_lshlrev_b32 v17, 16, v35
    s_barrier
    s_waitcnt lgkmcnt(10)
    v_mfma_f32_16x16x32_bf16 v[224:227], v[56:59], v[72:75], v[224:227]
    ds_read_b64_tr_b16 v[52:53], v20 offset:32768
    v_mfma_f32_16x16x32_bf16 v[240:243], v[56:59], v[76:79], v[240:243]
    ds_read_b64_tr_b16 v[54:55], v20 offset:34816
    v_and_b32 v18, 0xffff0000, v35
    v_add_f32 v14, v14, v17
    v_add_f32 v14, v14, v18
    s_add_u32 s38, s27, 10
    s_and_b32 s38, s38, 15
    s_lshl_b32 s38, s38, 18
    s_add_u32 s38, s38, s29
    s_add_u32 m0, s30, 65536
    s_add_u32 s38, s38, 0
    buffer_load_dwordx4 v10, s[8:11], s38 offen lds
    s_waitcnt lgkmcnt(10)
    v_mfma_f32_16x16x32_bf16 v[228:231], v[60:63], v[72:75], v[228:231]
    ds_read_b64_tr_b16 v[56:57], v21 offset:32768
    v_mfma_f32_16x16x32_bf16 v[244:247], v[60:63], v[76:79], v[244:247]
    ds_read_b64_tr_b16 v[58:59], v21 offset:34816
    v_add_f32_dpp v14, v14, v14 quad_perm:[1,0,3,2] row_mask:0xf bank_mask:0xf
    buffer_load_dwordx4 v11, s[8:11], s38 offen offset:1024 lds
    s_waitcnt lgkmcnt(8)
    v_mfma_f32_16x16x32_bf16 v[232:235], v[44:47], v[72:75], v[232:235]
    ds_read_b64_tr_b16 v[60:61], v20 offset:33280
    v_mfma_f32_16x16x32_bf16 v[248:251], v[44:47], v[76:79], v[248:251]
    ds_read_b64_tr_b16 v[62:63], v20 offset:35328
    v_add_f32_dpp v14, v14, v14 quad_perm:[2,3,0,1] row_mask:0xf bank_mask:0xf
    s_add_u32 s38, s27, 12
    s_and_b32 s38, s38, 15
    s_lshl_b32 s38, s38, 18
    s_add_u32 s38, s38, s29
    s_add_u32 m0, s30, 81920
    s_add_u32 s38, s38, 0
    buffer_load_dwordx4 v10, s[8:11], s38 offen lds
    s_waitcnt lgkmcnt(6)
    v_mfma_f32_16x16x32_bf16 v[236:239], v[48:51], v[72:75], v[236:239]
    ds_read_b64_tr_b16 v[44:45], v21 offset:33280
    v_mfma_f32_16x16x32_bf16 v[252:255], v[48:51], v[76:79], v[252:255]
    ds_read_b64_tr_b16 v[46:47], v21 offset:35328
    v_add_f32_dpp v14, v14, v14 row_half_mirror row_mask:0xf bank_mask:0xf
    buffer_load_dwordx4 v11, s[8:11], s38 offen offset:1024 lds
    s_waitcnt lgkmcnt(6)
    v_mfma_f32_16x16x32_bf16 v[192:195], v[52:55], v[112:115], v[192:195]
    ds_read_b64_tr_b16 v[48:49], v20 offset:36864
    v_mfma_f32_16x16x32_bf16 v[208:211], v[52:55], v[116:119], v[208:211]
    ds_read_b64_tr_b16 v[50:51], v20 offset:38912
    v_add_f32_dpp v14, v14, v14 row_mirror row_mask:0xf bank_mask:0xf
    v_mov_b32 v15, v14
    s_add_u32 s38, s25, 5
    s_and_b32 s38, s38, 7
    s_lshl_b32 s38, s38, 7
    s_add_u32 m0, s31, 0
    s_add_u32 s38, s38, s32
    buffer_load_dwordx4 v4, s[4:7], s38 offen offset:0 lds
    s_waitcnt lgkmcnt(6)
    v_mfma_f32_16x16x32_bf16 v[196:199], v[56:59], v[112:115], v[196:199]
    ds_read_b64_tr_b16 v[52:53], v21 offset:36864
    v_mfma_f32_16x16x32_bf16 v[212:215], v[56:59], v[116:119], v[212:215]
    ds_read_b64_tr_b16 v[54:55], v21 offset:38912
    v_permlane16_swap_b32 v14, v15
    buffer_load_dwordx4 v5, s[4:7], s38 offen offset:1024 lds
    s_waitcnt lgkmcnt(6)
    v_mfma_f32_16x16x32_bf16 v[200:203], v[60:63], v[112:115], v[200:203]
    ds_read_b64_tr_b16 v[56:57], v20 offset:37376
    v_mfma_f32_16x16x32_bf16 v[216:219], v[60:63], v[116:119], v[216:219]
    ds_read_b64_tr_b16 v[58:59], v20 offset:39424
    v_add_f32 v14, v14, v15
    v_mov_b32 v15, v14
    buffer_load_dwordx4 v6, s[4:7], s38 offen offset:2048 lds
    s_waitcnt lgkmcnt(6)
    v_mfma_f32_16x16x32_bf16 v[204:207], v[44:47], v[112:115], v[204:207]
    ds_read_b64_tr_b16 v[60:61], v21 offset:37376
    v_mfma_f32_16x16x32_bf16 v[220:223], v[44:47], v[116:119], v[220:223]
    ds_read_b64_tr_b16 v[62:63], v21 offset:39424
    v_permlane32_swap_b32 v14, v15
    buffer_load_dwordx4 v7, s[4:7], s38 offen offset:3072 lds
    s_waitcnt lgkmcnt(6)
    v_mfma_f32_16x16x32_bf16 v[224:227], v[48:51], v[80:83], v[224:227]
    ds_read_b64_tr_b16 v[44:45], v20 offset:40960
    v_mfma_f32_16x16x32_bf16 v[240:243], v[48:51], v[84:87], v[240:243]
    ds_read_b64_tr_b16 v[46:47], v20 offset:43008
    v_add_f32 v14, v14, v15
    v_mul_f32 v16, 0.0015625, v14
    v_lshlrev_b32 v17, 16, v32
    v_and_b32 v18, 0xffff0000, v32
    s_add_u32 s38, s27, 14
    s_and_b32 s38, s38, 15
    s_lshl_b32 s38, s38, 18
    s_add_u32 s38, s38, s29
    s_add_u32 m0, s30, 0
    s_add_u32 s38, s38, 0
    buffer_load_dwordx4 v10, s[8:11], s38 offen lds
    s_waitcnt lgkmcnt(6)
    v_mfma_f32_16x16x32_bf16 v[228:231], v[52:55], v[80:83], v[228:231]
    ds_read_b64_tr_b16 v[48:49], v21 offset:40960
    v_mfma_f32_16x16x32_bf16 v[244:247], v[52:55], v[84:87], v[244:247]
    ds_read_b64_tr_b16 v[50:51], v21 offset:43008
    v_sub_f32 v17, v17, v16
    v_sub_f32 v18, v18, v16
    v_mul_f32 v14, v17, v17
    v_fmac_f32 v14, v18, v18
    buffer_load_dwordx4 v11, s[8:11], s38 offen offset:1024 lds
    s_waitcnt lgkmcnt(6)
    v_mfma_f32_16x16x32_bf16 v[232:235], v[56:59], v[80:83], v[232:235]
    ds_read_b64_tr_b16 v[52:53], v20 offset:41472
    v_mfma_f32_16x16x32_bf16 v[248:251], v[56:59], v[84:87], v[248:251]
    ds_read_b64_tr_b16 v[54:55], v20 offset:43520
    v_lshlrev_b32 v17, 16, v33
    v_and_b32 v18, 0xffff0000, v33
    v_sub_f32 v17, v17, v16
    v_sub_f32 v18, v18, v16
    s_waitcnt lgkmcnt(6)
    v_mfma_f32_16x16x32_bf16 v[236:239], v[60:63], v[80:83], v[236:239]
    ds_read_b64_tr_b16 v[56:57], v21 offset:41472
    v_mfma_f32_16x16x32_bf16 v[252:255], v[60:63], v[84:87], v[252:255]
    ds_read_b64_tr_b16 v[58:59], v21 offset:43520
    v_fmac_f32 v14, v17, v17
    v_fmac_f32 v14, v18, v18
    v_lshlrev_b32 v17, 16, v34
    v_and_b32 v18, 0xffff0000, v34
    s_waitcnt lgkmcnt(6)
    v_mfma_f32_16x16x32_bf16 v[192:195], v[44:47], v[120:123], v[192:195]
    ds_read_b64_tr_b16 v[60:61], v20 offset:45056
    v_mfma_f32_16x16x32_bf16 v[208:211], v[44:47], v[124:127], v[208:211]
    ds_read_b64_tr_b16 v[62:63], v20 offset:47104
    v_sub_f32 v17, v17, v16
    v_sub_f32 v18, v18, v16
    v_fmac_f32 v14, v17, v17
    v_fmac_f32 v14, v18, v18
    s_lshl_b32 s39, s21, 3
    s_add_u32 s39, s39, s22
    v_bfe_u32 v19, v1, 4, 1
    v_lshrrev_b32 v27, 5, v1
    v_lshlrev_b32 v19, 7, v19
    v_lshl_add_u32 v19, v27, 13, v19
    s_mul_i32 s38, s39, 65536
    s_lshl_b32 s39, s20, 8
    s_add_u32 s38, s38, s39
    s_bfm_b64 exec, 16, 0
    buffer_load_dword v3, v19, s[16:19], s38 offen
    s_mov_b64 exec, -1
    s_waitcnt lgkmcnt(6)
    v_mfma_f32_16x16x32_bf16 v[196:199], v[48:51], v[120:123], v[196:199]
    ds_read_b64_tr_b16 v[44:45], v21 offset:45056
    v_mfma_f32_16x16x32_bf16 v[212:215], v[48:51], v[124:127], v[212:215]
    ds_read_b64_tr_b16 v[46:47], v21 offset:47104
    v_lshlrev_b32 v17, 16, v35
    v_and_b32 v18, 0xffff0000, v35
    v_sub_f32 v17, v17, v16
    v_sub_f32 v18, v18, v16
    s_waitcnt vmcnt(11)
    ds_read_b128 v[128:131], v8 offset:32768
    ds_read_b128 v[132:135], v8 offset:34816
    s_waitcnt lgkmcnt(8)
    v_mfma_f32_16x16x32_bf16 v[200:203], v[52:55], v[120:123], v[200:203]
    ds_read_b64_tr_b16 v[48:49], v20 offset:45568
    v_mfma_f32_16x16x32_bf16 v[216:219], v[52:55], v[124:127], v[216:219]
    ds_read_b64_tr_b16 v[50:51], v20 offset:47616
    v_fmac_f32 v14, v17, v17
    v_fmac_f32 v14, v18, v18
    v_cndmask_b32 v14, 0, v14, vcc
    v_lshlrev_b32 v17, 16, v28
    ds_read_b128 v[136:139], v9 offset:32768
    ds_read_b128 v[140:143], v9 offset:34816
    s_waitcnt lgkmcnt(10)
    v_mfma_f32_16x16x32_bf16 v[204:207], v[56:59], v[120:123], v[204:207]
    ds_read_b64_tr_b16 v[52:53], v21 offset:45568
    v_mfma_f32_16x16x32_bf16 v[220:223], v[56:59], v[124:127], v[220:223]
    ds_read_b64_tr_b16 v[54:55], v21 offset:47616
    v_and_b32 v18, 0xffff0000, v28
    v_sub_f32 v17, v17, v16
    v_sub_f32 v18, v18, v16
    v_fmac_f32 v14, v17, v17
    s_barrier
    s_waitcnt lgkmcnt(10)
    v_mfma_f32_16x16x32_bf16 v[224:227], v[60:63], v[88:91], v[224:227]
    ds_read_b64_tr_b16 v[56:57], v22 offset:0
    v_mfma_f32_16x16x32_bf16 v[240:243], v[60:63], v[92:95], v[240:243]
    ds_read_b64_tr_b16 v[58:59], v22 offset:2048
    v_fmac_f32 v14, v18, v18
    v_lshlrev_b32 v17, 16, v29
    v_and_b32 v18, 0xffff0000, v29
    v_sub_f32 v17, v17, v16
    s_add_u32 s38, s26, 12
    s_and_b32 s38, s38, 15
    s_lshl_b32 s38, s38, 18
    s_add_u32 s38, s38, s28
    s_add_u32 m0, s30, 16384
    s_add_u32 s38, s38, 128
    buffer_load_dwordx4 v10, s[8:11], s38 offen lds
    s_waitcnt lgkmcnt(10)
    v_mfma_f32_16x16x32_bf16 v[228:231], v[44:47], v[88:91], v[228:231]
    ds_read_b64_tr_b16 v[60:61], v23 offset:0
    v_mfma_f32_16x16x32_bf16 v[244:247], v[44:47], v[92:95], v[244:247]
    ds_read_b64_tr_b16 v[62:63], v23 offset:2048
    v_sub_f32 v18, v18, v16
    v_fmac_f32 v14, v17, v17
    v_fmac_f32 v14, v18, v18
    v_lshlrev_b32 v17, 16, v30
    buffer_load_dwordx4 v11, s[8:11], s38 offen offset:1024 lds
    s_waitcnt lgkmcnt(8)
    v_mfma_f32_16x16x32_bf16 v[232:235], v[48:51], v[88:91], v[232:235]
    ds_read_b64_tr_b16 v[44:45], v22 offset:512
    v_mfma_f32_16x16x32_bf16 v[248:251], v[48:51], v[92:95], v[248:251]
    ds_read_b64_tr_b16 v[46:47], v22 offset:2560
    v_and_b32 v18, 0xffff0000, v30
    v_sub_f32 v17, v17, v16
    v_sub_f32 v18, v18, v16
    v_fmac_f32 v14, v17, v17
    s_waitcnt lgkmcnt(6)
    v_mfma_f32_16x16x32_bf16 v[236:239], v[52:55], v[88:91], v[236:239]
    ds_read_b64_tr_b16 v[48:49], v23 offset:512
    v_mfma_f32_16x16x32_bf16 v[252:255], v[52:55], v[92:95], v[252:255]
    ds_read_b64_tr_b16 v[50:51], v23 offset:2560
    v_fmac_f32 v14, v18, v18
    v_lshlrev_b32 v17, 16, v31
    v_and_b32 v18, 0xffff0000, v31
    v_sub_f32 v17, v17, v16
    s_waitcnt lgkmcnt(6)
    v_mfma_f32_16x16x32_bf16 v[192:195], v[56:59], v[128:131], v[192:195]
    ds_read_b64_tr_b16 v[52:53], v22 offset:4096
    v_mfma_f32_16x16x32_bf16 v[208:211], v[56:59], v[132:135], v[208:211]
    ds_read_b64_tr_b16 v[54:55], v22 offset:6144
    v_sub_f32 v18, v18, v16
    v_fmac_f32 v14, v17, v17
    v_fmac_f32 v14, v18, v18
    s_add_u32 s38, s25, 6
    s_and_b32 s38, s38, 7
    s_lshl_b32 s38, s38, 7
    s_add_u32 m0, s31, 32768
    s_add_u32 s38, s38, s32
    buffer_load_dwordx4 v4, s[4:7], s38 offen offset:0 lds
    s_waitcnt lgkmcnt(6)
    v_mfma_f32_16x16x32_bf16 v[196:199], v[60:63], v[128:131], v[196:199]
    ds_read_b64_tr_b16 v[56:57], v23 offset:4096
    v_mfma_f32_16x16x32_bf16 v[212:215], v[60:63], v[132:135], v[212:215]
    ds_read_b64_tr_b16 v[58:59], v23 offset:6144
    v_add_f32_dpp v14, v14, v14 quad_perm:[1,0,3,2] row_mask:0xf bank_mask:0xf
    s_waitcnt lgkmcnt(6)
    v_mfma_f32_16x16x32_bf16 v[200:203], v[44:47], v[128:131], v[200:203]
    ds_read_b64_tr_b16 v[60:61], v22 offset:4608
    v_mfma_f32_16x16x32_bf16 v[216:219], v[44:47], v[132:135], v[216:219]
    ds_read_b64_tr_b16 v[62:63], v22 offset:6656
    v_add_f32_dpp v14, v14, v14 quad_perm:[2,3,0,1] row_mask:0xf bank_mask:0xf
    buffer_load_dwordx4 v5, s[4:7], s38 offen offset:1024 lds
    s_waitcnt lgkmcnt(6)
    v_mfma_f32_16x16x32_bf16 v[204:207], v[48:51], v[128:131], v[204:207]
    ds_read_b64_tr_b16 v[44:45], v23 offset:4608
    v_mfma_f32_16x16x32_bf16 v[220:223], v[48:51], v[132:135], v[220:223]
    ds_read_b64_tr_b16 v[46:47], v23 offset:6656
    v_add_f32_dpp v14, v14, v14 row_half_mirror row_mask:0xf bank_mask:0xf
    s_waitcnt lgkmcnt(6)
    v_mfma_f32_16x16x32_bf16 v[224:227], v[52:55], v[96:99], v[224:227]
    ds_read_b64_tr_b16 v[48:49], v22 offset:8192
    v_mfma_f32_16x16x32_bf16 v[240:243], v[52:55], v[100:103], v[240:243]
    ds_read_b64_tr_b16 v[50:51], v22 offset:10240
    v_add_f32_dpp v14, v14, v14 row_mirror row_mask:0xf bank_mask:0xf
    v_mov_b32 v15, v14
    buffer_load_dwordx4 v6, s[4:7], s38 offen offset:2048 lds
    s_waitcnt lgkmcnt(6)
    v_mfma_f32_16x16x32_bf16 v[228:231], v[56:59], v[96:99], v[228:231]
    ds_read_b64_tr_b16 v[52:53], v23 offset:8192
    v_mfma_f32_16x16x32_bf16 v[244:247], v[56:59], v[100:103], v[244:247]
    ds_read_b64_tr_b16 v[54:55], v23 offset:10240
    v_permlane16_swap_b32 v14, v15
    s_waitcnt lgkmcnt(6)
    v_mfma_f32_16x16x32_bf16 v[232:235], v[60:63], v[96:99], v[232:235]
    ds_read_b64_tr_b16 v[56:57], v22 offset:8704
    v_mfma_f32_16x16x32_bf16 v[248:251], v[60:63], v[100:103], v[248:251]
    ds_read_b64_tr_b16 v[58:59], v22 offset:10752
    v_add_f32 v14, v14, v15
    v_mov_b32 v15, v14
    buffer_load_dwordx4 v7, s[4:7], s38 offen offset:3072 lds
    s_waitcnt lgkmcnt(6)
    v_mfma_f32_16x16x32_bf16 v[236:239], v[44:47], v[96:99], v[236:239]
    ds_read_b64_tr_b16 v[60:61], v23 offset:8704
    v_mfma_f32_16x16x32_bf16 v[252:255], v[44:47], v[100:103], v[252:255]
    ds_read_b64_tr_b16 v[62:63], v23 offset:10752
    v_permlane32_swap_b32 v14, v15
    s_waitcnt lgkmcnt(6)
    v_mfma_f32_16x16x32_bf16 v[192:195], v[48:51], v[136:139], v[192:195]
    ds_read_b64_tr_b16 v[44:45], v22 offset:12288
    v_mfma_f32_16x16x32_bf16 v[208:211], v[48:51], v[140:143], v[208:211]
    ds_read_b64_tr_b16 v[46:47], v22 offset:14336
    v_add_f32 v14, v14, v15
    v_mul_f32 v14, 0.0015625, v14
    v_cvt_pk_bf16_f32 v14, v14, v14
    v_and_b32 v14, 0xffff0000, v14
    s_lshl_b32 s39, s21, 3
    s_add_u32 s39, s39, s22
    v_lshrrev_b32 v19, 4, v1
    v_mul_u32_u24 v19, 3456, v19
    s_mul_i32 s38, s39, 34560
    s_lshl_b32 s39, s56, 6
    s_add_u32 s38, s38, s39
    s_bfm_b64 exec, 10, 0
    buffer_load_dword v3, v19, s[64:67], s38 offen
    s_mov_b64 exec, -1
    s_mov_b64 exec, 9
    global_load_dword v3, v1, s[100:101]
    s_mov_b64 exec, -1
    s_waitcnt lgkmcnt(6)
    v_mfma_f32_16x16x32_bf16 v[196:199], v[52:55], v[136:139], v[196:199]
    ds_read_b64_tr_b16 v[48:49], v23 offset:12288
    v_mfma_f32_16x16x32_bf16 v[212:215], v[52:55], v[140:143], v[212:215]
    ds_read_b64_tr_b16 v[50:51], v23 offset:14336
    v_add_f32 v14, 1e-05, v14
    v_cvt_pk_bf16_f32 v14, v14, v14
    v_and_b32 v14, 0xffff0000, v14
    v_sqrt_f32 v14, v14
    s_waitcnt vmcnt(11)
    ds_read_b128 v[144:147], v8 offset:0
    ds_read_b128 v[148:151], v8 offset:2048
    s_waitcnt lgkmcnt(8)
    v_mfma_f32_16x16x32_bf16 v[200:203], v[56:59], v[136:139], v[200:203]
    ds_read_b64_tr_b16 v[52:53], v22 offset:12800
    v_mfma_f32_16x16x32_bf16 v[216:219], v[56:59], v[140:143], v[216:219]
    ds_read_b64_tr_b16 v[54:55], v22 offset:14848
    v_cvt_pk_bf16_f32 v14, v14, v14
    v_and_b32 v14, 0xffff0000, v14
    v_rcp_f32 v15, v14
    ds_read_b128 v[152:155], v9 offset:0
    ds_read_b128 v[156:159], v9 offset:2048
    s_waitcnt lgkmcnt(10)
    v_mfma_f32_16x16x32_bf16 v[204:207], v[60:63], v[136:139], v[204:207]
    ds_read_b64_tr_b16 v[56:57], v23 offset:12800
    v_mfma_f32_16x16x32_bf16 v[220:223], v[60:63], v[140:143], v[220:223]
    ds_read_b64_tr_b16 v[58:59], v23 offset:14848
    v_cvt_pk_bf16_f32 v16, v16, v16
    v_and_b32 v16, 0xffff0000, v16
    v_lshlrev_b32 v17, 16, v28
    v_and_b32 v18, 0xffff0000, v28
    s_barrier
    s_waitcnt lgkmcnt(10)
    v_mfma_f32_16x16x32_bf16 v[224:227], v[44:47], v[104:107], v[224:227]
    ds_read_b64_tr_b16 v[60:61], v22 offset:16384
    v_mfma_f32_16x16x32_bf16 v[240:243], v[44:47], v[108:111], v[240:243]
    ds_read_b64_tr_b16 v[62:63], v22 offset:18432
    v_sub_f32 v17, v17, v16
    v_sub_f32 v18, v18, v16
    v_cvt_pk_bf16_f32 v28, v17, v18
    v_lshlrev_b32 v17, 16, v28
    s_add_u32 s38, s26, 0
    s_and_b32 s38, s38, 15
    s_lshl_b32 s38, s38, 18
    s_add_u32 s38, s38, s28
    s_add_u32 m0, s30, 32768
    s_add_u32 s38, s38, 0
    buffer_load_dwordx4 v10, s[16:19], s38 offen lds
    s_waitcnt lgkmcnt(10)
    v_mfma_f32_16x16x32_bf16 v[228:231], v[48:51], v[104:107], v[228:231]
    ds_read_b64_tr_b16 v[44:45], v23 offset:16384
    v_mfma_f32_16x16x32_bf16 v[244:247], v[48:51], v[108:111], v[244:247]
    ds_read_b64_tr_b16 v[46:47], v23 offset:18432
    v_and_b32 v18, 0xffff0000, v28
    v_mul_f32 v17, v17, v15
    v_mul_f32 v18, v18, v15
    v_cvt_pk_bf16_f32 v28, v17, v18
    s_waitcnt lgkmcnt(8)
    v_mfma_f32_16x16x32_bf16 v[232:235], v[52:55], v[104:107], v[232:235]
    ds_read_b64_tr_b16 v[48:49], v22 offset:16896
    v_mfma_f32_16x16x32_bf16 v[248:251], v[52:55], v[108:111], v[248:251]
    ds_read_b64_tr_b16 v[50:51], v22 offset:18944
    v_lshlrev_b32 v17, 16, v29
    v_and_b32 v18, 0xffff0000, v29
    v_sub_f32 v17, v17, v16
    v_sub_f32 v18, v18, v16
    buffer_load_dwordx4 v11, s[16:19], s38 offen offset:1024 lds
    s_waitcnt lgkmcnt(6)
    v_mfma_f32_16x16x32_bf16 v[236:239], v[56:59], v[104:107], v[236:239]
    ds_read_b64_tr_b16 v[52:53], v23 offset:16896
    v_mfma_f32_16x16x32_bf16 v[252:255], v[56:59], v[108:111], v[252:255]
    ds_read_b64_tr_b16 v[54:55], v23 offset:18944
    v_cvt_pk_bf16_f32 v29, v17, v18
    v_lshlrev_b32 v17, 16, v29
    v_and_b32 v18, 0xffff0000, v29
    v_mul_f32 v17, v17, v15
    s_waitcnt lgkmcnt(6)
    v_mfma_f32_16x16x32_bf16 v[192:195], v[60:63], v[144:147], v[192:195]
    ds_read_b64_tr_b16 v[56:57], v22 offset:20480
    v_mfma_f32_16x16x32_bf16 v[208:211], v[60:63], v[148:151], v[208:211]
    ds_read_b64_tr_b16 v[58:59], v22 offset:22528
    v_mul_f32 v18, v18, v15
    v_cvt_pk_bf16_f32 v29, v17, v18
    v_lshlrev_b32 v17, 16, v30
    v_and_b32 v18, 0xffff0000, v30
    s_add_u32 s38, s25, 7
    s_and_b32 s38, s38, 7
    s_lshl_b32 s38, s38, 7
    s_add_u32 m0, s31, 0
    s_add_u32 s38, s38, s32
    buffer_load_dwordx4 v4, s[4:7], s38 offen offset:0 lds
    s_waitcnt lgkmcnt(6)
    v_mfma_f32_16x16x32_bf16 v[196:199], v[44:47], v[144:147], v[196:199]
    ds_read_b64_tr_b16 v[60:61], v23 offset:20480
    v_mfma_f32_16x16x32_bf16 v[212:215], v[44:47], v[148:151], v[212:215]
    ds_read_b64_tr_b16 v[62:63], v23 offset:22528
    v_sub_f32 v17, v17, v16
    v_sub_f32 v18, v18, v16
    v_cvt_pk_bf16_f32 v30, v17, v18
    v_lshlrev_b32 v17, 16, v30
    s_waitcnt lgkmcnt(6)
    v_mfma_f32_16x16x32_bf16 v[200:203], v[48:51], v[144:147], v[200:203]
    ds_read_b64_tr_b16 v[44:45], v22 offset:20992
    v_mfma_f32_16x16x32_bf16 v[216:219], v[48:51], v[148:151], v[216:219]
    ds_read_b64_tr_b16 v[46:47], v22 offset:23040
    v_and_b32 v18, 0xffff0000, v30
    v_mul_f32 v17, v17, v15
    v_mul_f32 v18, v18, v15
    v_cvt_pk_bf16_f32 v30, v17, v18
    buffer_load_dwordx4 v5, s[4:7], s38 offen offset:1024 lds
    s_waitcnt lgkmcnt(6)
    v_mfma_f32_16x16x32_bf16 v[204:207], v[52:55], v[144:147], v[204:207]
    ds_read_b64_tr_b16 v[48:49], v23 offset:20992
    v_mfma_f32_16x16x32_bf16 v[220:223], v[52:55], v[148:151], v[220:223]
    ds_read_b64_tr_b16 v[50:51], v23 offset:23040
    v_lshlrev_b32 v17, 16, v31
    v_and_b32 v18, 0xffff0000, v31
    v_sub_f32 v17, v17, v16
    v_sub_f32 v18, v18, v16
    s_waitcnt lgkmcnt(6)
    v_mfma_f32_16x16x32_bf16 v[224:227], v[56:59], v[112:115], v[224:227]
    ds_read_b64_tr_b16 v[52:53], v22 offset:24576
    v_mfma_f32_16x16x32_bf16 v[240:243], v[56:59], v[116:119], v[240:243]
    ds_read_b64_tr_b16 v[54:55], v22 offset:26624
    v_cvt_pk_bf16_f32 v31, v17, v18
    v_lshlrev_b32 v17, 16, v31
    v_and_b32 v18, 0xffff0000, v31
    v_mul_f32 v17, v17, v15
    buffer_load_dwordx4 v6, s[4:7], s38 offen offset:2048 lds
    s_waitcnt lgkmcnt(6)
    v_mfma_f32_16x16x32_bf16 v[228:231], v[60:63], v[112:115], v[228:231]
    ds_read_b64_tr_b16 v[56:57], v23 offset:24576
    v_mfma_f32_16x16x32_bf16 v[244:247], v[60:63], v[116:119], v[244:247]
    ds_read_b64_tr_b16 v[58:59], v23 offset:26624
    v_mul_f32 v18, v18, v15
    v_cvt_pk_bf16_f32 v31, v17, v18
    v_lshlrev_b32 v17, 16, v32
    v_and_b32 v18, 0xffff0000, v32
    s_waitcnt lgkmcnt(6)
    v_mfma_f32_16x16x32_bf16 v[232:235], v[44:47], v[112:115], v[232:235]
    ds_read_b64_tr_b16 v[60:61], v22 offset:25088
    v_mfma_f32_16x16x32_bf16 v[248:251], v[44:47], v[116:119], v[248:251]
    ds_read_b64_tr_b16 v[62:63], v22 offset:27136
    v_sub_f32 v17, v17, v16
    v_sub_f32 v18, v18, v16
    v_cvt_pk_bf16_f32 v32, v17, v18
    v_lshlrev_b32 v17, 16, v32
    buffer_load_dwordx4 v7, s[4:7], s38 offen offset:3072 lds
    s_waitcnt lgkmcnt(6)
    v_mfma_f32_16x16x32_bf16 v[236:239], v[48:51], v[112:115], v[236:239]
    ds_read_b64_tr_b16 v[44:45], v23 offset:25088
    v_mfma_f32_16x16x32_bf16 v[252:255], v[48:51], v[116:119], v[252:255]
    ds_read_b64_tr_b16 v[46:47], v23 offset:27136
    v_and_b32 v18, 0xffff0000, v32
    v_mul_f32 v17, v17, v15
    v_mul_f32 v18, v18, v15
    v_cvt_pk_bf16_f32 v32, v17, v18
    s_waitcnt lgkmcnt(6)
    v_mfma_f32_16x16x32_bf16 v[192:195], v[52:55], v[152:155], v[192:195]
    ds_read_b64_tr_b16 v[48:49], v22 offset:28672
    v_mfma_f32_16x16x32_bf16 v[208:211], v[52:55], v[156:159], v[208:211]
    ds_read_b64_tr_b16 v[50:51], v22 offset:30720
    v_lshlrev_b32 v17, 16, v33
    v_and_b32 v18, 0xffff0000, v33
    v_sub_f32 v17, v17, v16
    v_sub_f32 v18, v18, v16
    s_waitcnt lgkmcnt(6)
    v_mfma_f32_16x16x32_bf16 v[196:199], v[56:59], v[152:155], v[196:199]
    ds_read_b64_tr_b16 v[52:53], v23 offset:28672
    v_mfma_f32_16x16x32_bf16 v[212:215], v[56:59], v[156:159], v[212:215]
    ds_read_b64_tr_b16 v[54:55], v23 offset:30720
    v_cvt_pk_bf16_f32 v33, v17, v18
    v_lshlrev_b32 v17, 16, v33
    v_and_b32 v18, 0xffff0000, v33
    v_mul_f32 v17, v17, v15
    s_waitcnt vmcnt(8)
    ds_read_b128 v[160:163], v8 offset:32768
    ds_read_b128 v[164:167], v8 offset:34816
    s_waitcnt lgkmcnt(8)
    v_mfma_f32_16x16x32_bf16 v[200:203], v[60:63], v[152:155], v[200:203]
    ds_read_b64_tr_b16 v[56:57], v22 offset:29184
    v_mfma_f32_16x16x32_bf16 v[216:219], v[60:63], v[156:159], v[216:219]
    ds_read_b64_tr_b16 v[58:59], v22 offset:31232
    v_mul_f32 v18, v18, v15
    v_cvt_pk_bf16_f32 v33, v17, v18
    v_lshlrev_b32 v17, 16, v34
    v_and_b32 v18, 0xffff0000, v34
    ds_read_b128 v[168:171], v9 offset:32768
    ds_read_b128 v[172:175], v9 offset:34816
    s_waitcnt lgkmcnt(10)
    v_mfma_f32_16x16x32_bf16 v[204:207], v[44:47], v[152:155], v[204:207]
    ds_read_b64_tr_b16 v[60:61], v23 offset:29184
    v_mfma_f32_16x16x32_bf16 v[220:223], v[44:47], v[156:159], v[220:223]
    ds_read_b64_tr_b16 v[62:63], v23 offset:31232
    v_sub_f32 v17, v17, v16
    v_sub_f32 v18, v18, v16
    v_cvt_pk_bf16_f32 v34, v17, v18
    v_lshlrev_b32 v17, 16, v34
    s_barrier
    s_waitcnt lgkmcnt(10)
    v_mfma_f32_16x16x32_bf16 v[224:227], v[48:51], v[120:123], v[224:227]
    ds_read_b64_tr_b16 v[44:45], v22 offset:32768
    v_mfma_f32_16x16x32_bf16 v[240:243], v[48:51], v[124:127], v[240:243]
    ds_read_b64_tr_b16 v[46:47], v22 offset:34816
    v_and_b32 v18, 0xffff0000, v34
    v_mul_f32 v17, v17, v15
    v_mul_f32 v18, v18, v15
    v_cvt_pk_bf16_f32 v34, v17, v18
    s_lshl_b32 s39, s21, 3
    s_add_u32 s39, s39, s22
    v_bfe_u32 v19, v1, 4, 1
    v_lshrrev_b32 v27, 5, v1
    v_lshlrev_b32 v19, 7, v19
    v_lshl_add_u32 v19, v27, 13, v19
    s_mul_i32 s38, s39, 81920
    s_lshl_b32 s39, s20, 8
    s_add_u32 s38, s38, s39
    s_bfm_b64 exec, 20, 0
    buffer_load_dword v3, v19, s[60:63], s38 offen
    s_mov_b64 exec, -1
    s_waitcnt lgkmcnt(10)
    v_mfma_f32_16x16x32_bf16 v[228:231], v[52:55], v[120:123], v[228:231]
    ds_read_b64_tr_b16 v[48:49], v23 offset:32768
    v_mfma_f32_16x16x32_bf16 v[244:247], v[52:55], v[124:127], v[244:247]
    ds_read_b64_tr_b16 v[50:51], v23 offset:34816
    v_lshlrev_b32 v17, 16, v35
    v_and_b32 v18, 0xffff0000, v35
    v_sub_f32 v17, v17, v16
    v_sub_f32 v18, v18, v16
    s_waitcnt lgkmcnt(8)
    v_mfma_f32_16x16x32_bf16 v[232:235], v[56:59], v[120:123], v[232:235]
    ds_read_b64_tr_b16 v[52:53], v22 offset:33280
    v_mfma_f32_16x16x32_bf16 v[248:251], v[56:59], v[124:127], v[248:251]
    ds_read_b64_tr_b16 v[54:55], v22 offset:35328
    v_cvt_pk_bf16_f32 v35, v17, v18
    v_lshlrev_b32 v17, 16, v35
    v_and_b32 v18, 0xffff0000, v35
    v_mul_f32 v17, v17, v15
    s_waitcnt lgkmcnt(6)
    v_mfma_f32_16x16x32_bf16 v[236:239], v[60:63], v[120:123], v[236:239]
    ds_read_b64_tr_b16 v[56:57], v23 offset:33280
    v_mfma_f32_16x16x32_bf16 v[252:255], v[60:63], v[124:127], v[252:255]
    ds_read_b64_tr_b16 v[58:59], v23 offset:35328
    v_mul_f32 v18, v18, v15
    v_cvt_pk_bf16_f32 v35, v17, v18
    s_waitcnt lgkmcnt(6)
    v_mfma_f32_16x16x32_bf16 v[192:195], v[44:47], v[160:163], v[192:195]
    ds_read_b64_tr_b16 v[60:61], v22 offset:36864
    v_mfma_f32_16x16x32_bf16 v[208:211], v[44:47], v[164:167], v[208:211]
    ds_read_b64_tr_b16 v[62:63], v22 offset:38912
    ds_write_b128 v42, v[28:31] offset:0
    ds_write_b128 v42, v[32:35] offset:8192
    s_waitcnt lgkmcnt(8)
    v_mfma_f32_16x16x32_bf16 v[196:199], v[48:51], v[160:163], v[196:199]
    ds_read_b64_tr_b16 v[44:45], v23 offset:36864
    v_mfma_f32_16x16x32_bf16 v[212:215], v[48:51], v[164:167], v[212:215]
    ds_read_b64_tr_b16 v[46:47], v23 offset:38912
    s_waitcnt lgkmcnt(8)
    v_mfma_f32_16x16x32_bf16 v[200:203], v[52:55], v[160:163], v[200:203]
    ds_read_b64_tr_b16 v[48:49], v22 offset:37376
    v_mfma_f32_16x16x32_bf16 v[216:219], v[52:55], v[164:167], v[216:219]
    ds_read_b64_tr_b16 v[50:51], v22 offset:39424
    s_waitcnt lgkmcnt(8)
    v_mfma_f32_16x16x32_bf16 v[204:207], v[56:59], v[160:163], v[204:207]
    ds_read_b64_tr_b16 v[52:53], v23 offset:37376
    v_mfma_f32_16x16x32_bf16 v[220:223], v[56:59], v[164:167], v[220:223]
    ds_read_b64_tr_b16 v[54:55], v23 offset:39424
    s_waitcnt lgkmcnt(8)
    v_mfma_f32_16x16x32_bf16 v[224:227], v[60:63], v[128:131], v[224:227]
    ds_read_b64_tr_b16 v[56:57], v22 offset:40960
    v_mfma_f32_16x16x32_bf16 v[240:243], v[60:63], v[132:135], v[240:243]
    ds_read_b64_tr_b16 v[58:59], v22 offset:43008
    s_waitcnt lgkmcnt(6)
    v_mfma_f32_16x16x32_bf16 v[228:231], v[44:47], v[128:131], v[228:231]
    ds_read_b64_tr_b16 v[60:61], v23 offset:40960
    v_mfma_f32_16x16x32_bf16 v[244:247], v[44:47], v[132:135], v[244:247]
    ds_read_b64_tr_b16 v[62:63], v23 offset:43008
    s_waitcnt lgkmcnt(6)
    v_mfma_f32_16x16x32_bf16 v[232:235], v[48:51], v[128:131], v[232:235]
    ds_read_b64_tr_b16 v[44:45], v22 offset:41472
    v_mfma_f32_16x16x32_bf16 v[248:251], v[48:51], v[132:135], v[248:251]
    ds_read_b64_tr_b16 v[46:47], v22 offset:43520
    s_waitcnt lgkmcnt(6)
    v_mfma_f32_16x16x32_bf16 v[236:239], v[52:55], v[128:131], v[236:239]
    ds_read_b64_tr_b16 v[48:49], v23 offset:41472
    v_mfma_f32_16x16x32_bf16 v[252:255], v[52:55], v[132:135], v[252:255]
    ds_read_b64_tr_b16 v[50:51], v23 offset:43520
    s_waitcnt lgkmcnt(6)
    v_mfma_f32_16x16x32_bf16 v[192:195], v[56:59], v[168:171], v[192:195]
    ds_read_b64_tr_b16 v[52:53], v22 offset:45056
    v_mfma_f32_16x16x32_bf16 v[208:211], v[56:59], v[172:175], v[208:211]
    ds_read_b64_tr_b16 v[54:55], v22 offset:47104
    s_waitcnt lgkmcnt(6)
    v_mfma_f32_16x16x32_bf16 v[196:199], v[60:63], v[168:171], v[196:199]
    ds_read_b64_tr_b16 v[56:57], v23 offset:45056
    v_mfma_f32_16x16x32_bf16 v[212:215], v[60:63], v[172:175], v[212:215]
    ds_read_b64_tr_b16 v[58:59], v23 offset:47104
    s_waitcnt vmcnt(1)
    ds_read_b128 v[176:179], v8 offset:0
    ds_read_b128 v[180:183], v8 offset:2048
    s_waitcnt lgkmcnt(8)
    v_mfma_f32_16x16x32_bf16 v[200:203], v[44:47], v[168:171], v[200:203]
    ds_read_b64_tr_b16 v[60:61], v22 offset:45568
    v_mfma_f32_16x16x32_bf16 v[216:219], v[44:47], v[172:175], v[216:219]
    ds_read_b64_tr_b16 v[62:63], v22 offset:47616
    ds_read_b128 v[184:187], v9 offset:0
    ds_read_b128 v[188:191], v9 offset:2048
    s_waitcnt lgkmcnt(10)
    v_mfma_f32_16x16x32_bf16 v[204:207], v[48:51], v[168:171], v[204:207]
    ds_read_b64_tr_b16 v[44:45], v23 offset:45568
    v_mfma_f32_16x16x32_bf16 v[220:223], v[48:51], v[172:175], v[220:223]
    ds_read_b64_tr_b16 v[46:47], v23 offset:47616
    s_waitcnt lgkmcnt(0)
    s_barrier
    s_lshl_b32 s39, s22, 10
    s_add_u32 s39, s39, 49152
    v_add_u32 v42, s39, v1
    ds_read_b128 v[28:31], v42 offset:0
    ds_read_b128 v[32:35], v42 offset:8192
    v_mfma_f32_16x16x32_bf16 v[224:227], v[52:55], v[136:139], v[224:227]
    ds_read_b64_tr_b16 v[48:49], v20 offset:0
    v_mfma_f32_16x16x32_bf16 v[240:243], v[52:55], v[140:143], v[240:243]
    ds_read_b64_tr_b16 v[50:51], v20 offset:2048
    s_add_u32 s38, s26, 8
    s_and_b32 s38, s38, 15
    s_lshl_b32 s38, s38, 18
    s_add_u32 s38, s38, s28
    s_add_u32 m0, s30, 65536
    s_add_u32 s38, s38, 0
    buffer_load_dwordx4 v10, s[16:19], s38 offen lds
    v_mfma_f32_16x16x32_bf16 v[228:231], v[56:59], v[136:139], v[228:231]
    ds_read_b64_tr_b16 v[52:53], v21 offset:0
    v_mfma_f32_16x16x32_bf16 v[244:247], v[56:59], v[140:143], v[244:247]
    ds_read_b64_tr_b16 v[54:55], v21 offset:2048
    v_mfma_f32_16x16x32_bf16 v[232:235], v[60:63], v[136:139], v[232:235]
    ds_read_b64_tr_b16 v[56:57], v20 offset:512
    v_mfma_f32_16x16x32_bf16 v[248:251], v[60:63], v[140:143], v[248:251]
    ds_read_b64_tr_b16 v[58:59], v20 offset:2560
    buffer_load_dwordx4 v11, s[16:19], s38 offen offset:1024 lds
    s_waitcnt lgkmcnt(6)
    buffer_store_dwordx4 v[28:31], v43, s[12:15], s44 offen sc1
    v_mfma_f32_16x16x32_bf16 v[236:239], v[44:47], v[136:139], v[236:239]
    ds_read_b64_tr_b16 v[60:61], v21 offset:512
    v_mfma_f32_16x16x32_bf16 v[252:255], v[44:47], v[140:143], v[252:255]
    ds_read_b64_tr_b16 v[62:63], v21 offset:2560
    s_waitcnt lgkmcnt(6)
    v_mfma_f32_16x16x32_bf16 v[192:195], v[48:51], v[176:179], v[192:195]
    ds_read_b64_tr_b16 v[44:45], v20 offset:4096
    v_mfma_f32_16x16x32_bf16 v[208:211], v[48:51], v[180:183], v[208:211]
    ds_read_b64_tr_b16 v[46:47], v20 offset:6144
    s_waitcnt lgkmcnt(6)
    v_mfma_f32_16x16x32_bf16 v[196:199], v[52:55], v[176:179], v[196:199]
    ds_read_b64_tr_b16 v[48:49], v21 offset:4096
    v_mfma_f32_16x16x32_bf16 v[212:215], v[52:55], v[180:183], v[212:215]
    ds_read_b64_tr_b16 v[50:51], v21 offset:6144
    s_waitcnt lgkmcnt(6)
    v_mfma_f32_16x16x32_bf16 v[200:203], v[56:59], v[176:179], v[200:203]
    ds_read_b64_tr_b16 v[52:53], v20 offset:4608
    v_mfma_f32_16x16x32_bf16 v[216:219], v[56:59], v[180:183], v[216:219]
    ds_read_b64_tr_b16 v[54:55], v20 offset:6656
    s_cmp_lt_u32 s22, 2
    s_cselect_b32 s45, 16384, 0x40000000
    s_add_u32 s45, s45, s44
    buffer_store_dwordx4 v[32:35], v43, s[12:15], s45 offen sc1
    s_waitcnt lgkmcnt(6)
    v_mfma_f32_16x16x32_bf16 v[204:207], v[60:63], v[176:179], v[204:207]
    ds_read_b64_tr_b16 v[56:57], v21 offset:4608
    v_mfma_f32_16x16x32_bf16 v[220:223], v[60:63], v[180:183], v[220:223]
    ds_read_b64_tr_b16 v[58:59], v21 offset:6656
    s_waitcnt lgkmcnt(6)
    v_mfma_f32_16x16x32_bf16 v[224:227], v[44:47], v[144:147], v[224:227]
    ds_read_b64_tr_b16 v[60:61], v20 offset:8192
    v_mfma_f32_16x16x32_bf16 v[240:243], v[44:47], v[148:151], v[240:243]
    ds_read_b64_tr_b16 v[62:63], v20 offset:10240
    s_waitcnt lgkmcnt(6)
    v_mfma_f32_16x16x32_bf16 v[228:231], v[48:51], v[144:147], v[228:231]
    ds_read_b64_tr_b16 v[44:45], v21 offset:8192
    v_mfma_f32_16x16x32_bf16 v[244:247], v[48:51], v[148:151], v[244:247]
    ds_read_b64_tr_b16 v[46:47], v21 offset:10240
    s_waitcnt lgkmcnt(6)
    v_mfma_f32_16x16x32_bf16 v[232:235], v[52:55], v[144:147], v[232:235]
    ds_read_b64_tr_b16 v[48:49], v20 offset:8704
    v_mfma_f32_16x16x32_bf16 v[248:251], v[52:55], v[148:151], v[248:251]
    ds_read_b64_tr_b16 v[50:51], v20 offset:10752
    s_waitcnt lgkmcnt(6)
    v_mfma_f32_16x16x32_bf16 v[236:239], v[56:59], v[144:147], v[236:239]
    ds_read_b64_tr_b16 v[52:53], v21 offset:8704
    v_mfma_f32_16x16x32_bf16 v[252:255], v[56:59], v[148:151], v[252:255]
    ds_read_b64_tr_b16 v[54:55], v21 offset:10752
    s_waitcnt lgkmcnt(6)
    v_mfma_f32_16x16x32_bf16 v[192:195], v[60:63], v[184:187], v[192:195]
    ds_read_b64_tr_b16 v[56:57], v20 offset:12288
    v_mfma_f32_16x16x32_bf16 v[208:211], v[60:63], v[188:191], v[208:211]
    ds_read_b64_tr_b16 v[58:59], v20 offset:14336
    s_waitcnt lgkmcnt(6)
    v_mfma_f32_16x16x32_bf16 v[196:199], v[44:47], v[184:187], v[196:199]
    ds_read_b64_tr_b16 v[60:61], v21 offset:12288
    v_mfma_f32_16x16x32_bf16 v[212:215], v[44:47], v[188:191], v[212:215]
    ds_read_b64_tr_b16 v[62:63], v21 offset:14336
    s_waitcnt lgkmcnt(6)
    v_mfma_f32_16x16x32_bf16 v[200:203], v[48:51], v[184:187], v[200:203]
    ds_read_b64_tr_b16 v[44:45], v20 offset:12800
    v_mfma_f32_16x16x32_bf16 v[216:219], v[48:51], v[188:191], v[216:219]
    ds_read_b64_tr_b16 v[46:47], v20 offset:14848
    s_waitcnt lgkmcnt(6)
    v_mfma_f32_16x16x32_bf16 v[204:207], v[52:55], v[184:187], v[204:207]
    ds_read_b64_tr_b16 v[48:49], v21 offset:12800
    v_mul_f32 v192, 0.12751743082459868, v192
    v_mul_f32 v193, 0.12751743082459868, v193
    v_mul_f32 v194, 0.12751743082459868, v194
    v_mul_f32 v195, 0.12751743082459868, v195
    v_mfma_f32_16x16x32_bf16 v[220:223], v[52:55], v[188:191], v[220:223]
    ds_read_b64_tr_b16 v[50:51], v21 offset:14848
    s_barrier
    s_waitcnt lgkmcnt(6)
    v_mfma_f32_16x16x32_bf16 v[224:227], v[56:59], v[152:155], v[224:227]
    ds_read_b64_tr_b16 v[52:53], v20 offset:16384
    v_mul_f32 v196, 0.12751743082459868, v196
    v_mul_f32 v197, 0.12751743082459868, v197
    v_mul_f32 v198, 0.12751743082459868, v198
    v_mul_f32 v199, 0.12751743082459868, v199
    v_mfma_f32_16x16x32_bf16 v[240:243], v[56:59], v[156:159], v[240:243]
    ds_read_b64_tr_b16 v[54:55], v20 offset:18432
    s_add_u32 s38, s26, 4
    s_and_b32 s38, s38, 15
    s_lshl_b32 s38, s38, 18
    s_add_u32 s38, s38, s28
    s_add_u32 m0, s30, 49152
    s_add_u32 s38, s38, 0
    buffer_load_dwordx4 v10, s[16:19], s38 offen lds
    s_waitcnt lgkmcnt(6)
    v_mfma_f32_16x16x32_bf16 v[228:231], v[60:63], v[152:155], v[228:231]
    ds_read_b64_tr_b16 v[56:57], v21 offset:16384
    v_cvt_pk_bf16_f32 v28, v192, v193
    v_cvt_pk_bf16_f32 v29, v194, v195
    v_cvt_pk_bf16_f32 v30, v196, v197
    v_cvt_pk_bf16_f32 v31, v198, v199
    v_mfma_f32_16x16x32_bf16 v[244:247], v[60:63], v[156:159], v[244:247]
    ds_read_b64_tr_b16 v[58:59], v21 offset:18432
    s_waitcnt lgkmcnt(6)
    v_mfma_f32_16x16x32_bf16 v[232:235], v[44:47], v[152:155], v[232:235]
    ds_read_b64_tr_b16 v[60:61], v20 offset:16896
    v_mul_f32 v208, 0.12751743082459868, v208
    v_mul_f32 v209, 0.12751743082459868, v209
    v_mul_f32 v210, 0.12751743082459868, v210
    v_mul_f32 v211, 0.12751743082459868, v211
    v_mfma_f32_16x16x32_bf16 v[248:251], v[44:47], v[156:159], v[248:251]
    ds_read_b64_tr_b16 v[62:63], v20 offset:18944
    buffer_load_dwordx4 v11, s[16:19], s38 offen offset:1024 lds
    s_waitcnt lgkmcnt(6)
    v_mfma_f32_16x16x32_bf16 v[236:239], v[48:51], v[152:155], v[236:239]
    ds_read_b64_tr_b16 v[44:45], v21 offset:16896
    v_mul_f32 v212, 0.12751743082459868, v212
    v_mul_f32 v213, 0.12751743082459868, v213
    v_mul_f32 v214, 0.12751743082459868, v214
    v_mul_f32 v215, 0.12751743082459868, v215
    v_mfma_f32_16x16x32_bf16 v[252:255], v[48:51], v[156:159], v[252:255]
    ds_read_b64_tr_b16 v[46:47], v21 offset:18944
    s_add_u32 s45, s75, 0
    buffer_store_dwordx4 v[28:31], v1, s[12:15], s45 offen sc1
    s_waitcnt lgkmcnt(6)
    v_mfma_f32_16x16x32_bf16 v[224:227], v[52:55], v[160:163], v[224:227]
    ds_read_b64_tr_b16 v[48:49], v20 offset:20480
    v_cvt_pk_bf16_f32 v32, v208, v209
    v_cvt_pk_bf16_f32 v33, v210, v211
    v_cvt_pk_bf16_f32 v34, v212, v213
    v_cvt_pk_bf16_f32 v35, v214, v215
    v_mfma_f32_16x16x32_bf16 v[240:243], v[52:55], v[164:167], v[240:243]
    ds_read_b64_tr_b16 v[50:51], v20 offset:22528
    s_add_u32 s38, s26, 12
    s_and_b32 s38, s38, 15
    s_lshl_b32 s38, s38, 18
    s_add_u32 s38, s38, s28
    s_add_u32 m0, s30, 81920
    s_add_u32 s38, s38, 0
    buffer_load_dwordx4 v10, s[16:19], s38 offen lds
    s_waitcnt lgkmcnt(6)
    v_mfma_f32_16x16x32_bf16 v[228:231], v[56:59], v[160:163], v[228:231]
    ds_read_b64_tr_b16 v[52:53], v21 offset:20480
    v_mul_f32 v200, 0.12751743082459868, v200
    v_mul_f32 v201, 0.12751743082459868, v201
    v_mul_f32 v202, 0.12751743082459868, v202
    v_mul_f32 v203, 0.12751743082459868, v203
    v_mfma_f32_16x16x32_bf16 v[244:247], v[56:59], v[164:167], v[244:247]
    ds_read_b64_tr_b16 v[54:55], v21 offset:22528
    s_waitcnt lgkmcnt(6)
    v_mfma_f32_16x16x32_bf16 v[232:235], v[60:63], v[160:163], v[232:235]
    ds_read_b64_tr_b16 v[56:57], v20 offset:20992
    v_mul_f32 v204, 0.12751743082459868, v204
    v_mul_f32 v205, 0.12751743082459868, v205
    v_mul_f32 v206, 0.12751743082459868, v206
    v_mul_f32 v207, 0.12751743082459868, v207
    v_mfma_f32_16x16x32_bf16 v[248:251], v[60:63], v[164:167], v[248:251]
    ds_read_b64_tr_b16 v[58:59], v20 offset:23040
    buffer_load_dwordx4 v11, s[16:19], s38 offen offset:1024 lds
    s_waitcnt lgkmcnt(6)
    v_mfma_f32_16x16x32_bf16 v[236:239], v[44:47], v[160:163], v[236:239]
    ds_read_b64_tr_b16 v[60:61], v21 offset:20992
    v_cvt_pk_bf16_f32 v36, v200, v201
    v_cvt_pk_bf16_f32 v37, v202, v203
    v_cvt_pk_bf16_f32 v38, v204, v205
    v_cvt_pk_bf16_f32 v39, v206, v207
    v_mfma_f32_16x16x32_bf16 v[252:255], v[44:47], v[164:167], v[252:255]
    ds_read_b64_tr_b16 v[62:63], v21 offset:23040
    s_waitcnt lgkmcnt(6)
    v_mfma_f32_16x16x32_bf16 v[224:227], v[48:51], v[168:171], v[224:227]
    ds_read_b64_tr_b16 v[44:45], v20 offset:24576
    v_mul_f32 v216, 0.12751743082459868, v216
    v_mul_f32 v217, 0.12751743082459868, v217
    v_mul_f32 v218, 0.12751743082459868, v218
    v_mul_f32 v219, 0.12751743082459868, v219
    v_mfma_f32_16x16x32_bf16 v[240:243], v[48:51], v[172:175], v[240:243]
    ds_read_b64_tr_b16 v[46:47], v20 offset:26624
    s_add_u32 s38, s26, 0
    s_and_b32 s38, s38, 15
    s_lshl_b32 s38, s38, 18
    s_add_u32 s38, s38, s28
    s_add_u32 m0, s30, 98304
    s_add_u32 s38, s38, 128
    buffer_load_dwordx4 v10, s[16:19], s38 offen lds
    s_waitcnt lgkmcnt(6)
    v_mfma_f32_16x16x32_bf16 v[228:231], v[52:55], v[168:171], v[228:231]
    ds_read_b64_tr_b16 v[48:49], v21 offset:24576
    v_mul_f32 v220, 0.12751743082459868, v220
    v_mul_f32 v221, 0.12751743082459868, v221
    v_mul_f32 v222, 0.12751743082459868, v222
    v_mul_f32 v223, 0.12751743082459868, v223
    v_mfma_f32_16x16x32_bf16 v[244:247], v[52:55], v[172:175], v[244:247]
    ds_read_b64_tr_b16 v[50:51], v21 offset:26624
    s_waitcnt lgkmcnt(6)
    v_mfma_f32_16x16x32_bf16 v[232:235], v[56:59], v[168:171], v[232:235]
    ds_read_b64_tr_b16 v[52:53], v20 offset:25088
    v_cvt_pk_bf16_f32 v40, v216, v217
    v_cvt_pk_bf16_f32 v41, v218, v219
    v_cvt_pk_bf16_f32 v42, v220, v221
    v_cvt_pk_bf16_f32 v43, v222, v223
    v_mfma_f32_16x16x32_bf16 v[248:251], v[56:59], v[172:175], v[248:251]
    ds_read_b64_tr_b16 v[54:55], v20 offset:27136
    buffer_load_dwordx4 v11, s[16:19], s38 offen offset:1024 lds
    s_waitcnt lgkmcnt(6)
    v_mfma_f32_16x16x32_bf16 v[236:239], v[60:63], v[168:171], v[236:239]
    ds_read_b64_tr_b16 v[56:57], v21 offset:25088
    v_mfma_f32_16x16x32_bf16 v[252:255], v[60:63], v[172:175], v[252:255]
    ds_read_b64_tr_b16 v[58:59], v21 offset:27136
    s_waitcnt lgkmcnt(6)
    v_mfma_f32_16x16x32_bf16 v[224:227], v[44:47], v[176:179], v[224:227]
    ds_read_b64_tr_b16 v[60:61], v20 offset:28672
    v_mfma_f32_16x16x32_bf16 v[240:243], v[44:47], v[180:183], v[240:243]
    ds_read_b64_tr_b16 v[62:63], v20 offset:30720
    s_add_u32 s38, s26, 4
    s_and_b32 s38, s38, 15
    s_lshl_b32 s38, s38, 18
    s_add_u32 s38, s38, s28
    s_add_u32 m0, s30, 114688
    s_add_u32 s38, s38, 128
    buffer_load_dwordx4 v10, s[16:19], s38 offen lds
    s_waitcnt lgkmcnt(6)
    v_mfma_f32_16x16x32_bf16 v[228:231], v[48:51], v[176:179], v[228:231]
    ds_read_b64_tr_b16 v[44:45], v21 offset:28672
    v_mfma_f32_16x16x32_bf16 v[244:247], v[48:51], v[180:183], v[244:247]
    ds_read_b64_tr_b16 v[46:47], v21 offset:30720
    s_waitcnt lgkmcnt(6)
    v_mfma_f32_16x16x32_bf16 v[232:235], v[52:55], v[176:179], v[232:235]
    ds_read_b64_tr_b16 v[48:49], v20 offset:29184
    v_mfma_f32_16x16x32_bf16 v[248:251], v[52:55], v[180:183], v[248:251]
    ds_read_b64_tr_b16 v[50:51], v20 offset:31232
    buffer_load_dwordx4 v11, s[16:19], s38 offen offset:1024 lds
    s_waitcnt lgkmcnt(6)
    v_mfma_f32_16x16x32_bf16 v[236:239], v[56:59], v[176:179], v[236:239]
    ds_read_b64_tr_b16 v[52:53], v21 offset:29184
    v_mfma_f32_16x16x32_bf16 v[252:255], v[56:59], v[180:183], v[252:255]
    ds_read_b64_tr_b16 v[54:55], v21 offset:31232
    s_barrier
    s_waitcnt lgkmcnt(6)
    v_mfma_f32_16x16x32_bf16 v[224:227], v[60:63], v[184:187], v[224:227]
    ds_read_b64_tr_b16 v[56:57], v20 offset:32768
    v_mfma_f32_16x16x32_bf16 v[240:243], v[60:63], v[188:191], v[240:243]
    ds_read_b64_tr_b16 v[58:59], v20 offset:34816
    s_add_u32 s45, s75, 4096
    buffer_store_dwordx4 v[32:35], v1, s[12:15], s45 offen sc1
    s_waitcnt lgkmcnt(6)
    v_mfma_f32_16x16x32_bf16 v[228:231], v[44:47], v[184:187], v[228:231]
    ds_read_b64_tr_b16 v[60:61], v21 offset:32768
    v_mfma_f32_16x16x32_bf16 v[244:247], v[44:47], v[188:191], v[244:247]
    ds_read_b64_tr_b16 v[62:63], v21 offset:34816
    s_waitcnt lgkmcnt(6)
    v_mfma_f32_16x16x32_bf16 v[232:235], v[48:51], v[184:187], v[232:235]
    ds_read_b64_tr_b16 v[44:45], v20 offset:33280
    v_mfma_f32_16x16x32_bf16 v[248:251], v[48:51], v[188:191], v[248:251]
    ds_read_b64_tr_b16 v[46:47], v20 offset:35328
    s_waitcnt lgkmcnt(6)
    v_mfma_f32_16x16x32_bf16 v[236:239], v[52:55], v[184:187], v[236:239]
    ds_read_b64_tr_b16 v[48:49], v21 offset:33280
    v_mul_f32 v224, 0.12751743082459868, v224
    v_mul_f32 v225, 0.12751743082459868, v225
    v_mul_f32 v226, 0.12751743082459868, v226
    v_mul_f32 v227, 0.12751743082459868, v227
    v_mfma_f32_16x16x32_bf16 v[252:255], v[52:55], v[188:191], v[252:255]
    ds_read_b64_tr_b16 v[50:51], v21 offset:35328
    s_waitcnt lgkmcnt(6)
    v_mfma_f32_16x16x32_bf16 v[192:195], v[64:67], v[56:59], 0
    ds_read_b64_tr_b16 v[52:53], v20 offset:36864
    v_mul_f32 v228, 0.12751743082459868, v228
    v_mul_f32 v229, 0.12751743082459868, v229
    v_mul_f32 v230, 0.12751743082459868, v230
    v_mul_f32 v231, 0.12751743082459868, v231
    v_mfma_f32_16x16x32_bf16 v[208:211], v[68:71], v[56:59], 0
    ds_read_b64_tr_b16 v[54:55], v20 offset:38912
    s_waitcnt lgkmcnt(6)
    v_mfma_f32_16x16x32_bf16 v[196:199], v[64:67], v[60:63], 0
    ds_read_b64_tr_b16 v[56:57], v21 offset:36864
    v_cvt_pk_bf16_f32 v224, v224, v225
    v_cvt_pk_bf16_f32 v225, v226, v227
    v_cvt_pk_bf16_f32 v226, v228, v229
    v_cvt_pk_bf16_f32 v227, v230, v231
    v_mfma_f32_16x16x32_bf16 v[212:215], v[68:71], v[60:63], 0
    ds_read_b64_tr_b16 v[58:59], v21 offset:38912
    s_waitcnt lgkmcnt(6)
    v_mfma_f32_16x16x32_bf16 v[200:203], v[64:67], v[44:47], 0
    ds_read_b64_tr_b16 v[60:61], v20 offset:37376
    v_mul_f32 v240, 0.12751743082459868, v240
    v_mul_f32 v241, 0.12751743082459868, v241
    v_mul_f32 v242, 0.12751743082459868, v242
    v_mul_f32 v243, 0.12751743082459868, v243
    v_mfma_f32_16x16x32_bf16 v[216:219], v[68:71], v[44:47], 0
    ds_read_b64_tr_b16 v[62:63], v20 offset:39424
    s_waitcnt lgkmcnt(6)
    v_mfma_f32_16x16x32_bf16 v[204:207], v[64:67], v[48:51], 0
    ds_read_b64_tr_b16 v[44:45], v21 offset:37376
    v_mul_f32 v244, 0.12751743082459868, v244
    v_mul_f32 v245, 0.12751743082459868, v245
    v_mul_f32 v246, 0.12751743082459868, v246
    v_mul_f32 v247, 0.12751743082459868, v247
    v_mfma_f32_16x16x32_bf16 v[220:223], v[68:71], v[48:51], 0
    ds_read_b64_tr_b16 v[46:47], v21 offset:39424
    s_waitcnt lgkmcnt(6)
    v_mfma_f32_16x16x32_bf16 v[192:195], v[72:75], v[52:55], v[192:195]
    ds_read_b64_tr_b16 v[48:49], v20 offset:40960
    v_cvt_pk_bf16_f32 v240, v240, v241
    v_cvt_pk_bf16_f32 v241, v242, v243
    v_cvt_pk_bf16_f32 v242, v244, v245
    v_cvt_pk_bf16_f32 v243, v246, v247
    v_mfma_f32_16x16x32_bf16 v[208:211], v[76:79], v[52:55], v[208:211]
    ds_read_b64_tr_b16 v[50:51], v20 offset:43008
    s_waitcnt lgkmcnt(6)
    v_mfma_f32_16x16x32_bf16 v[196:199], v[72:75], v[56:59], v[196:199]
    ds_read_b64_tr_b16 v[52:53], v21 offset:40960
    v_mul_f32 v232, 0.12751743082459868, v232
    v_mul_f32 v233, 0.12751743082459868, v233
    v_mul_f32 v234, 0.12751743082459868, v234
    v_mul_f32 v235, 0.12751743082459868, v235
    v_mfma_f32_16x16x32_bf16 v[212:215], v[76:79], v[56:59], v[212:215]
    ds_read_b64_tr_b16 v[54:55], v21 offset:43008
    s_waitcnt lgkmcnt(6)
    v_mfma_f32_16x16x32_bf16 v[200:203], v[72:75], v[60:63], v[200:203]
    ds_read_b64_tr_b16 v[56:57], v20 offset:41472
    v_mul_f32 v236, 0.12751743082459868, v236
    v_mul_f32 v237, 0.12751743082459868, v237
    v_mul_f32 v238, 0.12751743082459868, v238
    v_mul_f32 v239, 0.12751743082459868, v239
    v_mfma_f32_16x16x32_bf16 v[216:219], v[76:79], v[60:63], v[216:219]
    ds_read_b64_tr_b16 v[58:59], v20 offset:43520
    s_waitcnt lgkmcnt(6)
    v_mfma_f32_16x16x32_bf16 v[204:207], v[72:75], v[44:47], v[204:207]
    ds_read_b64_tr_b16 v[60:61], v21 offset:41472
    v_cvt_pk_bf16_f32 v232, v232, v233
    v_cvt_pk_bf16_f32 v233, v234, v235
    v_cvt_pk_bf16_f32 v234, v236, v237
    v_cvt_pk_bf16_f32 v235, v238, v239
    v_mfma_f32_16x16x32_bf16 v[220:223], v[76:79], v[44:47], v[220:223]
    ds_read_b64_tr_b16 v[62:63], v21 offset:43520
    s_waitcnt lgkmcnt(6)
    v_mfma_f32_16x16x32_bf16 v[192:195], v[80:83], v[48:51], v[192:195]
    ds_read_b64_tr_b16 v[44:45], v20 offset:45056
    v_mul_f32 v248, 0.12751743082459868, v248
    v_mul_f32 v249, 0.12751743082459868, v249
    v_mul_f32 v250, 0.12751743082459868, v250
    v_mul_f32 v251, 0.12751743082459868, v251
    v_mfma_f32_16x16x32_bf16 v[208:211], v[84:87], v[48:51], v[208:211]
    ds_read_b64_tr_b16 v[46:47], v20 offset:47104
    s_waitcnt lgkmcnt(6)
    v_mfma_f32_16x16x32_bf16 v[196:199], v[80:83], v[52:55], v[196:199]
    ds_read_b64_tr_b16 v[48:49], v21 offset:45056
    v_mul_f32 v252, 0.12751743082459868, v252
    v_mul_f32 v253, 0.12751743082459868, v253
    v_mul_f32 v254, 0.12751743082459868, v254
    v_mul_f32 v255, 0.12751743082459868, v255
    v_mfma_f32_16x16x32_bf16 v[212:215], v[84:87], v[52:55], v[212:215]
    ds_read_b64_tr_b16 v[50:51], v21 offset:47104
    s_add_u32 s45, s75, 2048
    buffer_store_dwordx4 v[224:227], v1, s[12:15], s45 offen sc1
    s_waitcnt lgkmcnt(6)
    v_mfma_f32_16x16x32_bf16 v[200:203], v[80:83], v[56:59], v[200:203]
    ds_read_b64_tr_b16 v[52:53], v20 offset:45568
    v_cvt_pk_bf16_f32 v248, v248, v249
    v_cvt_pk_bf16_f32 v249, v250, v251
    v_cvt_pk_bf16_f32 v250, v252, v253
    v_cvt_pk_bf16_f32 v251, v254, v255
    v_mfma_f32_16x16x32_bf16 v[216:219], v[84:87], v[56:59], v[216:219]
    ds_read_b64_tr_b16 v[54:55], v20 offset:47616
    s_waitcnt lgkmcnt(6)
    v_mfma_f32_16x16x32_bf16 v[204:207], v[80:83], v[60:63], v[204:207]
    ds_read_b64_tr_b16 v[56:57], v21 offset:45568
    v_mfma_f32_16x16x32_bf16 v[220:223], v[84:87], v[60:63], v[220:223]
    ds_read_b64_tr_b16 v[58:59], v21 offset:47616
    s_waitcnt vmcnt(9)
    s_barrier
    s_cmp_eq_u32 s22, 0
    s_cbranch_scc0 L_fl_7
    s_add_u32 s45, s3, 1
    s_mov_b64 exec, 1
    v_mov_b32 v19, s45
    buffer_store_dword v19, off, s[12:15], s74 sc1
    s_mov_b64 exec, -1
L_fl_7:
    s_waitcnt lgkmcnt(6)
    v_mfma_f32_16x16x32_bf16 v[192:195], v[88:91], v[44:47], v[192:195]
    ds_read_b64_tr_b16 v[60:61], v22 offset:0
    v_mfma_f32_16x16x32_bf16 v[208:211], v[92:95], v[44:47], v[208:211]
    ds_read_b64_tr_b16 v[62:63], v22 offset:2048
    s_waitcnt lgkmcnt(6)
    v_mfma_f32_16x16x32_bf16 v[196:199], v[88:91], v[48:51], v[196:199]
    ds_read_b64_tr_b16 v[44:45], v23 offset:0
    v_mfma_f32_16x16x32_bf16 v[212:215], v[92:95], v[48:51], v[212:215]
    ds_read_b64_tr_b16 v[46:47], v23 offset:2048
    s_waitcnt lgkmcnt(6)
    v_mfma_f32_16x16x32_bf16 v[200:203], v[88:91], v[52:55], v[200:203]
    ds_read_b64_tr_b16 v[48:49], v22 offset:512
    v_mfma_f32_16x16x32_bf16 v[216:219], v[92:95], v[52:55], v[216:219]
    ds_read_b64_tr_b16 v[50:51], v22 offset:2560
    s_waitcnt lgkmcnt(6)
    v_mfma_f32_16x16x32_bf16 v[204:207], v[88:91], v[56:59], v[204:207]
    ds_read_b64_tr_b16 v[52:53], v23 offset:512
    v_mfma_f32_16x16x32_bf16 v[220:223], v[92:95], v[56:59], v[220:223]
    ds_read_b64_tr_b16 v[54:55], v23 offset:2560
    s_waitcnt lgkmcnt(6)
    v_mfma_f32_16x16x32_bf16 v[192:195], v[96:99], v[60:63], v[192:195]
    ds_read_b64_tr_b16 v[56:57], v22 offset:4096
    v_mfma_f32_16x16x32_bf16 v[208:211], v[100:103], v[60:63], v[208:211]
    ds_read_b64_tr_b16 v[58:59], v22 offset:6144
    s_waitcnt lgkmcnt(6)
    v_mfma_f32_16x16x32_bf16 v[196:199], v[96:99], v[44:47], v[196:199]
    ds_read_b64_tr_b16 v[60:61], v23 offset:4096
    v_mfma_f32_16x16x32_bf16 v[212:215], v[100:103], v[44:47], v[212:215]
    ds_read_b64_tr_b16 v[62:63], v23 offset:6144
    s_waitcnt lgkmcnt(6)
    v_mfma_f32_16x16x32_bf16 v[200:203], v[96:99], v[48:51], v[200:203]
    ds_read_b64_tr_b16 v[44:45], v22 offset:4608
    v_mfma_f32_16x16x32_bf16 v[216:219], v[100:103], v[48:51], v[216:219]
    ds_read_b64_tr_b16 v[46:47], v22 offset:6656
    s_waitcnt lgkmcnt(6)
    v_mfma_f32_16x16x32_bf16 v[204:207], v[96:99], v[52:55], v[204:207]
    ds_read_b64_tr_b16 v[48:49], v23 offset:4608
    v_mfma_f32_16x16x32_bf16 v[220:223], v[100:103], v[52:55], v[220:223]
    ds_read_b64_tr_b16 v[50:51], v23 offset:6656
    s_waitcnt lgkmcnt(6)
    v_mfma_f32_16x16x32_bf16 v[192:195], v[104:107], v[56:59], v[192:195]
    ds_read_b64_tr_b16 v[52:53], v22 offset:8192
    v_mfma_f32_16x16x32_bf16 v[208:211], v[108:111], v[56:59], v[208:211]
    ds_read_b64_tr_b16 v[54:55], v22 offset:10240
    s_waitcnt lgkmcnt(6)
    v_mfma_f32_16x16x32_bf16 v[196:199], v[104:107], v[60:63], v[196:199]
    ds_read_b64_tr_b16 v[56:57], v23 offset:8192
    v_mfma_f32_16x16x32_bf16 v[212:215], v[108:111], v[60:63], v[212:215]
    ds_read_b64_tr_b16 v[58:59], v23 offset:10240
    s_waitcnt lgkmcnt(6)
    v_mfma_f32_16x16x32_bf16 v[200:203], v[104:107], v[44:47], v[200:203]
    ds_read_b64_tr_b16 v[60:61], v22 offset:8704
    v_mfma_f32_16x16x32_bf16 v[216:219], v[108:111], v[44:47], v[216:219]
    ds_read_b64_tr_b16 v[62:63], v22 offset:10752
    s_add_u32 s45, s75, 6144
    buffer_store_dwordx4 v[240:243], v1, s[12:15], s45 offen sc1
    s_waitcnt lgkmcnt(6)
    v_mfma_f32_16x16x32_bf16 v[204:207], v[104:107], v[48:51], v[204:207]
    ds_read_b64_tr_b16 v[44:45], v23 offset:8704
    v_mfma_f32_16x16x32_bf16 v[220:223], v[108:111], v[48:51], v[220:223]
    ds_read_b64_tr_b16 v[46:47], v23 offset:10752
    s_waitcnt lgkmcnt(6)
    v_mfma_f32_16x16x32_bf16 v[192:195], v[112:115], v[52:55], v[192:195]
    ds_read_b64_tr_b16 v[48:49], v22 offset:12288
    v_mfma_f32_16x16x32_bf16 v[208:211], v[116:119], v[52:55], v[208:211]
    ds_read_b64_tr_b16 v[50:51], v22 offset:14336
    s_waitcnt lgkmcnt(6)
    v_mfma_f32_16x16x32_bf16 v[196:199], v[112:115], v[56:59], v[196:199]
    ds_read_b64_tr_b16 v[52:53], v23 offset:12288
    v_mfma_f32_16x16x32_bf16 v[212:215], v[116:119], v[56:59], v[212:215]
    ds_read_b64_tr_b16 v[54:55], v23 offset:14336
    s_waitcnt lgkmcnt(6)
    v_mfma_f32_16x16x32_bf16 v[200:203], v[112:115], v[60:63], v[200:203]
    ds_read_b64_tr_b16 v[56:57], v22 offset:12800
    v_mfma_f32_16x16x32_bf16 v[216:219], v[116:119], v[60:63], v[216:219]
    ds_read_b64_tr_b16 v[58:59], v22 offset:14848
    s_waitcnt lgkmcnt(6)
    v_mfma_f32_16x16x32_bf16 v[204:207], v[112:115], v[44:47], v[204:207]
    ds_read_b64_tr_b16 v[60:61], v23 offset:12800
    v_mfma_f32_16x16x32_bf16 v[220:223], v[116:119], v[44:47], v[220:223]
    ds_read_b64_tr_b16 v[62:63], v23 offset:14848
    s_barrier
    s_waitcnt lgkmcnt(6)
    v_mfma_f32_16x16x32_bf16 v[192:195], v[120:123], v[48:51], v[192:195]
    ds_read_b64_tr_b16 v[44:45], v22 offset:16384
    v_mfma_f32_16x16x32_bf16 v[208:211], v[124:127], v[48:51], v[208:211]
    ds_read_b64_tr_b16 v[46:47], v22 offset:18432
    s_waitcnt lgkmcnt(6)
    v_mfma_f32_16x16x32_bf16 v[196:199], v[120:123], v[52:55], v[196:199]
    ds_read_b64_tr_b16 v[48:49], v23 offset:16384
    v_mfma_f32_16x16x32_bf16 v[212:215], v[124:127], v[52:55], v[212:215]
    ds_read_b64_tr_b16 v[50:51], v23 offset:18432
    s_waitcnt lgkmcnt(6)
    v_mfma_f32_16x16x32_bf16 v[200:203], v[120:123], v[56:59], v[200:203]
    ds_read_b64_tr_b16 v[52:53], v22 offset:16896
    v_mfma_f32_16x16x32_bf16 v[216:219], v[124:127], v[56:59], v[216:219]
    ds_read_b64_tr_b16 v[54:55], v22 offset:18944
    s_waitcnt lgkmcnt(6)
    v_mfma_f32_16x16x32_bf16 v[204:207], v[120:123], v[60:63], v[204:207]
    ds_read_b64_tr_b16 v[56:57], v23 offset:16896
    v_mfma_f32_16x16x32_bf16 v[220:223], v[124:127], v[60:63], v[220:223]
    ds_read_b64_tr_b16 v[58:59], v23 offset:18944
    s_waitcnt lgkmcnt(6)
    v_mfma_f32_16x16x32_bf16 v[192:195], v[128:131], v[44:47], v[192:195]
    ds_read_b64_tr_b16 v[60:61], v22 offset:20480
    v_mfma_f32_16x16x32_bf16 v[208:211], v[132:135], v[44:47], v[208:211]
    ds_read_b64_tr_b16 v[62:63], v22 offset:22528
    s_add_u32 m0, s59, 0
    s_add_u32 s38, s58, 0
    buffer_load_dwordx4 v10, s[60:63], s38 offen lds
    s_waitcnt lgkmcnt(6)
    v_mfma_f32_16x16x32_bf16 v[196:199], v[128:131], v[48:51], v[196:199]
    ds_read_b64_tr_b16 v[44:45], v23 offset:20480
    v_mfma_f32_16x16x32_bf16 v[212:215], v[132:135], v[48:51], v[212:215]
    ds_read_b64_tr_b16 v[46:47], v23 offset:22528
    s_waitcnt lgkmcnt(6)
    v_mfma_f32_16x16x32_bf16 v[200:203], v[128:131], v[52:55], v[200:203]
    ds_read_b64_tr_b16 v[48:49], v22 offset:20992
    v_mfma_f32_16x16x32_bf16 v[216:219], v[132:135], v[52:55], v[216:219]
    ds_read_b64_tr_b16 v[50:51], v22 offset:23040
    buffer_load_dwordx4 v11, s[60:63], s38 offen offset:1024 lds
    s_waitcnt lgkmcnt(6)
    v_mfma_f32_16x16x32_bf16 v[204:207], v[128:131], v[56:59], v[204:207]
    ds_read_b64_tr_b16 v[52:53], v23 offset:20992
    v_mfma_f32_16x16x32_bf16 v[220:223], v[132:135], v[56:59], v[220:223]
    ds_read_b64_tr_b16 v[54:55], v23 offset:23040
    s_add_u32 s45, s75, 3072
    buffer_store_dwordx4 v[232:235], v1, s[12:15], s45 offen sc1
    s_waitcnt lgkmcnt(6)
    v_mfma_f32_16x16x32_bf16 v[192:195], v[136:139], v[60:63], v[192:195]
    ds_read_b64_tr_b16 v[56:57], v22 offset:24576
    v_mfma_f32_16x16x32_bf16 v[208:211], v[140:143], v[60:63], v[208:211]
    ds_read_b64_tr_b16 v[58:59], v22 offset:26624
    s_add_u32 m0, s69, 8192
    s_add_u32 s38, s68, 0
    s_mov_b32 exec_hi, 0
    buffer_load_dwordx4 v12, s[64:67], s38 offen lds
    s_mov_b32 exec_hi, -1
    s_waitcnt lgkmcnt(6)
    v_mfma_f32_16x16x32_bf16 v[196:199], v[136:139], v[44:47], v[196:199]
    ds_read_b64_tr_b16 v[60:61], v23 offset:24576
    v_mfma_f32_16x16x32_bf16 v[212:215], v[140:143], v[44:47], v[212:215]
    ds_read_b64_tr_b16 v[62:63], v23 offset:26624
    s_waitcnt lgkmcnt(6)
    v_mfma_f32_16x16x32_bf16 v[200:203], v[136:139], v[48:51], v[200:203]
    ds_read_b64_tr_b16 v[44:45], v22 offset:25088
    v_mfma_f32_16x16x32_bf16 v[216:219], v[140:143], v[48:51], v[216:219]
    ds_read_b64_tr_b16 v[46:47], v22 offset:27136
    s_add_u32 m0, s59, 24576
    s_add_u32 s38, s58, 524288
    buffer_load_dwordx4 v10, s[60:63], s38 offen lds
    s_waitcnt lgkmcnt(6)
    v_mfma_f32_16x16x32_bf16 v[204:207], v[136:139], v[52:55], v[204:207]
    ds_read_b64_tr_b16 v[48:49], v23 offset:25088
    v_mfma_f32_16x16x32_bf16 v[220:223], v[140:143], v[52:55], v[220:223]
    ds_read_b64_tr_b16 v[50:51], v23 offset:27136
    s_waitcnt lgkmcnt(6)
    v_mfma_f32_16x16x32_bf16 v[192:195], v[144:147], v[56:59], v[192:195]
    ds_read_b64_tr_b16 v[52:53], v22 offset:28672
    v_mfma_f32_16x16x32_bf16 v[208:211], v[148:151], v[56:59], v[208:211]
    ds_read_b64_tr_b16 v[54:55], v22 offset:30720
    buffer_load_dwordx4 v11, s[60:63], s38 offen offset:1024 lds
    s_waitcnt lgkmcnt(6)
    v_mfma_f32_16x16x32_bf16 v[196:199], v[144:147], v[60:63], v[196:199]
    ds_read_b64_tr_b16 v[56:57], v23 offset:28672
    v_mfma_f32_16x16x32_bf16 v[212:215], v[148:151], v[60:63], v[212:215]
    ds_read_b64_tr_b16 v[58:59], v23 offset:30720
    s_waitcnt lgkmcnt(6)
    v_mfma_f32_16x16x32_bf16 v[200:203], v[144:147], v[44:47], v[200:203]
    ds_read_b64_tr_b16 v[60:61], v22 offset:29184
    v_mfma_f32_16x16x32_bf16 v[216:219], v[148:151], v[44:47], v[216:219]
    ds_read_b64_tr_b16 v[62:63], v22 offset:31232
    s_add_u32 m0, s69, 32768
    s_add_u32 s38, s68, 221184
    s_mov_b32 exec_hi, 0
    buffer_load_dwordx4 v12, s[64:67], s38 offen lds
    s_mov_b32 exec_hi, -1
    s_waitcnt lgkmcnt(6)
    v_mfma_f32_16x16x32_bf16 v[204:207], v[144:147], v[48:51], v[204:207]
    ds_read_b64_tr_b16 v[44:45], v23 offset:29184
    v_mfma_f32_16x16x32_bf16 v[220:223], v[148:151], v[48:51], v[220:223]
    ds_read_b64_tr_b16 v[46:47], v23 offset:31232
    s_waitcnt vmcnt(14)
    s_barrier
    s_waitcnt lgkmcnt(6)
    v_mfma_f32_16x16x32_bf16 v[192:195], v[152:155], v[52:55], v[192:195]
    ds_read_b64_tr_b16 v[48:49], v22 offset:32768
    v_mfma_f32_16x16x32_bf16 v[208:211], v[156:159], v[52:55], v[208:211]
    ds_read_b64_tr_b16 v[50:51], v22 offset:34816
    s_add_u32 s38, s26, 8
    s_and_b32 s38, s38, 15
    s_lshl_b32 s38, s38, 18
    s_add_u32 s38, s38, s28
    s_add_u32 m0, s30, 131072
    s_add_u32 s38, s38, 128
    buffer_load_dwordx4 v10, s[16:19], s38 offen lds
    s_waitcnt lgkmcnt(6)
    v_mfma_f32_16x16x32_bf16 v[196:199], v[152:155], v[56:59], v[196:199]
    ds_read_b64_tr_b16 v[52:53], v23 offset:32768
    v_mfma_f32_16x16x32_bf16 v[212:215], v[156:159], v[56:59], v[212:215]
    ds_read_b64_tr_b16 v[54:55], v23 offset:34816
    s_waitcnt lgkmcnt(6)
    v_mfma_f32_16x16x32_bf16 v[200:203], v[152:155], v[60:63], v[200:203]
    ds_read_b64_tr_b16 v[56:57], v22 offset:33280
    v_mfma_f32_16x16x32_bf16 v[216:219], v[156:159], v[60:63], v[216:219]
    ds_read_b64_tr_b16 v[58:59], v22 offset:35328
    buffer_load_dwordx4 v11, s[16:19], s38 offen offset:1024 lds
    s_waitcnt lgkmcnt(6)
    v_mfma_f32_16x16x32_bf16 v[204:207], v[152:155], v[44:47], v[204:207]
    ds_read_b64_tr_b16 v[60:61], v23 offset:33280
    v_mfma_f32_16x16x32_bf16 v[220:223], v[156:159], v[44:47], v[220:223]
    ds_read_b64_tr_b16 v[62:63], v23 offset:35328
    s_waitcnt lgkmcnt(6)
    v_mfma_f32_16x16x32_bf16 v[192:195], v[160:163], v[48:51], v[192:195]
    ds_read_b64_tr_b16 v[44:45], v22 offset:36864
    v_mfma_f32_16x16x32_bf16 v[208:211], v[164:167], v[48:51], v[208:211]
    ds_read_b64_tr_b16 v[46:47], v22 offset:38912
    s_add_u32 s38, s26, 12
    s_and_b32 s38, s38, 15
    s_lshl_b32 s38, s38, 18
    s_add_u32 s38, s38, s28
    s_add_u32 m0, s30, 147456
    s_add_u32 s38, s38, 128
    buffer_load_dwordx4 v10, s[16:19], s38 offen lds
    s_add_u32 s45, s75, 7168
    buffer_store_dwordx4 v[248:251], v1, s[12:15], s45 offen sc1
    s_waitcnt lgkmcnt(6)
    v_mfma_f32_16x16x32_bf16 v[196:199], v[160:163], v[52:55], v[196:199]
    ds_read_b64_tr_b16 v[48:49], v23 offset:36864
    v_mfma_f32_16x16x32_bf16 v[212:215], v[164:167], v[52:55], v[212:215]
    ds_read_b64_tr_b16 v[50:51], v23 offset:38912
    s_waitcnt lgkmcnt(6)
    v_mfma_f32_16x16x32_bf16 v[200:203], v[160:163], v[56:59], v[200:203]
    ds_read_b64_tr_b16 v[52:53], v22 offset:37376
    v_mfma_f32_16x16x32_bf16 v[216:219], v[164:167], v[56:59], v[216:219]
    ds_read_b64_tr_b16 v[54:55], v22 offset:39424
    buffer_load_dwordx4 v11, s[16:19], s38 offen offset:1024 lds
    s_waitcnt lgkmcnt(6)
    v_mfma_f32_16x16x32_bf16 v[204:207], v[160:163], v[60:63], v[204:207]
    ds_read_b64_tr_b16 v[56:57], v23 offset:37376
    v_mfma_f32_16x16x32_bf16 v[220:223], v[164:167], v[60:63], v[220:223]
    ds_read_b64_tr_b16 v[58:59], v23 offset:39424
    s_waitcnt lgkmcnt(6)
    v_mfma_f32_16x16x32_bf16 v[192:195], v[168:171], v[44:47], v[192:195]
    ds_read_b64_tr_b16 v[60:61], v22 offset:40960
    v_mfma_f32_16x16x32_bf16 v[208:211], v[172:175], v[44:47], v[208:211]
    ds_read_b64_tr_b16 v[62:63], v22 offset:43008
    s_waitcnt lgkmcnt(6)
    v_mfma_f32_16x16x32_bf16 v[196:199], v[168:171], v[48:51], v[196:199]
    ds_read_b64_tr_b16 v[44:45], v23 offset:40960
    v_mfma_f32_16x16x32_bf16 v[212:215], v[172:175], v[48:51], v[212:215]
    ds_read_b64_tr_b16 v[46:47], v23 offset:43008
    s_waitcnt lgkmcnt(6)
    v_mfma_f32_16x16x32_bf16 v[200:203], v[168:171], v[52:55], v[200:203]
    ds_read_b64_tr_b16 v[48:49], v22 offset:41472
    v_mfma_f32_16x16x32_bf16 v[216:219], v[172:175], v[52:55], v[216:219]
    ds_read_b64_tr_b16 v[50:51], v22 offset:43520
    s_waitcnt lgkmcnt(6)
    v_mfma_f32_16x16x32_bf16 v[204:207], v[168:171], v[56:59], v[204:207]
    ds_read_b64_tr_b16 v[52:53], v23 offset:41472
    v_mfma_f32_16x16x32_bf16 v[220:223], v[172:175], v[56:59], v[220:223]
    ds_read_b64_tr_b16 v[54:55], v23 offset:43520
    s_waitcnt lgkmcnt(6)
    v_mfma_f32_16x16x32_bf16 v[192:195], v[176:179], v[60:63], v[192:195]
    ds_read_b64_tr_b16 v[56:57], v22 offset:45056
    v_mfma_f32_16x16x32_bf16 v[208:211], v[180:183], v[60:63], v[208:211]
    ds_read_b64_tr_b16 v[58:59], v22 offset:47104
    s_waitcnt lgkmcnt(6)
    v_mfma_f32_16x16x32_bf16 v[196:199], v[176:179], v[44:47], v[196:199]
    ds_read_b64_tr_b16 v[60:61], v23 offset:45056
    v_mfma_f32_16x16x32_bf16 v[212:215], v[180:183], v[44:47], v[212:215]
    ds_read_b64_tr_b16 v[62:63], v23 offset:47104
    s_waitcnt lgkmcnt(6)
    v_mfma_f32_16x16x32_bf16 v[200:203], v[176:179], v[48:51], v[200:203]
    ds_read_b64_tr_b16 v[44:45], v22 offset:45568
    v_mfma_f32_16x16x32_bf16 v[216:219], v[180:183], v[48:51], v[216:219]
    ds_read_b64_tr_b16 v[46:47], v22 offset:47616
    s_waitcnt lgkmcnt(6)
    v_mfma_f32_16x16x32_bf16 v[204:207], v[176:179], v[52:55], v[204:207]
    ds_read_b64_tr_b16 v[48:49], v23 offset:45568
    v_mfma_f32_16x16x32_bf16 v[220:223], v[180:183], v[52:55], v[220:223]
    ds_read_b64_tr_b16 v[50:51], v23 offset:47616
    s_waitcnt vmcnt(17)
    s_barrier
    s_waitcnt lgkmcnt(6)
    v_mfma_f32_16x16x32_bf16 v[192:195], v[184:187], v[56:59], v[192:195]
    ds_read_b64_tr_b16 v[52:53], v24 offset:0
    v_mfma_f32_16x16x32_bf16 v[208:211], v[188:191], v[56:59], v[208:211]
    ds_read_b64_tr_b16 v[54:55], v24 offset:2048
    buffer_load_dword v3, v2, s[12:15], 0 offen sc1
    s_waitcnt lgkmcnt(6)
    v_mfma_f32_16x16x32_bf16 v[196:199], v[184:187], v[60:63], v[196:199]
    ds_read_b64_tr_b16 v[56:57], v25 offset:0
    v_mfma_f32_16x16x32_bf16 v[212:215], v[188:191], v[60:63], v[212:215]
    ds_read_b64_tr_b16 v[58:59], v25 offset:2048
    s_add_u32 s45, s75, 1024
    buffer_store_dwordx4 v[36:39], v1, s[12:15], s45 offen sc1
    s_waitcnt lgkmcnt(6)
    v_mfma_f32_16x16x32_bf16 v[200:203], v[184:187], v[44:47], v[200:203]
    ds_read_b64_tr_b16 v[60:61], v24 offset:512
    v_cvt_pk_bf16_f32 v211, v210, v211
    v_cvt_pk_bf16_f32 v210, v208, v209
    v_cvt_pk_bf16_f32 v208, v192, v193
    v_cvt_pk_bf16_f32 v209, v194, v195
    v_mfma_f32_16x16x32_bf16 v[216:219], v[188:191], v[44:47], v[216:219]
    ds_read_b64_tr_b16 v[62:63], v24 offset:2560
    s_add_u32 m0, s59, 49152
    s_add_u32 s38, s58, 1048576
    buffer_load_dwordx4 v10, s[60:63], s38 offen lds
    s_waitcnt lgkmcnt(6)
    v_mfma_f32_16x16x32_bf16 v[204:207], v[184:187], v[48:51], v[204:207]
    ds_read_b64_tr_b16 v[44:45], v25 offset:512
    v_cvt_pk_bf16_f32 v215, v214, v215
    v_cvt_pk_bf16_f32 v214, v212, v213
    v_cvt_pk_bf16_f32 v212, v196, v197
    v_cvt_pk_bf16_f32 v213, v198, v199
    v_mfma_f32_16x16x32_bf16 v[220:223], v[188:191], v[48:51], v[220:223]
    ds_read_b64_tr_b16 v[46:47], v25 offset:2560
    s_waitcnt lgkmcnt(6)
    v_mfma_f32_16x16x32_bf16 v[224:227], v[64:67], v[52:55], 0
    ds_read_b64_tr_b16 v[48:49], v24 offset:4096
    v_cvt_pk_bf16_f32 v219, v218, v219
    v_cvt_pk_bf16_f32 v218, v216, v217
    v_cvt_pk_bf16_f32 v216, v200, v201
    v_cvt_pk_bf16_f32 v217, v202, v203
    v_mfma_f32_16x16x32_bf16 v[240:243], v[68:71], v[52:55], 0
    ds_read_b64_tr_b16 v[50:51], v24 offset:6144
    buffer_load_dwordx4 v11, s[60:63], s38 offen offset:1024 lds
    s_waitcnt lgkmcnt(6)
    v_mfma_f32_16x16x32_bf16 v[228:231], v[64:67], v[56:59], 0
    ds_read_b64_tr_b16 v[52:53], v25 offset:4096
    v_cvt_pk_bf16_f32 v223, v222, v223
    v_cvt_pk_bf16_f32 v222, v220, v221
    v_cvt_pk_bf16_f32 v220, v204, v205
    v_cvt_pk_bf16_f32 v221, v206, v207
    v_mfma_f32_16x16x32_bf16 v[244:247], v[68:71], v[56:59], 0
    ds_read_b64_tr_b16 v[54:55], v25 offset:6144
    s_waitcnt lgkmcnt(6)
    v_mfma_f32_16x16x32_bf16 v[232:235], v[64:67], v[60:63], 0
    ds_read_b64_tr_b16 v[56:57], v24 offset:4608
    v_mfma_f32_16x16x32_bf16 v[248:251], v[68:71], v[60:63], 0
    ds_read_b64_tr_b16 v[58:59], v24 offset:6656
    s_add_u32 m0, s69, 57344
    s_add_u32 s38, s68, 442368
    s_mov_b32 exec_hi, 0
    buffer_load_dwordx4 v12, s[64:67], s38 offen lds
    s_mov_b32 exec_hi, -1
    s_waitcnt lgkmcnt(6)
    v_mfma_f32_16x16x32_bf16 v[236:239], v[64:67], v[44:47], 0
    ds_read_b64_tr_b16 v[60:61], v25 offset:4608
    v_mfma_f32_16x16x32_bf16 v[252:255], v[68:71], v[44:47], 0
    ds_read_b64_tr_b16 v[62:63], v25 offset:6656
    s_waitcnt lgkmcnt(6)
    v_mfma_f32_16x16x32_bf16 v[224:227], v[72:75], v[48:51], v[224:227]
    ds_read_b64_tr_b16 v[44:45], v24 offset:8192
    v_mfma_f32_16x16x32_bf16 v[240:243], v[76:79], v[48:51], v[240:243]
    ds_read_b64_tr_b16 v[46:47], v24 offset:10240
    s_waitcnt lgkmcnt(6)
    v_mfma_f32_16x16x32_bf16 v[228:231], v[72:75], v[52:55], v[228:231]
    ds_read_b64_tr_b16 v[48:49], v25 offset:8192
    v_mfma_f32_16x16x32_bf16 v[244:247], v[76:79], v[52:55], v[244:247]
    ds_read_b64_tr_b16 v[50:51], v25 offset:10240
    s_waitcnt lgkmcnt(6)
    v_mfma_f32_16x16x32_bf16 v[232:235], v[72:75], v[56:59], v[232:235]
    ds_read_b64_tr_b16 v[52:53], v24 offset:8704
    v_mfma_f32_16x16x32_bf16 v[248:251], v[76:79], v[56:59], v[248:251]
    ds_read_b64_tr_b16 v[54:55], v24 offset:10752
    s_waitcnt lgkmcnt(6)
    v_mfma_f32_16x16x32_bf16 v[236:239], v[72:75], v[60:63], v[236:239]
    ds_read_b64_tr_b16 v[56:57], v25 offset:8704
    v_mfma_f32_16x16x32_bf16 v[252:255], v[76:79], v[60:63], v[252:255]
    ds_read_b64_tr_b16 v[58:59], v25 offset:10752
    s_waitcnt lgkmcnt(6)
    v_mfma_f32_16x16x32_bf16 v[224:227], v[80:83], v[44:47], v[224:227]
    ds_read_b64_tr_b16 v[60:61], v24 offset:12288
    v_mfma_f32_16x16x32_bf16 v[240:243], v[84:87], v[44:47], v[240:243]
    ds_read_b64_tr_b16 v[62:63], v24 offset:14336
    s_waitcnt lgkmcnt(6)
    v_mfma_f32_16x16x32_bf16 v[228:231], v[80:83], v[48:51], v[228:231]
    ds_read_b64_tr_b16 v[44:45], v25 offset:12288
    v_mfma_f32_16x16x32_bf16 v[244:247], v[84:87], v[48:51], v[244:247]
    ds_read_b64_tr_b16 v[46:47], v25 offset:14336
    s_waitcnt lgkmcnt(6)
    v_mfma_f32_16x16x32_bf16 v[232:235], v[80:83], v[52:55], v[232:235]
    ds_read_b64_tr_b16 v[48:49], v24 offset:12800
    v_mfma_f32_16x16x32_bf16 v[248:251], v[84:87], v[52:55], v[248:251]
    ds_read_b64_tr_b16 v[50:51], v24 offset:14848
    s_add_u32 s45, s75, 5120
    buffer_store_dwordx4 v[40:43], v1, s[12:15], s45 offen sc1
    s_waitcnt lgkmcnt(6)
    v_mfma_f32_16x16x32_bf16 v[236:239], v[80:83], v[56:59], v[236:239]
    ds_read_b64_tr_b16 v[52:53], v25 offset:12800
    v_mfma_f32_16x16x32_bf16 v[252:255], v[84:87], v[56:59], v[252:255]
    ds_read_b64_tr_b16 v[54:55], v25 offset:14848
    s_waitcnt vmcnt(21)
    s_barrier
    s_waitcnt lgkmcnt(6)
    v_mfma_f32_16x16x32_bf16 v[224:227], v[88:91], v[60:63], v[224:227]
    ds_read_b64_tr_b16 v[56:57], v24 offset:16384
    v_mfma_f32_16x16x32_bf16 v[240:243], v[92:95], v[60:63], v[240:243]
    ds_read_b64_tr_b16 v[58:59], v24 offset:18432
    s_add_u32 m0, s59, 73728
    s_add_u32 s38, s58, 1572864
    buffer_load_dwordx4 v10, s[60:63], s38 offen lds
    s_waitcnt lgkmcnt(6)
    v_mfma_f32_16x16x32_bf16 v[228:231], v[88:91], v[44:47], v[228:231]
    ds_read_b64_tr_b16 v[60:61], v25 offset:16384
    v_mfma_f32_16x16x32_bf16 v[244:247], v[92:95], v[44:47], v[244:247]
    ds_read_b64_tr_b16 v[62:63], v25 offset:18432
    buffer_load_dwordx4 v11, s[60:63], s38 offen offset:1024 lds
    s_waitcnt lgkmcnt(6)
    v_mfma_f32_16x16x32_bf16 v[232:235], v[88:91], v[48:51], v[232:235]
    ds_read_b64_tr_b16 v[44:45], v24 offset:16896
    v_mfma_f32_16x16x32_bf16 v[248:251], v[92:95], v[48:51], v[248:251]
    ds_read_b64_tr_b16 v[46:47], v24 offset:18944
    s_waitcnt vmcnt(7)
    v_cmp_eq_u32 s[46:47], v3, v13
    v_and_b32 v19, 7, v3
    v_cmp_gt_u32 vcc, 1, v19
    s_nop 1
    s_or_b64 vcc, vcc, s[46:47]
    s_cmp_lg_u32 vcc_lo, 0
    s_cbranch_scc1 L_spin_8
L_spinback_9:
    s_add_u32 m0, s69, 81920
    s_add_u32 s38, s68, 663552
    s_mov_b32 exec_hi, 0
    buffer_load_dwordx4 v12, s[64:67], s38 offen lds
    s_mov_b32 exec_hi, -1
    s_waitcnt lgkmcnt(6)
    v_mfma_f32_16x16x32_bf16 v[236:239], v[88:91], v[52:55], v[236:239]
    ds_read_b64_tr_b16 v[48:49], v25 offset:16896
    v_mfma_f32_16x16x32_bf16 v[252:255], v[92:95], v[52:55], v[252:255]
    ds_read_b64_tr_b16 v[50:51], v25 offset:18944
    s_waitcnt lgkmcnt(6)
    v_mfma_f32_16x16x32_bf16 v[224:227], v[96:99], v[56:59], v[224:227]
    ds_read_b64_tr_b16 v[52:53], v24 offset:20480
    v_mfma_f32_16x16x32_bf16 v[240:243], v[100:103], v[56:59], v[240:243]
    ds_read_b64_tr_b16 v[54:55], v24 offset:22528
    s_waitcnt lgkmcnt(6)
    v_mfma_f32_16x16x32_bf16 v[228:231], v[96:99], v[60:63], v[228:231]
    ds_read_b64_tr_b16 v[56:57], v25 offset:20480
    v_mfma_f32_16x16x32_bf16 v[244:247], v[100:103], v[60:63], v[244:247]
    ds_read_b64_tr_b16 v[58:59], v25 offset:22528
    buffer_load_dwordx4 v[64:67], v1, s[12:15], s33 offen offset:0 sc1
    s_waitcnt lgkmcnt(6)
    v_mfma_f32_16x16x32_bf16 v[232:235], v[96:99], v[44:47], v[232:235]
    ds_read_b64_tr_b16 v[60:61], v24 offset:20992
    v_mfma_f32_16x16x32_bf16 v[248:251], v[100:103], v[44:47], v[248:251]
    ds_read_b64_tr_b16 v[62:63], v24 offset:23040
    buffer_load_dwordx4 v[68:71], v1, s[12:15], s34 offen offset:0 sc1
    s_waitcnt lgkmcnt(6)
    v_mfma_f32_16x16x32_bf16 v[236:239], v[96:99], v[48:51], v[236:239]
    ds_read_b64_tr_b16 v[44:45], v25 offset:20992
    v_mfma_f32_16x16x32_bf16 v[252:255], v[100:103], v[48:51], v[252:255]
    ds_read_b64_tr_b16 v[46:47], v25 offset:23040
    buffer_load_dwordx4 v[72:75], v1, s[12:15], s33 offen offset:1024 sc1
    s_waitcnt lgkmcnt(6)
    v_mfma_f32_16x16x32_bf16 v[224:227], v[104:107], v[52:55], v[224:227]
    ds_read_b64_tr_b16 v[48:49], v24 offset:24576
    v_mfma_f32_16x16x32_bf16 v[240:243], v[108:111], v[52:55], v[240:243]
    ds_read_b64_tr_b16 v[50:51], v24 offset:26624
    buffer_load_dwordx4 v[76:79], v1, s[12:15], s34 offen offset:1024 sc1
    s_waitcnt lgkmcnt(6)
    v_mfma_f32_16x16x32_bf16 v[228:231], v[104:107], v[56:59], v[228:231]
    ds_read_b64_tr_b16 v[52:53], v25 offset:24576
    v_mfma_f32_16x16x32_bf16 v[244:247], v[108:111], v[56:59], v[244:247]
    ds_read_b64_tr_b16 v[54:55], v25 offset:26624
    s_waitcnt lgkmcnt(6)
    v_mfma_f32_16x16x32_bf16 v[232:235], v[104:107], v[60:63], v[232:235]
    ds_read_b64_tr_b16 v[56:57], v24 offset:25088
    v_mfma_f32_16x16x32_bf16 v[248:251], v[108:111], v[60:63], v[248:251]
    ds_read_b64_tr_b16 v[58:59], v24 offset:27136
    s_waitcnt lgkmcnt(6)
    v_mfma_f32_16x16x32_bf16 v[236:239], v[104:107], v[44:47], v[236:239]
    ds_read_b64_tr_b16 v[60:61], v25 offset:25088
    v_mfma_f32_16x16x32_bf16 v[252:255], v[108:111], v[44:47], v[252:255]
    ds_read_b64_tr_b16 v[62:63], v25 offset:27136
    s_add_u32 s45, s75, 16777216
    buffer_store_dwordx4 v[208:211], v1, s[12:15], s45 offen sc1
    s_waitcnt lgkmcnt(6)
    v_mfma_f32_16x16x32_bf16 v[224:227], v[112:115], v[48:51], v[224:227]
    ds_read_b64_tr_b16 v[44:45], v24 offset:28672
    v_mfma_f32_16x16x32_bf16 v[240:243], v[116:119], v[48:51], v[240:243]
    ds_read_b64_tr_b16 v[46:47], v24 offset:30720
    buffer_load_dwordx4 v[80:83], v1, s[12:15], s33 offen offset:2048 sc1
    s_waitcnt lgkmcnt(6)
    v_mfma_f32_16x16x32_bf16 v[228:231], v[112:115], v[52:55], v[228:231]
    ds_read_b64_tr_b16 v[48:49], v25 offset:28672
    v_mfma_f32_16x16x32_bf16 v[244:247], v[116:119], v[52:55], v[244:247]
    ds_read_b64_tr_b16 v[50:51], v25 offset:30720
    buffer_load_dwordx4 v[84:87], v1, s[12:15], s34 offen offset:2048 sc1
    s_waitcnt lgkmcnt(6)
    v_mfma_f32_16x16x32_bf16 v[232:235], v[112:115], v[56:59], v[232:235]
    ds_read_b64_tr_b16 v[52:53], v24 offset:29184
    v_mfma_f32_16x16x32_bf16 v[248:251], v[116:119], v[56:59], v[248:251]
    ds_read_b64_tr_b16 v[54:55], v24 offset:31232
    s_waitcnt lgkmcnt(6)
    v_mfma_f32_16x16x32_bf16 v[236:239], v[112:115], v[60:63], v[236:239]
    ds_read_b64_tr_b16 v[56:57], v25 offset:29184
    v_mfma_f32_16x16x32_bf16 v[252:255], v[116:119], v[60:63], v[252:255]
    ds_read_b64_tr_b16 v[58:59], v25 offset:31232
    s_barrier
    s_waitcnt lgkmcnt(6)
    v_mfma_f32_16x16x32_bf16 v[224:227], v[120:123], v[44:47], v[224:227]
    ds_read_b64_tr_b16 v[60:61], v24 offset:32768
    v_mfma_f32_16x16x32_bf16 v[240:243], v[124:127], v[44:47], v[240:243]
    ds_read_b64_tr_b16 v[62:63], v24 offset:34816
    s_waitcnt lgkmcnt(6)
    v_mfma_f32_16x16x32_bf16 v[228:231], v[120:123], v[48:51], v[228:231]
    ds_read_b64_tr_b16 v[44:45], v24 offset:36864
    v_mfma_f32_16x16x32_bf16 v[244:247], v[124:127], v[48:51], v[244:247]
    ds_read_b64_tr_b16 v[46:47], v24 offset:38912
    s_waitcnt lgkmcnt(6)
    v_mfma_f32_16x16x32_bf16 v[232:235], v[120:123], v[52:55], v[232:235]
    ds_read_b64_tr_b16 v[48:49], v24 offset:40960
    v_mfma_f32_16x16x32_bf16 v[248:251], v[124:127], v[52:55], v[248:251]
    ds_read_b64_tr_b16 v[50:51], v24 offset:43008
    s_waitcnt lgkmcnt(6)
    v_mfma_f32_16x16x32_bf16 v[236:239], v[120:123], v[56:59], v[236:239]
    ds_read_b64_tr_b16 v[52:53], v24 offset:45056
    v_mfma_f32_16x16x32_bf16 v[252:255], v[124:127], v[56:59], v[252:255]
    ds_read_b64_tr_b16 v[54:55], v24 offset:47104
    s_waitcnt lgkmcnt(6)
    v_mfma_f32_16x16x32_bf16 v[224:227], v[128:131], v[60:63], v[224:227]
    ds_read_b64_tr_b16 v[56:57], v24 offset:49152
    v_mfma_f32_16x16x32_bf16 v[240:243], v[132:135], v[60:63], v[240:243]
    ds_read_b64_tr_b16 v[58:59], v24 offset:51200
    s_waitcnt lgkmcnt(6)
    v_mfma_f32_16x16x32_bf16 v[224:227], v[136:139], v[44:47], v[224:227]
    ds_read_b64_tr_b16 v[60:61], v24 offset:53248
    v_mfma_f32_16x16x32_bf16 v[240:243], v[140:143], v[44:47], v[240:243]
    ds_read_b64_tr_b16 v[62:63], v24 offset:55296
    s_waitcnt lgkmcnt(6)
    v_mfma_f32_16x16x32_bf16 v[224:227], v[144:147], v[48:51], v[224:227]
    ds_read_b64_tr_b16 v[44:45], v24 offset:57344
    v_mfma_f32_16x16x32_bf16 v[240:243], v[148:151], v[48:51], v[240:243]
    ds_read_b64_tr_b16 v[46:47], v24 offset:59392
    s_mov_b32 s16, s100
    s_mov_b32 s17, s101
    s_and_b32 s17, s17, 0xffff
    s_mov_b32 s18, 64
    s_mov_b32 s19, 0x20000
    buffer_load_dwordx2 v[32:33], v26, s[16:19], 0 offen offset:0
    s_waitcnt lgkmcnt(6)
    v_mfma_f32_16x16x32_bf16 v[224:227], v[152:155], v[52:55], v[224:227]
    ds_read_b64_tr_b16 v[48:49], v24 offset:61440
    v_mfma_f32_16x16x32_bf16 v[240:243], v[156:159], v[52:55], v[240:243]
    ds_read_b64_tr_b16 v[50:51], v24 offset:63488
    buffer_load_dwordx2 v[34:35], v26, s[16:19], 0 offen offset:32
    s_waitcnt lgkmcnt(6)
    v_mfma_f32_16x16x32_bf16 v[224:227], v[160:163], v[56:59], v[224:227]
    ds_read_b64_tr_b16 v[52:53], v25 offset:32768
    v_mfma_f32_16x16x32_bf16 v[240:243], v[164:167], v[56:59], v[240:243]
    ds_read_b64_tr_b16 v[54:55], v25 offset:34816
    buffer_load_dwordx4 v[88:91], v1, s[12:15], s33 offen offset:3072 sc1
    s_add_u32 s33, s33, 4096
    s_add_u32 s45, s75, 16778240
    buffer_store_dwordx4 v[212:215], v1, s[12:15], s45 offen sc1
    s_waitcnt lgkmcnt(6)
    v_mfma_f32_16x16x32_bf16 v[224:227], v[168:171], v[60:63], v[224:227]
    ds_read_b64_tr_b16 v[56:57], v25 offset:36864
    v_mfma_f32_16x16x32_bf16 v[240:243], v[172:175], v[60:63], v[240:243]
    ds_read_b64_tr_b16 v[58:59], v25 offset:38912
    buffer_load_dwordx4 v[92:95], v1, s[12:15], s34 offen offset:3072 sc1
    s_add_u32 s34, s34, 4096
    s_waitcnt lgkmcnt(6)
    v_mfma_f32_16x16x32_bf16 v[224:227], v[176:179], v[44:47], v[224:227]
    ds_read_b64_tr_b16 v[60:61], v25 offset:40960
    v_mfma_f32_16x16x32_bf16 v[240:243], v[180:183], v[44:47], v[240:243]
    ds_read_b64_tr_b16 v[62:63], v25 offset:43008
    s_waitcnt lgkmcnt(6)
    v_mfma_f32_16x16x32_bf16 v[224:227], v[184:187], v[48:51], v[224:227]
    ds_read_b64_tr_b16 v[44:45], v25 offset:45056
    v_mfma_f32_16x16x32_bf16 v[240:243], v[188:191], v[48:51], v[240:243]
    ds_read_b64_tr_b16 v[46:47], v25 offset:47104
    s_waitcnt lgkmcnt(6)
    v_mfma_f32_16x16x32_bf16 v[228:231], v[128:131], v[52:55], v[228:231]
    ds_read_b64_tr_b16 v[48:49], v25 offset:49152
    v_mfma_f32_16x16x32_bf16 v[244:247], v[132:135], v[52:55], v[244:247]
    ds_read_b64_tr_b16 v[50:51], v25 offset:51200
    s_waitcnt lgkmcnt(6)
    v_mfma_f32_16x16x32_bf16 v[228:231], v[136:139], v[56:59], v[228:231]
    ds_read_b64_tr_b16 v[52:53], v25 offset:53248
    v_cvt_pk_bf16_f32 v224, v224, v225
    v_cvt_pk_bf16_f32 v225, v226, v227
    v_cvt_pk_bf16_f32 v226, v240, v241
    v_cvt_pk_bf16_f32 v227, v242, v243
    v_mfma_f32_16x16x32_bf16 v[244:247], v[140:143], v[56:59], v[244:247]
    ds_read_b64_tr_b16 v[54:55], v25 offset:55296
    s_waitcnt lgkmcnt(6)
    v_mfma_f32_16x16x32_bf16 v[228:231], v[144:147], v[60:63], v[228:231]
    ds_read_b64_tr_b16 v[56:57], v25 offset:57344
    v_mfma_f32_16x16x32_bf16 v[244:247], v[148:151], v[60:63], v[244:247]
    ds_read_b64_tr_b16 v[58:59], v25 offset:59392
    s_waitcnt lgkmcnt(6)
    v_mfma_f32_16x16x32_bf16 v[228:231], v[152:155], v[44:47], v[228:231]
    ds_read_b64_tr_b16 v[60:61], v25 offset:61440
    v_mfma_f32_16x16x32_bf16 v[244:247], v[156:159], v[44:47], v[244:247]
    ds_read_b64_tr_b16 v[62:63], v25 offset:63488
    s_waitcnt lgkmcnt(6)
    v_mfma_f32_16x16x32_bf16 v[228:231], v[160:163], v[48:51], v[228:231]
    ds_read_b64_tr_b16 v[44:45], v24 offset:33280
    v_mfma_f32_16x16x32_bf16 v[244:247], v[164:167], v[48:51], v[244:247]
    ds_read_b64_tr_b16 v[46:47], v24 offset:35328
    buffer_load_dwordx4 v[96:99], v1, s[12:15], s33 offen offset:0 sc1
    s_waitcnt lgkmcnt(6)
    v_mfma_f32_16x16x32_bf16 v[228:231], v[168:171], v[52:55], v[228:231]
    ds_read_b64_tr_b16 v[48:49], v24 offset:37376
    v_mfma_f32_16x16x32_bf16 v[244:247], v[172:175], v[52:55], v[244:247]
    ds_read_b64_tr_b16 v[50:51], v24 offset:39424
    buffer_load_dwordx4 v[100:103], v1, s[12:15], s34 offen offset:0 sc1
    s_waitcnt lgkmcnt(6)
    v_mfma_f32_16x16x32_bf16 v[228:231], v[176:179], v[56:59], v[228:231]
    ds_read_b64_tr_b16 v[52:53], v24 offset:41472
    v_mfma_f32_16x16x32_bf16 v[244:247], v[180:183], v[56:59], v[244:247]
    ds_read_b64_tr_b16 v[54:55], v24 offset:43520
    s_waitcnt lgkmcnt(6)
    v_mfma_f32_16x16x32_bf16 v[228:231], v[184:187], v[60:63], v[228:231]
    ds_read_b64_tr_b16 v[56:57], v24 offset:45568
    v_mfma_f32_16x16x32_bf16 v[244:247], v[188:191], v[60:63], v[244:247]
    ds_read_b64_tr_b16 v[58:59], v24 offset:47616
    s_waitcnt lgkmcnt(6)
    v_mfma_f32_16x16x32_bf16 v[232:235], v[128:131], v[44:47], v[232:235]
    ds_read_b64_tr_b16 v[60:61], v24 offset:49664
    v_mfma_f32_16x16x32_bf16 v[248:251], v[132:135], v[44:47], v[248:251]
    ds_read_b64_tr_b16 v[62:63], v24 offset:51712
    s_waitcnt lgkmcnt(6)
    v_mfma_f32_16x16x32_bf16 v[232:235], v[136:139], v[48:51], v[232:235]
    ds_read_b64_tr_b16 v[44:45], v24 offset:53760
    v_cvt_pk_bf16_f32 v228, v228, v229
    v_cvt_pk_bf16_f32 v229, v230, v231
    v_cvt_pk_bf16_f32 v230, v244, v245
    v_cvt_pk_bf16_f32 v231, v246, v247
    v_mfma_f32_16x16x32_bf16 v[248:251], v[140:143], v[48:51], v[248:251]
    ds_read_b64_tr_b16 v[46:47], v24 offset:55808
    s_add_u32 s45, s75, 16779264
    buffer_store_dwordx4 v[216:219], v1, s[12:15], s45 offen sc1
    s_waitcnt lgkmcnt(6)
    v_mfma_f32_16x16x32_bf16 v[232:235], v[144:147], v[52:55], v[232:235]
    ds_read_b64_tr_b16 v[48:49], v24 offset:57856
    v_mfma_f32_16x16x32_bf16 v[248:251], v[148:151], v[52:55], v[248:251]
    ds_read_b64_tr_b16 v[50:51], v24 offset:59904
    s_waitcnt lgkmcnt(6)
    v_mfma_f32_16x16x32_bf16 v[232:235], v[152:155], v[56:59], v[232:235]
    ds_read_b64_tr_b16 v[52:53], v24 offset:61952
    v_mfma_f32_16x16x32_bf16 v[248:251], v[156:159], v[56:59], v[248:251]
    ds_read_b64_tr_b16 v[54:55], v24 offset:64000
    s_waitcnt lgkmcnt(6)
    v_mfma_f32_16x16x32_bf16 v[232:235], v[160:163], v[60:63], v[232:235]
    ds_read_b64_tr_b16 v[56:57], v25 offset:33280
    v_mfma_f32_16x16x32_bf16 v[248:251], v[164:167], v[60:63], v[248:251]
    ds_read_b64_tr_b16 v[58:59], v25 offset:35328
    s_waitcnt lgkmcnt(6)
    v_mfma_f32_16x16x32_bf16 v[232:235], v[168:171], v[44:47], v[232:235]
    ds_read_b64_tr_b16 v[60:61], v25 offset:37376
    v_mfma_f32_16x16x32_bf16 v[248:251], v[172:175], v[44:47], v[248:251]
    ds_read_b64_tr_b16 v[62:63], v25 offset:39424
    s_waitcnt lgkmcnt(6)
    v_mfma_f32_16x16x32_bf16 v[232:235], v[176:179], v[48:51], v[232:235]
    ds_read_b64_tr_b16 v[44:45], v25 offset:41472
    v_mfma_f32_16x16x32_bf16 v[248:251], v[180:183], v[48:51], v[248:251]
    ds_read_b64_tr_b16 v[46:47], v25 offset:43520
    buffer_load_dwordx4 v[104:107], v1, s[12:15], s33 offen offset:1024 sc1
    s_waitcnt lgkmcnt(6)
    v_mfma_f32_16x16x32_bf16 v[232:235], v[184:187], v[52:55], v[232:235]
    ds_read_b64_tr_b16 v[48:49], v25 offset:45568
    v_mfma_f32_16x16x32_bf16 v[248:251], v[188:191], v[52:55], v[248:251]
    ds_read_b64_tr_b16 v[50:51], v25 offset:47616
    buffer_load_dwordx4 v[108:111], v1, s[12:15], s34 offen offset:1024 sc1
    s_add_u32 s45, s75, 16780288
    buffer_store_dwordx4 v[220:223], v1, s[12:15], s45 offen sc1
    s_waitcnt lgkmcnt(6)
    v_mfma_f32_16x16x32_bf16 v[236:239], v[128:131], v[56:59], v[236:239]
    ds_read_b64_tr_b16 v[52:53], v25 offset:49664
    v_mfma_f32_16x16x32_bf16 v[252:255], v[132:135], v[56:59], v[252:255]
    ds_read_b64_tr_b16 v[54:55], v25 offset:51712
    s_waitcnt lgkmcnt(6)
    v_mfma_f32_16x16x32_bf16 v[236:239], v[136:139], v[60:63], v[236:239]
    ds_read_b64_tr_b16 v[56:57], v25 offset:53760
    v_cvt_pk_bf16_f32 v232, v232, v233
    v_cvt_pk_bf16_f32 v233, v234, v235
    v_cvt_pk_bf16_f32 v234, v248, v249
    v_cvt_pk_bf16_f32 v235, v250, v251
    v_mfma_f32_16x16x32_bf16 v[252:255], v[140:143], v[60:63], v[252:255]
    ds_read_b64_tr_b16 v[58:59], v25 offset:55808
    s_waitcnt lgkmcnt(6)
    v_mfma_f32_16x16x32_bf16 v[236:239], v[144:147], v[44:47], v[236:239]
    ds_read_b64_tr_b16 v[60:61], v25 offset:57856
    v_mfma_f32_16x16x32_bf16 v[252:255], v[148:151], v[44:47], v[252:255]
    ds_read_b64_tr_b16 v[62:63], v25 offset:59904
    s_waitcnt vmcnt(9)
    v_lshlrev_b32 v192, 16, v32
    v_and_b32 v193, 0xffff0000, v32
    v_lshlrev_b32 v194, 16, v33
    v_and_b32 v195, 0xffff0000, v33
    v_lshlrev_b32 v196, 16, v34
    v_and_b32 v197, 0xffff0000, v34
    v_lshlrev_b32 v198, 16, v35
    v_and_b32 v199, 0xffff0000, v35
    s_waitcnt lgkmcnt(6)
    v_mfma_f32_16x16x32_bf16 v[236:239], v[152:155], v[48:51], v[236:239]
    ds_read_b64_tr_b16 v[44:45], v25 offset:61952
    v_mfma_f32_16x16x32_bf16 v[252:255], v[156:159], v[48:51], v[252:255]
    ds_read_b64_tr_b16 v[46:47], v25 offset:64000
    s_barrier
    s_waitcnt lgkmcnt(6)
    v_mfma_f32_16x16x32_bf16 v[236:239], v[160:163], v[52:55], v[236:239]
    ds_read_b64_tr_b16 v[48:49], v20 offset:8192
    v_mfma_f32_16x16x32_bf16 v[252:255], v[164:167], v[52:55], v[252:255]
    ds_read_b64_tr_b16 v[50:51], v20 offset:10240
    s_add_u32 m0, s59, 98304
    s_add_u32 s38, s58, 2097152
    buffer_load_dwordx4 v10, s[60:63], s38 offen lds
    s_waitcnt lgkmcnt(6)
    v_mfma_f32_16x16x32_bf16 v[236:239], v[168:171], v[56:59], v[236:239]
    ds_read_b64_tr_b16 v[52:53], v21 offset:8192
    v_mfma_f32_16x16x32_bf16 v[252:255], v[172:175], v[56:59], v[252:255]
    ds_read_b64_tr_b16 v[54:55], v21 offset:10240
    buffer_load_dwordx4 v11, s[60:63], s38 offen offset:1024 lds
    s_waitcnt lgkmcnt(6)
    v_mfma_f32_16x16x32_bf16 v[236:239], v[176:179], v[60:63], v[236:239]
    ds_read_b64_tr_b16 v[56:57], v20 offset:0
    v_mfma_f32_16x16x32_bf16 v[252:255], v[180:183], v[60:63], v[252:255]
    ds_read_b64_tr_b16 v[58:59], v20 offset:2048
    s_add_u32 m0, s69, 106496
    s_add_u32 s38, s68, 884736
    s_mov_b32 exec_hi, 0
    buffer_load_dwordx4 v12, s[64:67], s38 offen lds
    s_mov_b32 exec_hi, -1
    s_waitcnt lgkmcnt(6)
    v_mfma_f32_16x16x32_bf16 v[236:239], v[184:187], v[44:47], v[236:239]
    ds_read_b64_tr_b16 v[60:61], v21 offset:0
    v_mfma_f32_16x16x32_bf16 v[252:255], v[188:191], v[44:47], v[252:255]
    ds_read_b64_tr_b16 v[62:63], v21 offset:2048
    s_waitcnt lgkmcnt(6)
    v_mfma_f32_16x16x32_bf16 v[208:211], v[48:51], v[68:71], v[192:195]
    ds_read_b64_tr_b16 v[44:45], v20 offset:512
    v_mfma_f32_16x16x32_bf16 v[192:195], v[48:51], v[64:67], v[192:195]
    ds_read_b64_tr_b16 v[46:47], v20 offset:2560
    buffer_load_dwordx4 v[112:115], v1, s[12:15], s33 offen offset:2048 sc1
    s_waitcnt lgkmcnt(6)
    v_mfma_f32_16x16x32_bf16 v[212:215], v[52:55], v[68:71], v[196:199]
    ds_read_b64_tr_b16 v[48:49], v21 offset:512
    v_cvt_pk_bf16_f32 v236, v236, v237
    v_cvt_pk_bf16_f32 v237, v238, v239
    v_cvt_pk_bf16_f32 v238, v252, v253
    v_cvt_pk_bf16_f32 v239, v254, v255
    v_mfma_f32_16x16x32_bf16 v[196:199], v[52:55], v[64:67], v[196:199]
    ds_read_b64_tr_b16 v[50:51], v21 offset:2560
    buffer_load_dwordx4 v[116:119], v1, s[12:15], s34 offen offset:2048 sc1
    s_add_u32 s45, s75, 16781312
    buffer_store_dwordx4 v[224:227], v1, s[12:15], s45 offen sc1
    s_waitcnt lgkmcnt(6)
    v_mfma_f32_16x16x32_bf16 v[128:131], v[56:59], v[64:67], 0
    ds_read_b64_tr_b16 v[52:53], v20 offset:4096
    v_mfma_f32_16x16x32_bf16 v[160:163], v[56:59], v[68:71], 0
    ds_read_b64_tr_b16 v[54:55], v20 offset:6144
    s_waitcnt lgkmcnt(6)
    v_mfma_f32_16x16x32_bf16 v[132:135], v[60:63], v[64:67], 0
    ds_read_b64_tr_b16 v[56:57], v21 offset:4096
    v_mfma_f32_16x16x32_bf16 v[164:167], v[60:63], v[68:71], 0
    ds_read_b64_tr_b16 v[58:59], v21 offset:6144
    s_waitcnt lgkmcnt(6)
    v_mfma_f32_16x16x32_bf16 v[136:139], v[44:47], v[64:67], 0
    ds_read_b64_tr_b16 v[60:61], v20 offset:4608
    v_mfma_f32_16x16x32_bf16 v[168:171], v[44:47], v[68:71], 0
    ds_read_b64_tr_b16 v[62:63], v20 offset:6656
    s_waitcnt lgkmcnt(6)
    v_mfma_f32_16x16x32_bf16 v[140:143], v[48:51], v[64:67], 0
    ds_read_b64_tr_b16 v[44:45], v21 offset:4608
    v_mfma_f32_16x16x32_bf16 v[172:175], v[48:51], v[68:71], 0
    ds_read_b64_tr_b16 v[46:47], v21 offset:6656
    s_waitcnt lgkmcnt(6)
    v_mfma_f32_16x16x32_bf16 v[144:147], v[52:55], v[64:67], 0
    ds_read_b64_tr_b16 v[48:49], v20 offset:20480
    v_mfma_f32_16x16x32_bf16 v[176:179], v[52:55], v[68:71], 0
    ds_read_b64_tr_b16 v[50:51], v20 offset:22528
    s_waitcnt lgkmcnt(6)
    v_mfma_f32_16x16x32_bf16 v[148:151], v[56:59], v[64:67], 0
    ds_read_b64_tr_b16 v[52:53], v21 offset:20480
    v_mfma_f32_16x16x32_bf16 v[180:183], v[56:59], v[68:71], 0
    ds_read_b64_tr_b16 v[54:55], v21 offset:22528
    s_waitcnt lgkmcnt(6)
    v_mfma_f32_16x16x32_bf16 v[152:155], v[60:63], v[64:67], 0
    ds_read_b64_tr_b16 v[56:57], v20 offset:12288
    v_mfma_f32_16x16x32_bf16 v[184:187], v[60:63], v[68:71], 0
    ds_read_b64_tr_b16 v[58:59], v20 offset:14336
    s_waitcnt lgkmcnt(6)
    v_mfma_f32_16x16x32_bf16 v[156:159], v[44:47], v[64:67], 0
    ds_read_b64_tr_b16 v[60:61], v21 offset:12288
    v_mfma_f32_16x16x32_bf16 v[188:191], v[44:47], v[68:71], 0
    ds_read_b64_tr_b16 v[62:63], v21 offset:14336
    s_waitcnt lgkmcnt(6)
    v_mfma_f32_16x16x32_bf16 v[192:195], v[48:51], v[72:75], v[192:195]
    ds_read_b64_tr_b16 v[44:45], v20 offset:12800
    v_mfma_f32_16x16x32_bf16 v[208:211], v[48:51], v[76:79], v[208:211]
    ds_read_b64_tr_b16 v[46:47], v20 offset:14848
    buffer_load_dwordx4 v[120:123], v1, s[12:15], s33 offen offset:3072 sc1
    s_add_u32 s33, s33, 4096
    s_waitcnt lgkmcnt(6)
    v_mfma_f32_16x16x32_bf16 v[196:199], v[52:55], v[72:75], v[196:199]
    ds_read_b64_tr_b16 v[48:49], v21 offset:12800
    v_mfma_f32_16x16x32_bf16 v[212:215], v[52:55], v[76:79], v[212:215]
    ds_read_b64_tr_b16 v[50:51], v21 offset:14848
    buffer_load_dwordx4 v[124:127], v1, s[12:15], s34 offen offset:3072 sc1
    s_add_u32 s34, s34, 4096
    s_add_u32 s45, s75, 16782336
    buffer_store_dwordx4 v[228:231], v1, s[12:15], s45 offen sc1
    s_waitcnt lgkmcnt(6)
    v_mfma_f32_16x16x32_bf16 v[128:131], v[56:59], v[72:75], v[128:131]
    ds_read_b64_tr_b16 v[52:53], v20 offset:16384
    v_mfma_f32_16x16x32_bf16 v[160:163], v[56:59], v[76:79], v[160:163]
    ds_read_b64_tr_b16 v[54:55], v20 offset:18432
    s_waitcnt lgkmcnt(6)
    v_mfma_f32_16x16x32_bf16 v[132:135], v[60:63], v[72:75], v[132:135]
    ds_read_b64_tr_b16 v[56:57], v21 offset:16384
    v_mfma_f32_16x16x32_bf16 v[164:167], v[60:63], v[76:79], v[164:167]
    ds_read_b64_tr_b16 v[58:59], v21 offset:18432
    s_waitcnt lgkmcnt(6)
    v_mfma_f32_16x16x32_bf16 v[136:139], v[44:47], v[72:75], v[136:139]
    ds_read_b64_tr_b16 v[60:61], v20 offset:16896
    v_mfma_f32_16x16x32_bf16 v[168:171], v[44:47], v[76:79], v[168:171]
    ds_read_b64_tr_b16 v[62:63], v20 offset:18944
    s_waitcnt lgkmcnt(6)
    v_mfma_f32_16x16x32_bf16 v[140:143], v[48:51], v[72:75], v[140:143]
    ds_read_b64_tr_b16 v[44:45], v21 offset:16896
    v_mfma_f32_16x16x32_bf16 v[172:175], v[48:51], v[76:79], v[172:175]
    ds_read_b64_tr_b16 v[46:47], v21 offset:18944
    s_barrier
    s_waitcnt lgkmcnt(6)
    v_mfma_f32_16x16x32_bf16 v[144:147], v[52:55], v[72:75], v[144:147]
    ds_read_b64_tr_b16 v[48:49], v20 offset:32768
    v_mfma_f32_16x16x32_bf16 v[176:179], v[52:55], v[76:79], v[176:179]
    ds_read_b64_tr_b16 v[50:51], v20 offset:34816
    s_add_u32 m0, s59, 122880
    s_add_u32 s38, s58, 2621440
    buffer_load_dwordx4 v10, s[60:63], s38 offen lds
    s_waitcnt lgkmcnt(6)
    v_mfma_f32_16x16x32_bf16 v[148:151], v[56:59], v[72:75], v[148:151]
    ds_read_b64_tr_b16 v[52:53], v21 offset:32768
    v_mfma_f32_16x16x32_bf16 v[180:183], v[56:59], v[76:79], v[180:183]
    ds_read_b64_tr_b16 v[54:55], v21 offset:34816
    buffer_load_dwordx4 v11, s[60:63], s38 offen offset:1024 lds
    s_waitcnt lgkmcnt(6)
    v_mfma_f32_16x16x32_bf16 v[152:155], v[60:63], v[72:75], v[152:155]
    ds_read_b64_tr_b16 v[56:57], v20 offset:24576
    v_mfma_f32_16x16x32_bf16 v[184:187], v[60:63], v[76:79], v[184:187]
    ds_read_b64_tr_b16 v[58:59], v20 offset:26624
    s_add_u32 m0, s69, 131072
    s_add_u32 s38, s68, 1105920
    s_mov_b32 exec_hi, 0
    buffer_load_dwordx4 v12, s[64:67], s38 offen lds
    s_mov_b32 exec_hi, -1
    s_waitcnt lgkmcnt(6)
    v_mfma_f32_16x16x32_bf16 v[156:159], v[44:47], v[72:75], v[156:159]
    ds_read_b64_tr_b16 v[60:61], v21 offset:24576
    v_mfma_f32_16x16x32_bf16 v[188:191], v[44:47], v[76:79], v[188:191]
    ds_read_b64_tr_b16 v[62:63], v21 offset:26624
    s_waitcnt lgkmcnt(6)
    v_mfma_f32_16x16x32_bf16 v[192:195], v[48:51], v[80:83], v[192:195]
    ds_read_b64_tr_b16 v[44:45], v20 offset:25088
    v_mfma_f32_16x16x32_bf16 v[208:211], v[48:51], v[84:87], v[208:211]
    ds_read_b64_tr_b16 v[46:47], v20 offset:27136
    buffer_load_dwordx4 v[64:67], v1, s[12:15], s33 offen offset:0 sc1
    s_waitcnt lgkmcnt(6)
    v_mfma_f32_16x16x32_bf16 v[196:199], v[52:55], v[80:83], v[196:199]
    ds_read_b64_tr_b16 v[48:49], v21 offset:25088
    v_mfma_f32_16x16x32_bf16 v[212:215], v[52:55], v[84:87], v[212:215]
    ds_read_b64_tr_b16 v[50:51], v21 offset:27136
    buffer_load_dwordx4 v[68:71], v1, s[12:15], s34 offen offset:0 sc1
    s_add_u32 s45, s75, 16783360
    buffer_store_dwordx4 v[232:235], v1, s[12:15], s45 offen sc1
    s_waitcnt lgkmcnt(6)
    v_mfma_f32_16x16x32_bf16 v[128:131], v[56:59], v[80:83], v[128:131]
    ds_read_b64_tr_b16 v[52:53], v20 offset:28672
    v_mfma_f32_16x16x32_bf16 v[160:163], v[56:59], v[84:87], v[160:163]
    ds_read_b64_tr_b16 v[54:55], v20 offset:30720
    s_waitcnt lgkmcnt(6)
    v_mfma_f32_16x16x32_bf16 v[132:135], v[60:63], v[80:83], v[132:135]
    ds_read_b64_tr_b16 v[56:57], v21 offset:28672
    v_mfma_f32_16x16x32_bf16 v[164:167], v[60:63], v[84:87], v[164:167]
    ds_read_b64_tr_b16 v[58:59], v21 offset:30720
    s_waitcnt lgkmcnt(6)
    v_mfma_f32_16x16x32_bf16 v[136:139], v[44:47], v[80:83], v[136:139]
    ds_read_b64_tr_b16 v[60:61], v20 offset:29184
    v_mfma_f32_16x16x32_bf16 v[168:171], v[44:47], v[84:87], v[168:171]
    ds_read_b64_tr_b16 v[62:63], v20 offset:31232
    s_waitcnt lgkmcnt(6)
    v_mfma_f32_16x16x32_bf16 v[140:143], v[48:51], v[80:83], v[140:143]
    ds_read_b64_tr_b16 v[44:45], v21 offset:29184
    v_mfma_f32_16x16x32_bf16 v[172:175], v[48:51], v[84:87], v[172:175]
    ds_read_b64_tr_b16 v[46:47], v21 offset:31232
    s_waitcnt lgkmcnt(6)
    v_mfma_f32_16x16x32_bf16 v[144:147], v[52:55], v[80:83], v[144:147]
    ds_read_b64_tr_b16 v[48:49], v20 offset:45056
    v_mfma_f32_16x16x32_bf16 v[176:179], v[52:55], v[84:87], v[176:179]
    ds_read_b64_tr_b16 v[50:51], v20 offset:47104
    s_waitcnt lgkmcnt(6)
    v_mfma_f32_16x16x32_bf16 v[148:151], v[56:59], v[80:83], v[148:151]
    ds_read_b64_tr_b16 v[52:53], v21 offset:45056
    v_mfma_f32_16x16x32_bf16 v[180:183], v[56:59], v[84:87], v[180:183]
    ds_read_b64_tr_b16 v[54:55], v21 offset:47104
    s_waitcnt lgkmcnt(6)
    v_mfma_f32_16x16x32_bf16 v[152:155], v[60:63], v[80:83], v[152:155]
    ds_read_b64_tr_b16 v[56:57], v20 offset:36864
    v_mfma_f32_16x16x32_bf16 v[184:187], v[60:63], v[84:87], v[184:187]
    ds_read_b64_tr_b16 v[58:59], v20 offset:38912
    s_waitcnt lgkmcnt(6)
    v_mfma_f32_16x16x32_bf16 v[156:159], v[44:47], v[80:83], v[156:159]
    ds_read_b64_tr_b16 v[60:61], v21 offset:36864
    v_mfma_f32_16x16x32_bf16 v[188:191], v[44:47], v[84:87], v[188:191]
    ds_read_b64_tr_b16 v[62:63], v21 offset:38912
    s_waitcnt vmcnt(21)
    s_waitcnt lgkmcnt(6)
    v_mfma_f32_16x16x32_bf16 v[192:195], v[48:51], v[88:91], v[192:195]
    ds_read_b64_tr_b16 v[44:45], v20 offset:37376
    v_mfma_f32_16x16x32_bf16 v[208:211], v[48:51], v[92:95], v[208:211]
    ds_read_b64_tr_b16 v[46:47], v20 offset:39424
    buffer_load_dwordx4 v[72:75], v1, s[12:15], s33 offen offset:1024 sc1
    s_waitcnt lgkmcnt(6)
    v_mfma_f32_16x16x32_bf16 v[196:199], v[52:55], v[88:91], v[196:199]
    ds_read_b64_tr_b16 v[48:49], v21 offset:37376
    v_mfma_f32_16x16x32_bf16 v[212:215], v[52:55], v[92:95], v[212:215]
    ds_read_b64_tr_b16 v[50:51], v21 offset:39424
    buffer_load_dwordx4 v[76:79], v1, s[12:15], s34 offen offset:1024 sc1
    s_add_u32 s45, s75, 16784384
    buffer_store_dwordx4 v[236:239], v1, s[12:15], s45 offen sc1
    s_waitcnt lgkmcnt(6)
    v_mfma_f32_16x16x32_bf16 v[128:131], v[56:59], v[88:91], v[128:131]
    ds_read_b64_tr_b16 v[52:53], v20 offset:40960
    v_mfma_f32_16x16x32_bf16 v[160:163], v[56:59], v[92:95], v[160:163]
    ds_read_b64_tr_b16 v[54:55], v20 offset:43008
    s_waitcnt lgkmcnt(6)
    v_mfma_f32_16x16x32_bf16 v[132:135], v[60:63], v[88:91], v[132:135]
    ds_read_b64_tr_b16 v[56:57], v21 offset:40960
    v_mfma_f32_16x16x32_bf16 v[164:167], v[60:63], v[92:95], v[164:167]
    ds_read_b64_tr_b16 v[58:59], v21 offset:43008
    s_waitcnt lgkmcnt(6)
    v_mfma_f32_16x16x32_bf16 v[136:139], v[44:47], v[88:91], v[136:139]
    ds_read_b64_tr_b16 v[60:61], v20 offset:41472
    v_mfma_f32_16x16x32_bf16 v[168:171], v[44:47], v[92:95], v[168:171]
    ds_read_b64_tr_b16 v[62:63], v20 offset:43520
    s_waitcnt lgkmcnt(6)
    v_mfma_f32_16x16x32_bf16 v[140:143], v[48:51], v[88:91], v[140:143]
    ds_read_b64_tr_b16 v[44:45], v21 offset:41472
    v_mfma_f32_16x16x32_bf16 v[172:175], v[48:51], v[92:95], v[172:175]
    ds_read_b64_tr_b16 v[46:47], v21 offset:43520
    s_barrier
    s_waitcnt lgkmcnt(6)
    v_mfma_f32_16x16x32_bf16 v[144:147], v[52:55], v[88:91], v[144:147]
    ds_read_b64_tr_b16 v[48:49], v22 offset:8192
    v_mfma_f32_16x16x32_bf16 v[176:179], v[52:55], v[92:95], v[176:179]
    ds_read_b64_tr_b16 v[50:51], v22 offset:10240
    s_add_u32 m0, s59, 0
    s_add_u32 s38, s58, 3145728
    buffer_load_dwordx4 v10, s[60:63], s38 offen lds
    s_waitcnt lgkmcnt(6)
    v_mfma_f32_16x16x32_bf16 v[148:151], v[56:59], v[88:91], v[148:151]
    ds_read_b64_tr_b16 v[52:53], v23 offset:8192
    v_mfma_f32_16x16x32_bf16 v[180:183], v[56:59], v[92:95], v[180:183]
    ds_read_b64_tr_b16 v[54:55], v23 offset:10240
    buffer_load_dwordx4 v11, s[60:63], s38 offen offset:1024 lds
    s_waitcnt lgkmcnt(6)
    v_mfma_f32_16x16x32_bf16 v[152:155], v[60:63], v[88:91], v[152:155]
    ds_read_b64_tr_b16 v[56:57], v22 offset:0
    v_mfma_f32_16x16x32_bf16 v[184:187], v[60:63], v[92:95], v[184:187]
    ds_read_b64_tr_b16 v[58:59], v22 offset:2048
    s_add_u32 m0, s69, 8192
    s_add_u32 s38, s68, 1327104
    s_mov_b32 exec_hi, 0
    buffer_load_dwordx4 v12, s[64:67], s38 offen lds
    s_mov_b32 exec_hi, -1
    s_waitcnt lgkmcnt(6)
    v_mfma_f32_16x16x32_bf16 v[156:159], v[44:47], v[88:91], v[156:159]
    ds_read_b64_tr_b16 v[60:61], v23 offset:0
    v_mfma_f32_16x16x32_bf16 v[188:191], v[44:47], v[92:95], v[188:191]
    ds_read_b64_tr_b16 v[62:63], v23 offset:2048
    s_waitcnt vmcnt(25)
    s_waitcnt lgkmcnt(6)
    v_mfma_f32_16x16x32_bf16 v[192:195], v[48:51], v[96:99], v[192:195]
    ds_read_b64_tr_b16 v[44:45], v22 offset:512
    v_mfma_f32_16x16x32_bf16 v[208:211], v[48:51], v[100:103], v[208:211]
    ds_read_b64_tr_b16 v[46:47], v22 offset:2560
    buffer_load_dwordx4 v[80:83], v1, s[12:15], s33 offen offset:2048 sc1
    s_waitcnt lgkmcnt(6)
    v_mfma_f32_16x16x32_bf16 v[196:199], v[52:55], v[96:99], v[196:199]
    ds_read_b64_tr_b16 v[48:49], v23 offset:512
    v_mfma_f32_16x16x32_bf16 v[212:215], v[52:55], v[100:103], v[212:215]
    ds_read_b64_tr_b16 v[50:51], v23 offset:2560
    buffer_load_dwordx4 v[84:87], v1, s[12:15], s34 offen offset:2048 sc1
    s_waitcnt lgkmcnt(6)
    v_mfma_f32_16x16x32_bf16 v[128:131], v[56:59], v[96:99], v[128:131]
    ds_read_b64_tr_b16 v[52:53], v22 offset:4096
    v_mfma_f32_16x16x32_bf16 v[160:163], v[56:59], v[100:103], v[160:163]
    ds_read_b64_tr_b16 v[54:55], v22 offset:6144
    s_waitcnt lgkmcnt(6)
    v_mfma_f32_16x16x32_bf16 v[132:135], v[60:63], v[96:99], v[132:135]
    ds_read_b64_tr_b16 v[56:57], v23 offset:4096
    v_mfma_f32_16x16x32_bf16 v[164:167], v[60:63], v[100:103], v[164:167]
    ds_read_b64_tr_b16 v[58:59], v23 offset:6144
    s_waitcnt lgkmcnt(6)
    v_mfma_f32_16x16x32_bf16 v[136:139], v[44:47], v[96:99], v[136:139]
    ds_read_b64_tr_b16 v[60:61], v22 offset:4608
    v_mfma_f32_16x16x32_bf16 v[168:171], v[44:47], v[100:103], v[168:171]
    ds_read_b64_tr_b16 v[62:63], v22 offset:6656
    s_waitcnt lgkmcnt(6)
    v_mfma_f32_16x16x32_bf16 v[140:143], v[48:51], v[96:99], v[140:143]
    ds_read_b64_tr_b16 v[44:45], v23 offset:4608
    v_mfma_f32_16x16x32_bf16 v[172:175], v[48:51], v[100:103], v[172:175]
    ds_read_b64_tr_b16 v[46:47], v23 offset:6656
    s_waitcnt lgkmcnt(6)
    v_mfma_f32_16x16x32_bf16 v[144:147], v[52:55], v[96:99], v[144:147]
    ds_read_b64_tr_b16 v[48:49], v22 offset:20480
    v_mfma_f32_16x16x32_bf16 v[176:179], v[52:55], v[100:103], v[176:179]
    ds_read_b64_tr_b16 v[50:51], v22 offset:22528
    s_waitcnt lgkmcnt(6)
    v_mfma_f32_16x16x32_bf16 v[148:151], v[56:59], v[96:99], v[148:151]
    ds_read_b64_tr_b16 v[52:53], v23 offset:20480
    v_mfma_f32_16x16x32_bf16 v[180:183], v[56:59], v[100:103], v[180:183]
    ds_read_b64_tr_b16 v[54:55], v23 offset:22528
    s_waitcnt lgkmcnt(6)
    v_mfma_f32_16x16x32_bf16 v[152:155], v[60:63], v[96:99], v[152:155]
    ds_read_b64_tr_b16 v[56:57], v22 offset:12288
    v_mfma_f32_16x16x32_bf16 v[184:187], v[60:63], v[100:103], v[184:187]
    ds_read_b64_tr_b16 v[58:59], v22 offset:14336
    s_waitcnt lgkmcnt(6)
    v_mfma_f32_16x16x32_bf16 v[156:159], v[44:47], v[96:99], v[156:159]
    ds_read_b64_tr_b16 v[60:61], v23 offset:12288
    v_mfma_f32_16x16x32_bf16 v[188:191], v[44:47], v[100:103], v[188:191]
    ds_read_b64_tr_b16 v[62:63], v23 offset:14336
    s_waitcnt vmcnt(24)
    s_waitcnt lgkmcnt(6)
    v_mfma_f32_16x16x32_bf16 v[192:195], v[48:51], v[104:107], v[192:195]
    ds_read_b64_tr_b16 v[44:45], v22 offset:12800
    v_mfma_f32_16x16x32_bf16 v[208:211], v[48:51], v[108:111], v[208:211]
    ds_read_b64_tr_b16 v[46:47], v22 offset:14848
    buffer_load_dwordx4 v[88:91], v1, s[12:15], s33 offen offset:3072 sc1
    s_add_u32 s33, s33, 4096
    s_waitcnt lgkmcnt(6)
    v_mfma_f32_16x16x32_bf16 v[196:199], v[52:55], v[104:107], v[196:199]
    ds_read_b64_tr_b16 v[48:49], v23 offset:12800
    v_mfma_f32_16x16x32_bf16 v[212:215], v[52:55], v[108:111], v[212:215]
    ds_read_b64_tr_b16 v[50:51], v23 offset:14848
    buffer_load_dwordx4 v[92:95], v1, s[12:15], s34 offen offset:3072 sc1
    s_add_u32 s34, s34, 4096
    s_waitcnt lgkmcnt(6)
    v_mfma_f32_16x16x32_bf16 v[128:131], v[56:59], v[104:107], v[128:131]
    ds_read_b64_tr_b16 v[52:53], v22 offset:16384
    v_mfma_f32_16x16x32_bf16 v[160:163], v[56:59], v[108:111], v[160:163]
    ds_read_b64_tr_b16 v[54:55], v22 offset:18432
    s_waitcnt lgkmcnt(6)
    v_mfma_f32_16x16x32_bf16 v[132:135], v[60:63], v[104:107], v[132:135]
    ds_read_b64_tr_b16 v[56:57], v23 offset:16384
    v_mfma_f32_16x16x32_bf16 v[164:167], v[60:63], v[108:111], v[164:167]
    ds_read_b64_tr_b16 v[58:59], v23 offset:18432
    s_waitcnt lgkmcnt(6)
    v_mfma_f32_16x16x32_bf16 v[136:139], v[44:47], v[104:107], v[136:139]
    ds_read_b64_tr_b16 v[60:61], v22 offset:16896
    v_mfma_f32_16x16x32_bf16 v[168:171], v[44:47], v[108:111], v[168:171]
    ds_read_b64_tr_b16 v[62:63], v22 offset:18944
    s_waitcnt lgkmcnt(6)
    v_mfma_f32_16x16x32_bf16 v[140:143], v[48:51], v[104:107], v[140:143]
    ds_read_b64_tr_b16 v[44:45], v23 offset:16896
    v_mfma_f32_16x16x32_bf16 v[172:175], v[48:51], v[108:111], v[172:175]
    ds_read_b64_tr_b16 v[46:47], v23 offset:18944
    s_waitcnt vmcnt(7)
    s_barrier
    s_cmp_eq_u32 s22, 0
    s_cbranch_scc0 L_fl_10
    s_add_u32 s45, s3, 2
    s_mov_b64 exec, 1
    v_mov_b32 v19, s45
    buffer_store_dword v19, off, s[12:15], s74 sc1
    s_mov_b64 exec, -1
L_fl_10:
    s_waitcnt lgkmcnt(6)
    v_mfma_f32_16x16x32_bf16 v[144:147], v[52:55], v[104:107], v[144:147]
    ds_read_b64_tr_b16 v[48:49], v22 offset:32768
    v_mfma_f32_16x16x32_bf16 v[176:179], v[52:55], v[108:111], v[176:179]
    ds_read_b64_tr_b16 v[50:51], v22 offset:34816
    s_add_u32 m0, s59, 24576
    s_add_u32 s38, s58, 3670016
    buffer_load_dwordx4 v10, s[60:63], s38 offen lds
    s_waitcnt lgkmcnt(6)
    v_mfma_f32_16x16x32_bf16 v[148:151], v[56:59], v[104:107], v[148:151]
    ds_read_b64_tr_b16 v[52:53], v23 offset:32768
    v_mfma_f32_16x16x32_bf16 v[180:183], v[56:59], v[108:111], v[180:183]
    ds_read_b64_tr_b16 v[54:55], v23 offset:34816
    buffer_load_dwordx4 v11, s[60:63], s38 offen offset:1024 lds
    s_waitcnt lgkmcnt(6)
    v_mfma_f32_16x16x32_bf16 v[152:155], v[60:63], v[104:107], v[152:155]
    ds_read_b64_tr_b16 v[56:57], v22 offset:24576
    v_mfma_f32_16x16x32_bf16 v[184:187], v[60:63], v[108:111], v[184:187]
    ds_read_b64_tr_b16 v[58:59], v22 offset:26624
    s_add_u32 m0, s69, 32768
    s_add_u32 s38, s68, 1548288
    s_mov_b32 exec_hi, 0
    buffer_load_dwordx4 v12, s[64:67], s38 offen lds
    s_mov_b32 exec_hi, -1
    s_waitcnt lgkmcnt(6)
    v_mfma_f32_16x16x32_bf16 v[156:159], v[44:47], v[104:107], v[156:159]
    ds_read_b64_tr_b16 v[60:61], v23 offset:24576
    v_mfma_f32_16x16x32_bf16 v[188:191], v[44:47], v[108:111], v[188:191]
    ds_read_b64_tr_b16 v[62:63], v23 offset:26624
    s_waitcnt lgkmcnt(6)
    v_mfma_f32_16x16x32_bf16 v[192:195], v[48:51], v[112:115], v[192:195]
    ds_read_b64_tr_b16 v[44:45], v22 offset:25088
    v_mfma_f32_16x16x32_bf16 v[208:211], v[48:51], v[116:119], v[208:211]
    ds_read_b64_tr_b16 v[46:47], v22 offset:27136
    buffer_load_dwordx4 v[96:99], v1, s[12:15], s33 offen offset:0 sc1
    s_waitcnt lgkmcnt(6)
    v_mfma_f32_16x16x32_bf16 v[196:199], v[52:55], v[112:115], v[196:199]
    ds_read_b64_tr_b16 v[48:49], v23 offset:25088
    v_mfma_f32_16x16x32_bf16 v[212:215], v[52:55], v[116:119], v[212:215]
    ds_read_b64_tr_b16 v[50:51], v23 offset:27136
    buffer_load_dwordx4 v[100:103], v1, s[12:15], s34 offen offset:0 sc1
    s_waitcnt lgkmcnt(6)
    v_mfma_f32_16x16x32_bf16 v[128:131], v[56:59], v[112:115], v[128:131]
    ds_read_b64_tr_b16 v[52:53], v22 offset:28672
    v_mfma_f32_16x16x32_bf16 v[160:163], v[56:59], v[116:119], v[160:163]
    ds_read_b64_tr_b16 v[54:55], v22 offset:30720
    s_waitcnt lgkmcnt(6)
    v_mfma_f32_16x16x32_bf16 v[132:135], v[60:63], v[112:115], v[132:135]
    ds_read_b64_tr_b16 v[56:57], v23 offset:28672
    v_mfma_f32_16x16x32_bf16 v[164:167], v[60:63], v[116:119], v[164:167]
    ds_read_b64_tr_b16 v[58:59], v23 offset:30720
    s_waitcnt lgkmcnt(6)
    v_mfma_f32_16x16x32_bf16 v[136:139], v[44:47], v[112:115], v[136:139]
    ds_read_b64_tr_b16 v[60:61], v22 offset:29184
    v_mfma_f32_16x16x32_bf16 v[168:171], v[44:47], v[116:119], v[168:171]
    ds_read_b64_tr_b16 v[62:63], v22 offset:31232
    s_waitcnt lgkmcnt(6)
    v_mfma_f32_16x16x32_bf16 v[140:143], v[48:51], v[112:115], v[140:143]
    ds_read_b64_tr_b16 v[44:45], v23 offset:29184
    v_mfma_f32_16x16x32_bf16 v[172:175], v[48:51], v[116:119], v[172:175]
    ds_read_b64_tr_b16 v[46:47], v23 offset:31232
    s_waitcnt lgkmcnt(6)
    v_mfma_f32_16x16x32_bf16 v[144:147], v[52:55], v[112:115], v[144:147]
    ds_read_b64_tr_b16 v[48:49], v22 offset:45056
    v_mfma_f32_16x16x32_bf16 v[176:179], v[52:55], v[116:119], v[176:179]
    ds_read_b64_tr_b16 v[50:51], v22 offset:47104
    s_waitcnt lgkmcnt(6)
    v_mfma_f32_16x16x32_bf16 v[148:151], v[56:59], v[112:115], v[148:151]
    ds_read_b64_tr_b16 v[52:53], v23 offset:45056
    v_mfma_f32_16x16x32_bf16 v[180:183], v[56:59], v[116:119], v[180:183]
    ds_read_b64_tr_b16 v[54:55], v23 offset:47104
    s_waitcnt lgkmcnt(6)
    v_mfma_f32_16x16x32_bf16 v[152:155], v[60:63], v[112:115], v[152:155]
    ds_read_b64_tr_b16 v[56:57], v22 offset:36864
    v_mfma_f32_16x16x32_bf16 v[184:187], v[60:63], v[116:119], v[184:187]
    ds_read_b64_tr_b16 v[58:59], v22 offset:38912
    s_waitcnt lgkmcnt(6)
    v_mfma_f32_16x16x32_bf16 v[156:159], v[44:47], v[112:115], v[156:159]
    ds_read_b64_tr_b16 v[60:61], v23 offset:36864
    v_mfma_f32_16x16x32_bf16 v[188:191], v[44:47], v[116:119], v[188:191]
    ds_read_b64_tr_b16 v[62:63], v23 offset:38912
    s_waitcnt lgkmcnt(6)
    v_mfma_f32_16x16x32_bf16 v[192:195], v[48:51], v[120:123], v[192:195]
    ds_read_b64_tr_b16 v[44:45], v22 offset:37376
    v_mfma_f32_16x16x32_bf16 v[208:211], v[48:51], v[124:127], v[208:211]
    ds_read_b64_tr_b16 v[46:47], v22 offset:39424
    buffer_load_dwordx4 v[104:107], v1, s[12:15], s33 offen offset:1024 sc1
    s_waitcnt lgkmcnt(6)
    v_mfma_f32_16x16x32_bf16 v[196:199], v[52:55], v[120:123], v[196:199]
    ds_read_b64_tr_b16 v[48:49], v23 offset:37376
    v_mfma_f32_16x16x32_bf16 v[212:215], v[52:55], v[124:127], v[212:215]
    ds_read_b64_tr_b16 v[50:51], v23 offset:39424
    buffer_load_dwordx4 v[108:111], v1, s[12:15], s34 offen offset:1024 sc1
    s_waitcnt lgkmcnt(6)
    v_mfma_f32_16x16x32_bf16 v[128:131], v[56:59], v[120:123], v[128:131]
    ds_read_b64_tr_b16 v[52:53], v22 offset:40960
    v_mfma_f32_16x16x32_bf16 v[160:163], v[56:59], v[124:127], v[160:163]
    ds_read_b64_tr_b16 v[54:55], v22 offset:43008
    s_waitcnt lgkmcnt(6)
    v_mfma_f32_16x16x32_bf16 v[132:135], v[60:63], v[120:123], v[132:135]
    ds_read_b64_tr_b16 v[56:57], v23 offset:40960
    v_mfma_f32_16x16x32_bf16 v[164:167], v[60:63], v[124:127], v[164:167]
    ds_read_b64_tr_b16 v[58:59], v23 offset:43008
    s_waitcnt lgkmcnt(6)
    v_mfma_f32_16x16x32_bf16 v[136:139], v[44:47], v[120:123], v[136:139]
    ds_read_b64_tr_b16 v[60:61], v22 offset:41472
    v_mfma_f32_16x16x32_bf16 v[168:171], v[44:47], v[124:127], v[168:171]
    ds_read_b64_tr_b16 v[62:63], v22 offset:43520
    s_waitcnt lgkmcnt(6)
    v_mfma_f32_16x16x32_bf16 v[140:143], v[48:51], v[120:123], v[140:143]
    ds_read_b64_tr_b16 v[44:45], v23 offset:41472
    v_mfma_f32_16x16x32_bf16 v[172:175], v[48:51], v[124:127], v[172:175]
    ds_read_b64_tr_b16 v[46:47], v23 offset:43520
    s_barrier
    s_waitcnt lgkmcnt(6)
    v_mfma_f32_16x16x32_bf16 v[144:147], v[52:55], v[120:123], v[144:147]
    ds_read_b64_tr_b16 v[48:49], v24 offset:8192
    v_mfma_f32_16x16x32_bf16 v[176:179], v[52:55], v[124:127], v[176:179]
    ds_read_b64_tr_b16 v[50:51], v24 offset:10240
    s_add_u32 m0, s59, 49152
    s_add_u32 s38, s58, 4194304
    buffer_load_dwordx4 v10, s[60:63], s38 offen lds
    s_waitcnt lgkmcnt(6)
    v_mfma_f32_16x16x32_bf16 v[148:151], v[56:59], v[120:123], v[148:151]
    ds_read_b64_tr_b16 v[52:53], v25 offset:8192
    v_mfma_f32_16x16x32_bf16 v[180:183], v[56:59], v[124:127], v[180:183]
    ds_read_b64_tr_b16 v[54:55], v25 offset:10240
    buffer_load_dwordx4 v11, s[60:63], s38 offen offset:1024 lds
    s_waitcnt lgkmcnt(6)
    v_mfma_f32_16x16x32_bf16 v[152:155], v[60:63], v[120:123], v[152:155]
    ds_read_b64_tr_b16 v[56:57], v24 offset:0
    v_mfma_f32_16x16x32_bf16 v[184:187], v[60:63], v[124:127], v[184:187]
    ds_read_b64_tr_b16 v[58:59], v24 offset:2048
    s_add_u32 m0, s69, 57344
    s_add_u32 s38, s68, 1769472
    s_mov_b32 exec_hi, 0
    buffer_load_dwordx4 v12, s[64:67], s38 offen lds
    s_mov_b32 exec_hi, -1
    s_waitcnt lgkmcnt(6)
    v_mfma_f32_16x16x32_bf16 v[156:159], v[44:47], v[120:123], v[156:159]
    ds_read_b64_tr_b16 v[60:61], v25 offset:0
    v_mfma_f32_16x16x32_bf16 v[188:191], v[44:47], v[124:127], v[188:191]
    ds_read_b64_tr_b16 v[62:63], v25 offset:2048
    s_waitcnt lgkmcnt(6)
    v_mfma_f32_16x16x32_bf16 v[192:195], v[48:51], v[64:67], v[192:195]
    ds_read_b64_tr_b16 v[44:45], v24 offset:512
    v_mfma_f32_16x16x32_bf16 v[208:211], v[48:51], v[68:71], v[208:211]
    ds_read_b64_tr_b16 v[46:47], v24 offset:2560
    buffer_load_dwordx4 v[112:115], v1, s[12:15], s33 offen offset:2048 sc1
    s_waitcnt lgkmcnt(6)
    v_mfma_f32_16x16x32_bf16 v[196:199], v[52:55], v[64:67], v[196:199]
    ds_read_b64_tr_b16 v[48:49], v25 offset:512
    v_mfma_f32_16x16x32_bf16 v[212:215], v[52:55], v[68:71], v[212:215]
    ds_read_b64_tr_b16 v[50:51], v25 offset:2560
    buffer_load_dwordx4 v[116:119], v1, s[12:15], s34 offen offset:2048 sc1
    s_waitcnt lgkmcnt(6)
    v_mfma_f32_16x16x32_bf16 v[128:131], v[56:59], v[64:67], v[128:131]
    ds_read_b64_tr_b16 v[52:53], v24 offset:4096
    v_mfma_f32_16x16x32_bf16 v[160:163], v[56:59], v[68:71], v[160:163]
    ds_read_b64_tr_b16 v[54:55], v24 offset:6144
    s_waitcnt lgkmcnt(6)
    v_mfma_f32_16x16x32_bf16 v[132:135], v[60:63], v[64:67], v[132:135]
    ds_read_b64_tr_b16 v[56:57], v25 offset:4096
    v_mfma_f32_16x16x32_bf16 v[164:167], v[60:63], v[68:71], v[164:167]
    ds_read_b64_tr_b16 v[58:59], v25 offset:6144
    s_waitcnt lgkmcnt(6)
    v_mfma_f32_16x16x32_bf16 v[136:139], v[44:47], v[64:67], v[136:139]
    ds_read_b64_tr_b16 v[60:61], v24 offset:4608
    v_mfma_f32_16x16x32_bf16 v[168:171], v[44:47], v[68:71], v[168:171]
    ds_read_b64_tr_b16 v[62:63], v24 offset:6656
    s_waitcnt lgkmcnt(6)
    v_mfma_f32_16x16x32_bf16 v[140:143], v[48:51], v[64:67], v[140:143]
    ds_read_b64_tr_b16 v[44:45], v25 offset:4608
    v_mfma_f32_16x16x32_bf16 v[172:175], v[48:51], v[68:71], v[172:175]
    ds_read_b64_tr_b16 v[46:47], v25 offset:6656
    s_waitcnt lgkmcnt(6)
    v_mfma_f32_16x16x32_bf16 v[144:147], v[52:55], v[64:67], v[144:147]
    ds_read_b64_tr_b16 v[48:49], v24 offset:20480
    v_mfma_f32_16x16x32_bf16 v[176:179], v[52:55], v[68:71], v[176:179]
    ds_read_b64_tr_b16 v[50:51], v24 offset:22528
    s_waitcnt lgkmcnt(6)
    v_mfma_f32_16x16x32_bf16 v[148:151], v[56:59], v[64:67], v[148:151]
    ds_read_b64_tr_b16 v[52:53], v25 offset:20480
    v_mfma_f32_16x16x32_bf16 v[180:183], v[56:59], v[68:71], v[180:183]
    ds_read_b64_tr_b16 v[54:55], v25 offset:22528
    s_waitcnt lgkmcnt(6)
    v_mfma_f32_16x16x32_bf16 v[152:155], v[60:63], v[64:67], v[152:155]
    ds_read_b64_tr_b16 v[56:57], v24 offset:12288
    v_mfma_f32_16x16x32_bf16 v[184:187], v[60:63], v[68:71], v[184:187]
    ds_read_b64_tr_b16 v[58:59], v24 offset:14336
    s_waitcnt lgkmcnt(6)
    v_mfma_f32_16x16x32_bf16 v[156:159], v[44:47], v[64:67], v[156:159]
    ds_read_b64_tr_b16 v[60:61], v25 offset:12288
    v_mfma_f32_16x16x32_bf16 v[188:191], v[44:47], v[68:71], v[188:191]
    ds_read_b64_tr_b16 v[62:63], v25 offset:14336
    s_waitcnt lgkmcnt(6)
    v_mfma_f32_16x16x32_bf16 v[192:195], v[48:51], v[72:75], v[192:195]
    ds_read_b64_tr_b16 v[44:45], v24 offset:12800
    v_mfma_f32_16x16x32_bf16 v[208:211], v[48:51], v[76:79], v[208:211]
    ds_read_b64_tr_b16 v[46:47], v24 offset:14848
    s_lshl_b32 s39, s21, 3
    s_add_u32 s39, s39, s22
    v_lshrrev_b32 v19, 4, v1
    v_mul_u32_u24 v19, 1280, v19
    s_mov_b32 s38, s90
    s_bfm_b64 exec, 16, 0
    buffer_load_dword v3, v19, s[84:87], s38 offen
    s_mov_b64 exec, -1
    buffer_load_dwordx4 v[120:123], v1, s[12:15], s33 offen offset:3072 sc1
    s_add_u32 s33, s33, 4096
    s_waitcnt lgkmcnt(6)
    v_mfma_f32_16x16x32_bf16 v[196:199], v[52:55], v[72:75], v[196:199]
    ds_read_b64_tr_b16 v[48:49], v25 offset:12800
    v_mfma_f32_16x16x32_bf16 v[212:215], v[52:55], v[76:79], v[212:215]
    ds_read_b64_tr_b16 v[50:51], v25 offset:14848
    buffer_load_dwordx4 v[124:127], v1, s[12:15], s34 offen offset:3072 sc1
    s_add_u32 s34, s34, 4096
    s_waitcnt lgkmcnt(6)
    v_mfma_f32_16x16x32_bf16 v[128:131], v[56:59], v[72:75], v[128:131]
    ds_read_b64_tr_b16 v[52:53], v24 offset:16384
    v_mfma_f32_16x16x32_bf16 v[160:163], v[56:59], v[76:79], v[160:163]
    ds_read_b64_tr_b16 v[54:55], v24 offset:18432
    s_waitcnt lgkmcnt(6)
    v_mfma_f32_16x16x32_bf16 v[132:135], v[60:63], v[72:75], v[132:135]
    ds_read_b64_tr_b16 v[56:57], v25 offset:16384
    v_mfma_f32_16x16x32_bf16 v[164:167], v[60:63], v[76:79], v[164:167]
    ds_read_b64_tr_b16 v[58:59], v25 offset:18432
    s_waitcnt lgkmcnt(6)
    v_mfma_f32_16x16x32_bf16 v[136:139], v[44:47], v[72:75], v[136:139]
    ds_read_b64_tr_b16 v[60:61], v24 offset:16896
    v_mfma_f32_16x16x32_bf16 v[168:171], v[44:47], v[76:79], v[168:171]
    ds_read_b64_tr_b16 v[62:63], v24 offset:18944
    s_waitcnt lgkmcnt(6)
    v_mfma_f32_16x16x32_bf16 v[140:143], v[48:51], v[72:75], v[140:143]
    ds_read_b64_tr_b16 v[44:45], v25 offset:16896
    v_mfma_f32_16x16x32_bf16 v[172:175], v[48:51], v[76:79], v[172:175]
    ds_read_b64_tr_b16 v[46:47], v25 offset:18944
    s_barrier
    s_waitcnt lgkmcnt(6)
    v_mfma_f32_16x16x32_bf16 v[144:147], v[52:55], v[72:75], v[144:147]
    ds_read_b64_tr_b16 v[48:49], v24 offset:32768
    v_mfma_f32_16x16x32_bf16 v[176:179], v[52:55], v[76:79], v[176:179]
    ds_read_b64_tr_b16 v[50:51], v24 offset:34816
    s_add_u32 m0, s59, 73728
    s_add_u32 s38, s58, 4718592
    buffer_load_dwordx4 v10, s[60:63], s38 offen lds
    s_waitcnt lgkmcnt(6)
    v_mfma_f32_16x16x32_bf16 v[148:151], v[56:59], v[72:75], v[148:151]
    ds_read_b64_tr_b16 v[52:53], v25 offset:32768
    v_mfma_f32_16x16x32_bf16 v[180:183], v[56:59], v[76:79], v[180:183]
    ds_read_b64_tr_b16 v[54:55], v25 offset:34816
    buffer_load_dwordx4 v11, s[60:63], s38 offen offset:1024 lds
    s_waitcnt lgkmcnt(6)
    v_mfma_f32_16x16x32_bf16 v[152:155], v[60:63], v[72:75], v[152:155]
    ds_read_b64_tr_b16 v[56:57], v24 offset:24576
    v_mfma_f32_16x16x32_bf16 v[184:187], v[60:63], v[76:79], v[184:187]
    ds_read_b64_tr_b16 v[58:59], v24 offset:26624
    s_add_u32 m0, s69, 81920
    s_add_u32 s38, s68, 1990656
    s_mov_b32 exec_hi, 0
    buffer_load_dwordx4 v12, s[64:67], s38 offen lds
    s_mov_b32 exec_hi, -1
    s_waitcnt lgkmcnt(6)
    v_mfma_f32_16x16x32_bf16 v[156:159], v[44:47], v[72:75], v[156:159]
    ds_read_b64_tr_b16 v[60:61], v25 offset:24576
    v_mfma_f32_16x16x32_bf16 v[188:191], v[44:47], v[76:79], v[188:191]
    ds_read_b64_tr_b16 v[62:63], v25 offset:26624
    s_waitcnt vmcnt(20)
    s_waitcnt lgkmcnt(6)
    v_mfma_f32_16x16x32_bf16 v[192:195], v[48:51], v[80:83], v[192:195]
    ds_read_b64_tr_b16 v[44:45], v24 offset:25088
    v_mfma_f32_16x16x32_bf16 v[208:211], v[48:51], v[84:87], v[208:211]
    ds_read_b64_tr_b16 v[46:47], v24 offset:27136
    buffer_load_dwordx4 v[64:67], v1, s[12:15], s33 offen offset:0 sc1
    s_waitcnt lgkmcnt(6)
    v_mfma_f32_16x16x32_bf16 v[196:199], v[52:55], v[80:83], v[196:199]
    ds_read_b64_tr_b16 v[48:49], v25 offset:25088
    v_mfma_f32_16x16x32_bf16 v[212:215], v[52:55], v[84:87], v[212:215]
    ds_read_b64_tr_b16 v[50:51], v25 offset:27136
    buffer_load_dwordx4 v[68:71], v1, s[12:15], s34 offen offset:0 sc1
    s_waitcnt lgkmcnt(6)
    v_mfma_f32_16x16x32_bf16 v[128:131], v[56:59], v[80:83], v[128:131]
    ds_read_b64_tr_b16 v[52:53], v24 offset:28672
    v_mfma_f32_16x16x32_bf16 v[160:163], v[56:59], v[84:87], v[160:163]
    ds_read_b64_tr_b16 v[54:55], v24 offset:30720
    s_waitcnt lgkmcnt(6)
    v_mfma_f32_16x16x32_bf16 v[132:135], v[60:63], v[80:83], v[132:135]
    ds_read_b64_tr_b16 v[56:57], v25 offset:28672
    v_mfma_f32_16x16x32_bf16 v[164:167], v[60:63], v[84:87], v[164:167]
    ds_read_b64_tr_b16 v[58:59], v25 offset:30720
    s_waitcnt lgkmcnt(6)
    v_mfma_f32_16x16x32_bf16 v[136:139], v[44:47], v[80:83], v[136:139]
    ds_read_b64_tr_b16 v[60:61], v24 offset:29184
    v_mfma_f32_16x16x32_bf16 v[168:171], v[44:47], v[84:87], v[168:171]
    ds_read_b64_tr_b16 v[62:63], v24 offset:31232
    s_waitcnt lgkmcnt(6)
    v_mfma_f32_16x16x32_bf16 v[140:143], v[48:51], v[80:83], v[140:143]
    ds_read_b64_tr_b16 v[44:45], v25 offset:29184
    v_mfma_f32_16x16x32_bf16 v[172:175], v[48:51], v[84:87], v[172:175]
    ds_read_b64_tr_b16 v[46:47], v25 offset:31232
    s_waitcnt lgkmcnt(6)
    v_mfma_f32_16x16x32_bf16 v[144:147], v[52:55], v[80:83], v[144:147]
    ds_read_b64_tr_b16 v[48:49], v24 offset:45056
    v_mfma_f32_16x16x32_bf16 v[176:179], v[52:55], v[84:87], v[176:179]
    ds_read_b64_tr_b16 v[50:51], v24 offset:47104
    s_waitcnt lgkmcnt(6)
    v_mfma_f32_16x16x32_bf16 v[148:151], v[56:59], v[80:83], v[148:151]
    ds_read_b64_tr_b16 v[52:53], v25 offset:45056
    v_mfma_f32_16x16x32_bf16 v[180:183], v[56:59], v[84:87], v[180:183]
    ds_read_b64_tr_b16 v[54:55], v25 offset:47104
    s_waitcnt lgkmcnt(6)
    v_mfma_f32_16x16x32_bf16 v[152:155], v[60:63], v[80:83], v[152:155]
    ds_read_b64_tr_b16 v[56:57], v24 offset:36864
    v_mfma_f32_16x16x32_bf16 v[184:187], v[60:63], v[84:87], v[184:187]
    ds_read_b64_tr_b16 v[58:59], v24 offset:38912
    s_waitcnt lgkmcnt(6)
    v_mfma_f32_16x16x32_bf16 v[156:159], v[44:47], v[80:83], v[156:159]
    ds_read_b64_tr_b16 v[60:61], v25 offset:36864
    v_mfma_f32_16x16x32_bf16 v[188:191], v[44:47], v[84:87], v[188:191]
    ds_read_b64_tr_b16 v[62:63], v25 offset:38912
    s_waitcnt vmcnt(20)
    s_waitcnt lgkmcnt(6)
    v_mfma_f32_16x16x32_bf16 v[192:195], v[48:51], v[88:91], v[192:195]
    ds_read_b64_tr_b16 v[44:45], v24 offset:37376
    v_mfma_f32_16x16x32_bf16 v[208:211], v[48:51], v[92:95], v[208:211]
    ds_read_b64_tr_b16 v[46:47], v24 offset:39424
    buffer_load_dwordx4 v[72:75], v1, s[12:15], s33 offen offset:1024 sc1
    s_waitcnt lgkmcnt(6)
    v_mfma_f32_16x16x32_bf16 v[196:199], v[52:55], v[88:91], v[196:199]
    ds_read_b64_tr_b16 v[48:49], v25 offset:37376
    v_mfma_f32_16x16x32_bf16 v[212:215], v[52:55], v[92:95], v[212:215]
    ds_read_b64_tr_b16 v[50:51], v25 offset:39424
    buffer_load_dwordx4 v[76:79], v1, s[12:15], s34 offen offset:1024 sc1
    s_waitcnt lgkmcnt(6)
    v_mfma_f32_16x16x32_bf16 v[128:131], v[56:59], v[88:91], v[128:131]
    ds_read_b64_tr_b16 v[52:53], v24 offset:40960
    v_mfma_f32_16x16x32_bf16 v[160:163], v[56:59], v[92:95], v[160:163]
    ds_read_b64_tr_b16 v[54:55], v24 offset:43008
    s_waitcnt lgkmcnt(6)
    v_mfma_f32_16x16x32_bf16 v[132:135], v[60:63], v[88:91], v[132:135]
    ds_read_b64_tr_b16 v[56:57], v25 offset:40960
    v_mfma_f32_16x16x32_bf16 v[164:167], v[60:63], v[92:95], v[164:167]
    ds_read_b64_tr_b16 v[58:59], v25 offset:43008
    s_waitcnt lgkmcnt(6)
    v_mfma_f32_16x16x32_bf16 v[136:139], v[44:47], v[88:91], v[136:139]
    ds_read_b64_tr_b16 v[60:61], v24 offset:41472
    v_mfma_f32_16x16x32_bf16 v[168:171], v[44:47], v[92:95], v[168:171]
    ds_read_b64_tr_b16 v[62:63], v24 offset:43520
    s_waitcnt lgkmcnt(6)
    v_mfma_f32_16x16x32_bf16 v[140:143], v[48:51], v[88:91], v[140:143]
    ds_read_b64_tr_b16 v[44:45], v25 offset:41472
    v_mfma_f32_16x16x32_bf16 v[172:175], v[48:51], v[92:95], v[172:175]
    ds_read_b64_tr_b16 v[46:47], v25 offset:43520
    s_barrier
    s_waitcnt lgkmcnt(6)
    v_mfma_f32_16x16x32_bf16 v[144:147], v[52:55], v[88:91], v[144:147]
    ds_read_b64_tr_b16 v[48:49], v20 offset:8192
    v_mfma_f32_16x16x32_bf16 v[176:179], v[52:55], v[92:95], v[176:179]
    ds_read_b64_tr_b16 v[50:51], v20 offset:10240
    s_waitcnt lgkmcnt(6)
    v_mfma_f32_16x16x32_bf16 v[148:151], v[56:59], v[88:91], v[148:151]
    ds_read_b64_tr_b16 v[52:53], v21 offset:8192
    v_mfma_f32_16x16x32_bf16 v[180:183], v[56:59], v[92:95], v[180:183]
    ds_read_b64_tr_b16 v[54:55], v21 offset:10240
    s_waitcnt lgkmcnt(6)
    v_mfma_f32_16x16x32_bf16 v[152:155], v[60:63], v[88:91], v[152:155]
    ds_read_b64_tr_b16 v[56:57], v20 offset:0
    v_mfma_f32_16x16x32_bf16 v[184:187], v[60:63], v[92:95], v[184:187]
    ds_read_b64_tr_b16 v[58:59], v20 offset:2048
    s_waitcnt lgkmcnt(6)
    v_mfma_f32_16x16x32_bf16 v[156:159], v[44:47], v[88:91], v[156:159]
    ds_read_b64_tr_b16 v[60:61], v21 offset:0
    v_mfma_f32_16x16x32_bf16 v[188:191], v[44:47], v[92:95], v[188:191]
    ds_read_b64_tr_b16 v[62:63], v21 offset:2048
    s_waitcnt vmcnt(17)
    s_waitcnt lgkmcnt(6)
    v_mfma_f32_16x16x32_bf16 v[192:195], v[48:51], v[96:99], v[192:195]
    ds_read_b64_tr_b16 v[44:45], v20 offset:512
    v_mfma_f32_16x16x32_bf16 v[208:211], v[48:51], v[100:103], v[208:211]
    ds_read_b64_tr_b16 v[46:47], v20 offset:2560
    s_lshl_b32 s39, s21, 3
    s_add_u32 s39, s39, s22
    v_lshrrev_b32 v19, 4, v1
    v_mul_u32_u24 v19, 1280, v19
    s_mov_b32 s38, s90
    s_bfm_b64 exec, 16, 16
    buffer_load_dword v3, v19, s[84:87], s38 offen
    s_mov_b64 exec, -1
    buffer_load_dwordx4 v[80:83], v1, s[12:15], s33 offen offset:2048 sc1
    s_waitcnt lgkmcnt(6)
    v_mfma_f32_16x16x32_bf16 v[196:199], v[52:55], v[96:99], v[196:199]
    ds_read_b64_tr_b16 v[48:49], v21 offset:512
    v_mfma_f32_16x16x32_bf16 v[212:215], v[52:55], v[100:103], v[212:215]
    ds_read_b64_tr_b16 v[50:51], v21 offset:2560
    buffer_load_dwordx4 v[84:87], v1, s[12:15], s34 offen offset:2048 sc1
    s_waitcnt lgkmcnt(6)
    v_mfma_f32_16x16x32_bf16 v[128:131], v[56:59], v[96:99], v[128:131]
    ds_read_b64_tr_b16 v[52:53], v20 offset:4096
    v_mfma_f32_16x16x32_bf16 v[160:163], v[56:59], v[100:103], v[160:163]
    ds_read_b64_tr_b16 v[54:55], v20 offset:6144
    s_waitcnt lgkmcnt(6)
    v_mfma_f32_16x16x32_bf16 v[132:135], v[60:63], v[96:99], v[132:135]
    ds_read_b64_tr_b16 v[56:57], v21 offset:4096
    v_mfma_f32_16x16x32_bf16 v[164:167], v[60:63], v[100:103], v[164:167]
    ds_read_b64_tr_b16 v[58:59], v21 offset:6144
    s_waitcnt lgkmcnt(6)
    v_mfma_f32_16x16x32_bf16 v[136:139], v[44:47], v[96:99], v[136:139]
    ds_read_b64_tr_b16 v[60:61], v20 offset:4608
    v_mfma_f32_16x16x32_bf16 v[168:171], v[44:47], v[100:103], v[168:171]
    ds_read_b64_tr_b16 v[62:63], v20 offset:6656
    s_waitcnt lgkmcnt(6)
    v_mfma_f32_16x16x32_bf16 v[140:143], v[48:51], v[96:99], v[140:143]
    ds_read_b64_tr_b16 v[44:45], v21 offset:4608
    v_mfma_f32_16x16x32_bf16 v[172:175], v[48:51], v[100:103], v[172:175]
    ds_read_b64_tr_b16 v[46:47], v21 offset:6656
    s_waitcnt lgkmcnt(6)
    v_mfma_f32_16x16x32_bf16 v[144:147], v[52:55], v[96:99], v[144:147]
    ds_read_b64_tr_b16 v[48:49], v20 offset:20480
    v_mfma_f32_16x16x32_bf16 v[176:179], v[52:55], v[100:103], v[176:179]
    ds_read_b64_tr_b16 v[50:51], v20 offset:22528
    s_waitcnt lgkmcnt(6)
    v_mfma_f32_16x16x32_bf16 v[148:151], v[56:59], v[96:99], v[148:151]
    ds_read_b64_tr_b16 v[52:53], v21 offset:20480
    v_mfma_f32_16x16x32_bf16 v[180:183], v[56:59], v[100:103], v[180:183]
    ds_read_b64_tr_b16 v[54:55], v21 offset:22528
    s_waitcnt lgkmcnt(6)
    v_mfma_f32_16x16x32_bf16 v[152:155], v[60:63], v[96:99], v[152:155]
    ds_read_b64_tr_b16 v[56:57], v20 offset:12288
    v_mfma_f32_16x16x32_bf16 v[184:187], v[60:63], v[100:103], v[184:187]
    ds_read_b64_tr_b16 v[58:59], v20 offset:14336
    s_waitcnt lgkmcnt(6)
    v_mfma_f32_16x16x32_bf16 v[156:159], v[44:47], v[96:99], v[156:159]
    ds_read_b64_tr_b16 v[60:61], v21 offset:12288
    v_mfma_f32_16x16x32_bf16 v[188:191], v[44:47], v[100:103], v[188:191]
    ds_read_b64_tr_b16 v[62:63], v21 offset:14336
    s_waitcnt vmcnt(18)
    s_waitcnt lgkmcnt(6)
    v_mfma_f32_16x16x32_bf16 v[192:195], v[48:51], v[104:107], v[192:195]
    ds_read_b64_tr_b16 v[44:45], v20 offset:12800
    v_mfma_f32_16x16x32_bf16 v[208:211], v[48:51], v[108:111], v[208:211]
    ds_read_b64_tr_b16 v[46:47], v20 offset:14848
    buffer_load_dwordx4 v[88:91], v1, s[12:15], s33 offen offset:3072 sc1
    s_add_u32 s33, s33, 4096
    s_waitcnt lgkmcnt(6)
    v_mfma_f32_16x16x32_bf16 v[196:199], v[52:55], v[104:107], v[196:199]
    ds_read_b64_tr_b16 v[48:49], v21 offset:12800
    v_mfma_f32_16x16x32_bf16 v[212:215], v[52:55], v[108:111], v[212:215]
    ds_read_b64_tr_b16 v[50:51], v21 offset:14848
    buffer_load_dwordx4 v[92:95], v1, s[12:15], s34 offen offset:3072 sc1
    s_add_u32 s34, s34, 4096
    s_waitcnt lgkmcnt(6)
    v_mfma_f32_16x16x32_bf16 v[128:131], v[56:59], v[104:107], v[128:131]
    ds_read_b64_tr_b16 v[52:53], v20 offset:16384
    v_mfma_f32_16x16x32_bf16 v[160:163], v[56:59], v[108:111], v[160:163]
    ds_read_b64_tr_b16 v[54:55], v20 offset:18432
    s_waitcnt lgkmcnt(6)
    v_mfma_f32_16x16x32_bf16 v[132:135], v[60:63], v[104:107], v[132:135]
    ds_read_b64_tr_b16 v[56:57], v21 offset:16384
    v_mfma_f32_16x16x32_bf16 v[164:167], v[60:63], v[108:111], v[164:167]
    ds_read_b64_tr_b16 v[58:59], v21 offset:18432
    s_waitcnt lgkmcnt(6)
    v_mfma_f32_16x16x32_bf16 v[136:139], v[44:47], v[104:107], v[136:139]
    ds_read_b64_tr_b16 v[60:61], v20 offset:16896
    v_mfma_f32_16x16x32_bf16 v[168:171], v[44:47], v[108:111], v[168:171]
    ds_read_b64_tr_b16 v[62:63], v20 offset:18944
    s_waitcnt lgkmcnt(6)
    v_mfma_f32_16x16x32_bf16 v[140:143], v[48:51], v[104:107], v[140:143]
    ds_read_b64_tr_b16 v[44:45], v21 offset:16896
    v_mfma_f32_16x16x32_bf16 v[172:175], v[48:51], v[108:111], v[172:175]
    ds_read_b64_tr_b16 v[46:47], v21 offset:18944
    s_barrier
    s_waitcnt lgkmcnt(6)
    v_mfma_f32_16x16x32_bf16 v[144:147], v[52:55], v[104:107], v[144:147]
    ds_read_b64_tr_b16 v[48:49], v20 offset:32768
    v_mfma_f32_16x16x32_bf16 v[176:179], v[52:55], v[108:111], v[176:179]
    ds_read_b64_tr_b16 v[50:51], v20 offset:34816
    s_waitcnt lgkmcnt(6)
    v_mfma_f32_16x16x32_bf16 v[148:151], v[56:59], v[104:107], v[148:151]
    ds_read_b64_tr_b16 v[52:53], v21 offset:32768
    v_mfma_f32_16x16x32_bf16 v[180:183], v[56:59], v[108:111], v[180:183]
    ds_read_b64_tr_b16 v[54:55], v21 offset:34816
    s_waitcnt lgkmcnt(6)
    v_mfma_f32_16x16x32_bf16 v[152:155], v[60:63], v[104:107], v[152:155]
    ds_read_b64_tr_b16 v[56:57], v20 offset:24576
    v_mfma_f32_16x16x32_bf16 v[184:187], v[60:63], v[108:111], v[184:187]
    ds_read_b64_tr_b16 v[58:59], v20 offset:26624
    s_waitcnt lgkmcnt(6)
    v_mfma_f32_16x16x32_bf16 v[156:159], v[44:47], v[104:107], v[156:159]
    ds_read_b64_tr_b16 v[60:61], v21 offset:24576
    v_mfma_f32_16x16x32_bf16 v[188:191], v[44:47], v[108:111], v[188:191]
    ds_read_b64_tr_b16 v[62:63], v21 offset:26624
    s_waitcnt vmcnt(15)
    s_waitcnt lgkmcnt(6)
    v_mfma_f32_16x16x32_bf16 v[192:195], v[48:51], v[112:115], v[192:195]
    ds_read_b64_tr_b16 v[44:45], v20 offset:25088
    v_mfma_f32_16x16x32_bf16 v[208:211], v[48:51], v[116:119], v[208:211]
    ds_read_b64_tr_b16 v[46:47], v20 offset:27136
    s_waitcnt lgkmcnt(6)
    v_mfma_f32_16x16x32_bf16 v[196:199], v[52:55], v[112:115], v[196:199]
    ds_read_b64_tr_b16 v[48:49], v21 offset:25088
    v_mfma_f32_16x16x32_bf16 v[212:215], v[52:55], v[116:119], v[212:215]
    ds_read_b64_tr_b16 v[50:51], v21 offset:27136
    s_waitcnt lgkmcnt(6)
    v_mfma_f32_16x16x32_bf16 v[128:131], v[56:59], v[112:115], v[128:131]
    ds_read_b64_tr_b16 v[52:53], v20 offset:28672
    v_mfma_f32_16x16x32_bf16 v[160:163], v[56:59], v[116:119], v[160:163]
    ds_read_b64_tr_b16 v[54:55], v20 offset:30720
    s_waitcnt lgkmcnt(6)
    v_mfma_f32_16x16x32_bf16 v[132:135], v[60:63], v[112:115], v[132:135]
    ds_read_b64_tr_b16 v[56:57], v21 offset:28672
    v_mfma_f32_16x16x32_bf16 v[164:167], v[60:63], v[116:119], v[164:167]
    ds_read_b64_tr_b16 v[58:59], v21 offset:30720
    s_waitcnt lgkmcnt(6)
    v_mfma_f32_16x16x32_bf16 v[136:139], v[44:47], v[112:115], v[136:139]
    ds_read_b64_tr_b16 v[60:61], v20 offset:29184
    v_mfma_f32_16x16x32_bf16 v[168:171], v[44:47], v[116:119], v[168:171]
    ds_read_b64_tr_b16 v[62:63], v20 offset:31232
    buffer_load_dword v3, v2, s[12:15], 0 offen sc1
    s_waitcnt lgkmcnt(6)
    v_mfma_f32_16x16x32_bf16 v[140:143], v[48:51], v[112:115], v[140:143]
    ds_read_b64_tr_b16 v[44:45], v21 offset:29184
    v_mfma_f32_16x16x32_bf16 v[172:175], v[48:51], v[116:119], v[172:175]
    ds_read_b64_tr_b16 v[46:47], v21 offset:31232
    s_waitcnt lgkmcnt(6)
    v_mfma_f32_16x16x32_bf16 v[144:147], v[52:55], v[112:115], v[144:147]
    ds_read_b64_tr_b16 v[48:49], v20 offset:45056
    v_mfma_f32_16x16x32_bf16 v[176:179], v[52:55], v[116:119], v[176:179]
    ds_read_b64_tr_b16 v[50:51], v20 offset:47104
    s_waitcnt lgkmcnt(6)
    v_mfma_f32_16x16x32_bf16 v[148:151], v[56:59], v[112:115], v[148:151]
    ds_read_b64_tr_b16 v[52:53], v21 offset:45056
    v_mfma_f32_16x16x32_bf16 v[180:183], v[56:59], v[116:119], v[180:183]
    ds_read_b64_tr_b16 v[54:55], v21 offset:47104
    s_waitcnt lgkmcnt(6)
    v_mfma_f32_16x16x32_bf16 v[152:155], v[60:63], v[112:115], v[152:155]
    ds_read_b64_tr_b16 v[56:57], v20 offset:36864
    v_mfma_f32_16x16x32_bf16 v[184:187], v[60:63], v[116:119], v[184:187]
    ds_read_b64_tr_b16 v[58:59], v20 offset:38912
    s_waitcnt lgkmcnt(6)
    v_mfma_f32_16x16x32_bf16 v[156:159], v[44:47], v[112:115], v[156:159]
    ds_read_b64_tr_b16 v[60:61], v21 offset:36864
    v_mfma_f32_16x16x32_bf16 v[188:191], v[44:47], v[116:119], v[188:191]
    ds_read_b64_tr_b16 v[62:63], v21 offset:38912
    s_waitcnt vmcnt(13)
    s_waitcnt lgkmcnt(6)
    v_mfma_f32_16x16x32_bf16 v[192:195], v[48:51], v[120:123], v[192:195]
    ds_read_b64_tr_b16 v[44:45], v20 offset:37376
    v_mfma_f32_16x16x32_bf16 v[208:211], v[48:51], v[124:127], v[208:211]
    ds_read_b64_tr_b16 v[46:47], v20 offset:39424
    s_waitcnt lgkmcnt(6)
    v_mfma_f32_16x16x32_bf16 v[196:199], v[52:55], v[120:123], v[196:199]
    ds_read_b64_tr_b16 v[48:49], v21 offset:37376
    v_mfma_f32_16x16x32_bf16 v[212:215], v[52:55], v[124:127], v[212:215]
    ds_read_b64_tr_b16 v[50:51], v21 offset:39424
    s_waitcnt lgkmcnt(6)
    v_mfma_f32_16x16x32_bf16 v[128:131], v[56:59], v[120:123], v[128:131]
    ds_read_b64_tr_b16 v[52:53], v20 offset:40960
    v_mfma_f32_16x16x32_bf16 v[160:163], v[56:59], v[124:127], v[160:163]
    ds_read_b64_tr_b16 v[54:55], v20 offset:43008
    s_waitcnt lgkmcnt(6)
    v_mfma_f32_16x16x32_bf16 v[132:135], v[60:63], v[120:123], v[132:135]
    ds_read_b64_tr_b16 v[56:57], v21 offset:40960
    v_mfma_f32_16x16x32_bf16 v[164:167], v[60:63], v[124:127], v[164:167]
    ds_read_b64_tr_b16 v[58:59], v21 offset:43008
    s_waitcnt lgkmcnt(6)
    v_mfma_f32_16x16x32_bf16 v[136:139], v[44:47], v[120:123], v[136:139]
    ds_read_b64_tr_b16 v[60:61], v20 offset:41472
    v_mfma_f32_16x16x32_bf16 v[168:171], v[44:47], v[124:127], v[168:171]
    ds_read_b64_tr_b16 v[62:63], v20 offset:43520
    s_waitcnt lgkmcnt(6)
    v_mfma_f32_16x16x32_bf16 v[140:143], v[48:51], v[120:123], v[140:143]
    ds_read_b64_tr_b16 v[44:45], v21 offset:41472
    v_mfma_f32_16x16x32_bf16 v[172:175], v[48:51], v[124:127], v[172:175]
    ds_read_b64_tr_b16 v[46:47], v21 offset:43520
    v_mov_b32 v18, 1
    s_add_u32 s39, s20, 32
    s_lshr_b32 s45, s35, 1
    s_cmp_le_u32 s22, s45
    s_cselect_b32 s39, s39, 0
    v_writelane_b32 v18, 2, s39
    s_waitcnt vmcnt(0)
    v_cmp_eq_u32 s[46:47], v3, v13
    v_and_b32 v19, 7, v3
    v_cmp_gt_u32 vcc, v18, v19
    s_nop 1
    s_or_b64 vcc, vcc, s[46:47]
    s_cmp_lg_u32 vcc_hi, 0
    s_cbranch_scc1 L_spin_11
L_spinback_12:
    s_barrier
    s_waitcnt lgkmcnt(6)
    v_mfma_f32_16x16x32_bf16 v[144:147], v[52:55], v[120:123], v[144:147]
    ds_read_b64_tr_b16 v[48:49], v22 offset:8192
    s_xor_b32 s38, s20, 0
    s_lshl_b32 s38, s38, 19
    v_mfma_f32_16x16x32_bf16 v[176:179], v[52:55], v[124:127], v[176:179]
    ds_read_b64_tr_b16 v[50:51], v22 offset:10240
    s_mov_b32 s4, s54
    s_mov_b32 s5, s55
    s_waitcnt lgkmcnt(6)
    v_mfma_f32_16x16x32_bf16 v[148:151], v[56:59], v[120:123], v[148:151]
    ds_read_b64_tr_b16 v[52:53], v23 offset:8192
    s_add_u32 s4, s4, s38
    s_addc_u32 s5, s5, 0
    v_mfma_f32_16x16x32_bf16 v[180:183], v[56:59], v[124:127], v[180:183]
    ds_read_b64_tr_b16 v[54:55], v23 offset:10240
    s_and_b32 s5, s5, 0xffff
    s_mov_b32 s6, 524288
    s_waitcnt lgkmcnt(6)
    v_mfma_f32_16x16x32_bf16 v[152:155], v[60:63], v[120:123], v[152:155]
    ds_read_b64_tr_b16 v[56:57], v22 offset:0
    s_mov_b32 s7, 0x20000
    s_add_u32 s8, s54, 16777216
    s_addc_u32 s9, s55, 0
    v_mfma_f32_16x16x32_bf16 v[184:187], v[60:63], v[124:127], v[184:187]
    ds_read_b64_tr_b16 v[58:59], v22 offset:2048
    s_add_u32 s8, s8, s38
    s_addc_u32 s9, s9, 0
    s_waitcnt lgkmcnt(6)
    v_mfma_f32_16x16x32_bf16 v[156:159], v[44:47], v[120:123], v[156:159]
    ds_read_b64_tr_b16 v[60:61], v23 offset:0
    s_and_b32 s9, s9, 0xffff
    s_mov_b32 s10, 524288
    v_mfma_f32_16x16x32_bf16 v[188:191], v[44:47], v[124:127], v[188:191]
    ds_read_b64_tr_b16 v[62:63], v23 offset:2048
    s_mov_b32 s11, 0x20000
    s_lshl_b32 s38, s24, 13
    s_waitcnt lgkmcnt(6)
    v_mfma_f32_16x16x32_bf16 v[192:195], v[48:51], v[64:67], v[192:195]
    ds_read_b64_tr_b16 v[44:45], v22 offset:512
    v_add_u32 v5, s38, v1
    s_mul_i32 s39, s24, 12288
    v_mfma_f32_16x16x32_bf16 v[208:211], v[48:51], v[68:71], v[208:211]
    ds_read_b64_tr_b16 v[46:47], v22 offset:2560
    s_add_u32 s39, s39, 49152
    v_add_u32 v6, s39, v1
    s_waitcnt lgkmcnt(6)
    v_mfma_f32_16x16x32_bf16 v[196:199], v[52:55], v[64:67], v[196:199]
    ds_read_b64_tr_b16 v[48:49], v23 offset:512
    s_lshl_b32 s39, s24, 12
    s_add_u32 s39, s39, 49152
    v_mfma_f32_16x16x32_bf16 v[212:215], v[52:55], v[68:71], v[212:215]
    ds_read_b64_tr_b16 v[50:51], v23 offset:2560
    v_add_u32 v7, s39, v1
    v_bfe_u32 v16, v1, 4, 4
    s_waitcnt lgkmcnt(6)
    v_mfma_f32_16x16x32_bf16 v[128:131], v[56:59], v[64:67], v[128:131]
    ds_read_b64_tr_b16 v[52:53], v22 offset:4096
    v_lshrrev_b32 v18, 8, v1
    v_lshlrev_b32 v19, 2, v18
    v_mfma_f32_16x16x32_bf16 v[160:163], v[56:59], v[68:71], v[160:163]
    ds_read_b64_tr_b16 v[54:55], v22 offset:6144
    v_sub_u32 v8, v16, v19
    v_mov_b32 v9, 0xff800000
    s_waitcnt lgkmcnt(6)
    v_mfma_f32_16x16x32_bf16 v[132:135], v[60:63], v[64:67], v[132:135]
    ds_read_b64_tr_b16 v[56:57], v23 offset:4096
    s_lshl_b32 s44, s23, 18
    s_add_u32 s44, s44, 33554432
    v_mfma_f32_16x16x32_bf16 v[164:167], v[60:63], v[68:71], v[164:167]
    ds_read_b64_tr_b16 v[58:59], v23 offset:6144
    s_lshl_b32 s38, s20, 12
    s_add_u32 s44, s44, s38
    s_waitcnt lgkmcnt(6)
    v_mfma_f32_16x16x32_bf16 v[136:139], v[44:47], v[64:67], v[136:139]
    ds_read_b64_tr_b16 v[60:61], v22 offset:4608
    s_lshl_b32 s38, s24, 11
    s_add_u32 s44, s44, s38
    v_mfma_f32_16x16x32_bf16 v[168:171], v[44:47], v[68:71], v[168:171]
    ds_read_b64_tr_b16 v[62:63], v22 offset:6656
    s_mov_b32 s37, 0x40004000
    s_lshl_b32 s40, s22, 11
    s_waitcnt lgkmcnt(6)
    v_mfma_f32_16x16x32_bf16 v[140:143], v[48:51], v[64:67], v[140:143]
    ds_read_b64_tr_b16 v[44:45], v23 offset:4608
    s_mov_b32 s25, s40
    s_mov_b32 s26, s40
    v_mfma_f32_16x16x32_bf16 v[172:175], v[48:51], v[68:71], v[172:175]
    ds_read_b64_tr_b16 v[46:47], v23 offset:6656
    s_lshl_b32 s38, s35, 15
    s_add_u32 s38, s38, 32768
    s_waitcnt lgkmcnt(6)
    v_mfma_f32_16x16x32_bf16 v[144:147], v[52:55], v[64:67], v[144:147]
    ds_read_b64_tr_b16 v[48:49], v22 offset:20480
    s_add_u32 s27, s38, s40
    s_mov_b32 s28, s27
    v_mfma_f32_16x16x32_bf16 v[176:179], v[52:55], v[68:71], v[176:179]
    ds_read_b64_tr_b16 v[50:51], v22 offset:22528
    s_add_u32 s56, s40, 0
    s_mov_b32 s29, s56
    s_waitcnt lgkmcnt(6)
    v_mfma_f32_16x16x32_bf16 v[148:151], v[56:59], v[64:67], v[148:151]
    ds_read_b64_tr_b16 v[52:53], v23 offset:20480
    s_add_u32 s41, s56, 49152
    s_add_u32 s57, s40, 49152
    v_mfma_f32_16x16x32_bf16 v[180:183], v[56:59], v[68:71], v[180:183]
    ds_read_b64_tr_b16 v[54:55], v23 offset:22528
    s_mov_b32 s30, 0
    s_mov_b32 s31, 32768
    s_waitcnt lgkmcnt(6)
    v_mfma_f32_16x16x32_bf16 v[152:155], v[60:63], v[64:67], v[152:155]
    ds_read_b64_tr_b16 v[56:57], v22 offset:12288
    s_mov_b32 s32, 49152
    s_mov_b32 s36, 0
    v_mfma_f32_16x16x32_bf16 v[184:187], v[60:63], v[68:71], v[184:187]
    ds_read_b64_tr_b16 v[58:59], v22 offset:14336
    s_lshl_b32 s43, s23, 13
    s_add_u32 s39, s43, 131072
    s_waitcnt lgkmcnt(6)
    v_mfma_f32_16x16x32_bf16 v[156:159], v[44:47], v[64:67], v[156:159]
    ds_read_b64_tr_b16 v[60:61], v23 offset:12288
    v_add_u32 v30, s39, v1
    s_add_u32 s43, s43, 98304
    v_mfma_f32_16x16x32_bf16 v[188:191], v[44:47], v[68:71], v[188:191]
    ds_read_b64_tr_b16 v[62:63], v23 offset:14336
    v_add_u32 v29, s43, v1
    s_cmp_eq_u32 s24, 0
    s_cselect_b32 s39, s43, s39
    s_waitcnt lgkmcnt(6)
    v_mfma_f32_16x16x32_bf16 v[192:195], v[48:51], v[72:75], v[192:195]
    ds_read_b64_tr_b16 v[44:45], v22 offset:12800
    v_add_u32 v27, s39, v1
    v_mfma_f32_16x16x32_bf16 v[208:211], v[48:51], v[76:79], v[208:211]
    ds_read_b64_tr_b16 v[46:47], v22 offset:14848
    s_waitcnt lgkmcnt(6)
    v_mfma_f32_16x16x32_bf16 v[196:199], v[52:55], v[72:75], v[196:199]
    ds_read_b64_tr_b16 v[48:49], v23 offset:12800
    v_mfma_f32_16x16x32_bf16 v[212:215], v[52:55], v[76:79], v[212:215]
    ds_read_b64_tr_b16 v[50:51], v23 offset:14848
    s_waitcnt lgkmcnt(6)
    v_mfma_f32_16x16x32_bf16 v[128:131], v[56:59], v[72:75], v[128:131]
    ds_read_b64_tr_b16 v[52:53], v22 offset:16384
    v_mfma_f32_16x16x32_bf16 v[160:163], v[56:59], v[76:79], v[160:163]
    ds_read_b64_tr_b16 v[54:55], v22 offset:18432
    s_waitcnt lgkmcnt(6)
    v_mfma_f32_16x16x32_bf16 v[132:135], v[60:63], v[72:75], v[132:135]
    ds_read_b64_tr_b16 v[56:57], v23 offset:16384
    v_mfma_f32_16x16x32_bf16 v[164:167], v[60:63], v[76:79], v[164:167]
    ds_read_b64_tr_b16 v[58:59], v23 offset:18432
    s_waitcnt lgkmcnt(6)
    v_mfma_f32_16x16x32_bf16 v[136:139], v[44:47], v[72:75], v[136:139]
    ds_read_b64_tr_b16 v[60:61], v22 offset:16896
    v_mfma_f32_16x16x32_bf16 v[168:171], v[44:47], v[76:79], v[168:171]
    ds_read_b64_tr_b16 v[62:63], v22 offset:18944
    s_waitcnt lgkmcnt(6)
    v_mfma_f32_16x16x32_bf16 v[140:143], v[48:51], v[72:75], v[140:143]
    ds_read_b64_tr_b16 v[44:45], v23 offset:16896
    v_mfma_f32_16x16x32_bf16 v[172:175], v[48:51], v[76:79], v[172:175]
    ds_read_b64_tr_b16 v[46:47], v23 offset:18944
    s_barrier
    s_waitcnt lgkmcnt(6)
    v_mfma_f32_16x16x32_bf16 v[144:147], v[52:55], v[72:75], v[144:147]
    ds_read_b64_tr_b16 v[48:49], v22 offset:32768
    v_mfma_f32_16x16x32_bf16 v[176:179], v[52:55], v[76:79], v[176:179]
    ds_read_b64_tr_b16 v[50:51], v22 offset:34816
    s_mov_b32 m0, s29
    s_add_u32 s29, s29, 16384
    buffer_load_dwordx4 v1, s[4:7], s25 offen sc1 lds
    s_waitcnt lgkmcnt(6)
    v_mfma_f32_16x16x32_bf16 v[148:151], v[56:59], v[72:75], v[148:151]
    ds_read_b64_tr_b16 v[52:53], v23 offset:32768
    v_mfma_f32_16x16x32_bf16 v[180:183], v[56:59], v[76:79], v[180:183]
    ds_read_b64_tr_b16 v[54:55], v23 offset:34816
    buffer_load_dwordx4 v1, s[4:7], s25 offen offset:1024 sc1 lds
    s_cmp_eq_u32 s29, s41
    s_cselect_b32 s29, s56, s29
    s_add_u32 s25, s25, 16384
    s_cmp_eq_u32 s25, s27
    s_cselect_b32 s25, s40, s25
    s_waitcnt lgkmcnt(6)
    v_mfma_f32_16x16x32_bf16 v[152:155], v[60:63], v[72:75], v[152:155]
    ds_read_b64_tr_b16 v[56:57], v22 offset:24576
    v_mfma_f32_16x16x32_bf16 v[184:187], v[60:63], v[76:79], v[184:187]
    ds_read_b64_tr_b16 v[58:59], v22 offset:26624
    s_mov_b32 m0, s29
    s_add_u32 s29, s29, 16384
    buffer_load_dwordx4 v1, s[4:7], s25 offen sc1 lds
    s_waitcnt lgkmcnt(6)
    v_mfma_f32_16x16x32_bf16 v[156:159], v[44:47], v[72:75], v[156:159]
    ds_read_b64_tr_b16 v[60:61], v23 offset:24576
    v_mfma_f32_16x16x32_bf16 v[188:191], v[44:47], v[76:79], v[188:191]
    ds_read_b64_tr_b16 v[62:63], v23 offset:26624
    buffer_load_dwordx4 v1, s[4:7], s25 offen offset:1024 sc1 lds
    s_cmp_eq_u32 s29, s41
    s_cselect_b32 s29, s56, s29
    s_add_u32 s25, s25, 16384
    s_cmp_eq_u32 s25, s27
    s_cselect_b32 s25, s40, s25
    s_waitcnt lgkmcnt(6)
    v_mfma_f32_16x16x32_bf16 v[192:195], v[48:51], v[80:83], v[192:195]
    ds_read_b64_tr_b16 v[44:45], v22 offset:25088
    v_mfma_f32_16x16x32_bf16 v[208:211], v[48:51], v[84:87], v[208:211]
    ds_read_b64_tr_b16 v[46:47], v22 offset:27136
    s_mov_b32 m0, s29
    s_add_u32 s29, s29, 16384
    buffer_load_dwordx4 v1, s[4:7], s25 offen sc1 lds
    s_waitcnt lgkmcnt(6)
    v_mfma_f32_16x16x32_bf16 v[196:199], v[52:55], v[80:83], v[196:199]
    ds_read_b64_tr_b16 v[48:49], v23 offset:25088
    v_mfma_f32_16x16x32_bf16 v[212:215], v[52:55], v[84:87], v[212:215]
    ds_read_b64_tr_b16 v[50:51], v23 offset:27136
    buffer_load_dwordx4 v1, s[4:7], s25 offen offset:1024 sc1 lds
    s_cmp_eq_u32 s29, s41
    s_cselect_b32 s29, s56, s29
    s_add_u32 s25, s25, 16384
    s_cmp_eq_u32 s25, s27
    s_cselect_b32 s25, s40, s25
    s_waitcnt lgkmcnt(6)
    v_mfma_f32_16x16x32_bf16 v[128:131], v[56:59], v[80:83], v[128:131]
    ds_read_b64_tr_b16 v[52:53], v22 offset:28672
    v_mfma_f32_16x16x32_bf16 v[160:163], v[56:59], v[84:87], v[160:163]
    ds_read_b64_tr_b16 v[54:55], v22 offset:30720
    s_waitcnt lgkmcnt(6)
    v_mfma_f32_16x16x32_bf16 v[132:135], v[60:63], v[80:83], v[132:135]
    ds_read_b64_tr_b16 v[56:57], v23 offset:28672
    v_mfma_f32_16x16x32_bf16 v[164:167], v[60:63], v[84:87], v[164:167]
    ds_read_b64_tr_b16 v[58:59], v23 offset:30720
    s_waitcnt lgkmcnt(6)
    v_mfma_f32_16x16x32_bf16 v[136:139], v[44:47], v[80:83], v[136:139]
    ds_read_b64_tr_b16 v[60:61], v22 offset:29184
    v_mfma_f32_16x16x32_bf16 v[168:171], v[44:47], v[84:87], v[168:171]
    ds_read_b64_tr_b16 v[62:63], v22 offset:31232
    s_waitcnt lgkmcnt(6)
    v_mfma_f32_16x16x32_bf16 v[140:143], v[48:51], v[80:83], v[140:143]
    ds_read_b64_tr_b16 v[44:45], v23 offset:29184
    v_mfma_f32_16x16x32_bf16 v[172:175], v[48:51], v[84:87], v[172:175]
    ds_read_b64_tr_b16 v[46:47], v23 offset:31232
    s_waitcnt lgkmcnt(6)
    v_mfma_f32_16x16x32_bf16 v[144:147], v[52:55], v[80:83], v[144:147]
    ds_read_b64_tr_b16 v[48:49], v22 offset:45056
    v_mfma_f32_16x16x32_bf16 v[176:179], v[52:55], v[84:87], v[176:179]
    ds_read_b64_tr_b16 v[50:51], v22 offset:47104
    s_waitcnt lgkmcnt(6)
    v_mfma_f32_16x16x32_bf16 v[148:151], v[56:59], v[80:83], v[148:151]
    ds_read_b64_tr_b16 v[52:53], v23 offset:45056
    v_mfma_f32_16x16x32_bf16 v[180:183], v[56:59], v[84:87], v[180:183]
    ds_read_b64_tr_b16 v[54:55], v23 offset:47104
    s_waitcnt lgkmcnt(6)
    v_mfma_f32_16x16x32_bf16 v[152:155], v[60:63], v[80:83], v[152:155]
    ds_read_b64_tr_b16 v[56:57], v22 offset:36864
    v_mfma_f32_16x16x32_bf16 v[184:187], v[60:63], v[84:87], v[184:187]
    ds_read_b64_tr_b16 v[58:59], v22 offset:38912
    s_waitcnt lgkmcnt(6)
    v_mfma_f32_16x16x32_bf16 v[156:159], v[44:47], v[80:83], v[156:159]
    ds_read_b64_tr_b16 v[60:61], v23 offset:36864
    v_mfma_f32_16x16x32_bf16 v[188:191], v[44:47], v[84:87], v[188:191]
    ds_read_b64_tr_b16 v[62:63], v23 offset:38912
    s_waitcnt lgkmcnt(6)
    v_mfma_f32_16x16x32_bf16 v[192:195], v[48:51], v[88:91], v[192:195]
    ds_read_b64_tr_b16 v[44:45], v22 offset:37376
    v_mfma_f32_16x16x32_bf16 v[208:211], v[48:51], v[92:95], v[208:211]
    ds_read_b64_tr_b16 v[46:47], v22 offset:39424
    s_waitcnt lgkmcnt(6)
    v_mfma_f32_16x16x32_bf16 v[196:199], v[52:55], v[88:91], v[196:199]
    ds_read_b64_tr_b16 v[48:49], v23 offset:37376
    v_mfma_f32_16x16x32_bf16 v[212:215], v[52:55], v[92:95], v[212:215]
    ds_read_b64_tr_b16 v[50:51], v23 offset:39424
    s_waitcnt lgkmcnt(6)
    v_mfma_f32_16x16x32_bf16 v[128:131], v[56:59], v[88:91], v[128:131]
    ds_read_b64_tr_b16 v[52:53], v22 offset:40960
    v_mfma_f32_16x16x32_bf16 v[160:163], v[56:59], v[92:95], v[160:163]
    ds_read_b64_tr_b16 v[54:55], v22 offset:43008
    s_waitcnt lgkmcnt(6)
    v_mfma_f32_16x16x32_bf16 v[132:135], v[60:63], v[88:91], v[132:135]
    ds_read_b64_tr_b16 v[56:57], v23 offset:40960
    v_mfma_f32_16x16x32_bf16 v[164:167], v[60:63], v[92:95], v[164:167]
    ds_read_b64_tr_b16 v[58:59], v23 offset:43008
    s_waitcnt lgkmcnt(6)
    v_mfma_f32_16x16x32_bf16 v[136:139], v[44:47], v[88:91], v[136:139]
    ds_read_b64_tr_b16 v[60:61], v22 offset:41472
    s_mov_b32 s52, 1.4426950408889634
    v_fma_f32 v96, v192, s52, -0.5
    v_fma_f32 v97, v193, s52, -0.5
    v_mfma_f32_16x16x32_bf16 v[168:171], v[44:47], v[92:95], v[168:171]
    ds_read_b64_tr_b16 v[62:63], v22 offset:43520
    v_fma_f32 v98, v194, s52, -0.5
    v_fma_f32 v99, v195, s52, -0.5
    v_fma_f32 v100, v196, s52, -0.5
    s_waitcnt lgkmcnt(6)
    v_mfma_f32_16x16x32_bf16 v[140:143], v[48:51], v[88:91], v[140:143]
    ds_read_b64_tr_b16 v[44:45], v23 offset:41472
    v_fma_f32 v101, v197, s52, -0.5
    v_fma_f32 v102, v198, s52, -0.5
    v_fma_f32 v103, v199, s52, -0.5
    v_mfma_f32_16x16x32_bf16 v[172:175], v[48:51], v[92:95], v[172:175]
    ds_read_b64_tr_b16 v[46:47], v23 offset:43520
    v_exp_f32 v96, v96
    v_exp_f32 v97, v97
    v_exp_f32 v98, v98
    s_waitcnt lgkmcnt(6)
    v_mfma_f32_16x16x32_bf16 v[144:147], v[52:55], v[88:91], v[144:147]
    v_cvt_pk_bf16_f32 v128, v128, v129
    v_cvt_pk_bf16_f32 v129, v130, v131
    v_cvt_pk_bf16_f32 v130, v132, v133
    v_cvt_pk_bf16_f32 v131, v134, v135
    ds_write_b128 v27, v[128:131] offset:0
    v_mfma_f32_16x16x32_bf16 v[176:179], v[52:55], v[92:95], v[176:179]
    v_cvt_pk_bf16_f32 v160, v160, v161
    v_cvt_pk_bf16_f32 v161, v162, v163
    v_cvt_pk_bf16_f32 v162, v164, v165
    v_cvt_pk_bf16_f32 v163, v166, v167
    ds_write_b128 v27, v[160:163] offset:4096
    s_waitcnt lgkmcnt(6)
    v_mfma_f32_16x16x32_bf16 v[148:151], v[56:59], v[88:91], v[148:151]
    v_exp_f32 v99, v99
    v_exp_f32 v100, v100
    v_exp_f32 v101, v101
    v_mfma_f32_16x16x32_bf16 v[180:183], v[56:59], v[92:95], v[180:183]
    v_exp_f32 v102, v102
    v_exp_f32 v103, v103
    v_add_f32 v96, 0.7071067811865476, v96
    s_waitcnt lgkmcnt(4)
    v_mfma_f32_16x16x32_bf16 v[152:155], v[60:63], v[88:91], v[152:155]
    v_cvt_pk_bf16_f32 v136, v136, v137
    v_cvt_pk_bf16_f32 v137, v138, v139
    v_cvt_pk_bf16_f32 v138, v140, v141
    v_cvt_pk_bf16_f32 v139, v142, v143
    ds_write_b128 v27, v[136:139] offset:1024
    v_mfma_f32_16x16x32_bf16 v[184:187], v[60:63], v[92:95], v[184:187]
    v_cvt_pk_bf16_f32 v168, v168, v169
    v_cvt_pk_bf16_f32 v169, v170, v171
    v_cvt_pk_bf16_f32 v170, v172, v173
    v_cvt_pk_bf16_f32 v171, v174, v175
    ds_write_b128 v27, v[168:171] offset:5120
    s_waitcnt lgkmcnt(4)
    v_mfma_f32_16x16x32_bf16 v[156:159], v[44:47], v[88:91], v[156:159]
    v_add_f32 v97, 0.7071067811865476, v97
    v_add_f32 v98, 0.7071067811865476, v98
    v_add_f32 v99, 0.7071067811865476, v99
    v_mfma_f32_16x16x32_bf16 v[188:191], v[44:47], v[92:95], v[188:191]
    v_add_f32 v100, 0.7071067811865476, v100
    v_add_f32 v101, 0.7071067811865476, v101
    v_add_f32 v102, 0.7071067811865476, v102
    v_cvt_pk_bf16_f32 v144, v144, v145
    v_cvt_pk_bf16_f32 v145, v146, v147
    v_cvt_pk_bf16_f32 v146, v148, v149
    v_cvt_pk_bf16_f32 v147, v150, v151
    ds_write_b128 v27, v[144:147] offset:2048
    v_cvt_pk_bf16_f32 v176, v176, v177
    v_cvt_pk_bf16_f32 v177, v178, v179
    v_cvt_pk_bf16_f32 v178, v180, v181
    v_cvt_pk_bf16_f32 v179, v182, v183
    ds_write_b128 v27, v[176:179] offset:6144
    v_add_f32 v103, 0.7071067811865476, v103
    v_fma_f32 v96, v96, v96, 0.5
    v_fma_f32 v97, v97, v97, 0.5
    v_fma_f32 v98, v98, v98, 0.5
    v_fma_f32 v99, v99, v99, 0.5
    v_fma_f32 v100, v100, v100, 0.5
    v_fma_f32 v101, v101, v101, 0.5
    v_fma_f32 v102, v102, v102, 0.5
    v_cvt_pk_bf16_f32 v152, v152, v153
    v_cvt_pk_bf16_f32 v153, v154, v155
    v_cvt_pk_bf16_f32 v154, v156, v157
    v_cvt_pk_bf16_f32 v155, v158, v159
    ds_write_b128 v27, v[152:155] offset:3072
    v_cvt_pk_bf16_f32 v184, v184, v185
    v_cvt_pk_bf16_f32 v185, v186, v187
    v_cvt_pk_bf16_f32 v186, v188, v189
    v_cvt_pk_bf16_f32 v187, v190, v191
    ds_write_b128 v27, v[184:187] offset:7168
    v_fma_f32 v103, v103, v103, 0.5
    v_rcp_f32 v96, v96
    v_rcp_f32 v97, v97
    v_rcp_f32 v98, v98
    v_rcp_f32 v99, v99
    v_rcp_f32 v100, v100
    v_rcp_f32 v101, v101
    v_rcp_f32 v102, v102
    s_mov_b32 s46, 1.4426950408889634
    s_mov_b32 s47, 0.7071067811865476
    s_waitcnt vmcnt(4) lgkmcnt(0)
    s_barrier
    ds_read_b128 v[128:131], v29 offset:0
    ds_read_b128 v[132:135], v29 offset:1024
    ds_read_b128 v[136:139], v29 offset:2048
    ds_read_b128 v[140:143], v29 offset:3072
    ds_read_b128 v[144:147], v29 offset:4096
    ds_read_b128 v[148:151], v29 offset:5120
    ds_read_b128 v[152:155], v29 offset:6144
    ds_read_b128 v[156:159], v29 offset:7168
    s_add_u32 m0, s30, s57
    s_add_u32 s30, s30, 16384
    buffer_load_dwordx4 v1, s[8:11], s26 offen sc1 lds
    buffer_load_dwordx4 v1, s[8:11], s26 offen offset:1024 sc1 lds
    s_and_b32 s30, s30, 0xffff
    s_add_u32 s26, s26, 16384
    s_cmp_eq_u32 s26, s28
    s_cselect_b32 s26, s40, s26
    s_add_u32 m0, s30, s57
    s_add_u32 s30, s30, 16384
    buffer_load_dwordx4 v1, s[8:11], s26 offen sc1 lds
    buffer_load_dwordx4 v1, s[8:11], s26 offen offset:1024 sc1 lds
    s_and_b32 s30, s30, 0xffff
    s_add_u32 s26, s26, 16384
    s_cmp_eq_u32 s26, s28
    s_cselect_b32 s26, s40, s26
    v_mov_b32 v12, 0x3f803f80
    v_mov_b32 v13, 0x3f803f80
    v_mov_b32 v14, 0x3f803f80
    v_mov_b32 v15, 0x3f803f80
    v_mov_b32 v160, -20.0
    v_mov_b32 v161, -20.0
    v_mov_b32 v162, -20.0
    v_mov_b32 v163, -20.0
    v_mov_b32 v164, -20.0
    v_mov_b32 v165, -20.0
    v_mov_b32 v166, -20.0
    v_mov_b32 v167, -20.0
    s_lshl_b32 s34, s35, 2
    s_add_u32 s34, s34, s23
    s_sub_u32 s34, s34, s24
    s_lshl_b32 s34, s34, 5
    s_mov_b32 s33, s35
    s_add_u32 s31, s31, 16384
    s_cmp_eq_u32 s31, 49152
    s_cselect_b32 s31, 0, s31
    v_add_u32 v2, s31, v5
    ds_read_b128 v[32:35], v2 offset:0
    ds_read_b128 v[36:39], v2 offset:1024
    ds_read_b128 v[40:43], v2 offset:2048
    ds_read_b128 v[44:47], v2 offset:3072
    v_rcp_f32 v103, v103
    v_fma_f32 v192, -v96, v192, v192
    v_fma_f32 v193, -v97, v193, v193
    v_fma_f32 v194, -v98, v194, v194
    v_fma_f32 v195, -v99, v195, v195
    v_fma_f32 v196, -v100, v196, v196
    v_fma_f32 v197, -v101, v197, v197
    v_fma_f32 v198, -v102, v198, v198
    v_fma_f32 v199, -v103, v199, v199
    v_cvt_pk_bf16_f32 v192, v192, v193
    v_cvt_pk_bf16_f32 v193, v194, v195
    v_cvt_pk_bf16_f32 v194, v196, v197
    v_cvt_pk_bf16_f32 v195, v198, v199
    s_add_u32 s39, s42, 0
    buffer_store_dwordx4 v[192:195], v1, s[12:15], s39 offen offset:0 sc1
    s_waitcnt lgkmcnt(3)
    v_mfma_f32_16x16x32_bf16 v[176:179], v[32:35], v[128:131], v[160:163]
    v_fma_f32 v104, v208, s52, -0.5
    v_fma_f32 v105, v209, s52, -0.5
    v_fma_f32 v106, v210, s52, -0.5
    v_fma_f32 v107, v211, s52, -0.5
    v_mfma_f32_16x16x32_bf16 v[180:183], v[32:35], v[144:147], v[164:167]
    ds_read_b128 v[32:35], v2 offset:4096
    ds_read_b128 v[224:227], v30 offset:0
    ds_read_b128 v[228:231], v30 offset:1024
    ds_read_b128 v[232:235], v30 offset:2048
    ds_read_b128 v[236:239], v30 offset:3072
    v_fma_f32 v108, v212, s52, -0.5
    v_fma_f32 v109, v213, s52, -0.5
    v_fma_f32 v110, v214, s52, -0.5
    s_waitcnt lgkmcnt(7)
    v_mfma_f32_16x16x32_bf16 v[176:179], v[36:39], v[132:135], v[176:179]
    v_fma_f32 v111, v215, s52, -0.5
    v_exp_f32 v104, v104
    v_exp_f32 v105, v105
    v_exp_f32 v106, v106
    v_mfma_f32_16x16x32_bf16 v[180:183], v[36:39], v[148:151], v[180:183]
    ds_read_b128 v[36:39], v2 offset:5120
    ds_read_b128 v[240:243], v30 offset:4096
    ds_read_b128 v[244:247], v30 offset:5120
    ds_read_b128 v[248:251], v30 offset:6144
    ds_read_b128 v[252:255], v30 offset:7168
    v_exp_f32 v107, v107
    v_exp_f32 v108, v108
    v_exp_f32 v109, v109
    s_waitcnt lgkmcnt(11)
    v_mfma_f32_16x16x32_bf16 v[176:179], v[40:43], v[136:139], v[176:179]
    v_exp_f32 v110, v110
    v_exp_f32 v111, v111
    v_add_f32 v104, 0.7071067811865476, v104
    v_mfma_f32_16x16x32_bf16 v[180:183], v[40:43], v[152:155], v[180:183]
    ds_read_b128 v[40:43], v2 offset:6144
    v_add_f32 v105, 0.7071067811865476, v105
    v_add_f32 v106, 0.7071067811865476, v106
    v_add_f32 v107, 0.7071067811865476, v107
    v_add_f32 v108, 0.7071067811865476, v108
    s_waitcnt lgkmcnt(11)
    v_mfma_f32_16x16x32_bf16 v[176:179], v[44:47], v[140:143], v[176:179]
    v_add_f32 v109, 0.7071067811865476, v109
    v_add_f32 v110, 0.7071067811865476, v110
    v_add_f32 v111, 0.7071067811865476, v111
    v_mfma_f32_16x16x32_bf16 v[180:183], v[44:47], v[156:159], v[180:183]
    ds_read_b128 v[44:47], v2 offset:7168
    v_fma_f32 v104, v104, v104, 0.5
    v_fma_f32 v105, v105, v105, 0.5
    v_fma_f32 v106, v106, v106, 0.5
    s_waitcnt lgkmcnt(0)
    s_waitcnt vmcnt(7)
    s_barrier
    v_mfma_f32_16x16x32_bf16 v[184:187], v[32:35], v[128:131], v[160:163]
    v_fma_f32 v107, v107, v107, 0.5
    v_fma_f32 v108, v108, v108, 0.5
    v_fma_f32 v109, v109, v109, 0.5
    v_fma_f32 v110, v110, v110, 0.5
    v_lshrrev_b32 v49, 13, v10
    v_and_b32 v50, 3, v49
    v_mfma_f32_16x16x32_bf16 v[188:191], v[32:35], v[144:147], v[164:167]
    s_add_u32 s31, s31, 16384
    s_cmp_eq_u32 s31, 49152
    s_cselect_b32 s31, 0, s31
    v_add_u32 v2, s31, v5
    ds_read_b128 v[32:35], v2 offset:0
    s_mov_b32 m0, s29
    s_add_u32 s29, s29, 16384
    buffer_load_dwordx4 v1, s[4:7], s25 offen sc1 lds
    v_fma_f32 v111, v111, v111, 0.5
    v_rcp_f32 v104, v104
    v_rcp_f32 v105, v105
    v_lshrrev_b32 v49, 3, v49
    v_lshl_add_u32 v49, v49, 2, v50
    v_mfma_f32_16x16x32_bf16 v[184:187], v[36:39], v[132:135], v[184:187]
    v_rcp_f32 v106, v106
    v_rcp_f32 v107, v107
    v_rcp_f32 v108, v108
    v_rcp_f32 v109, v109
    v_and_b32 v48, 0x7f, v10
    v_mfma_f32_16x16x32_bf16 v[188:191], v[36:39], v[148:151], v[188:191]
    ds_read_b128 v[36:39], v2 offset:1024
    v_rcp_f32 v110, v110
    v_rcp_f32 v111, v111
    v_fma_f32 v208, -v104, v208, v208
    v_mul_u32_u24 v49, 1280, v49
    v_add_u32 v48, v48, v49
    v_mfma_f32_16x16x32_bf16 v[184:187], v[40:43], v[136:139], v[184:187]
    v_fma_f32 v209, -v105, v209, v209
    v_fma_f32 v210, -v106, v210, v210
    v_fma_f32 v211, -v107, v211, v211
    s_lshl_b32 s93, s22, 12
    s_add_u32 s93, s93, 114688
    v_mfma_f32_16x16x32_bf16 v[188:191], v[40:43], v[152:155], v[188:191]
    ds_read_b128 v[40:43], v2 offset:2048
    v_fma_f32 v212, -v108, v212, v212
    v_fma_f32 v213, -v109, v213, v213
    v_fma_f32 v214, -v110, v214, v214
    v_fma_f32 v215, -v111, v215, v215
    v_add_u32 v52, s93, v20
    v_mfma_f32_16x16x32_bf16 v[184:187], v[44:47], v[140:143], v[184:187]
    v_cvt_pk_bf16_f32 v208, v208, v209
    v_cvt_pk_bf16_f32 v209, v210, v211
    v_cvt_pk_bf16_f32 v210, v212, v213
    v_add_u32 v53, s93, v21
    v_mov_b32 v10, 20.0
    v_mfma_f32_16x16x32_bf16 v[188:191], v[44:47], v[156:159], v[188:191]
    ds_read_b128 v[44:47], v2 offset:3072
    v_cvt_pk_bf16_f32 v211, v214, v215
    s_add_u32 s39, s42, 55296
    buffer_store_dwordx4 v[208:211], v1, s[12:15], s39 offen offset:0 sc1
    v_mov_b32 v11, 20.0
recurrent_scan__compressed_kv_cla__dense_activation_mish__prompt_kernel_pj:
    s_nop 7
    s_waitcnt lgkmcnt(3)
    v_mfma_f32_16x16x32_bf16 v[192:195], v[32:35], v[128:131], v[160:163]
    v_exp_f32 v20, v176
    v_exp_f32 v21, v177
    v_exp_f32 v22, v178
    v_mfma_f32_16x16x32_bf16 v[196:199], v[32:35], v[144:147], v[164:167]
    ds_read_b128 v[32:35], v2 offset:4096
    buffer_load_dwordx4 v1, s[4:7], s25 offen offset:1024 sc1 lds
    s_cmp_eq_u32 s29, s41
    s_cselect_b32 s29, s56, s29
    s_add_u32 s25, s25, 16384
    s_cmp_eq_u32 s25, s27
    s_cselect_b32 s25, s40, s25
    v_cvt_pk_bf16_f32 v208, v20, v21
    v_exp_f32 v23, v179
    s_waitcnt lgkmcnt(3)
    v_mfma_f32_16x16x32_bf16 v[192:195], v[36:39], v[132:135], v[192:195]
    v_exp_f32 v24, v184
    v_cvt_pk_bf16_f32 v209, v22, v23
    v_mfma_f32_16x16x32_bf16 v[196:199], v[36:39], v[148:151], v[196:199]
    ds_read_b128 v[36:39], v2 offset:5120
    v_exp_f32 v25, v185
    v_exp_f32 v26, v186
    s_waitcnt lgkmcnt(3)
    v_mfma_f32_16x16x32_bf16 v[192:195], v[40:43], v[136:139], v[192:195]
    v_cvt_pk_bf16_f32 v210, v24, v25
    v_or3_b32 v16, v208, v209, v210
    v_mfma_f32_16x16x32_bf16 v[196:199], v[40:43], v[152:155], v[196:199]
    ds_read_b128 v[40:43], v2 offset:6144
    v_exp_f32 v27, v187
    v_exp_f32 v20, v180
    s_waitcnt lgkmcnt(3)
    v_mfma_f32_16x16x32_bf16 v[192:195], v[44:47], v[140:143], v[192:195]
    v_cvt_pk_bf16_f32 v211, v26, v27
    v_or_b32 v16, v16, v211
    v_mfma_f32_16x16x32_bf16 v[196:199], v[44:47], v[156:159], v[196:199]
    ds_read_b128 v[44:47], v2 offset:7168
    v_exp_f32 v21, v181
    v_exp_f32 v22, v182
    s_waitcnt lgkmcnt(0)
    s_waitcnt vmcnt(6)
    s_barrier
    v_mfma_f32_16x16x32_bf16 v[200:203], v[32:35], v[128:131], v[160:163]
    v_cvt_pk_bf16_f32 v212, v20, v21
    v_exp_f32 v23, v183
    v_exp_f32 v24, v188
    v_mfma_f32_16x16x32_bf16 v[204:207], v[32:35], v[144:147], v[164:167]
    s_add_u32 s31, s31, 16384
    s_cmp_eq_u32 s31, 49152
    s_cselect_b32 s31, 0, s31
    v_add_u32 v2, s31, v5
    ds_read_b128 v[32:35], v2 offset:0
    s_mov_b32 m0, s29
    s_add_u32 s29, s29, 16384
    buffer_load_dwordx4 v1, s[4:7], s25 offen sc1 lds
    v_cvt_pk_bf16_f32 v213, v22, v23
    v_exp_f32 v25, v189
    v_mfma_f32_16x16x32_bf16 v[200:203], v[36:39], v[132:135], v[200:203]
    v_exp_f32 v26, v190
    v_cvt_pk_bf16_f32 v214, v24, v25
    v_mfma_f32_16x16x32_bf16 v[204:207], v[36:39], v[148:151], v[204:207]
    ds_read_b128 v[36:39], v2 offset:1024
    v_or3_b32 v17, v212, v213, v214
    v_exp_f32 v27, v191
    v_mfma_f32_16x16x32_bf16 v[200:203], v[40:43], v[136:139], v[200:203]
    s_nop 0
    v_cvt_pk_bf16_f32 v215, v26, v27
    v_mfma_f32_16x16x32_bf16 v[204:207], v[40:43], v[152:155], v[204:207]
    ds_read_b128 v[40:43], v2 offset:2048
    v_or_b32 v17, v17, v215
    v_or_b32 v28, v16, v17
    v_mfma_f32_16x16x32_bf16 v[200:203], v[44:47], v[140:143], v[200:203]
    v_and_b32 v16, 0x60006000, v16
    v_and_b32 v17, 0x60006000, v17
    v_mfma_f32_16x16x32_bf16 v[204:207], v[44:47], v[156:159], v[204:207]
    ds_read_b128 v[44:47], v2 offset:3072
    v_and_b32 v28, s37, v28
    v_min_u32 v16, v16, v17
    v_cmp_eq_u32 s[46:47], 0, v16
    v_cmp_ne_u32 vcc, 0, v28
    s_sub_u32 s34, s34, 64
    s_nop 1
    s_or_b64 vcc, vcc, s[46:47]
    s_cbranch_scc1 L_rare_13
L_rareback_14:
    s_waitcnt lgkmcnt(3)
    v_mfma_f32_16x16x32_bf16 v[176:179], v[32:35], v[128:131], v[160:163]
    v_exp_f32 v20, v192
    v_mfma_f32_16x16x32_bf16 v[180:183], v[32:35], v[144:147], v[164:167]
    ds_read_b128 v[32:35], v2 offset:4096
    s_waitcnt lgkmcnt(3)
    v_mfma_f32_16x16x32_bf16 v[176:179], v[36:39], v[132:135], v[176:179]
    v_exp_f32 v21, v193
    v_mfma_f32_16x16x32_bf16 v[180:183], v[36:39], v[148:151], v[180:183]
    ds_read_b128 v[36:39], v2 offset:5120
    buffer_load_dwordx4 v1, s[4:7], s25 offen offset:1024 sc1 lds
    s_cmp_eq_u32 s29, s41
    s_cselect_b32 s29, s56, s29
    s_add_u32 s25, s25, 16384
    s_cmp_eq_u32 s25, s27
    s_cselect_b32 s25, s40, s25
    v_cvt_pk_bf16_f32 v216, v20, v21
    s_waitcnt lgkmcnt(3)
    v_mfma_f32_16x16x32_bf16 v[176:179], v[40:43], v[136:139], v[176:179]
    v_exp_f32 v22, v194
    v_mfma_f32_16x16x32_bf16 v[180:183], v[40:43], v[152:155], v[180:183]
    ds_read_b128 v[40:43], v2 offset:6144
    s_waitcnt lgkmcnt(3)
    v_mfma_f32_16x16x32_bf16 v[176:179], v[44:47], v[140:143], v[176:179]
    v_exp_f32 v23, v195
    v_mfma_f32_16x16x32_bf16 v[180:183], v[44:47], v[156:159], v[180:183]
    ds_read_b128 v[44:47], v2 offset:7168
    v_cvt_pk_bf16_f32 v217, v22, v23
    s_waitcnt lgkmcnt(3)
    v_mfma_f32_16x16x32_bf16 v[184:187], v[32:35], v[128:131], v[160:163]
    v_exp_f32 v24, v200
    v_mfma_f32_16x16x32_bf16 v[188:191], v[32:35], v[144:147], v[164:167]
    s_add_u32 s32, s32, 16384
    s_and_b32 s32, s32, 0xffff
    v_add_u32 v3, s32, v6
    v_add_u32 v4, s32, v7
    ds_read_b128 v[32:35], v3 offset:0
    s_waitcnt lgkmcnt(3)
    v_mfma_f32_16x16x32_bf16 v[184:187], v[36:39], v[132:135], v[184:187]
    v_exp_f32 v25, v201
    v_mfma_f32_16x16x32_bf16 v[188:191], v[36:39], v[148:151], v[188:191]
    ds_read_b128 v[36:39], v3 offset:1024
    s_add_u32 m0, s30, s57
    s_add_u32 s30, s30, 16384
    buffer_load_dwordx4 v1, s[8:11], s26 offen sc1 lds
    v_cvt_pk_bf16_f32 v218, v24, v25
    v_or3_b32 v28, v216, v217, v218
    s_waitcnt lgkmcnt(3)
    v_mfma_f32_16x16x32_bf16 v[184:187], v[40:43], v[136:139], v[184:187]
    v_exp_f32 v26, v202
    v_mfma_f32_16x16x32_bf16 v[188:191], v[40:43], v[152:155], v[188:191]
    ds_read_b128 v[40:43], v3 offset:2048
    s_waitcnt lgkmcnt(3)
    v_mfma_f32_16x16x32_bf16 v[184:187], v[44:47], v[140:143], v[184:187]
    v_exp_f32 v27, v203
    v_mfma_f32_16x16x32_bf16 v[188:191], v[44:47], v[156:159], v[188:191]
    ds_read_b128 v[44:47], v3 offset:3072
    v_cvt_pk_bf16_f32 v219, v26, v27
    v_mfma_f32_16x16x32_bf16 v[168:171], v[12:15], v[208:211], 0
    v_exp_f32 v20, v196
    v_mfma_f32_16x16x32_bf16 v[172:175], v[12:15], v[212:215], 0
    s_waitcnt lgkmcnt(3)
    v_mfma_f32_16x16x32_bf16 v[64:67], v[32:35], v[208:211], 0
    v_exp_f32 v21, v197
    v_mfma_f32_16x16x32_bf16 v[68:71], v[32:35], v[212:215], 0
    ds_read_b128 v[32:35], v4 offset:4096
    v_cvt_pk_bf16_f32 v220, v20, v21
    v_or3_b32 v28, v28, v219, v220
    s_waitcnt lgkmcnt(3)
    v_mfma_f32_16x16x32_bf16 v[72:75], v[36:39], v[208:211], 0
    v_exp_f32 v22, v198
    v_mfma_f32_16x16x32_bf16 v[76:79], v[36:39], v[212:215], 0
    ds_read_b128 v[36:39], v4 offset:5120
    buffer_load_dwordx4 v1, s[8:11], s26 offen offset:1024 sc1 lds
    s_and_b32 s30, s30, 0xffff
    s_add_u32 s26, s26, 16384
    s_cmp_eq_u32 s26, s28
    s_cselect_b32 s26, s40, s26
    s_waitcnt lgkmcnt(3)
    v_mfma_f32_16x16x32_bf16 v[80:83], v[40:43], v[208:211], 0
    v_exp_f32 v23, v199
    v_mfma_f32_16x16x32_bf16 v[84:87], v[40:43], v[212:215], 0
    ds_read_b128 v[40:43], v4 offset:6144
    s_add_u32 m0, s93, 0
    s_add_u32 s45, s90, 0
    buffer_load_dwordx4 v48, s[84:87], s45 offen lds
    v_cvt_pk_bf16_f32 v221, v22, v23
    s_waitcnt lgkmcnt(3)
    v_mfma_f32_16x16x32_bf16 v[88:91], v[44:47], v[208:211], 0
    v_exp_f32 v24, v204
    v_mfma_f32_16x16x32_bf16 v[92:95], v[44:47], v[212:215], 0
    ds_read_b128 v[44:47], v4 offset:7168
    s_waitcnt vmcnt(5)
    s_barrier
    s_waitcnt lgkmcnt(3)
    v_mfma_f32_16x16x32_bf16 v[96:99], v[32:35], v[208:211], 0
    v_exp_f32 v25, v205
    v_mfma_f32_16x16x32_bf16 v[100:103], v[32:35], v[212:215], 0
    s_add_u32 s31, s31, 16384
    s_cmp_eq_u32 s31, 49152
    s_cselect_b32 s31, 0, s31
    v_add_u32 v2, s31, v5
    ds_read_b128 v[32:35], v2 offset:0
    s_mov_b32 m0, s29
    s_add_u32 s29, s29, 16384
    buffer_load_dwordx4 v1, s[4:7], s25 offen sc1 lds
    v_cvt_pk_bf16_f32 v222, v24, v25
    v_or3_b32 v28, v28, v221, v222
    s_waitcnt lgkmcnt(3)
    v_mfma_f32_16x16x32_bf16 v[104:107], v[36:39], v[208:211], 0
    v_exp_f32 v26, v206
    v_mfma_f32_16x16x32_bf16 v[108:111], v[36:39], v[212:215], 0
    ds_read_b128 v[36:39], v2 offset:1024
    s_waitcnt lgkmcnt(3)
    v_mfma_f32_16x16x32_bf16 v[112:115], v[40:43], v[208:211], 0
    v_exp_f32 v27, v207
    v_mfma_f32_16x16x32_bf16 v[116:119], v[40:43], v[212:215], 0
    ds_read_b128 v[40:43], v2 offset:2048
    v_cvt_pk_bf16_f32 v223, v26, v27
    v_or_b32 v28, v28, v223
    s_waitcnt lgkmcnt(3)
    v_mfma_f32_16x16x32_bf16 v[120:123], v[44:47], v[208:211], 0
    v_and_b32 v28, s37, v28
    v_mfma_f32_16x16x32_bf16 v[124:127], v[44:47], v[212:215], 0
    ds_read_b128 v[44:47], v2 offset:3072
    v_cmp_ne_u32 vcc, 0, v28
    s_sub_u32 s34, s34, 64
    s_cbranch_vccnz L_rare_17
L_rareback_18:
    s_waitcnt lgkmcnt(3)
    v_mfma_f32_16x16x32_bf16 v[192:195], v[32:35], v[128:131], v[160:163]
    v_exp_f32 v20, v176
    v_mfma_f32_16x16x32_bf16 v[196:199], v[32:35], v[144:147], v[164:167]
    ds_read_b128 v[32:35], v2 offset:4096
    s_waitcnt lgkmcnt(3)
    v_mfma_f32_16x16x32_bf16 v[192:195], v[36:39], v[132:135], v[192:195]
    v_exp_f32 v21, v177
    v_mfma_f32_16x16x32_bf16 v[196:199], v[36:39], v[148:151], v[196:199]
    ds_read_b128 v[36:39], v2 offset:5120
    buffer_load_dwordx4 v1, s[4:7], s25 offen offset:1024 sc1 lds
    s_cmp_eq_u32 s29, s41
    s_cselect_b32 s29, s56, s29
    s_add_u32 s25, s25, 16384
    s_cmp_eq_u32 s25, s27
    s_cselect_b32 s25, s40, s25
    v_cvt_pk_bf16_f32 v208, v20, v21
    s_waitcnt lgkmcnt(3)
    v_mfma_f32_16x16x32_bf16 v[192:195], v[40:43], v[136:139], v[192:195]
    v_exp_f32 v22, v178
    v_mfma_f32_16x16x32_bf16 v[196:199], v[40:43], v[152:155], v[196:199]
    ds_read_b128 v[40:43], v2 offset:6144
    s_waitcnt lgkmcnt(3)
    v_mfma_f32_16x16x32_bf16 v[192:195], v[44:47], v[140:143], v[192:195]
    v_exp_f32 v23, v179
    v_mfma_f32_16x16x32_bf16 v[196:199], v[44:47], v[156:159], v[196:199]
    ds_read_b128 v[44:47], v2 offset:7168
    v_cvt_pk_bf16_f32 v209, v22, v23
    s_waitcnt lgkmcnt(3)
    v_mfma_f32_16x16x32_bf16 v[200:203], v[32:35], v[128:131], v[160:163]
    v_exp_f32 v24, v184
    v_mfma_f32_16x16x32_bf16 v[204:207], v[32:35], v[144:147], v[164:167]
    s_add_u32 s32, s32, 16384
    s_and_b32 s32, s32, 0xffff
    v_add_u32 v3, s32, v6
    v_add_u32 v4, s32, v7
    ds_read_b128 v[32:35], v3 offset:0
    s_waitcnt lgkmcnt(3)
    v_mfma_f32_16x16x32_bf16 v[200:203], v[36:39], v[132:135], v[200:203]
    v_exp_f32 v25, v185
    v_mfma_f32_16x16x32_bf16 v[204:207], v[36:39], v[148:151], v[204:207]
    ds_read_b128 v[36:39], v3 offset:1024
    s_add_u32 m0, s30, s57
    s_add_u32 s30, s30, 16384
    buffer_load_dwordx4 v1, s[8:11], s26 offen sc1 lds
    v_cvt_pk_bf16_f32 v210, v24, v25
    v_or3_b32 v28, v208, v209, v210
    s_waitcnt lgkmcnt(3)
    v_mfma_f32_16x16x32_bf16 v[200:203], v[40:43], v[136:139], v[200:203]
    v_exp_f32 v26, v186
    v_mfma_f32_16x16x32_bf16 v[204:207], v[40:43], v[152:155], v[204:207]
    ds_read_b128 v[40:43], v3 offset:2048
    s_waitcnt lgkmcnt(3)
    v_mfma_f32_16x16x32_bf16 v[200:203], v[44:47], v[140:143], v[200:203]
    v_exp_f32 v27, v187
    v_mfma_f32_16x16x32_bf16 v[204:207], v[44:47], v[156:159], v[204:207]
    ds_read_b128 v[44:47], v3 offset:3072
    v_cvt_pk_bf16_f32 v211, v26, v27
    v_mfma_f32_16x16x32_bf16 v[168:171], v[12:15], v[216:219], v[168:171]
    v_exp_f32 v20, v180
    v_mfma_f32_16x16x32_bf16 v[172:175], v[12:15], v[220:223], v[172:175]
    s_waitcnt lgkmcnt(3)
    v_mfma_f32_16x16x32_bf16 v[64:67], v[32:35], v[216:219], v[64:67]
    v_exp_f32 v21, v181
    v_mfma_f32_16x16x32_bf16 v[68:71], v[32:35], v[220:223], v[68:71]
    ds_read_b128 v[32:35], v4 offset:4096
    v_cvt_pk_bf16_f32 v212, v20, v21
    v_or3_b32 v28, v28, v211, v212
    s_waitcnt lgkmcnt(3)
    v_mfma_f32_16x16x32_bf16 v[72:75], v[36:39], v[216:219], v[72:75]
    v_exp_f32 v22, v182
    v_mfma_f32_16x16x32_bf16 v[76:79], v[36:39], v[220:223], v[76:79]
    ds_read_b128 v[36:39], v4 offset:5120
    buffer_load_dwordx4 v1, s[8:11], s26 offen offset:1024 sc1 lds
    s_and_b32 s30, s30, 0xffff
    s_add_u32 s26, s26, 16384
    s_cmp_eq_u32 s26, s28
    s_cselect_b32 s26, s40, s26
    s_waitcnt lgkmcnt(3)
    v_mfma_f32_16x16x32_bf16 v[80:83], v[40:43], v[216:219], v[80:83]
    v_exp_f32 v23, v183
    v_mfma_f32_16x16x32_bf16 v[84:87], v[40:43], v[220:223], v[84:87]
    ds_read_b128 v[40:43], v4 offset:6144
    v_cvt_pk_bf16_f32 v213, v22, v23
    s_waitcnt lgkmcnt(3)
    v_mfma_f32_16x16x32_bf16 v[88:91], v[44:47], v[216:219], v[88:91]
    v_exp_f32 v24, v188
    v_mfma_f32_16x16x32_bf16 v[92:95], v[44:47], v[220:223], v[92:95]
    ds_read_b128 v[44:47], v4 offset:7168
    s_waitcnt vmcnt(5)
    s_barrier
    s_waitcnt lgkmcnt(3)
    v_mfma_f32_16x16x32_bf16 v[96:99], v[32:35], v[216:219], v[96:99]
    v_exp_f32 v25, v189
    v_mfma_f32_16x16x32_bf16 v[100:103], v[32:35], v[220:223], v[100:103]
    s_add_u32 s31, s31, 16384
    s_cmp_eq_u32 s31, 49152
    s_cselect_b32 s31, 0, s31
    v_add_u32 v2, s31, v5
    ds_read_b128 v[32:35], v2 offset:0
    s_mov_b32 m0, s29
    s_add_u32 s29, s29, 16384
    buffer_load_dwordx4 v1, s[4:7], s25 offen sc1 lds
    v_cvt_pk_bf16_f32 v214, v24, v25
    v_or3_b32 v28, v28, v213, v214
    s_waitcnt lgkmcnt(3)
    v_mfma_f32_16x16x32_bf16 v[104:107], v[36:39], v[216:219], v[104:107]
    v_exp_f32 v26, v190
    v_mfma_f32_16x16x32_bf16 v[108:111], v[36:39], v[220:223], v[108:111]
    ds_read_b128 v[36:39], v2 offset:1024
    s_waitcnt lgkmcnt(3)
    v_mfma_f32_16x16x32_bf16 v[112:115], v[40:43], v[216:219], v[112:115]
    v_exp_f32 v27, v191
    v_mfma_f32_16x16x32_bf16 v[116:119], v[40:43], v[220:223], v[116:119]
    ds_read_b128 v[40:43], v2 offset:2048
    v_cvt_pk_bf16_f32 v215, v26, v27
    v_or_b32 v28, v28, v215
    s_waitcnt lgkmcnt(3)
    v_mfma_f32_16x16x32_bf16 v[120:123], v[44:47], v[216:219], v[120:123]
    v_and_b32 v28, s37, v28
    v_mfma_f32_16x16x32_bf16 v[124:127], v[44:47], v[220:223], v[124:127]
    ds_read_b128 v[44:47], v2 offset:3072
    v_cmp_ne_u32 vcc, 0, v28
    s_sub_u32 s34, s34, 64
    s_cbranch_vccnz L_rare_19
L_rareback_20:
    s_waitcnt lgkmcnt(3)
    v_mfma_f32_16x16x32_bf16 v[176:179], v[32:35], v[128:131], v[160:163]
    v_exp_f32 v20, v192
    v_mfma_f32_16x16x32_bf16 v[180:183], v[32:35], v[144:147], v[164:167]
    ds_read_b128 v[32:35], v2 offset:4096
    s_waitcnt lgkmcnt(3)
    v_mfma_f32_16x16x32_bf16 v[176:179], v[36:39], v[132:135], v[176:179]
    v_exp_f32 v21, v193
    v_mfma_f32_16x16x32_bf16 v[180:183], v[36:39], v[148:151], v[180:183]
    ds_read_b128 v[36:39], v2 offset:5120
    buffer_load_dwordx4 v1, s[4:7], s25 offen offset:1024 sc1 lds
    s_cmp_eq_u32 s29, s41
    s_cselect_b32 s29, s56, s29
    s_add_u32 s25, s25, 16384
    s_cmp_eq_u32 s25, s27
    s_cselect_b32 s25, s40, s25
    v_cvt_pk_bf16_f32 v216, v20, v21
    s_waitcnt lgkmcnt(3)
    v_mfma_f32_16x16x32_bf16 v[176:179], v[40:43], v[136:139], v[176:179]
    v_exp_f32 v22, v194
    v_mfma_f32_16x16x32_bf16 v[180:183], v[40:43], v[152:155], v[180:183]
    ds_read_b128 v[40:43], v2 offset:6144
    s_waitcnt lgkmcnt(3)
    v_mfma_f32_16x16x32_bf16 v[176:179], v[44:47], v[140:143], v[176:179]
    v_exp_f32 v23, v195
    v_mfma_f32_16x16x32_bf16 v[180:183], v[44:47], v[156:159], v[180:183]
    ds_read_b128 v[44:47], v2 offset:7168
    v_cvt_pk_bf16_f32 v217, v22, v23
    s_waitcnt lgkmcnt(3)
    v_mfma_f32_16x16x32_bf16 v[184:187], v[32:35], v[128:131], v[160:163]
    v_exp_f32 v24, v200
    v_mfma_f32_16x16x32_bf16 v[188:191], v[32:35], v[144:147], v[164:167]
    s_add_u32 s32, s32, 16384
    s_and_b32 s32, s32, 0xffff
    v_add_u32 v3, s32, v6
    v_add_u32 v4, s32, v7
    ds_read_b128 v[32:35], v3 offset:0
    s_waitcnt lgkmcnt(3)
    v_mfma_f32_16x16x32_bf16 v[184:187], v[36:39], v[132:135], v[184:187]
    v_exp_f32 v25, v201
    v_mfma_f32_16x16x32_bf16 v[188:191], v[36:39], v[148:151], v[188:191]
    ds_read_b128 v[36:39], v3 offset:1024
    s_add_u32 m0, s30, s57
    s_add_u32 s30, s30, 16384
    buffer_load_dwordx4 v1, s[8:11], s26 offen sc1 lds
    v_cvt_pk_bf16_f32 v218, v24, v25
    v_or3_b32 v28, v216, v217, v218
    s_waitcnt lgkmcnt(3)
    v_mfma_f32_16x16x32_bf16 v[184:187], v[40:43], v[136:139], v[184:187]
    v_exp_f32 v26, v202
    v_mfma_f32_16x16x32_bf16 v[188:191], v[40:43], v[152:155], v[188:191]
    ds_read_b128 v[40:43], v3 offset:2048
    s_waitcnt lgkmcnt(3)
    v_mfma_f32_16x16x32_bf16 v[184:187], v[44:47], v[140:143], v[184:187]
    v_exp_f32 v27, v203
    v_mfma_f32_16x16x32_bf16 v[188:191], v[44:47], v[156:159], v[188:191]
    ds_read_b128 v[44:47], v3 offset:3072
    v_cvt_pk_bf16_f32 v219, v26, v27
    v_mfma_f32_16x16x32_bf16 v[168:171], v[12:15], v[208:211], v[168:171]
    v_exp_f32 v20, v196
    v_mfma_f32_16x16x32_bf16 v[172:175], v[12:15], v[212:215], v[172:175]
    s_waitcnt lgkmcnt(3)
    v_mfma_f32_16x16x32_bf16 v[64:67], v[32:35], v[208:211], v[64:67]
    v_exp_f32 v21, v197
    v_mfma_f32_16x16x32_bf16 v[68:71], v[32:35], v[212:215], v[68:71]
    ds_read_b128 v[32:35], v4 offset:4096
    v_cvt_pk_bf16_f32 v220, v20, v21
    v_or3_b32 v28, v28, v219, v220
    s_waitcnt lgkmcnt(3)
    v_mfma_f32_16x16x32_bf16 v[72:75], v[36:39], v[208:211], v[72:75]
    v_exp_f32 v22, v198
    v_mfma_f32_16x16x32_bf16 v[76:79], v[36:39], v[212:215], v[76:79]
    ds_read_b128 v[36:39], v4 offset:5120
    buffer_load_dwordx4 v1, s[8:11], s26 offen offset:1024 sc1 lds
    s_and_b32 s30, s30, 0xffff
    s_add_u32 s26, s26, 16384
    s_cmp_eq_u32 s26, s28
    s_cselect_b32 s26, s40, s26
    s_waitcnt lgkmcnt(3)
    v_mfma_f32_16x16x32_bf16 v[80:83], v[40:43], v[208:211], v[80:83]
    v_exp_f32 v23, v199
    v_mfma_f32_16x16x32_bf16 v[84:87], v[40:43], v[212:215], v[84:87]
    ds_read_b128 v[40:43], v4 offset:6144
    s_add_u32 m0, s93, 1024
    s_add_u32 s45, s90, 10240
    buffer_load_dwordx4 v48, s[84:87], s45 offen lds
    v_cvt_pk_bf16_f32 v221, v22, v23
    s_waitcnt lgkmcnt(3)
    v_mfma_f32_16x16x32_bf16 v[88:91], v[44:47], v[208:211], v[88:91]
    v_exp_f32 v24, v204
    v_mfma_f32_16x16x32_bf16 v[92:95], v[44:47], v[212:215], v[92:95]
    ds_read_b128 v[44:47], v4 offset:7168
    s_waitcnt vmcnt(5)
    s_barrier
    s_waitcnt lgkmcnt(3)
    v_mfma_f32_16x16x32_bf16 v[96:99], v[32:35], v[208:211], v[96:99]
    v_exp_f32 v25, v205
    v_mfma_f32_16x16x32_bf16 v[100:103], v[32:35], v[212:215], v[100:103]
    s_add_u32 s31, s31, 16384
    s_cmp_eq_u32 s31, 49152
    s_cselect_b32 s31, 0, s31
    v_add_u32 v2, s31, v5
    ds_read_b128 v[32:35], v2 offset:0
    s_mov_b32 m0, s29
    s_add_u32 s29, s29, 16384
    buffer_load_dwordx4 v1, s[4:7], s25 offen sc1 lds
    v_cvt_pk_bf16_f32 v222, v24, v25
    v_or3_b32 v28, v28, v221, v222
    s_waitcnt lgkmcnt(3)
    v_mfma_f32_16x16x32_bf16 v[104:107], v[36:39], v[208:211], v[104:107]
    v_exp_f32 v26, v206
    v_mfma_f32_16x16x32_bf16 v[108:111], v[36:39], v[212:215], v[108:111]
    ds_read_b128 v[36:39], v2 offset:1024
    s_waitcnt lgkmcnt(3)
    v_mfma_f32_16x16x32_bf16 v[112:115], v[40:43], v[208:211], v[112:115]
    v_exp_f32 v27, v207
    v_mfma_f32_16x16x32_bf16 v[116:119], v[40:43], v[212:215], v[116:119]
    ds_read_b128 v[40:43], v2 offset:2048
    v_cvt_pk_bf16_f32 v223, v26, v27
    v_or_b32 v28, v28, v223
    s_waitcnt lgkmcnt(3)
    v_mfma_f32_16x16x32_bf16 v[120:123], v[44:47], v[208:211], v[120:123]
    v_and_b32 v28, s37, v28
    v_mfma_f32_16x16x32_bf16 v[124:127], v[44:47], v[212:215], v[124:127]
    ds_read_b128 v[44:47], v2 offset:3072
    v_cmp_ne_u32 vcc, 0, v28
    s_sub_u32 s34, s34, 64
    s_cbranch_vccnz L_rare_21
L_rareback_22:
    s_waitcnt lgkmcnt(3)
    v_mfma_f32_16x16x32_bf16 v[192:195], v[32:35], v[128:131], v[160:163]
    v_exp_f32 v20, v176
    v_mfma_f32_16x16x32_bf16 v[196:199], v[32:35], v[144:147], v[164:167]
    ds_read_b128 v[32:35], v2 offset:4096
    s_waitcnt lgkmcnt(3)
    v_mfma_f32_16x16x32_bf16 v[192:195], v[36:39], v[132:135], v[192:195]
    v_exp_f32 v21, v177
    v_mfma_f32_16x16x32_bf16 v[196:199], v[36:39], v[148:151], v[196:199]
    ds_read_b128 v[36:39], v2 offset:5120
    buffer_load_dwordx4 v1, s[4:7], s25 offen offset:1024 sc1 lds
    s_cmp_eq_u32 s29, s41
    s_cselect_b32 s29, s56, s29
    s_add_u32 s25, s25, 16384
    s_cmp_eq_u32 s25, s27
    s_cselect_b32 s25, s40, s25
    v_cvt_pk_bf16_f32 v208, v20, v21
    s_waitcnt lgkmcnt(3)
    v_mfma_f32_16x16x32_bf16 v[192:195], v[40:43], v[136:139], v[192:195]
    v_exp_f32 v22, v178
    v_mfma_f32_16x16x32_bf16 v[196:199], v[40:43], v[152:155], v[196:199]
    ds_read_b128 v[40:43], v2 offset:6144
    s_waitcnt lgkmcnt(3)
    v_mfma_f32_16x16x32_bf16 v[192:195], v[44:47], v[140:143], v[192:195]
    v_exp_f32 v23, v179
    v_mfma_f32_16x16x32_bf16 v[196:199], v[44:47], v[156:159], v[196:199]
    ds_read_b128 v[44:47], v2 offset:7168
    v_cvt_pk_bf16_f32 v209, v22, v23
    s_waitcnt lgkmcnt(3)
    v_mfma_f32_16x16x32_bf16 v[200:203], v[32:35], v[128:131], v[160:163]
    v_exp_f32 v24, v184
    v_mfma_f32_16x16x32_bf16 v[204:207], v[32:35], v[144:147], v[164:167]
    s_add_u32 s32, s32, 16384
    s_and_b32 s32, s32, 0xffff
    v_add_u32 v3, s32, v6
    v_add_u32 v4, s32, v7
    ds_read_b128 v[32:35], v3 offset:0
    s_waitcnt lgkmcnt(3)
    v_mfma_f32_16x16x32_bf16 v[200:203], v[36:39], v[132:135], v[200:203]
    v_exp_f32 v25, v185
    v_mfma_f32_16x16x32_bf16 v[204:207], v[36:39], v[148:151], v[204:207]
    ds_read_b128 v[36:39], v3 offset:1024
    s_add_u32 m0, s30, s57
    s_add_u32 s30, s30, 16384
    buffer_load_dwordx4 v1, s[8:11], s26 offen sc1 lds
    v_cvt_pk_bf16_f32 v210, v24, v25
    v_or3_b32 v28, v208, v209, v210
    s_waitcnt lgkmcnt(3)
    v_mfma_f32_16x16x32_bf16 v[200:203], v[40:43], v[136:139], v[200:203]
    v_exp_f32 v26, v186
    v_mfma_f32_16x16x32_bf16 v[204:207], v[40:43], v[152:155], v[204:207]
    ds_read_b128 v[40:43], v3 offset:2048
    s_waitcnt lgkmcnt(3)
    v_mfma_f32_16x16x32_bf16 v[200:203], v[44:47], v[140:143], v[200:203]
    v_exp_f32 v27, v187
    v_mfma_f32_16x16x32_bf16 v[204:207], v[44:47], v[156:159], v[204:207]
    ds_read_b128 v[44:47], v3 offset:3072
    v_cvt_pk_bf16_f32 v211, v26, v27
    v_mfma_f32_16x16x32_bf16 v[168:171], v[12:15], v[216:219], v[168:171]
    v_exp_f32 v20, v180
    v_mfma_f32_16x16x32_bf16 v[172:175], v[12:15], v[220:223], v[172:175]
    s_waitcnt lgkmcnt(3)
    v_mfma_f32_16x16x32_bf16 v[64:67], v[32:35], v[216:219], v[64:67]
    v_exp_f32 v21, v181
    v_mfma_f32_16x16x32_bf16 v[68:71], v[32:35], v[220:223], v[68:71]
    ds_read_b128 v[32:35], v4 offset:4096
    v_cvt_pk_bf16_f32 v212, v20, v21
    v_or3_b32 v28, v28, v211, v212
    s_waitcnt lgkmcnt(3)
    v_mfma_f32_16x16x32_bf16 v[72:75], v[36:39], v[216:219], v[72:75]
    v_exp_f32 v22, v182
    v_mfma_f32_16x16x32_bf16 v[76:79], v[36:39], v[220:223], v[76:79]
    ds_read_b128 v[36:39], v4 offset:5120
    buffer_load_dwordx4 v1, s[8:11], s26 offen offset:1024 sc1 lds
    s_and_b32 s30, s30, 0xffff
    s_add_u32 s26, s26, 16384
    s_cmp_eq_u32 s26, s28
    s_cselect_b32 s26, s40, s26
    s_waitcnt lgkmcnt(3)
    v_mfma_f32_16x16x32_bf16 v[80:83], v[40:43], v[216:219], v[80:83]
    v_exp_f32 v23, v183
    v_mfma_f32_16x16x32_bf16 v[84:87], v[40:43], v[220:223], v[84:87]
    ds_read_b128 v[40:43], v4 offset:6144
    v_cvt_pk_bf16_f32 v213, v22, v23
    s_waitcnt lgkmcnt(3)
    v_mfma_f32_16x16x32_bf16 v[88:91], v[44:47], v[216:219], v[88:91]
    v_exp_f32 v24, v188
    v_mfma_f32_16x16x32_bf16 v[92:95], v[44:47], v[220:223], v[92:95]
    ds_read_b128 v[44:47], v4 offset:7168
    s_waitcnt vmcnt(5)
    s_barrier
    s_waitcnt lgkmcnt(3)
    v_mfma_f32_16x16x32_bf16 v[96:99], v[32:35], v[216:219], v[96:99]
    v_exp_f32 v25, v189
    v_mfma_f32_16x16x32_bf16 v[100:103], v[32:35], v[220:223], v[100:103]
    s_add_u32 s31, s31, 16384
    s_cmp_eq_u32 s31, 49152
    s_cselect_b32 s31, 0, s31
    v_add_u32 v2, s31, v5
    ds_read_b128 v[32:35], v2 offset:0
    s_mov_b32 m0, s29
    s_add_u32 s29, s29, 16384
    buffer_load_dwordx4 v1, s[4:7], s25 offen sc1 lds
    v_cvt_pk_bf16_f32 v214, v24, v25
    v_or3_b32 v28, v28, v213, v214
    s_waitcnt lgkmcnt(3)
    v_mfma_f32_16x16x32_bf16 v[104:107], v[36:39], v[216:219], v[104:107]
    v_exp_f32 v26, v190
    v_mfma_f32_16x16x32_bf16 v[108:111], v[36:39], v[220:223], v[108:111]
    ds_read_b128 v[36:39], v2 offset:1024
    s_waitcnt lgkmcnt(3)
    v_mfma_f32_16x16x32_bf16 v[112:115], v[40:43], v[216:219], v[112:115]
    v_exp_f32 v27, v191
    v_mfma_f32_16x16x32_bf16 v[116:119], v[40:43], v[220:223], v[116:119]
    ds_read_b128 v[40:43], v2 offset:2048
    v_cvt_pk_bf16_f32 v215, v26, v27
    v_or_b32 v28, v28, v215
    s_waitcnt lgkmcnt(3)
    v_mfma_f32_16x16x32_bf16 v[120:123], v[44:47], v[216:219], v[120:123]
    v_and_b32 v28, s37, v28
    v_mfma_f32_16x16x32_bf16 v[124:127], v[44:47], v[220:223], v[124:127]
    ds_read_b128 v[44:47], v2 offset:3072
    v_cmp_ne_u32 vcc, 0, v28
    s_sub_u32 s34, s34, 64
    s_cbranch_vccnz L_rare_23
L_rareback_24:
    s_waitcnt lgkmcnt(3)
    v_mfma_f32_16x16x32_bf16 v[176:179], v[32:35], v[128:131], v[160:163]
    v_exp_f32 v20, v192
    v_mfma_f32_16x16x32_bf16 v[180:183], v[32:35], v[144:147], v[164:167]
    ds_read_b128 v[32:35], v2 offset:4096
    s_waitcnt lgkmcnt(3)
    v_mfma_f32_16x16x32_bf16 v[176:179], v[36:39], v[132:135], v[176:179]
    v_exp_f32 v21, v193
    v_mfma_f32_16x16x32_bf16 v[180:183], v[36:39], v[148:151], v[180:183]
    ds_read_b128 v[36:39], v2 offset:5120
    buffer_load_dwordx4 v1, s[4:7], s25 offen offset:1024 sc1 lds
    s_cmp_eq_u32 s29, s41
    s_cselect_b32 s29, s56, s29
    s_add_u32 s25, s25, 16384
    s_cmp_eq_u32 s25, s27
    s_cselect_b32 s25, s40, s25
    v_cvt_pk_bf16_f32 v216, v20, v21
    s_waitcnt lgkmcnt(3)
    v_mfma_f32_16x16x32_bf16 v[176:179], v[40:43], v[136:139], v[176:179]
    v_exp_f32 v22, v194
    v_mfma_f32_16x16x32_bf16 v[180:183], v[40:43], v[152:155], v[180:183]
    ds_read_b128 v[40:43], v2 offset:6144
    s_waitcnt lgkmcnt(3)
    v_mfma_f32_16x16x32_bf16 v[176:179], v[44:47], v[140:143], v[176:179]
    v_exp_f32 v23, v195
    v_mfma_f32_16x16x32_bf16 v[180:183], v[44:47], v[156:159], v[180:183]
    ds_read_b128 v[44:47], v2 offset:7168
    v_cvt_pk_bf16_f32 v217, v22, v23
    s_waitcnt lgkmcnt(3)
    v_mfma_f32_16x16x32_bf16 v[184:187], v[32:35], v[128:131], v[160:163]
    v_exp_f32 v24, v200
    v_mfma_f32_16x16x32_bf16 v[188:191], v[32:35], v[144:147], v[164:167]
    s_add_u32 s32, s32, 16384
    s_and_b32 s32, s32, 0xffff
    v_add_u32 v3, s32, v6
    v_add_u32 v4, s32, v7
    ds_read_b128 v[32:35], v3 offset:0
    s_waitcnt lgkmcnt(3)
    v_mfma_f32_16x16x32_bf16 v[184:187], v[36:39], v[132:135], v[184:187]
    v_exp_f32 v25, v201
    v_mfma_f32_16x16x32_bf16 v[188:191], v[36:39], v[148:151], v[188:191]
    ds_read_b128 v[36:39], v3 offset:1024
    s_add_u32 m0, s30, s57
    s_add_u32 s30, s30, 16384
    buffer_load_dwordx4 v1, s[8:11], s26 offen sc1 lds
    v_cvt_pk_bf16_f32 v218, v24, v25
    v_or3_b32 v28, v216, v217, v218
    s_waitcnt lgkmcnt(3)
    v_mfma_f32_16x16x32_bf16 v[184:187], v[40:43], v[136:139], v[184:187]
    v_exp_f32 v26, v202
    v_mfma_f32_16x16x32_bf16 v[188:191], v[40:43], v[152:155], v[188:191]
    ds_read_b128 v[40:43], v3 offset:2048
    s_waitcnt lgkmcnt(3)
    v_mfma_f32_16x16x32_bf16 v[184:187], v[44:47], v[140:143], v[184:187]
    v_exp_f32 v27, v203
    v_mfma_f32_16x16x32_bf16 v[188:191], v[44:47], v[156:159], v[188:191]
    ds_read_b128 v[44:47], v3 offset:3072
    v_cvt_pk_bf16_f32 v219, v26, v27
    v_mfma_f32_16x16x32_bf16 v[168:171], v[12:15], v[208:211], v[168:171]
    v_exp_f32 v20, v196
    v_mfma_f32_16x16x32_bf16 v[172:175], v[12:15], v[212:215], v[172:175]
    s_waitcnt lgkmcnt(3)
    v_mfma_f32_16x16x32_bf16 v[64:67], v[32:35], v[208:211], v[64:67]
    v_exp_f32 v21, v197
    v_mfma_f32_16x16x32_bf16 v[68:71], v[32:35], v[212:215], v[68:71]
    ds_read_b128 v[32:35], v4 offset:4096
    v_cvt_pk_bf16_f32 v220, v20, v21
    v_or3_b32 v28, v28, v219, v220
    s_waitcnt lgkmcnt(3)
    v_mfma_f32_16x16x32_bf16 v[72:75], v[36:39], v[208:211], v[72:75]
    v_exp_f32 v22, v198
    v_mfma_f32_16x16x32_bf16 v[76:79], v[36:39], v[212:215], v[76:79]
    ds_read_b128 v[36:39], v4 offset:5120
    buffer_load_dwordx4 v1, s[8:11], s26 offen offset:1024 sc1 lds
    s_and_b32 s30, s30, 0xffff
    s_add_u32 s26, s26, 16384
    s_cmp_eq_u32 s26, s28
    s_cselect_b32 s26, s40, s26
    s_waitcnt lgkmcnt(3)
    v_mfma_f32_16x16x32_bf16 v[80:83], v[40:43], v[208:211], v[80:83]
    v_exp_f32 v23, v199
    v_mfma_f32_16x16x32_bf16 v[84:87], v[40:43], v[212:215], v[84:87]
    ds_read_b128 v[40:43], v4 offset:6144
    s_add_u32 m0, s93, 2048
    s_add_u32 s45, s90, 20480
    buffer_load_dwordx4 v48, s[84:87], s45 offen lds
    v_cvt_pk_bf16_f32 v221, v22, v23
    s_waitcnt lgkmcnt(3)
    v_mfma_f32_16x16x32_bf16 v[88:91], v[44:47], v[208:211], v[88:91]
    v_exp_f32 v24, v204
    v_mfma_f32_16x16x32_bf16 v[92:95], v[44:47], v[212:215], v[92:95]
    ds_read_b128 v[44:47], v4 offset:7168
    s_waitcnt vmcnt(5)
    s_barrier
    s_waitcnt lgkmcnt(3)
    v_mfma_f32_16x16x32_bf16 v[96:99], v[32:35], v[208:211], v[96:99]
    v_exp_f32 v25, v205
    v_mfma_f32_16x16x32_bf16 v[100:103], v[32:35], v[212:215], v[100:103]
    s_add_u32 s31, s31, 16384
    s_cmp_eq_u32 s31, 49152
    s_cselect_b32 s31, 0, s31
    v_add_u32 v2, s31, v5
    ds_read_b128 v[32:35], v2 offset:0
    s_mov_b32 m0, s29
    s_add_u32 s29, s29, 16384
    buffer_load_dwordx4 v1, s[4:7], s25 offen sc1 lds
    v_cvt_pk_bf16_f32 v222, v24, v25
    v_or3_b32 v28, v28, v221, v222
    s_waitcnt lgkmcnt(3)
    v_mfma_f32_16x16x32_bf16 v[104:107], v[36:39], v[208:211], v[104:107]
    v_exp_f32 v26, v206
    v_mfma_f32_16x16x32_bf16 v[108:111], v[36:39], v[212:215], v[108:111]
    ds_read_b128 v[36:39], v2 offset:1024
    s_waitcnt lgkmcnt(3)
    v_mfma_f32_16x16x32_bf16 v[112:115], v[40:43], v[208:211], v[112:115]
    v_exp_f32 v27, v207
    v_mfma_f32_16x16x32_bf16 v[116:119], v[40:43], v[212:215], v[116:119]
    ds_read_b128 v[40:43], v2 offset:2048
    v_cvt_pk_bf16_f32 v223, v26, v27
    v_or_b32 v28, v28, v223
    s_waitcnt lgkmcnt(3)
    v_mfma_f32_16x16x32_bf16 v[120:123], v[44:47], v[208:211], v[120:123]
    v_and_b32 v28, s37, v28
    v_mfma_f32_16x16x32_bf16 v[124:127], v[44:47], v[212:215], v[124:127]
    ds_read_b128 v[44:47], v2 offset:3072
    v_cmp_ne_u32 vcc, 0, v28
    s_sub_u32 s34, s34, 64
    s_cbranch_vccnz L_rare_25
L_rareback_26:
    s_waitcnt lgkmcnt(3)
    v_mfma_f32_16x16x32_bf16 v[192:195], v[32:35], v[128:131], v[160:163]
    v_exp_f32 v20, v176
    v_mfma_f32_16x16x32_bf16 v[196:199], v[32:35], v[144:147], v[164:167]
    ds_read_b128 v[32:35], v2 offset:4096
    s_waitcnt lgkmcnt(3)
    v_mfma_f32_16x16x32_bf16 v[192:195], v[36:39], v[132:135], v[192:195]
    v_exp_f32 v21, v177
    v_mfma_f32_16x16x32_bf16 v[196:199], v[36:39], v[148:151], v[196:199]
    ds_read_b128 v[36:39], v2 offset:5120
    buffer_load_dwordx4 v1, s[4:7], s25 offen offset:1024 sc1 lds
    s_cmp_eq_u32 s29, s41
    s_cselect_b32 s29, s56, s29
    s_add_u32 s25, s25, 16384
    s_cmp_eq_u32 s25, s27
    s_cselect_b32 s25, s40, s25
    v_cvt_pk_bf16_f32 v208, v20, v21
    s_waitcnt lgkmcnt(3)
    v_mfma_f32_16x16x32_bf16 v[192:195], v[40:43], v[136:139], v[192:195]
    v_exp_f32 v22, v178
    v_mfma_f32_16x16x32_bf16 v[196:199], v[40:43], v[152:155], v[196:199]
    ds_read_b128 v[40:43], v2 offset:6144
    s_waitcnt lgkmcnt(3)
    v_mfma_f32_16x16x32_bf16 v[192:195], v[44:47], v[140:143], v[192:195]
    v_exp_f32 v23, v179
    v_mfma_f32_16x16x32_bf16 v[196:199], v[44:47], v[156:159], v[196:199]
    ds_read_b128 v[44:47], v2 offset:7168
    v_cvt_pk_bf16_f32 v209, v22, v23
    s_waitcnt lgkmcnt(3)
    v_mfma_f32_16x16x32_bf16 v[200:203], v[32:35], v[128:131], v[160:163]
    v_exp_f32 v24, v184
    v_mfma_f32_16x16x32_bf16 v[204:207], v[32:35], v[144:147], v[164:167]
    s_add_u32 s32, s32, 16384
    s_and_b32 s32, s32, 0xffff
    v_add_u32 v3, s32, v6
    v_add_u32 v4, s32, v7
    ds_read_b128 v[32:35], v3 offset:0
    s_waitcnt lgkmcnt(3)
    v_mfma_f32_16x16x32_bf16 v[200:203], v[36:39], v[132:135], v[200:203]
    v_exp_f32 v25, v185
    v_mfma_f32_16x16x32_bf16 v[204:207], v[36:39], v[148:151], v[204:207]
    ds_read_b128 v[36:39], v3 offset:1024
    s_add_u32 m0, s30, s57
    s_add_u32 s30, s30, 16384
    buffer_load_dwordx4 v1, s[8:11], s26 offen sc1 lds
    v_cvt_pk_bf16_f32 v210, v24, v25
    v_or3_b32 v28, v208, v209, v210
    s_waitcnt lgkmcnt(3)
    v_mfma_f32_16x16x32_bf16 v[200:203], v[40:43], v[136:139], v[200:203]
    v_exp_f32 v26, v186
    v_mfma_f32_16x16x32_bf16 v[204:207], v[40:43], v[152:155], v[204:207]
    ds_read_b128 v[40:43], v3 offset:2048
    s_waitcnt lgkmcnt(3)
    v_mfma_f32_16x16x32_bf16 v[200:203], v[44:47], v[140:143], v[200:203]
    v_exp_f32 v27, v187
    v_mfma_f32_16x16x32_bf16 v[204:207], v[44:47], v[156:159], v[204:207]
    ds_read_b128 v[44:47], v3 offset:3072
    v_cvt_pk_bf16_f32 v211, v26, v27
    v_mfma_f32_16x16x32_bf16 v[168:171], v[12:15], v[216:219], v[168:171]
    v_exp_f32 v20, v180
    v_mfma_f32_16x16x32_bf16 v[172:175], v[12:15], v[220:223], v[172:175]
    s_waitcnt lgkmcnt(3)
    v_mfma_f32_16x16x32_bf16 v[64:67], v[32:35], v[216:219], v[64:67]
    v_exp_f32 v21, v181
    v_mfma_f32_16x16x32_bf16 v[68:71], v[32:35], v[220:223], v[68:71]
    ds_read_b128 v[32:35], v4 offset:4096
    v_cvt_pk_bf16_f32 v212, v20, v21
    v_or3_b32 v28, v28, v211, v212
    s_waitcnt lgkmcnt(3)
    v_mfma_f32_16x16x32_bf16 v[72:75], v[36:39], v[216:219], v[72:75]
    v_exp_f32 v22, v182
    v_mfma_f32_16x16x32_bf16 v[76:79], v[36:39], v[220:223], v[76:79]
    ds_read_b128 v[36:39], v4 offset:5120
    buffer_load_dwordx4 v1, s[8:11], s26 offen offset:1024 sc1 lds
    s_and_b32 s30, s30, 0xffff
    s_add_u32 s26, s26, 16384
    s_cmp_eq_u32 s26, s28
    s_cselect_b32 s26, s40, s26
    s_waitcnt lgkmcnt(3)
    v_mfma_f32_16x16x32_bf16 v[80:83], v[40:43], v[216:219], v[80:83]
    v_exp_f32 v23, v183
    v_mfma_f32_16x16x32_bf16 v[84:87], v[40:43], v[220:223], v[84:87]
    ds_read_b128 v[40:43], v4 offset:6144
    s_add_u32 m0, s93, 3072
    s_add_u32 s45, s90, 30720
    buffer_load_dwordx4 v48, s[84:87], s45 offen lds
    v_cvt_pk_bf16_f32 v213, v22, v23
    s_waitcnt lgkmcnt(3)
    v_mfma_f32_16x16x32_bf16 v[88:91], v[44:47], v[216:219], v[88:91]
    v_exp_f32 v24, v188
    v_mfma_f32_16x16x32_bf16 v[92:95], v[44:47], v[220:223], v[92:95]
    ds_read_b128 v[44:47], v4 offset:7168
    s_waitcnt vmcnt(6)
    s_barrier
    s_waitcnt lgkmcnt(3)
    v_mfma_f32_16x16x32_bf16 v[96:99], v[32:35], v[216:219], v[96:99]
    v_exp_f32 v25, v189
    v_mfma_f32_16x16x32_bf16 v[100:103], v[32:35], v[220:223], v[100:103]
    s_add_u32 s31, s31, 16384
    s_cmp_eq_u32 s31, 49152
    s_cselect_b32 s31, 0, s31
    v_add_u32 v2, s31, v5
    ds_read_b128 v[32:35], v2 offset:0
    s_mov_b32 m0, s29
    s_add_u32 s29, s29, 16384
    buffer_load_dwordx4 v1, s[4:7], s25 offen sc1 lds
    v_cvt_pk_bf16_f32 v214, v24, v25
    v_or3_b32 v28, v28, v213, v214
    s_waitcnt lgkmcnt(3)
    v_mfma_f32_16x16x32_bf16 v[104:107], v[36:39], v[216:219], v[104:107]
    v_exp_f32 v26, v190
    v_mfma_f32_16x16x32_bf16 v[108:111], v[36:39], v[220:223], v[108:111]
    ds_read_b128 v[36:39], v2 offset:1024
    s_waitcnt lgkmcnt(3)
    v_mfma_f32_16x16x32_bf16 v[112:115], v[40:43], v[216:219], v[112:115]
    v_exp_f32 v27, v191
    v_mfma_f32_16x16x32_bf16 v[116:119], v[40:43], v[220:223], v[116:119]
    ds_read_b128 v[40:43], v2 offset:2048
    v_cvt_pk_bf16_f32 v215, v26, v27
    v_or_b32 v28, v28, v215
    s_waitcnt lgkmcnt(3)
    v_mfma_f32_16x16x32_bf16 v[120:123], v[44:47], v[216:219], v[120:123]
    v_and_b32 v28, s37, v28
    v_mfma_f32_16x16x32_bf16 v[124:127], v[44:47], v[220:223], v[124:127]
    ds_read_b128 v[44:47], v2 offset:3072
    v_cmp_ne_u32 vcc, 0, v28
    s_sub_u32 s34, s34, 64
    s_cbranch_vccnz L_rare_27
L_rareback_28:
    s_waitcnt lgkmcnt(3)
    v_mfma_f32_16x16x32_bf16 v[176:179], v[32:35], v[128:131], v[160:163]
    v_exp_f32 v20, v192
    s_bfe_u32 s101, s2, 0x20001
    v_mfma_f32_16x16x32_bf16 v[180:183], v[32:35], v[144:147], v[164:167]
    ds_read_b128 v[32:35], v2 offset:4096
    s_waitcnt lgkmcnt(3)
    v_mfma_f32_16x16x32_bf16 v[176:179], v[36:39], v[132:135], v[176:179]
    v_exp_f32 v21, v193
    s_lshl_b32 s101, s101, 3
    v_mfma_f32_16x16x32_bf16 v[180:183], v[36:39], v[148:151], v[180:183]
    ds_read_b128 v[36:39], v2 offset:5120
    buffer_load_dwordx4 v1, s[4:7], s25 offen offset:1024 sc1 lds
    s_cmp_eq_u32 s29, s41
    s_cselect_b32 s29, s56, s29
    s_add_u32 s25, s25, 16384
    s_cmp_eq_u32 s25, s27
    s_cselect_b32 s25, s40, s25
    v_cvt_pk_bf16_f32 v216, v20, v21
    s_waitcnt lgkmcnt(3)
    v_mfma_f32_16x16x32_bf16 v[176:179], v[40:43], v[136:139], v[176:179]
    v_exp_f32 v22, v194
    s_lshr_b32 s45, s2, 5
    v_mfma_f32_16x16x32_bf16 v[180:183], v[40:43], v[152:155], v[180:183]
    ds_read_b128 v[40:43], v2 offset:6144
    s_waitcnt lgkmcnt(3)
    v_mfma_f32_16x16x32_bf16 v[176:179], v[44:47], v[140:143], v[176:179]
    v_exp_f32 v23, v195
    s_add_u32 s101, s101, s45
    v_mfma_f32_16x16x32_bf16 v[180:183], v[44:47], v[156:159], v[180:183]
    ds_read_b128 v[44:47], v2 offset:7168
    v_cvt_pk_bf16_f32 v217, v22, v23
    s_waitcnt lgkmcnt(3)
    v_mfma_f32_16x16x32_bf16 v[184:187], v[32:35], v[128:131], v[160:163]
    v_exp_f32 v24, v200
    s_and_b32 s75, s2, 1
    v_mfma_f32_16x16x32_bf16 v[188:191], v[32:35], v[144:147], v[164:167]
    s_add_u32 s32, s32, 16384
    s_and_b32 s32, s32, 0xffff
    v_add_u32 v3, s32, v6
    v_add_u32 v4, s32, v7
    ds_read_b128 v[32:35], v3 offset:0
    s_waitcnt lgkmcnt(3)
    v_mfma_f32_16x16x32_bf16 v[184:187], v[36:39], v[132:135], v[184:187]
    v_exp_f32 v25, v201
    s_lshl_b32 s75, s75, 2
    v_mfma_f32_16x16x32_bf16 v[188:191], v[36:39], v[148:151], v[188:191]
    ds_read_b128 v[36:39], v3 offset:1024
    s_add_u32 m0, s30, s57
    s_add_u32 s30, s30, 16384
    buffer_load_dwordx4 v1, s[8:11], s26 offen sc1 lds
    v_cvt_pk_bf16_f32 v218, v24, v25
    v_or3_b32 v28, v216, v217, v218
    s_waitcnt lgkmcnt(3)
    v_mfma_f32_16x16x32_bf16 v[184:187], v[40:43], v[136:139], v[184:187]
    v_exp_f32 v26, v202
    s_bfe_u32 s45, s2, 0x20003
    v_mfma_f32_16x16x32_bf16 v[188:191], v[40:43], v[152:155], v[188:191]
    ds_read_b128 v[40:43], v3 offset:2048
    s_waitcnt lgkmcnt(3)
    v_mfma_f32_16x16x32_bf16 v[184:187], v[44:47], v[140:143], v[184:187]
    v_exp_f32 v27, v203
    s_add_u32 s75, s75, s45
    v_mfma_f32_16x16x32_bf16 v[188:191], v[44:47], v[156:159], v[188:191]
    ds_read_b128 v[44:47], v3 offset:3072
    v_cvt_pk_bf16_f32 v219, v26, v27
    v_mfma_f32_16x16x32_bf16 v[168:171], v[12:15], v[208:211], v[168:171]
    v_exp_f32 v20, v196
    s_and_b32 s101, s2, 1
    v_mfma_f32_16x16x32_bf16 v[172:175], v[12:15], v[212:215], v[172:175]
    s_waitcnt lgkmcnt(3)
    v_mfma_f32_16x16x32_bf16 v[64:67], v[32:35], v[208:211], v[64:67]
    v_exp_f32 v21, v197
    s_lshl_b32 s101, s101, 3
    v_mfma_f32_16x16x32_bf16 v[68:71], v[32:35], v[212:215], v[68:71]
    ds_read_b128 v[32:35], v4 offset:4096
    v_cvt_pk_bf16_f32 v220, v20, v21
    v_or3_b32 v28, v28, v219, v220
    s_waitcnt lgkmcnt(3)
    v_mfma_f32_16x16x32_bf16 v[72:75], v[36:39], v[208:211], v[72:75]
    v_exp_f32 v22, v198
    s_lshr_b32 s75, s2, 5
    v_mfma_f32_16x16x32_bf16 v[76:79], v[36:39], v[212:215], v[76:79]
    ds_read_b128 v[36:39], v4 offset:5120
    buffer_load_dwordx4 v1, s[8:11], s26 offen offset:1024 sc1 lds
    s_and_b32 s30, s30, 0xffff
    s_add_u32 s26, s26, 16384
    s_cmp_eq_u32 s26, s28
    s_cselect_b32 s26, s40, s26
    s_waitcnt lgkmcnt(3)
    v_mfma_f32_16x16x32_bf16 v[80:83], v[40:43], v[208:211], v[80:83]
    v_exp_f32 v23, v199
    s_add_u32 s101, s101, s75
    v_mfma_f32_16x16x32_bf16 v[84:87], v[40:43], v[212:215], v[84:87]
    ds_read_b128 v[40:43], v4 offset:6144
    v_cvt_pk_bf16_f32 v221, v22, v23
    s_waitcnt lgkmcnt(3)
    v_mfma_f32_16x16x32_bf16 v[88:91], v[44:47], v[208:211], v[88:91]
    v_exp_f32 v24, v204
    s_lshl_b32 s101, s101, 1
    v_mfma_f32_16x16x32_bf16 v[92:95], v[44:47], v[212:215], v[92:95]
    ds_read_b128 v[44:47], v4 offset:7168
    s_waitcnt vmcnt(5)
    s_barrier
    s_waitcnt lgkmcnt(3)
    v_mfma_f32_16x16x32_bf16 v[96:99], v[32:35], v[208:211], v[96:99]
    v_exp_f32 v25, v205
    s_bfe_u32 s75, s2, 0x10002
    v_mfma_f32_16x16x32_bf16 v[100:103], v[32:35], v[212:215], v[100:103]
    s_add_u32 s31, s31, 16384
    s_cmp_eq_u32 s31, 49152
    s_cselect_b32 s31, 0, s31
    v_add_u32 v2, s31, v5
    ds_read_b128 v[32:35], v2 offset:0
    s_mov_b32 m0, s29
    s_add_u32 s29, s29, 16384
    buffer_load_dwordx4 v1, s[4:7], s25 offen sc1 lds
    v_cvt_pk_bf16_f32 v222, v24, v25
    v_or3_b32 v28, v28, v221, v222
    s_waitcnt lgkmcnt(3)
    v_mfma_f32_16x16x32_bf16 v[104:107], v[36:39], v[208:211], v[104:107]
    v_exp_f32 v26, v206
    s_add_u32 s101, s101, s75
    v_mfma_f32_16x16x32_bf16 v[108:111], v[36:39], v[212:215], v[108:111]
    ds_read_b128 v[36:39], v2 offset:1024
    s_waitcnt lgkmcnt(3)
    v_mfma_f32_16x16x32_bf16 v[112:115], v[40:43], v[208:211], v[112:115]
    v_exp_f32 v27, v207
    s_lshl_b32 s75, s45, 1
    v_mfma_f32_16x16x32_bf16 v[116:119], v[40:43], v[212:215], v[116:119]
    ds_read_b128 v[40:43], v2 offset:2048
    v_cvt_pk_bf16_f32 v223, v26, v27
    v_or_b32 v28, v28, v223
    s_waitcnt lgkmcnt(3)
    v_mfma_f32_16x16x32_bf16 v[120:123], v[44:47], v[208:211], v[120:123]
    v_and_b32 v28, s37, v28
    s_bfe_u32 s45, s2, 0x10001
    v_mfma_f32_16x16x32_bf16 v[124:127], v[44:47], v[212:215], v[124:127]
    ds_read_b128 v[44:47], v2 offset:3072
    v_cmp_ne_u32 vcc, 0, v28
    s_sub_u32 s34, s34, 64
    s_cbranch_vccnz L_rare_29
L_rareback_30:
    s_waitcnt lgkmcnt(3)
    v_mfma_f32_16x16x32_bf16 v[192:195], v[32:35], v[128:131], v[160:163]
    v_exp_f32 v20, v176
    s_add_u32 s75, s75, s45
    v_mfma_f32_16x16x32_bf16 v[196:199], v[32:35], v[144:147], v[164:167]
    ds_read_b128 v[32:35], v2 offset:4096
    s_waitcnt lgkmcnt(3)
    v_mfma_f32_16x16x32_bf16 v[192:195], v[36:39], v[132:135], v[192:195]
    v_exp_f32 v21, v177
    s_lshr_b32 s45, s101, 1
    v_mfma_f32_16x16x32_bf16 v[196:199], v[36:39], v[148:151], v[196:199]
    ds_read_b128 v[36:39], v2 offset:5120
    buffer_load_dwordx4 v1, s[4:7], s25 offen offset:1024 sc1 lds
    s_cmp_eq_u32 s29, s41
    s_cselect_b32 s29, s56, s29
    s_add_u32 s25, s25, 16384
    s_cmp_eq_u32 s25, s27
    s_cselect_b32 s25, s40, s25
    v_cvt_pk_bf16_f32 v208, v20, v21
    s_waitcnt lgkmcnt(3)
    v_mfma_f32_16x16x32_bf16 v[192:195], v[40:43], v[136:139], v[192:195]
    v_exp_f32 v22, v178
    s_sub_u32 s69, 15, s45
    v_mfma_f32_16x16x32_bf16 v[196:199], v[40:43], v[152:155], v[196:199]
    ds_read_b128 v[40:43], v2 offset:6144
    s_waitcnt lgkmcnt(3)
    v_mfma_f32_16x16x32_bf16 v[192:195], v[44:47], v[140:143], v[192:195]
    v_exp_f32 v23, v179
    s_cmp_lt_u32 s45, 8
    s_cselect_b32 s69, s45, s69
    s_cselect_b32 s100, 6, 5
    v_mfma_f32_16x16x32_bf16 v[196:199], v[44:47], v[156:159], v[196:199]
    ds_read_b128 v[44:47], v2 offset:7168
    v_cvt_pk_bf16_f32 v209, v22, v23
    s_waitcnt lgkmcnt(3)
    v_mfma_f32_16x16x32_bf16 v[200:203], v[32:35], v[128:131], v[160:163]
    v_exp_f32 v24, v184
    s_lshl_b32 s69, s69, 7
    v_mfma_f32_16x16x32_bf16 v[204:207], v[32:35], v[144:147], v[164:167]
    s_add_u32 s32, s32, 16384
    s_and_b32 s32, s32, 0xffff
    v_add_u32 v3, s32, v6
    v_add_u32 v4, s32, v7
    ds_read_b128 v[32:35], v3 offset:0
    s_waitcnt lgkmcnt(3)
    v_mfma_f32_16x16x32_bf16 v[200:203], v[36:39], v[132:135], v[200:203]
    v_exp_f32 v25, v185
    s_add_u32 s69, s69, 73400320
    v_mfma_f32_16x16x32_bf16 v[204:207], v[36:39], v[148:151], v[204:207]
    ds_read_b128 v[36:39], v3 offset:1024
    s_add_u32 m0, s30, s57
    s_add_u32 s30, s30, 16384
    buffer_load_dwordx4 v1, s[8:11], s26 offen sc1 lds
    v_cvt_pk_bf16_f32 v210, v24, v25
    v_or3_b32 v28, v208, v209, v210
    s_waitcnt lgkmcnt(3)
    v_mfma_f32_16x16x32_bf16 v[200:203], v[40:43], v[136:139], v[200:203]
    v_exp_f32 v26, v186
    s_mul_i32 s67, s22, 7
    v_mfma_f32_16x16x32_bf16 v[204:207], v[40:43], v[152:155], v[204:207]
    ds_read_b128 v[40:43], v3 offset:2048
    s_waitcnt lgkmcnt(3)
    v_mfma_f32_16x16x32_bf16 v[200:203], v[44:47], v[140:143], v[200:203]
    v_exp_f32 v27, v187
    s_cmp_eq_u32 s22, 7
    s_cselect_b32 s67, 48, s67
    v_mfma_f32_16x16x32_bf16 v[204:207], v[44:47], v[156:159], v[204:207]
    ds_read_b128 v[44:47], v3 offset:3072
    v_cvt_pk_bf16_f32 v211, v26, v27
    v_mfma_f32_16x16x32_bf16 v[168:171], v[12:15], v[216:219], v[168:171]
    v_exp_f32 v20, v180
    s_lshl_b32 s67, s67, 10
    v_mfma_f32_16x16x32_bf16 v[172:175], v[12:15], v[220:223], v[172:175]
    s_waitcnt lgkmcnt(3)
    v_mfma_f32_16x16x32_bf16 v[64:67], v[32:35], v[216:219], v[64:67]
    v_exp_f32 v21, v181
    s_mul_i32 s45, s101, 221184
    v_mfma_f32_16x16x32_bf16 v[68:71], v[32:35], v[220:223], v[68:71]
    ds_read_b128 v[32:35], v4 offset:4096
    v_cvt_pk_bf16_f32 v212, v20, v21
    v_or3_b32 v28, v28, v211, v212
    s_waitcnt lgkmcnt(3)
    v_mfma_f32_16x16x32_bf16 v[72:75], v[36:39], v[216:219], v[72:75]
    v_exp_f32 v22, v182
    s_add_u32 s45, s45, s67
    v_mfma_f32_16x16x32_bf16 v[76:79], v[36:39], v[220:223], v[76:79]
    ds_read_b128 v[36:39], v4 offset:5120
    buffer_load_dwordx4 v1, s[8:11], s26 offen offset:1024 sc1 lds
    s_and_b32 s30, s30, 0xffff
    s_add_u32 s26, s26, 16384
    s_cmp_eq_u32 s26, s28
    s_cselect_b32 s26, s40, s26
    s_waitcnt lgkmcnt(3)
    v_mfma_f32_16x16x32_bf16 v[80:83], v[40:43], v[216:219], v[80:83]
    v_exp_f32 v23, v183
    s_add_u32 s58, s45, 54525952
    v_mfma_f32_16x16x32_bf16 v[84:87], v[40:43], v[220:223], v[84:87]
    ds_read_b128 v[40:43], v4 offset:6144
    v_cvt_pk_bf16_f32 v213, v22, v23
    s_waitcnt lgkmcnt(3)
    v_mfma_f32_16x16x32_bf16 v[88:91], v[44:47], v[216:219], v[88:91]
    v_exp_f32 v24, v188
    s_add_u32 s59, s45, 54581248
    v_mfma_f32_16x16x32_bf16 v[92:95], v[44:47], v[220:223], v[92:95]
    ds_read_b128 v[44:47], v4 offset:7168
    s_waitcnt vmcnt(4)
    s_barrier
    s_waitcnt lgkmcnt(3)
    v_mfma_f32_16x16x32_bf16 v[96:99], v[32:35], v[216:219], v[96:99]
    v_exp_f32 v25, v189
    s_add_u32 s60, s45, 54636544
    v_mfma_f32_16x16x32_bf16 v[100:103], v[32:35], v[220:223], v[100:103]
    s_add_u32 s31, s31, 16384
    s_cmp_eq_u32 s31, 49152
    s_cselect_b32 s31, 0, s31
    v_add_u32 v2, s31, v5
    ds_read_b128 v[32:35], v2 offset:0
    s_mov_b32 m0, s29
    s_add_u32 s29, s29, 16384
    buffer_load_dwordx4 v1, s[4:7], s25 offen sc1 lds
    ds_read_b64_tr_b16 v[48:49], v52 offset:0
    ds_read_b64_tr_b16 v[50:51], v52 offset:2048
    v_cvt_pk_bf16_f32 v214, v24, v25
    v_or3_b32 v28, v28, v213, v214
    s_waitcnt lgkmcnt(5)
    v_mfma_f32_16x16x32_bf16 v[104:107], v[36:39], v[216:219], v[104:107]
    v_exp_f32 v26, v190
    s_add_u32 s61, s45, 54691840
    v_mfma_f32_16x16x32_bf16 v[108:111], v[36:39], v[220:223], v[108:111]
    ds_read_b128 v[36:39], v2 offset:1024
    ds_read_b64_tr_b16 v[56:57], v52 offset:512
    ds_read_b64_tr_b16 v[58:59], v52 offset:2560
    s_waitcnt lgkmcnt(7)
    v_mfma_f32_16x16x32_bf16 v[112:115], v[40:43], v[216:219], v[112:115]
    v_exp_f32 v27, v191
    s_mul_i32 s45, s75, 276480
    v_mfma_f32_16x16x32_bf16 v[116:119], v[40:43], v[220:223], v[116:119]
    ds_read_b128 v[40:43], v2 offset:2048
    ds_read_b64_tr_b16 v[60:61], v53 offset:512
    ds_read_b64_tr_b16 v[62:63], v53 offset:2560
    v_cvt_pk_bf16_f32 v215, v26, v27
    v_or_b32 v28, v28, v215
    s_waitcnt lgkmcnt(9)
    v_mfma_f32_16x16x32_bf16 v[120:123], v[44:47], v[216:219], v[120:123]
    v_and_b32 v28, s37, v28
    s_add_u32 s45, s45, s67
    v_mfma_f32_16x16x32_bf16 v[124:127], v[44:47], v[220:223], v[124:127]
    ds_read_b128 v[44:47], v2 offset:3072
    ds_read_b64_tr_b16 v[54:55], v53 offset:2048
    ds_read_b64_tr_b16 v[52:53], v53 offset:0
    v_cmp_ne_u32 vcc, 0, v28
    s_sub_u32 s34, s34, 64
    s_cbranch_vccnz L_rare_31
L_rareback_32:
    s_waitcnt lgkmcnt(11)
    v_mfma_f32_16x16x32_bf16 v[176:179], v[32:35], v[128:131], v[160:163]
    v_exp_f32 v20, v192
    s_add_u32 s62, s45, 69206016
    v_mfma_f32_16x16x32_bf16 v[180:183], v[32:35], v[144:147], v[164:167]
    ds_read_b128 v[32:35], v2 offset:4096
    s_waitcnt lgkmcnt(9)
    v_mfma_f32_16x16x32_bf16 v[176:179], v[36:39], v[132:135], v[176:179]
    v_exp_f32 v21, v193
    s_add_u32 s63, s45, 69261312
    v_mfma_f32_16x16x32_bf16 v[180:183], v[36:39], v[148:151], v[180:183]
    ds_read_b128 v[36:39], v2 offset:5120
    buffer_load_dwordx4 v1, s[4:7], s25 offen offset:1024 sc1 lds
    s_cmp_eq_u32 s29, s41
    s_cselect_b32 s29, s56, s29
    s_add_u32 s25, s25, 16384
    s_cmp_eq_u32 s25, s27
    s_cselect_b32 s25, s40, s25
    v_cvt_pk_bf16_f32 v216, v20, v21
    s_waitcnt lgkmcnt(7)
    v_mfma_f32_16x16x32_bf16 v[176:179], v[40:43], v[136:139], v[176:179]
    v_exp_f32 v22, v194
    s_add_u32 s64, s45, 69316608
    v_mfma_f32_16x16x32_bf16 v[180:183], v[40:43], v[152:155], v[180:183]
    ds_read_b128 v[40:43], v2 offset:6144
    s_waitcnt lgkmcnt(5)
    v_mfma_f32_16x16x32_bf16 v[176:179], v[44:47], v[140:143], v[176:179]
    v_exp_f32 v23, v195
    s_add_u32 s65, s45, 69371904
    v_mfma_f32_16x16x32_bf16 v[180:183], v[44:47], v[156:159], v[180:183]
    ds_read_b128 v[44:47], v2 offset:7168
    v_cvt_pk_bf16_f32 v217, v22, v23
    s_waitcnt lgkmcnt(3)
    v_mfma_f32_16x16x32_bf16 v[184:187], v[32:35], v[128:131], v[160:163]
    v_exp_f32 v24, v200
    s_add_u32 s66, s45, 69427200
    v_mfma_f32_16x16x32_bf16 v[188:191], v[32:35], v[144:147], v[164:167]
    s_add_u32 s32, s32, 16384
    s_and_b32 s32, s32, 0xffff
    v_add_u32 v3, s32, v6
    v_add_u32 v4, s32, v7
    ds_read_b128 v[32:35], v3 offset:0
    s_waitcnt lgkmcnt(3)
    v_mfma_f32_16x16x32_bf16 v[184:187], v[36:39], v[132:135], v[184:187]
    v_exp_f32 v25, v201
    s_lshl_b32 s67, s101, 2
    v_mfma_f32_16x16x32_bf16 v[188:191], v[36:39], v[148:151], v[188:191]
    ds_read_b128 v[36:39], v3 offset:1024
    s_add_u32 m0, s30, s57
    s_add_u32 s30, s30, 16384
    buffer_load_dwordx4 v1, s[8:11], s26 offen sc1 lds
    v_cvt_pk_bf16_f32 v218, v24, v25
    v_or3_b32 v28, v216, v217, v218
    s_waitcnt lgkmcnt(3)
    v_mfma_f32_16x16x32_bf16 v[184:187], v[40:43], v[136:139], v[184:187]
    v_exp_f32 v26, v202
    s_lshr_b32 s45, s22, 1
    v_mfma_f32_16x16x32_bf16 v[188:191], v[40:43], v[152:155], v[188:191]
    ds_read_b128 v[40:43], v3 offset:2048
    s_waitcnt lgkmcnt(3)
    v_mfma_f32_16x16x32_bf16 v[184:187], v[44:47], v[140:143], v[184:187]
    v_exp_f32 v27, v203
    s_add_u32 s67, s67, s45
    v_mfma_f32_16x16x32_bf16 v[188:191], v[44:47], v[156:159], v[188:191]
    ds_read_b128 v[44:47], v3 offset:3072
    v_cvt_pk_bf16_f32 v219, v26, v27
    v_mfma_f32_16x16x32_bf16 v[168:171], v[12:15], v[208:211], v[168:171]
    v_exp_f32 v20, v196
    s_mul_i32 s67, s67, 20480
    v_mfma_f32_16x16x32_bf16 v[172:175], v[12:15], v[212:215], v[172:175]
    s_waitcnt lgkmcnt(3)
    v_mfma_f32_16x16x32_bf16 v[64:67], v[32:35], v[208:211], v[64:67]
    v_exp_f32 v21, v197
    s_mul_i32 s45, s75, 160
    v_mfma_f32_16x16x32_bf16 v[68:71], v[32:35], v[212:215], v[68:71]
    ds_read_b128 v[32:35], v4 offset:4096
    v_cvt_pk_bf16_f32 v220, v20, v21
    v_or3_b32 v28, v28, v219, v220
    s_waitcnt lgkmcnt(3)
    v_mfma_f32_16x16x32_bf16 v[72:75], v[36:39], v[208:211], v[72:75]
    v_exp_f32 v22, v198
    s_add_u32 s67, s67, s45
    v_mfma_f32_16x16x32_bf16 v[76:79], v[36:39], v[212:215], v[76:79]
    ds_read_b128 v[36:39], v4 offset:5120
    buffer_load_dwordx4 v1, s[8:11], s26 offen offset:1024 sc1 lds
    s_and_b32 s30, s30, 0xffff
    s_add_u32 s26, s26, 16384
    s_cmp_eq_u32 s26, s28
    s_cselect_b32 s26, s40, s26
    s_waitcnt lgkmcnt(3)
    v_mfma_f32_16x16x32_bf16 v[80:83], v[40:43], v[208:211], v[80:83]
    v_exp_f32 v23, v199
    s_and_b32 s45, s22, 1
    v_mfma_f32_16x16x32_bf16 v[84:87], v[40:43], v[212:215], v[84:87]
    ds_read_b128 v[40:43], v4 offset:6144
    s_mul_i32 s38, s92, 0
    s_add_u32 s38, s38, s91
    buffer_store_dwordx4 v[48:51], v1, s[12:15], s38 offen sc1
    v_cvt_pk_bf16_f32 v221, v22, v23
    s_waitcnt lgkmcnt(3)
    v_mfma_f32_16x16x32_bf16 v[88:91], v[44:47], v[208:211], v[88:91]
    v_exp_f32 v24, v204
    s_lshl_b32 s45, s45, 2
    v_mfma_f32_16x16x32_bf16 v[92:95], v[44:47], v[212:215], v[92:95]
    ds_read_b128 v[44:47], v4 offset:7168
    s_waitcnt vmcnt(5)
    s_barrier
    s_waitcnt lgkmcnt(3)
    v_mfma_f32_16x16x32_bf16 v[96:99], v[32:35], v[208:211], v[96:99]
    v_exp_f32 v25, v205
    s_add_u32 s68, s67, s45
    v_mfma_f32_16x16x32_bf16 v[100:103], v[32:35], v[212:215], v[100:103]
    s_add_u32 s31, s31, 16384
    s_cmp_eq_u32 s31, 49152
    s_cselect_b32 s31, 0, s31
    v_add_u32 v2, s31, v5
    ds_read_b128 v[32:35], v2 offset:0
    s_mov_b32 m0, s29
    s_add_u32 s29, s29, 16384
    buffer_load_dwordx4 v1, s[4:7], s25 offen sc1 lds
    v_cvt_pk_bf16_f32 v222, v24, v25
    v_or3_b32 v28, v28, v221, v222
    s_waitcnt lgkmcnt(3)
    v_mfma_f32_16x16x32_bf16 v[104:107], v[36:39], v[208:211], v[104:107]
    v_exp_f32 v26, v206
    s_add_u32 s68, s68, 128
    v_mfma_f32_16x16x32_bf16 v[108:111], v[36:39], v[212:215], v[108:111]
    ds_read_b128 v[36:39], v2 offset:1024
    s_waitcnt lgkmcnt(3)
    v_mfma_f32_16x16x32_bf16 v[112:115], v[40:43], v[208:211], v[112:115]
    v_exp_f32 v27, v207
    s_lshl_b32 s45, s45, 4
    v_mfma_f32_16x16x32_bf16 v[116:119], v[40:43], v[212:215], v[116:119]
    ds_read_b128 v[40:43], v2 offset:2048
    v_cvt_pk_bf16_f32 v223, v26, v27
    v_or_b32 v28, v28, v223
    s_waitcnt lgkmcnt(3)
    v_mfma_f32_16x16x32_bf16 v[120:123], v[44:47], v[208:211], v[120:123]
    v_and_b32 v28, s37, v28
    s_add_u32 s67, s67, s45
    v_mfma_f32_16x16x32_bf16 v[124:127], v[44:47], v[212:215], v[124:127]
    ds_read_b128 v[44:47], v2 offset:3072
    v_cmp_ne_u32 vcc, 0, v28
    s_sub_u32 s34, s34, 64
    s_cbranch_vccnz L_rare_33
L_rareback_34:
    s_waitcnt lgkmcnt(3)
    v_mfma_f32_16x16x32_bf16 v[192:195], v[32:35], v[128:131], v[160:163]
    v_exp_f32 v20, v176
    s_bfe_u32 s46, s2, 0x20001
    v_mfma_f32_16x16x32_bf16 v[196:199], v[32:35], v[144:147], v[164:167]
    ds_read_b128 v[32:35], v2 offset:4096
    s_lshr_b32 s48, s101, 1
    s_waitcnt lgkmcnt(3)
    v_mfma_f32_16x16x32_bf16 v[192:195], v[36:39], v[132:135], v[192:195]
    v_exp_f32 v21, v177
    v_mfma_f32_16x16x32_bf16 v[196:199], v[36:39], v[148:151], v[196:199]
    ds_read_b128 v[36:39], v2 offset:5120
    buffer_load_dwordx4 v1, s[4:7], s25 offen offset:1024 sc1 lds
    s_cmp_eq_u32 s29, s41
    s_cselect_b32 s29, s56, s29
    s_add_u32 s25, s25, 16384
    s_cmp_eq_u32 s25, s27
    s_cselect_b32 s25, s40, s25
    v_cvt_pk_bf16_f32 v208, v20, v21
    s_lshr_b32 s50, s75, 1
    s_waitcnt lgkmcnt(3)
    v_mfma_f32_16x16x32_bf16 v[192:195], v[40:43], v[136:139], v[192:195]
    v_exp_f32 v22, v178
    v_mfma_f32_16x16x32_bf16 v[196:199], v[40:43], v[152:155], v[196:199]
    ds_read_b128 v[40:43], v2 offset:6144
    s_lshl_b32 s45, s46, 3
    s_waitcnt lgkmcnt(3)
    v_mfma_f32_16x16x32_bf16 v[192:195], v[44:47], v[140:143], v[192:195]
    v_exp_f32 v23, v179
    v_mfma_f32_16x16x32_bf16 v[196:199], v[44:47], v[156:159], v[196:199]
    ds_read_b128 v[44:47], v2 offset:7168
    v_cvt_pk_bf16_f32 v209, v22, v23
    s_bfm_b64 s[88:89], 8, s45
    s_waitcnt lgkmcnt(3)
    v_mfma_f32_16x16x32_bf16 v[200:203], v[32:35], v[128:131], v[160:163]
    v_exp_f32 v24, v184
    v_mfma_f32_16x16x32_bf16 v[204:207], v[32:35], v[144:147], v[164:167]
    s_add_u32 s32, s32, 16384
    s_and_b32 s32, s32, 0xffff
    v_add_u32 v3, s32, v6
    v_add_u32 v4, s32, v7
    ds_read_b128 v[32:35], v3 offset:0
    s_cmp_eq_u32 s46, 3
    s_cselect_b32 s82, 0x40000000, 0
    s_waitcnt lgkmcnt(3)
    v_mfma_f32_16x16x32_bf16 v[200:203], v[36:39], v[132:135], v[200:203]
    v_exp_f32 v25, v185
    v_mfma_f32_16x16x32_bf16 v[204:207], v[36:39], v[148:151], v[204:207]
    ds_read_b128 v[36:39], v3 offset:1024
    s_add_u32 m0, s30, s57
    s_add_u32 s30, s30, 16384
    buffer_load_dwordx4 v1, s[8:11], s26 offen sc1 lds
    v_cvt_pk_bf16_f32 v210, v24, v25
    v_or3_b32 v28, v208, v209, v210
    s_lshl_b32 s61, s48, 3
    s_waitcnt lgkmcnt(3)
    v_mfma_f32_16x16x32_bf16 v[200:203], v[40:43], v[136:139], v[200:203]
    v_exp_f32 v26, v186
    v_mfma_f32_16x16x32_bf16 v[204:207], v[40:43], v[152:155], v[204:207]
    ds_read_b128 v[40:43], v3 offset:2048
    s_add_u32 s61, s61, s22
    s_waitcnt lgkmcnt(3)
    v_mfma_f32_16x16x32_bf16 v[200:203], v[44:47], v[140:143], v[200:203]
    v_exp_f32 v27, v187
    v_mfma_f32_16x16x32_bf16 v[204:207], v[44:47], v[156:159], v[204:207]
    ds_read_b128 v[44:47], v3 offset:3072
    v_cvt_pk_bf16_f32 v211, v26, v27
    s_mul_i32 s62, s50, 10
    v_mfma_f32_16x16x32_bf16 v[168:171], v[12:15], v[216:219], v[168:171]
    v_exp_f32 v20, v180
    v_mfma_f32_16x16x32_bf16 v[172:175], v[12:15], v[220:223], v[172:175]
    s_bfe_u32 s45, s22, 0x10001
    s_waitcnt lgkmcnt(3)
    v_mfma_f32_16x16x32_bf16 v[64:67], v[32:35], v[216:219], v[64:67]
    v_exp_f32 v21, v181
    s_add_u32 s63, s62, s45
    v_mfma_f32_16x16x32_bf16 v[68:71], v[32:35], v[220:223], v[68:71]
    ds_read_b128 v[32:35], v4 offset:4096
    v_cvt_pk_bf16_f32 v212, v20, v21
    v_or3_b32 v28, v28, v211, v212
    s_waitcnt lgkmcnt(3)
    v_mfma_f32_16x16x32_bf16 v[72:75], v[36:39], v[216:219], v[72:75]
    v_exp_f32 v22, v182
    s_add_u32 s63, s63, 8
    v_mfma_f32_16x16x32_bf16 v[76:79], v[36:39], v[220:223], v[76:79]
    ds_read_b128 v[36:39], v4 offset:5120
    buffer_load_dwordx4 v1, s[8:11], s26 offen offset:1024 sc1 lds
    s_and_b32 s30, s30, 0xffff
    s_add_u32 s26, s26, 16384
    s_cmp_eq_u32 s26, s28
    s_cselect_b32 s26, s40, s26
    s_waitcnt lgkmcnt(3)
    v_mfma_f32_16x16x32_bf16 v[80:83], v[40:43], v[216:219], v[80:83]
    v_exp_f32 v23, v183
    s_add_u32 s62, s62, s22
    v_mfma_f32_16x16x32_bf16 v[84:87], v[40:43], v[220:223], v[84:87]
    ds_read_b128 v[40:43], v4 offset:6144
    s_mul_i32 s38, s92, 1
    s_add_u32 s38, s38, s91
    buffer_store_dwordx4 v[52:55], v1, s[12:15], s38 offen sc1
    v_cvt_pk_bf16_f32 v213, v22, v23
    s_waitcnt lgkmcnt(3)
    v_mfma_f32_16x16x32_bf16 v[88:91], v[44:47], v[216:219], v[88:91]
    v_exp_f32 v24, v188
    s_mul_i32 s52, s46, 14336
    v_mfma_f32_16x16x32_bf16 v[92:95], v[44:47], v[220:223], v[92:95]
    ds_read_b128 v[44:47], v4 offset:7168
    s_waitcnt vmcnt(6)
    s_barrier
    s_waitcnt lgkmcnt(3)
    v_mfma_f32_16x16x32_bf16 v[96:99], v[32:35], v[216:219], v[96:99]
    v_exp_f32 v25, v189
    s_mul_i32 s58, s61, 55296
    v_mfma_f32_16x16x32_bf16 v[100:103], v[32:35], v[220:223], v[100:103]
    s_add_u32 s31, s31, 16384
    s_cmp_eq_u32 s31, 49152
    s_cselect_b32 s31, 0, s31
    v_add_u32 v2, s31, v5
    ds_read_b128 v[32:35], v2 offset:0
    s_mov_b32 m0, s29
    s_add_u32 s29, s29, 16384
    buffer_load_dwordx4 v1, s[4:7], s25 offen sc1 lds
    v_cvt_pk_bf16_f32 v214, v24, v25
    v_or3_b32 v28, v28, v213, v214
    s_waitcnt lgkmcnt(3)
    v_mfma_f32_16x16x32_bf16 v[104:107], v[36:39], v[216:219], v[104:107]
    v_exp_f32 v26, v190
    s_mul_i32 s59, s62, 55296
    v_mfma_f32_16x16x32_bf16 v[108:111], v[36:39], v[220:223], v[108:111]
    ds_read_b128 v[36:39], v2 offset:1024
    s_waitcnt lgkmcnt(3)
    v_mfma_f32_16x16x32_bf16 v[112:115], v[40:43], v[216:219], v[112:115]
    v_exp_f32 v27, v191
    s_mul_i32 s60, s63, 55296
    v_mfma_f32_16x16x32_bf16 v[116:119], v[40:43], v[220:223], v[116:119]
    ds_read_b128 v[40:43], v2 offset:2048
    v_cvt_pk_bf16_f32 v215, v26, v27
    v_or_b32 v28, v28, v215
    s_waitcnt lgkmcnt(3)
    v_mfma_f32_16x16x32_bf16 v[120:123], v[44:47], v[216:219], v[120:123]
    v_and_b32 v28, s37, v28
    s_add_u32 s45, s52, 54525952
    v_mfma_f32_16x16x32_bf16 v[124:127], v[44:47], v[220:223], v[124:127]
    ds_read_b128 v[44:47], v2 offset:3072
    v_cmp_ne_u32 vcc, 0, v28
    s_sub_u32 s34, s34, 64
    s_cbranch_vccnz L_rare_35
L_rareback_36:
    s_waitcnt lgkmcnt(3)
    v_mfma_f32_16x16x32_bf16 v[176:179], v[32:35], v[128:131], v[160:163]
    v_exp_f32 v20, v192
    s_add_u32 s58, s58, s45
    v_mfma_f32_16x16x32_bf16 v[180:183], v[32:35], v[144:147], v[164:167]
    ds_read_b128 v[32:35], v2 offset:4096
    s_waitcnt lgkmcnt(3)
    v_mfma_f32_16x16x32_bf16 v[176:179], v[36:39], v[132:135], v[176:179]
    v_exp_f32 v21, v193
    s_add_u32 s45, s52, 69206016
    v_mfma_f32_16x16x32_bf16 v[180:183], v[36:39], v[148:151], v[180:183]
    ds_read_b128 v[36:39], v2 offset:5120
    buffer_load_dwordx4 v1, s[4:7], s25 offen offset:1024 sc1 lds
    s_cmp_eq_u32 s29, s41
    s_cselect_b32 s29, s56, s29
    s_add_u32 s25, s25, 16384
    s_cmp_eq_u32 s25, s27
    s_cselect_b32 s25, s40, s25
    v_cvt_pk_bf16_f32 v216, v20, v21
    s_waitcnt lgkmcnt(3)
    v_mfma_f32_16x16x32_bf16 v[176:179], v[40:43], v[136:139], v[176:179]
    v_exp_f32 v22, v194
    s_add_u32 s59, s59, s45
    v_mfma_f32_16x16x32_bf16 v[180:183], v[40:43], v[152:155], v[180:183]
    ds_read_b128 v[40:43], v2 offset:6144
    s_waitcnt lgkmcnt(3)
    v_mfma_f32_16x16x32_bf16 v[176:179], v[44:47], v[140:143], v[176:179]
    v_exp_f32 v23, v195
    s_add_u32 s60, s60, s45
    v_mfma_f32_16x16x32_bf16 v[180:183], v[44:47], v[156:159], v[180:183]
    ds_read_b128 v[44:47], v2 offset:7168
    v_cvt_pk_bf16_f32 v217, v22, v23
    s_waitcnt lgkmcnt(3)
    v_mfma_f32_16x16x32_bf16 v[184:187], v[32:35], v[128:131], v[160:163]
    v_exp_f32 v24, v200
    s_lshl_b32 s52, s46, 15
    v_mfma_f32_16x16x32_bf16 v[188:191], v[32:35], v[144:147], v[164:167]
    s_add_u32 s32, s32, 16384
    s_and_b32 s32, s32, 0xffff
    v_add_u32 v3, s32, v6
    v_add_u32 v4, s32, v7
    ds_read_b128 v[32:35], v3 offset:0
    s_waitcnt lgkmcnt(3)
    v_mfma_f32_16x16x32_bf16 v[184:187], v[36:39], v[132:135], v[184:187]
    v_exp_f32 v25, v201
    s_lshl_b32 s61, s61, 17
    v_mfma_f32_16x16x32_bf16 v[188:191], v[36:39], v[148:151], v[188:191]
    ds_read_b128 v[36:39], v3 offset:1024
    s_add_u32 m0, s30, s57
    s_add_u32 s30, s30, 16384
    buffer_load_dwordx4 v1, s[8:11], s26 offen sc1 lds
    v_cvt_pk_bf16_f32 v218, v24, v25
    v_or3_b32 v28, v216, v217, v218
    s_waitcnt lgkmcnt(3)
    v_mfma_f32_16x16x32_bf16 v[184:187], v[40:43], v[136:139], v[184:187]
    v_exp_f32 v26, v202
    s_lshl_b32 s62, s62, 17
    v_mfma_f32_16x16x32_bf16 v[188:191], v[40:43], v[152:155], v[188:191]
    ds_read_b128 v[40:43], v3 offset:2048
    s_waitcnt lgkmcnt(3)
    v_mfma_f32_16x16x32_bf16 v[184:187], v[44:47], v[140:143], v[184:187]
    v_exp_f32 v27, v203
    s_lshl_b32 s63, s63, 17
    v_mfma_f32_16x16x32_bf16 v[188:191], v[44:47], v[156:159], v[188:191]
    ds_read_b128 v[44:47], v3 offset:3072
    v_cvt_pk_bf16_f32 v219, v26, v27
    v_mfma_f32_16x16x32_bf16 v[168:171], v[12:15], v[208:211], v[168:171]
    v_exp_f32 v20, v196
    s_add_u32 s45, s52, 33554432
    v_mfma_f32_16x16x32_bf16 v[172:175], v[12:15], v[212:215], v[172:175]
    s_waitcnt lgkmcnt(3)
    v_mfma_f32_16x16x32_bf16 v[64:67], v[32:35], v[208:211], v[64:67]
    v_exp_f32 v21, v197
    s_add_u32 s61, s61, s45
    v_mfma_f32_16x16x32_bf16 v[68:71], v[32:35], v[212:215], v[68:71]
    ds_read_b128 v[32:35], v4 offset:4096
    v_cvt_pk_bf16_f32 v220, v20, v21
    v_or3_b32 v28, v28, v219, v220
    s_waitcnt lgkmcnt(3)
    v_mfma_f32_16x16x32_bf16 v[72:75], v[36:39], v[208:211], v[72:75]
    v_exp_f32 v22, v198
    s_add_u32 s45, s52, 62914560
    v_mfma_f32_16x16x32_bf16 v[76:79], v[36:39], v[212:215], v[76:79]
    ds_read_b128 v[36:39], v4 offset:5120
    buffer_load_dwordx4 v1, s[8:11], s26 offen offset:1024 sc1 lds
    s_and_b32 s30, s30, 0xffff
    s_add_u32 s26, s26, 16384
    s_cmp_eq_u32 s26, s28
    s_cselect_b32 s26, s40, s26
    s_waitcnt lgkmcnt(3)
    v_mfma_f32_16x16x32_bf16 v[80:83], v[40:43], v[208:211], v[80:83]
    v_exp_f32 v23, v199
    s_add_u32 s62, s62, s45
    v_mfma_f32_16x16x32_bf16 v[84:87], v[40:43], v[212:215], v[84:87]
    ds_read_b128 v[40:43], v4 offset:6144
    s_mul_i32 s38, s92, 2
    s_add_u32 s38, s38, s91
    buffer_store_dwordx4 v[56:59], v1, s[12:15], s38 offen sc1
    v_cvt_pk_bf16_f32 v221, v22, v23
    s_waitcnt lgkmcnt(3)
    v_mfma_f32_16x16x32_bf16 v[88:91], v[44:47], v[208:211], v[88:91]
    v_exp_f32 v24, v204
    s_add_u32 s63, s63, s45
    v_mfma_f32_16x16x32_bf16 v[92:95], v[44:47], v[212:215], v[92:95]
    ds_read_b128 v[44:47], v4 offset:7168
    s_waitcnt vmcnt(6)
    s_barrier
    s_waitcnt lgkmcnt(3)
    v_mfma_f32_16x16x32_bf16 v[96:99], v[32:35], v[208:211], v[96:99]
    v_exp_f32 v25, v205
    s_lshl_b32 s52, s24, 1
    v_mfma_f32_16x16x32_bf16 v[100:103], v[32:35], v[212:215], v[100:103]
    s_add_u32 s31, s31, 16384
    s_cmp_eq_u32 s31, 49152
    s_cselect_b32 s31, 0, s31
    v_add_u32 v2, s31, v5
    ds_read_b128 v[32:35], v2 offset:0
    s_mov_b32 m0, s29
    s_add_u32 s29, s29, 16384
    buffer_load_dwordx4 v1, s[4:7], s25 offen sc1 lds
    v_cvt_pk_bf16_f32 v222, v24, v25
    v_or3_b32 v28, v28, v221, v222
    s_waitcnt lgkmcnt(3)
    v_mfma_f32_16x16x32_bf16 v[104:107], v[36:39], v[208:211], v[104:107]
    v_exp_f32 v26, v206
    s_and_b32 s45, s22, 1
    v_mfma_f32_16x16x32_bf16 v[108:111], v[36:39], v[212:215], v[108:111]
    ds_read_b128 v[36:39], v2 offset:1024
    s_waitcnt lgkmcnt(3)
    v_mfma_f32_16x16x32_bf16 v[112:115], v[40:43], v[208:211], v[112:115]
    v_exp_f32 v27, v207
    s_add_u32 s52, s52, s45
    v_mfma_f32_16x16x32_bf16 v[116:119], v[40:43], v[212:215], v[116:119]
    ds_read_b128 v[40:43], v2 offset:2048
    v_cvt_pk_bf16_f32 v223, v26, v27
    v_or_b32 v28, v28, v223
    s_waitcnt lgkmcnt(3)
    v_mfma_f32_16x16x32_bf16 v[120:123], v[44:47], v[208:211], v[120:123]
    v_and_b32 v28, s37, v28
    s_lshl_b32 s52, s52, 10
    v_mfma_f32_16x16x32_bf16 v[124:127], v[44:47], v[212:215], v[124:127]
    ds_read_b128 v[44:47], v2 offset:3072
    v_cmp_ne_u32 vcc, 0, v28
    s_sub_u32 s34, s34, 64
    s_cbranch_vccnz L_rare_37
L_rareback_38:
    s_waitcnt lgkmcnt(3)
    v_mfma_f32_16x16x32_bf16 v[192:195], v[32:35], v[128:131], v[160:163]
    v_exp_f32 v20, v176
    s_add_u32 s60, s60, s52
    v_mfma_f32_16x16x32_bf16 v[196:199], v[32:35], v[144:147], v[164:167]
    ds_read_b128 v[32:35], v2 offset:4096
    s_waitcnt lgkmcnt(3)
    v_mfma_f32_16x16x32_bf16 v[192:195], v[36:39], v[132:135], v[192:195]
    v_exp_f32 v21, v177
    s_add_u32 s63, s63, s52
    v_mfma_f32_16x16x32_bf16 v[196:199], v[36:39], v[148:151], v[196:199]
    ds_read_b128 v[36:39], v2 offset:5120
    buffer_load_dwordx4 v1, s[4:7], s25 offen offset:1024 sc1 lds
    s_cmp_eq_u32 s29, s41
    s_cselect_b32 s29, s56, s29
    s_add_u32 s25, s25, 16384
    s_cmp_eq_u32 s25, s27
    s_cselect_b32 s25, s40, s25
    v_cvt_pk_bf16_f32 v208, v20, v21
    s_waitcnt lgkmcnt(3)
    v_mfma_f32_16x16x32_bf16 v[192:195], v[40:43], v[136:139], v[192:195]
    v_exp_f32 v22, v178
    s_lshl_b32 s64, s22, 11
    v_mfma_f32_16x16x32_bf16 v[196:199], v[40:43], v[152:155], v[196:199]
    ds_read_b128 v[40:43], v2 offset:6144
    s_waitcnt lgkmcnt(3)
    v_mfma_f32_16x16x32_bf16 v[192:195], v[44:47], v[140:143], v[192:195]
    v_exp_f32 v23, v179
    s_lshl_b32 s65, s22, 10
    v_mfma_f32_16x16x32_bf16 v[196:199], v[44:47], v[156:159], v[196:199]
    ds_read_b128 v[44:47], v2 offset:7168
    v_cvt_pk_bf16_f32 v209, v22, v23
    s_waitcnt lgkmcnt(3)
    v_mfma_f32_16x16x32_bf16 v[200:203], v[32:35], v[128:131], v[160:163]
    v_exp_f32 v24, v184
    s_lshl_b32 s66, s48, 1
    v_mfma_f32_16x16x32_bf16 v[204:207], v[32:35], v[144:147], v[164:167]
    s_add_u32 s32, s32, 16384
    s_and_b32 s32, s32, 0xffff
    v_add_u32 v3, s32, v6
    v_add_u32 v4, s32, v7
    ds_read_b128 v[32:35], v3 offset:0
    s_waitcnt lgkmcnt(3)
    v_mfma_f32_16x16x32_bf16 v[200:203], v[36:39], v[132:135], v[200:203]
    v_exp_f32 v25, v185
    s_lshr_b32 s45, s23, 1
    v_mfma_f32_16x16x32_bf16 v[204:207], v[36:39], v[148:151], v[204:207]
    ds_read_b128 v[36:39], v3 offset:1024
    s_add_u32 m0, s30, s57
    s_add_u32 s30, s30, 16384
    buffer_load_dwordx4 v1, s[8:11], s26 offen sc1 lds
    v_cvt_pk_bf16_f32 v210, v24, v25
    v_or3_b32 v28, v208, v209, v210
    s_waitcnt lgkmcnt(3)
    v_mfma_f32_16x16x32_bf16 v[200:203], v[40:43], v[136:139], v[200:203]
    v_exp_f32 v26, v186
    s_add_u32 s66, s66, s45
    v_mfma_f32_16x16x32_bf16 v[204:207], v[40:43], v[152:155], v[204:207]
    ds_read_b128 v[40:43], v3 offset:2048
    s_waitcnt lgkmcnt(3)
    v_mfma_f32_16x16x32_bf16 v[200:203], v[44:47], v[140:143], v[200:203]
    v_exp_f32 v27, v187
    s_lshl_b32 s66, s66, 3
    v_mfma_f32_16x16x32_bf16 v[204:207], v[44:47], v[156:159], v[204:207]
    ds_read_b128 v[44:47], v3 offset:3072
    v_cvt_pk_bf16_f32 v211, v26, v27
    v_mfma_f32_16x16x32_bf16 v[168:171], v[12:15], v[216:219], v[168:171]
    v_exp_f32 v20, v180
    s_lshl_b32 s45, s50, 1
    v_mfma_f32_16x16x32_bf16 v[172:175], v[12:15], v[220:223], v[172:175]
    s_waitcnt lgkmcnt(3)
    v_mfma_f32_16x16x32_bf16 v[64:67], v[32:35], v[216:219], v[64:67]
    v_exp_f32 v21, v181
    s_add_u32 s66, s66, s45
    v_mfma_f32_16x16x32_bf16 v[68:71], v[32:35], v[220:223], v[68:71]
    ds_read_b128 v[32:35], v4 offset:4096
    v_cvt_pk_bf16_f32 v212, v20, v21
    v_or3_b32 v28, v28, v211, v212
    s_waitcnt lgkmcnt(3)
    v_mfma_f32_16x16x32_bf16 v[72:75], v[36:39], v[216:219], v[72:75]
    v_exp_f32 v22, v182
    s_add_u32 s66, s66, s24
    v_mfma_f32_16x16x32_bf16 v[76:79], v[36:39], v[220:223], v[76:79]
    ds_read_b128 v[36:39], v4 offset:5120
    buffer_load_dwordx4 v1, s[8:11], s26 offen offset:1024 sc1 lds
    s_and_b32 s30, s30, 0xffff
    s_add_u32 s26, s26, 16384
    s_cmp_eq_u32 s26, s28
    s_cselect_b32 s26, s40, s26
    s_waitcnt lgkmcnt(3)
    v_mfma_f32_16x16x32_bf16 v[80:83], v[40:43], v[216:219], v[80:83]
    v_exp_f32 v23, v183
    s_lshl_b32 s66, s66, 2
    v_mfma_f32_16x16x32_bf16 v[84:87], v[40:43], v[220:223], v[84:87]
    ds_read_b128 v[40:43], v4 offset:6144
    s_mul_i32 s38, s92, 3
    s_add_u32 s38, s38, s91
    buffer_store_dwordx4 v[60:63], v1, s[12:15], s38 offen sc1
    v_cvt_pk_bf16_f32 v213, v22, v23
    s_waitcnt lgkmcnt(3)
    v_mfma_f32_16x16x32_bf16 v[88:91], v[44:47], v[216:219], v[88:91]
    v_exp_f32 v24, v188
    s_andn2_b32 s45, s23, 1
    v_mfma_f32_16x16x32_bf16 v[92:95], v[44:47], v[220:223], v[92:95]
    ds_read_b128 v[44:47], v4 offset:7168
    s_waitcnt vmcnt(6)
    s_barrier
    s_waitcnt lgkmcnt(3)
    v_mfma_f32_16x16x32_bf16 v[96:99], v[32:35], v[216:219], v[96:99]
    v_exp_f32 v25, v189
    s_add_u32 s45, s45, s24
    v_mfma_f32_16x16x32_bf16 v[100:103], v[32:35], v[220:223], v[100:103]
    s_add_u32 s31, s31, 16384
    s_cmp_eq_u32 s31, 49152
    s_cselect_b32 s31, 0, s31
    v_add_u32 v2, s31, v5
    ds_read_b128 v[32:35], v2 offset:0
    s_mov_b32 m0, s29
    s_add_u32 s29, s29, 16384
    buffer_load_dwordx4 v1, s[4:7], s25 offen sc1 lds
    v_cvt_pk_bf16_f32 v214, v24, v25
    v_or3_b32 v28, v28, v213, v214
    s_waitcnt lgkmcnt(3)
    v_mfma_f32_16x16x32_bf16 v[104:107], v[36:39], v[216:219], v[104:107]
    v_exp_f32 v26, v190
    s_sub_u32 s46, s46, s45
    v_mfma_f32_16x16x32_bf16 v[108:111], v[36:39], v[220:223], v[108:111]
    ds_read_b128 v[36:39], v2 offset:1024
    s_waitcnt lgkmcnt(3)
    v_mfma_f32_16x16x32_bf16 v[112:115], v[40:43], v[216:219], v[112:115]
    v_exp_f32 v27, v191
    s_add_u32 s46, s46, 3
    v_mfma_f32_16x16x32_bf16 v[116:119], v[40:43], v[220:223], v[116:119]
    ds_read_b128 v[40:43], v2 offset:2048
    v_cvt_pk_bf16_f32 v215, v26, v27
    v_or_b32 v28, v28, v215
    s_waitcnt lgkmcnt(3)
    v_mfma_f32_16x16x32_bf16 v[120:123], v[44:47], v[216:219], v[120:123]
    v_and_b32 v28, s37, v28
    s_and_b32 s46, s46, 3
    v_mfma_f32_16x16x32_bf16 v[124:127], v[44:47], v[220:223], v[124:127]
    ds_read_b128 v[44:47], v2 offset:3072
    v_cmp_ne_u32 vcc, 0, v28
    s_sub_u32 s34, s34, 64
    s_cbranch_vccnz L_rare_39
L_rareback_40:
    s_waitcnt lgkmcnt(3)
    v_mfma_f32_16x16x32_bf16 v[176:179], v[32:35], v[128:131], v[160:163]
    v_exp_f32 v20, v192
    s_add_u32 s66, s66, s46
    v_mfma_f32_16x16x32_bf16 v[180:183], v[32:35], v[144:147], v[164:167]
    ds_read_b128 v[32:35], v2 offset:4096
    s_mul_i32 s66, s66, 20480
    s_waitcnt lgkmcnt(3)
    v_mfma_f32_16x16x32_bf16 v[176:179], v[36:39], v[132:135], v[176:179]
    v_exp_f32 v21, v193
    v_mfma_f32_16x16x32_bf16 v[180:183], v[36:39], v[148:151], v[180:183]
    ds_read_b128 v[36:39], v2 offset:5120
    buffer_load_dwordx4 v1, s[4:7], s25 offen offset:1024 sc1 lds
    s_cmp_eq_u32 s29, s41
    s_cselect_b32 s29, s56, s29
    s_add_u32 s25, s25, 16384
    s_cmp_eq_u32 s25, s27
    s_cselect_b32 s25, s40, s25
    v_cvt_pk_bf16_f32 v216, v20, v21
    s_add_u32 s66, s66, 75497472
    s_waitcnt lgkmcnt(3)
    v_mfma_f32_16x16x32_bf16 v[176:179], v[40:43], v[136:139], v[176:179]
    v_exp_f32 v22, v194
    v_mfma_f32_16x16x32_bf16 v[180:183], v[40:43], v[152:155], v[180:183]
    ds_read_b128 v[40:43], v2 offset:6144
    s_and_b32 s45, s23, 1
    s_waitcnt lgkmcnt(3)
    v_mfma_f32_16x16x32_bf16 v[176:179], v[44:47], v[140:143], v[176:179]
    v_exp_f32 v23, v195
    v_mfma_f32_16x16x32_bf16 v[180:183], v[44:47], v[156:159], v[180:183]
    ds_read_b128 v[44:47], v2 offset:7168
    v_cvt_pk_bf16_f32 v217, v22, v23
    s_mul_i32 s45, s45, 5120
    s_waitcnt lgkmcnt(3)
    v_mfma_f32_16x16x32_bf16 v[184:187], v[32:35], v[128:131], v[160:163]
    v_exp_f32 v24, v200
    v_mfma_f32_16x16x32_bf16 v[188:191], v[32:35], v[144:147], v[164:167]
    s_add_u32 s32, s32, 16384
    s_and_b32 s32, s32, 0xffff
    v_add_u32 v3, s32, v6
    v_add_u32 v4, s32, v7
    ds_read_b128 v[32:35], v3 offset:0
    s_add_u32 s66, s66, s45
    s_waitcnt lgkmcnt(3)
    v_mfma_f32_16x16x32_bf16 v[184:187], v[36:39], v[132:135], v[184:187]
    v_exp_f32 v25, v201
    v_mfma_f32_16x16x32_bf16 v[188:191], v[36:39], v[148:151], v[188:191]
    ds_read_b128 v[36:39], v3 offset:1024
    s_add_u32 m0, s30, s57
    s_add_u32 s30, s30, 16384
    buffer_load_dwordx4 v1, s[8:11], s26 offen sc1 lds
    v_cvt_pk_bf16_f32 v218, v24, v25
    v_or3_b32 v28, v216, v217, v218
    s_add_u32 s86, s66, 10240
    s_waitcnt lgkmcnt(3)
    v_mfma_f32_16x16x32_bf16 v[184:187], v[40:43], v[136:139], v[184:187]
    v_exp_f32 v26, v202
    v_mfma_f32_16x16x32_bf16 v[188:191], v[40:43], v[152:155], v[188:191]
    ds_read_b128 v[40:43], v3 offset:2048
    s_cmp_eq_u32 s46, 3
    s_cselect_b32 s45, 0x40000000, 0
    s_waitcnt lgkmcnt(3)
    v_mfma_f32_16x16x32_bf16 v[184:187], v[44:47], v[140:143], v[184:187]
    v_exp_f32 v27, v203
    v_mfma_f32_16x16x32_bf16 v[188:191], v[44:47], v[156:159], v[188:191]
    ds_read_b128 v[44:47], v3 offset:3072
    v_cvt_pk_bf16_f32 v219, v26, v27
    s_add_u32 s86, s86, s45
    v_mfma_f32_16x16x32_bf16 v[168:171], v[12:15], v[208:211], v[168:171]
    v_exp_f32 v20, v196
    v_mfma_f32_16x16x32_bf16 v[172:175], v[12:15], v[212:215], v[172:175]
    s_add_u32 s66, s66, s45
    s_waitcnt lgkmcnt(3)
    v_mfma_f32_16x16x32_bf16 v[64:67], v[32:35], v[208:211], v[64:67]
    v_exp_f32 v21, v197
    s_lshl_b32 s80, s101, 3
    v_mfma_f32_16x16x32_bf16 v[68:71], v[32:35], v[212:215], v[68:71]
    ds_read_b128 v[32:35], v4 offset:4096
    v_cvt_pk_bf16_f32 v220, v20, v21
    v_or3_b32 v28, v28, v219, v220
    s_waitcnt lgkmcnt(3)
    v_mfma_f32_16x16x32_bf16 v[72:75], v[36:39], v[208:211], v[72:75]
    v_exp_f32 v22, v198
    s_add_u32 s80, s80, s75
    v_mfma_f32_16x16x32_bf16 v[76:79], v[36:39], v[212:215], v[76:79]
    ds_read_b128 v[36:39], v4 offset:5120
    buffer_load_dwordx4 v1, s[8:11], s26 offen offset:1024 sc1 lds
    s_and_b32 s30, s30, 0xffff
    s_add_u32 s26, s26, 16384
    s_cmp_eq_u32 s26, s28
    s_cselect_b32 s26, s40, s26
    s_waitcnt lgkmcnt(3)
    v_mfma_f32_16x16x32_bf16 v[80:83], v[40:43], v[208:211], v[80:83]
    v_exp_f32 v23, v199
    s_mul_i32 s80, s80, 81920
    v_mfma_f32_16x16x32_bf16 v[84:87], v[40:43], v[212:215], v[84:87]
    ds_read_b128 v[40:43], v4 offset:6144
    v_cvt_pk_bf16_f32 v221, v22, v23
    s_waitcnt lgkmcnt(3)
    v_mfma_f32_16x16x32_bf16 v[88:91], v[44:47], v[208:211], v[88:91]
    v_exp_f32 v24, v204
    s_add_u32 s80, s80, 75497472
    v_mfma_f32_16x16x32_bf16 v[92:95], v[44:47], v[212:215], v[92:95]
    ds_read_b128 v[44:47], v4 offset:7168
    s_waitcnt vmcnt(5)
    s_barrier
    s_waitcnt lgkmcnt(3)
    v_mfma_f32_16x16x32_bf16 v[96:99], v[32:35], v[208:211], v[96:99]
    v_exp_f32 v25, v205
    s_mul_i32 s45, s24, 5120
    v_mfma_f32_16x16x32_bf16 v[100:103], v[32:35], v[212:215], v[100:103]
    s_add_u32 s31, s31, 16384
    s_cmp_eq_u32 s31, 49152
    s_cselect_b32 s31, 0, s31
    v_add_u32 v2, s31, v5
    ds_read_b128 v[32:35], v2 offset:0
    s_mov_b32 m0, s29
    s_add_u32 s29, s29, 16384
    buffer_load_dwordx4 v1, s[4:7], s25 offen sc1 lds
    v_cvt_pk_bf16_f32 v222, v24, v25
    v_or3_b32 v28, v28, v221, v222
    s_waitcnt lgkmcnt(3)
    v_mfma_f32_16x16x32_bf16 v[104:107], v[36:39], v[208:211], v[104:107]
    v_exp_f32 v26, v206
    s_add_u32 s80, s80, s45
    v_mfma_f32_16x16x32_bf16 v[108:111], v[36:39], v[212:215], v[108:111]
    ds_read_b128 v[36:39], v2 offset:1024
    s_waitcnt lgkmcnt(3)
    v_mfma_f32_16x16x32_bf16 v[112:115], v[40:43], v[208:211], v[112:115]
    v_exp_f32 v27, v207
    s_mov_b32 s83, 0x3f80
    v_mfma_f32_16x16x32_bf16 v[116:119], v[40:43], v[212:215], v[116:119]
    ds_read_b128 v[40:43], v2 offset:2048
    v_cvt_pk_bf16_f32 v223, v26, v27
    v_or_b32 v28, v28, v223
    s_waitcnt lgkmcnt(3)
    v_mfma_f32_16x16x32_bf16 v[120:123], v[44:47], v[208:211], v[120:123]
    v_and_b32 v28, s37, v28
    s_mov_b32 s84, 0x3f800000
    v_mfma_f32_16x16x32_bf16 v[124:127], v[44:47], v[212:215], v[124:127]
    ds_read_b128 v[44:47], v2 offset:3072
    v_cmp_ne_u32 vcc, 0, v28
    s_sub_u32 s34, s34, 64
    s_cbranch_vccnz L_rare_41
L_rareback_42:
    s_waitcnt lgkmcnt(3)
    v_mfma_f32_16x16x32_bf16 v[192:195], v[32:35], v[128:131], v[160:163]
    v_exp_f32 v20, v176
    v_mfma_f32_16x16x32_bf16 v[196:199], v[32:35], v[144:147], v[164:167]
    ds_read_b128 v[32:35], v2 offset:4096
    s_waitcnt lgkmcnt(3)
    v_mfma_f32_16x16x32_bf16 v[192:195], v[36:39], v[132:135], v[192:195]
    v_exp_f32 v21, v177
    v_mfma_f32_16x16x32_bf16 v[196:199], v[36:39], v[148:151], v[196:199]
    ds_read_b128 v[36:39], v2 offset:5120
    buffer_load_dwordx4 v1, s[4:7], s25 offen offset:1024 sc1 lds
    s_cmp_eq_u32 s29, s41
    s_cselect_b32 s29, s56, s29
    s_add_u32 s25, s25, 16384
    s_cmp_eq_u32 s25, s27
    s_cselect_b32 s25, s40, s25
    v_cvt_pk_bf16_f32 v208, v20, v21
    s_waitcnt lgkmcnt(3)
    v_mfma_f32_16x16x32_bf16 v[192:195], v[40:43], v[136:139], v[192:195]
    v_exp_f32 v22, v178
    v_mfma_f32_16x16x32_bf16 v[196:199], v[40:43], v[152:155], v[196:199]
    ds_read_b128 v[40:43], v2 offset:6144
    s_waitcnt lgkmcnt(3)
    v_mfma_f32_16x16x32_bf16 v[192:195], v[44:47], v[140:143], v[192:195]
    v_exp_f32 v23, v179
    v_mfma_f32_16x16x32_bf16 v[196:199], v[44:47], v[156:159], v[196:199]
    ds_read_b128 v[44:47], v2 offset:7168
    v_cvt_pk_bf16_f32 v209, v22, v23
    s_waitcnt lgkmcnt(3)
    v_mfma_f32_16x16x32_bf16 v[200:203], v[32:35], v[128:131], v[160:163]
    v_exp_f32 v24, v184
    v_mfma_f32_16x16x32_bf16 v[204:207], v[32:35], v[144:147], v[164:167]
    s_add_u32 s32, s32, 16384
    s_and_b32 s32, s32, 0xffff
    v_add_u32 v3, s32, v6
    v_add_u32 v4, s32, v7
    ds_read_b128 v[32:35], v3 offset:0
    s_waitcnt lgkmcnt(3)
    v_mfma_f32_16x16x32_bf16 v[200:203], v[36:39], v[132:135], v[200:203]
    v_exp_f32 v25, v185
    v_mfma_f32_16x16x32_bf16 v[204:207], v[36:39], v[148:151], v[204:207]
    ds_read_b128 v[36:39], v3 offset:1024
    s_add_u32 m0, s30, s57
    s_add_u32 s30, s30, 16384
    buffer_load_dwordx4 v1, s[8:11], s26 offen sc1 lds
    v_cvt_pk_bf16_f32 v210, v24, v25
    v_or3_b32 v28, v208, v209, v210
    s_waitcnt lgkmcnt(3)
    v_mfma_f32_16x16x32_bf16 v[200:203], v[40:43], v[136:139], v[200:203]
    v_exp_f32 v26, v186
    v_mfma_f32_16x16x32_bf16 v[204:207], v[40:43], v[152:155], v[204:207]
    ds_read_b128 v[40:43], v3 offset:2048
    s_waitcnt lgkmcnt(3)
    v_mfma_f32_16x16x32_bf16 v[200:203], v[44:47], v[140:143], v[200:203]
    v_exp_f32 v27, v187
    v_mfma_f32_16x16x32_bf16 v[204:207], v[44:47], v[156:159], v[204:207]
    ds_read_b128 v[44:47], v3 offset:3072
    v_cvt_pk_bf16_f32 v211, v26, v27
    v_mfma_f32_16x16x32_bf16 v[168:171], v[12:15], v[216:219], v[168:171]
    v_exp_f32 v20, v180
    v_mfma_f32_16x16x32_bf16 v[172:175], v[12:15], v[220:223], v[172:175]
    s_waitcnt lgkmcnt(3)
    v_mfma_f32_16x16x32_bf16 v[64:67], v[32:35], v[216:219], v[64:67]
    v_exp_f32 v21, v181
    v_mfma_f32_16x16x32_bf16 v[68:71], v[32:35], v[220:223], v[68:71]
    ds_read_b128 v[32:35], v4 offset:4096
    v_cvt_pk_bf16_f32 v212, v20, v21
    v_or3_b32 v28, v28, v211, v212
    s_waitcnt lgkmcnt(3)
    v_mfma_f32_16x16x32_bf16 v[72:75], v[36:39], v[216:219], v[72:75]
    v_exp_f32 v22, v182
    v_mfma_f32_16x16x32_bf16 v[76:79], v[36:39], v[220:223], v[76:79]
    ds_read_b128 v[36:39], v4 offset:5120
    buffer_load_dwordx4 v1, s[8:11], s26 offen offset:1024 sc1 lds
    s_and_b32 s30, s30, 0xffff
    s_add_u32 s26, s26, 16384
    s_cmp_eq_u32 s26, s28
    s_cselect_b32 s26, s40, s26
    s_waitcnt lgkmcnt(3)
    v_mfma_f32_16x16x32_bf16 v[80:83], v[40:43], v[216:219], v[80:83]
    v_exp_f32 v23, v183
    v_mfma_f32_16x16x32_bf16 v[84:87], v[40:43], v[220:223], v[84:87]
    ds_read_b128 v[40:43], v4 offset:6144
    v_cvt_pk_bf16_f32 v213, v22, v23
    s_waitcnt lgkmcnt(3)
    v_mfma_f32_16x16x32_bf16 v[88:91], v[44:47], v[216:219], v[88:91]
    v_exp_f32 v24, v188
    v_mfma_f32_16x16x32_bf16 v[92:95], v[44:47], v[220:223], v[92:95]
    ds_read_b128 v[44:47], v4 offset:7168
    s_waitcnt vmcnt(4)
    s_barrier
    s_waitcnt lgkmcnt(3)
    v_mfma_f32_16x16x32_bf16 v[96:99], v[32:35], v[216:219], v[96:99]
    v_exp_f32 v25, v189
    v_mfma_f32_16x16x32_bf16 v[100:103], v[32:35], v[220:223], v[100:103]
    s_add_u32 s31, s31, 16384
    s_cmp_eq_u32 s31, 49152
    s_cselect_b32 s31, 0, s31
    v_add_u32 v2, s31, v5
    ds_read_b128 v[32:35], v2 offset:0
    s_mov_b32 m0, s29
    s_add_u32 s29, s29, 16384
    buffer_load_dwordx4 v1, s[4:7], s25 offen sc1 lds
    s_cmp_eq_u32 s22, 0
    s_cbranch_scc0 L_fl_43
    s_add_u32 s45, s3, 4
    s_mov_b64 exec, 1
    v_mov_b32 v16, s45
    buffer_store_dword v16, off, s[12:15], s74 sc1
    s_mov_b64 exec, -1
L_fl_43:
    v_cvt_pk_bf16_f32 v214, v24, v25
    v_or3_b32 v28, v28, v213, v214
    s_waitcnt lgkmcnt(3)
    v_mfma_f32_16x16x32_bf16 v[104:107], v[36:39], v[216:219], v[104:107]
    v_exp_f32 v26, v190
    v_mfma_f32_16x16x32_bf16 v[108:111], v[36:39], v[220:223], v[108:111]
    ds_read_b128 v[36:39], v2 offset:1024
    s_waitcnt lgkmcnt(3)
    v_mfma_f32_16x16x32_bf16 v[112:115], v[40:43], v[216:219], v[112:115]
    v_exp_f32 v27, v191
    v_mfma_f32_16x16x32_bf16 v[116:119], v[40:43], v[220:223], v[116:119]
    ds_read_b128 v[40:43], v2 offset:2048
    v_cvt_pk_bf16_f32 v215, v26, v27
    v_or_b32 v28, v28, v215
    s_waitcnt lgkmcnt(3)
    v_mfma_f32_16x16x32_bf16 v[120:123], v[44:47], v[216:219], v[120:123]
    v_and_b32 v28, s37, v28
    v_mfma_f32_16x16x32_bf16 v[124:127], v[44:47], v[220:223], v[124:127]
    ds_read_b128 v[44:47], v2 offset:3072
    v_cmp_ne_u32 vcc, 0, v28
    s_sub_u32 s34, s34, 64
    s_cbranch_vccnz L_rare_44
L_rareback_45:
    s_sub_u32 s33, s33, 7
.p2align 3
L_loop_15:
    s_cmp_lt_i32 s34, 32
    s_cbranch_scc1 L_mask_46
L_maskback_47:
    s_waitcnt lgkmcnt(3)
    v_mfma_f32_16x16x32_bf16 v[176:179], v[32:35], v[128:131], v[160:163]
    v_exp_f32 v20, v192
    v_mfma_f32_16x16x32_bf16 v[180:183], v[32:35], v[144:147], v[164:167]
    ds_read_b128 v[32:35], v2 offset:4096
    s_waitcnt lgkmcnt(3)
    v_mfma_f32_16x16x32_bf16 v[176:179], v[36:39], v[132:135], v[176:179]
    v_exp_f32 v21, v193
    v_mfma_f32_16x16x32_bf16 v[180:183], v[36:39], v[148:151], v[180:183]
    ds_read_b128 v[36:39], v2 offset:5120
    buffer_load_dwordx4 v1, s[4:7], s25 offen offset:1024 sc1 lds
    s_cmp_eq_u32 s29, s41
    s_cselect_b32 s29, s56, s29
    s_add_u32 s25, s25, 16384
    s_cmp_eq_u32 s25, s27
    s_cselect_b32 s25, s40, s25
    v_cvt_pk_bf16_f32 v216, v20, v21
    s_waitcnt lgkmcnt(3)
    v_mfma_f32_16x16x32_bf16 v[176:179], v[40:43], v[136:139], v[176:179]
    v_exp_f32 v22, v194
    v_mfma_f32_16x16x32_bf16 v[180:183], v[40:43], v[152:155], v[180:183]
    ds_read_b128 v[40:43], v2 offset:6144
    s_waitcnt lgkmcnt(3)
    v_mfma_f32_16x16x32_bf16 v[176:179], v[44:47], v[140:143], v[176:179]
    v_exp_f32 v23, v195
    v_mfma_f32_16x16x32_bf16 v[180:183], v[44:47], v[156:159], v[180:183]
    ds_read_b128 v[44:47], v2 offset:7168
    v_cvt_pk_bf16_f32 v217, v22, v23
    s_waitcnt lgkmcnt(3)
    v_mfma_f32_16x16x32_bf16 v[184:187], v[32:35], v[128:131], v[160:163]
    v_exp_f32 v24, v200
    v_mfma_f32_16x16x32_bf16 v[188:191], v[32:35], v[144:147], v[164:167]
    s_add_u32 s32, s32, 16384
    s_and_b32 s32, s32, 0xffff
    v_add_u32 v3, s32, v6
    v_add_u32 v4, s32, v7
    ds_read_b128 v[32:35], v3 offset:0
    s_waitcnt lgkmcnt(3)
    v_mfma_f32_16x16x32_bf16 v[184:187], v[36:39], v[132:135], v[184:187]
    v_exp_f32 v25, v201
    v_mfma_f32_16x16x32_bf16 v[188:191], v[36:39], v[148:151], v[188:191]
    ds_read_b128 v[36:39], v3 offset:1024
    s_add_u32 m0, s30, s57
    s_add_u32 s30, s30, 16384
    buffer_load_dwordx4 v1, s[8:11], s26 offen sc1 lds
    v_cvt_pk_bf16_f32 v218, v24, v25
    v_or3_b32 v28, v216, v217, v218
    s_waitcnt lgkmcnt(3)
    v_mfma_f32_16x16x32_bf16 v[184:187], v[40:43], v[136:139], v[184:187]
    v_exp_f32 v26, v202
    v_mfma_f32_16x16x32_bf16 v[188:191], v[40:43], v[152:155], v[188:191]
    ds_read_b128 v[40:43], v3 offset:2048
    s_waitcnt lgkmcnt(3)
    v_mfma_f32_16x16x32_bf16 v[184:187], v[44:47], v[140:143], v[184:187]
    v_exp_f32 v27, v203
    v_mfma_f32_16x16x32_bf16 v[188:191], v[44:47], v[156:159], v[188:191]
    ds_read_b128 v[44:47], v3 offset:3072
    v_cvt_pk_bf16_f32 v219, v26, v27
    v_mfma_f32_16x16x32_bf16 v[168:171], v[12:15], v[208:211], v[168:171]
    v_exp_f32 v20, v196
    v_mfma_f32_16x16x32_bf16 v[172:175], v[12:15], v[212:215], v[172:175]
    s_waitcnt lgkmcnt(3)
    v_mfma_f32_16x16x32_bf16 v[64:67], v[32:35], v[208:211], v[64:67]
    v_exp_f32 v21, v197
    v_mfma_f32_16x16x32_bf16 v[68:71], v[32:35], v[212:215], v[68:71]
    ds_read_b128 v[32:35], v4 offset:4096
    v_cvt_pk_bf16_f32 v220, v20, v21
    v_or3_b32 v28, v28, v219, v220
    s_waitcnt lgkmcnt(3)
    v_mfma_f32_16x16x32_bf16 v[72:75], v[36:39], v[208:211], v[72:75]
    v_exp_f32 v22, v198
    v_mfma_f32_16x16x32_bf16 v[76:79], v[36:39], v[212:215], v[76:79]
    ds_read_b128 v[36:39], v4 offset:5120
    buffer_load_dwordx4 v1, s[8:11], s26 offen offset:1024 sc1 lds
    s_and_b32 s30, s30, 0xffff
    s_add_u32 s26, s26, 16384
    s_cmp_eq_u32 s26, s28
    s_cselect_b32 s26, s40, s26
    s_waitcnt lgkmcnt(3)
    v_mfma_f32_16x16x32_bf16 v[80:83], v[40:43], v[208:211], v[80:83]
    v_exp_f32 v23, v199
    v_mfma_f32_16x16x32_bf16 v[84:87], v[40:43], v[212:215], v[84:87]
    ds_read_b128 v[40:43], v4 offset:6144
    v_cvt_pk_bf16_f32 v221, v22, v23
    s_waitcnt lgkmcnt(3)
    v_mfma_f32_16x16x32_bf16 v[88:91], v[44:47], v[208:211], v[88:91]
    v_exp_f32 v24, v204
    v_mfma_f32_16x16x32_bf16 v[92:95], v[44:47], v[212:215], v[92:95]
    ds_read_b128 v[44:47], v4 offset:7168
    s_waitcnt vmcnt(4)
    s_barrier
    s_waitcnt lgkmcnt(3)
    v_mfma_f32_16x16x32_bf16 v[96:99], v[32:35], v[208:211], v[96:99]
    v_exp_f32 v25, v205
    v_mfma_f32_16x16x32_bf16 v[100:103], v[32:35], v[212:215], v[100:103]
    s_add_u32 s31, s31, 16384
    s_cmp_eq_u32 s31, 49152
    s_cselect_b32 s31, 0, s31
    v_add_u32 v2, s31, v5
    ds_read_b128 v[32:35], v2 offset:0
    s_mov_b32 m0, s29
    s_add_u32 s29, s29, 16384
    buffer_load_dwordx4 v1, s[4:7], s25 offen sc1 lds
    v_cvt_pk_bf16_f32 v222, v24, v25
    v_or3_b32 v28, v28, v221, v222
    s_waitcnt lgkmcnt(3)
    v_mfma_f32_16x16x32_bf16 v[104:107], v[36:39], v[208:211], v[104:107]
    v_exp_f32 v26, v206
    v_mfma_f32_16x16x32_bf16 v[108:111], v[36:39], v[212:215], v[108:111]
    ds_read_b128 v[36:39], v2 offset:1024
    s_waitcnt lgkmcnt(3)
    v_mfma_f32_16x16x32_bf16 v[112:115], v[40:43], v[208:211], v[112:115]
    v_exp_f32 v27, v207
    v_mfma_f32_16x16x32_bf16 v[116:119], v[40:43], v[212:215], v[116:119]
    ds_read_b128 v[40:43], v2 offset:2048
    v_cvt_pk_bf16_f32 v223, v26, v27
    v_or_b32 v28, v28, v223
    s_waitcnt lgkmcnt(3)
    v_mfma_f32_16x16x32_bf16 v[120:123], v[44:47], v[208:211], v[120:123]
    v_and_b32 v28, s37, v28
    v_mfma_f32_16x16x32_bf16 v[124:127], v[44:47], v[212:215], v[124:127]
    ds_read_b128 v[44:47], v2 offset:3072
    v_cmp_ne_u32 vcc, 0, v28
    s_sub_u32 s34, s34, 64
    s_cbranch_vccnz L_rare_48
L_rareback_49:
    s_cmp_lt_i32 s34, 32
    s_cbranch_scc1 L_mask_50
L_maskback_51:
    s_waitcnt lgkmcnt(3)
    v_mfma_f32_16x16x32_bf16 v[192:195], v[32:35], v[128:131], v[160:163]
    v_exp_f32 v20, v176
    v_mfma_f32_16x16x32_bf16 v[196:199], v[32:35], v[144:147], v[164:167]
    ds_read_b128 v[32:35], v2 offset:4096
    s_waitcnt lgkmcnt(3)
    v_mfma_f32_16x16x32_bf16 v[192:195], v[36:39], v[132:135], v[192:195]
    v_exp_f32 v21, v177
    v_mfma_f32_16x16x32_bf16 v[196:199], v[36:39], v[148:151], v[196:199]
    ds_read_b128 v[36:39], v2 offset:5120
    buffer_load_dwordx4 v1, s[4:7], s25 offen offset:1024 sc1 lds
    s_cmp_eq_u32 s29, s41
    s_cselect_b32 s29, s56, s29
    s_add_u32 s25, s25, 16384
    s_cmp_eq_u32 s25, s27
    s_cselect_b32 s25, s40, s25
    v_cvt_pk_bf16_f32 v208, v20, v21
    s_waitcnt lgkmcnt(3)
    v_mfma_f32_16x16x32_bf16 v[192:195], v[40:43], v[136:139], v[192:195]
    v_exp_f32 v22, v178
    v_mfma_f32_16x16x32_bf16 v[196:199], v[40:43], v[152:155], v[196:199]
    ds_read_b128 v[40:43], v2 offset:6144
    s_waitcnt lgkmcnt(3)
    v_mfma_f32_16x16x32_bf16 v[192:195], v[44:47], v[140:143], v[192:195]
    v_exp_f32 v23, v179
    v_mfma_f32_16x16x32_bf16 v[196:199], v[44:47], v[156:159], v[196:199]
    ds_read_b128 v[44:47], v2 offset:7168
    v_cvt_pk_bf16_f32 v209, v22, v23
    s_waitcnt lgkmcnt(3)
    v_mfma_f32_16x16x32_bf16 v[200:203], v[32:35], v[128:131], v[160:163]
    v_exp_f32 v24, v184
    v_mfma_f32_16x16x32_bf16 v[204:207], v[32:35], v[144:147], v[164:167]
    s_add_u32 s32, s32, 16384
    s_and_b32 s32, s32, 0xffff
    v_add_u32 v3, s32, v6
    v_add_u32 v4, s32, v7
    ds_read_b128 v[32:35], v3 offset:0
    s_waitcnt lgkmcnt(3)
    v_mfma_f32_16x16x32_bf16 v[200:203], v[36:39], v[132:135], v[200:203]
    v_exp_f32 v25, v185
    v_mfma_f32_16x16x32_bf16 v[204:207], v[36:39], v[148:151], v[204:207]
    ds_read_b128 v[36:39], v3 offset:1024
    s_add_u32 m0, s30, s57
    s_add_u32 s30, s30, 16384
    buffer_load_dwordx4 v1, s[8:11], s26 offen sc1 lds
    v_cvt_pk_bf16_f32 v210, v24, v25
    v_or3_b32 v28, v208, v209, v210
    s_waitcnt lgkmcnt(3)
    v_mfma_f32_16x16x32_bf16 v[200:203], v[40:43], v[136:139], v[200:203]
    v_exp_f32 v26, v186
    v_mfma_f32_16x16x32_bf16 v[204:207], v[40:43], v[152:155], v[204:207]
    ds_read_b128 v[40:43], v3 offset:2048
    s_waitcnt lgkmcnt(3)
    v_mfma_f32_16x16x32_bf16 v[200:203], v[44:47], v[140:143], v[200:203]
    v_exp_f32 v27, v187
    v_mfma_f32_16x16x32_bf16 v[204:207], v[44:47], v[156:159], v[204:207]
    ds_read_b128 v[44:47], v3 offset:3072
    v_cvt_pk_bf16_f32 v211, v26, v27
    v_mfma_f32_16x16x32_bf16 v[168:171], v[12:15], v[216:219], v[168:171]
    v_exp_f32 v20, v180
    v_mfma_f32_16x16x32_bf16 v[172:175], v[12:15], v[220:223], v[172:175]
    s_waitcnt lgkmcnt(3)
    v_mfma_f32_16x16x32_bf16 v[64:67], v[32:35], v[216:219], v[64:67]
    v_exp_f32 v21, v181
    v_mfma_f32_16x16x32_bf16 v[68:71], v[32:35], v[220:223], v[68:71]
    ds_read_b128 v[32:35], v4 offset:4096
    v_cvt_pk_bf16_f32 v212, v20, v21
    v_or3_b32 v28, v28, v211, v212
    s_waitcnt lgkmcnt(3)
    v_mfma_f32_16x16x32_bf16 v[72:75], v[36:39], v[216:219], v[72:75]
    v_exp_f32 v22, v182
    v_mfma_f32_16x16x32_bf16 v[76:79], v[36:39], v[220:223], v[76:79]
    ds_read_b128 v[36:39], v4 offset:5120
    buffer_load_dwordx4 v1, s[8:11], s26 offen offset:1024 sc1 lds
    s_and_b32 s30, s30, 0xffff
    s_add_u32 s26, s26, 16384
    s_cmp_eq_u32 s26, s28
    s_cselect_b32 s26, s40, s26
    s_waitcnt lgkmcnt(3)
    v_mfma_f32_16x16x32_bf16 v[80:83], v[40:43], v[216:219], v[80:83]
    v_exp_f32 v23, v183
    v_mfma_f32_16x16x32_bf16 v[84:87], v[40:43], v[220:223], v[84:87]
    ds_read_b128 v[40:43], v4 offset:6144
    v_cvt_pk_bf16_f32 v213, v22, v23
    s_waitcnt lgkmcnt(3)
    v_mfma_f32_16x16x32_bf16 v[88:91], v[44:47], v[216:219], v[88:91]
    v_exp_f32 v24, v188
    v_mfma_f32_16x16x32_bf16 v[92:95], v[44:47], v[220:223], v[92:95]
    ds_read_b128 v[44:47], v4 offset:7168
    s_waitcnt vmcnt(4)
    s_barrier
    s_waitcnt lgkmcnt(3)
    v_mfma_f32_16x16x32_bf16 v[96:99], v[32:35], v[216:219], v[96:99]
    v_exp_f32 v25, v189
    v_mfma_f32_16x16x32_bf16 v[100:103], v[32:35], v[220:223], v[100:103]
    s_add_u32 s31, s31, 16384
    s_cmp_eq_u32 s31, 49152
    s_cselect_b32 s31, 0, s31
    v_add_u32 v2, s31, v5
    ds_read_b128 v[32:35], v2 offset:0
    s_mov_b32 m0, s29
    s_add_u32 s29, s29, 16384
    buffer_load_dwordx4 v1, s[4:7], s25 offen sc1 lds
    v_cvt_pk_bf16_f32 v214, v24, v25
    v_or3_b32 v28, v28, v213, v214
    s_waitcnt lgkmcnt(3)
    v_mfma_f32_16x16x32_bf16 v[104:107], v[36:39], v[216:219], v[104:107]
    v_exp_f32 v26, v190
    v_mfma_f32_16x16x32_bf16 v[108:111], v[36:39], v[220:223], v[108:111]
    ds_read_b128 v[36:39], v2 offset:1024
    s_waitcnt lgkmcnt(3)
    v_mfma_f32_16x16x32_bf16 v[112:115], v[40:43], v[216:219], v[112:115]
    v_exp_f32 v27, v191
    v_mfma_f32_16x16x32_bf16 v[116:119], v[40:43], v[220:223], v[116:119]
    ds_read_b128 v[40:43], v2 offset:2048
    v_cvt_pk_bf16_f32 v215, v26, v27
    v_or_b32 v28, v28, v215
    s_waitcnt lgkmcnt(3)
    v_mfma_f32_16x16x32_bf16 v[120:123], v[44:47], v[216:219], v[120:123]
    v_and_b32 v28, s37, v28
    v_mfma_f32_16x16x32_bf16 v[124:127], v[44:47], v[220:223], v[124:127]
    ds_read_b128 v[44:47], v2 offset:3072
    v_cmp_ne_u32 vcc, 0, v28
    s_sub_u32 s34, s34, 64
    s_cbranch_vccnz L_rare_52
L_rareback_53:
    s_sub_u32 s33, s33, 1
    s_cmp_lg_u32 s33, 0
    s_cbranch_scc1 L_loop_15
L_loopend_16:
    v_mov_b32 v160, -20.0
    v_mov_b32 v161, -20.0
    v_mov_b32 v162, -20.0
    v_mov_b32 v163, -20.0
    v_mov_b32 v164, -20.0
    v_mov_b32 v165, -20.0
    v_mov_b32 v166, -20.0
    v_mov_b32 v167, -20.0
    s_nop 0
    s_waitcnt lgkmcnt(3)
    v_mfma_f32_16x16x32_bf16 v[176:179], v[32:35], v[224:227], v[160:163]
    v_add_u32 v16, s34, v8
    v_cmp_le_i32 s[46:47], 0, v16
    v_mfma_f32_16x16x32_bf16 v[180:183], v[32:35], v[240:243], v[164:167]
    ds_read_b128 v[32:35], v2 offset:4096
    v_cmp_le_i32 s[48:49], 1, v16
    v_cmp_le_i32 s[50:51], 2, v16
    s_waitcnt lgkmcnt(3)
    v_mfma_f32_16x16x32_bf16 v[176:179], v[36:39], v[228:231], v[176:179]
    v_cmp_le_i32 s[52:53], 3, v16
    v_cndmask_b32 v192, v9, v192, s[46:47]
    v_mfma_f32_16x16x32_bf16 v[180:183], v[36:39], v[244:247], v[180:183]
    ds_read_b128 v[36:39], v2 offset:5120
    buffer_load_dwordx4 v1, s[4:7], s25 offen offset:1024 sc1 lds
    s_cmp_eq_u32 s29, s41
    s_cselect_b32 s29, s56, s29
    s_add_u32 s25, s25, 16384
    s_cmp_eq_u32 s25, s27
    s_cselect_b32 s25, s40, s25
    v_cmp_le_i32 s[46:47], 16, v16
    v_cndmask_b32 v193, v9, v193, s[48:49]
    s_waitcnt lgkmcnt(3)
    v_mfma_f32_16x16x32_bf16 v[176:179], v[40:43], v[232:235], v[176:179]
    v_exp_f32 v20, v192
    v_cmp_le_i32 s[48:49], 17, v16
    v_mfma_f32_16x16x32_bf16 v[180:183], v[40:43], v[248:251], v[180:183]
    ds_read_b128 v[40:43], v2 offset:6144
    v_cndmask_b32 v194, v9, v194, s[50:51]
    v_exp_f32 v21, v193
    s_waitcnt lgkmcnt(3)
    v_mfma_f32_16x16x32_bf16 v[176:179], v[44:47], v[236:239], v[176:179]
    v_cmp_le_i32 s[50:51], 18, v16
    v_mfma_f32_16x16x32_bf16 v[180:183], v[44:47], v[252:255], v[180:183]
    ds_read_b128 v[44:47], v2 offset:7168
    v_cndmask_b32 v195, v9, v195, s[52:53]
    v_exp_f32 v22, v194
    s_waitcnt lgkmcnt(3)
    v_mfma_f32_16x16x32_bf16 v[184:187], v[32:35], v[224:227], v[160:163]
    v_cvt_pk_bf16_f32 v216, v20, v21
    v_cmp_le_i32 s[52:53], 19, v16
    v_mfma_f32_16x16x32_bf16 v[188:191], v[32:35], v[240:243], v[164:167]
    s_add_u32 s32, s32, 16384
    s_and_b32 s32, s32, 0xffff
    v_add_u32 v3, s32, v6
    v_add_u32 v4, s32, v7
    ds_read_b128 v[32:35], v3 offset:0
    v_cndmask_b32 v200, v9, v200, s[46:47]
    v_exp_f32 v23, v195
    s_waitcnt lgkmcnt(3)
    v_mfma_f32_16x16x32_bf16 v[184:187], v[36:39], v[228:231], v[184:187]
    v_cmp_le_i32 s[46:47], -16, v16
    v_cndmask_b32 v201, v9, v201, s[48:49]
    v_mfma_f32_16x16x32_bf16 v[188:191], v[36:39], v[244:247], v[188:191]
    ds_read_b128 v[36:39], v3 offset:1024
    s_add_u32 m0, s30, s57
    s_add_u32 s30, s30, 16384
    buffer_load_dwordx4 v1, s[8:11], s26 offen sc1 lds
    v_exp_f32 v24, v200
    v_cvt_pk_bf16_f32 v217, v22, v23
    s_waitcnt lgkmcnt(3)
    v_mfma_f32_16x16x32_bf16 v[184:187], v[40:43], v[232:235], v[184:187]
    v_cmp_le_i32 s[48:49], -15, v16
    v_cndmask_b32 v202, v9, v202, s[50:51]
    v_mfma_f32_16x16x32_bf16 v[188:191], v[40:43], v[248:251], v[188:191]
    ds_read_b128 v[40:43], v3 offset:2048
    v_exp_f32 v25, v201
    s_waitcnt lgkmcnt(3)
    v_mfma_f32_16x16x32_bf16 v[184:187], v[44:47], v[236:239], v[184:187]
    v_cmp_le_i32 s[50:51], -14, v16
    v_cndmask_b32 v203, v9, v203, s[52:53]
    v_mfma_f32_16x16x32_bf16 v[188:191], v[44:47], v[252:255], v[188:191]
    ds_read_b128 v[44:47], v3 offset:3072
    v_exp_f32 v26, v202
    v_cvt_pk_bf16_f32 v218, v24, v25
    v_mfma_f32_16x16x32_bf16 v[168:171], v[12:15], v[208:211], v[168:171]
    v_or3_b32 v28, v216, v217, v218
    v_cmp_le_i32 s[52:53], -13, v16
    v_mfma_f32_16x16x32_bf16 v[172:175], v[12:15], v[212:215], v[172:175]
    v_cndmask_b32 v196, v9, v196, s[46:47]
    v_exp_f32 v27, v203
    s_waitcnt lgkmcnt(3)
    v_mfma_f32_16x16x32_bf16 v[64:67], v[32:35], v[208:211], v[64:67]
    v_cmp_le_i32 s[46:47], 0, v16
    v_cndmask_b32 v197, v9, v197, s[48:49]
    v_mfma_f32_16x16x32_bf16 v[68:71], v[32:35], v[212:215], v[68:71]
    ds_read_b128 v[32:35], v4 offset:4096
    v_exp_f32 v20, v196
    v_cvt_pk_bf16_f32 v219, v26, v27
    s_waitcnt lgkmcnt(3)
    v_mfma_f32_16x16x32_bf16 v[72:75], v[36:39], v[208:211], v[72:75]
    v_cmp_le_i32 s[48:49], 1, v16
    v_mfma_f32_16x16x32_bf16 v[76:79], v[36:39], v[212:215], v[76:79]
    ds_read_b128 v[36:39], v4 offset:5120
    buffer_load_dwordx4 v1, s[8:11], s26 offen offset:1024 sc1 lds
    s_and_b32 s30, s30, 0xffff
    s_add_u32 s26, s26, 16384
    s_cmp_eq_u32 s26, s28
    s_cselect_b32 s26, s40, s26
    v_cndmask_b32 v198, v9, v198, s[50:51]
    v_exp_f32 v21, v197
    s_waitcnt lgkmcnt(3)
    v_mfma_f32_16x16x32_bf16 v[80:83], v[40:43], v[208:211], v[80:83]
    v_cmp_le_i32 s[50:51], 2, v16
    v_cndmask_b32 v199, v9, v199, s[52:53]
    v_mfma_f32_16x16x32_bf16 v[84:87], v[40:43], v[212:215], v[84:87]
    ds_read_b128 v[40:43], v4 offset:6144
    v_exp_f32 v22, v198
    v_cvt_pk_bf16_f32 v220, v20, v21
    s_waitcnt lgkmcnt(3)
    v_mfma_f32_16x16x32_bf16 v[88:91], v[44:47], v[208:211], v[88:91]
    v_or3_b32 v28, v28, v219, v220
    v_cmp_le_i32 s[52:53], 3, v16
    v_mfma_f32_16x16x32_bf16 v[92:95], v[44:47], v[212:215], v[92:95]
    ds_read_b128 v[44:47], v4 offset:7168
    v_cndmask_b32 v204, v9, v204, s[46:47]
    v_exp_f32 v23, v199
    s_waitcnt lgkmcnt(0)
    s_waitcnt vmcnt(4)
    s_barrier
    v_mfma_f32_16x16x32_bf16 v[96:99], v[32:35], v[208:211], v[96:99]
    v_cndmask_b32 v205, v9, v205, s[48:49]
    v_exp_f32 v24, v204
    v_mfma_f32_16x16x32_bf16 v[100:103], v[32:35], v[212:215], v[100:103]
    s_add_u32 s32, s32, 16384
    s_and_b32 s32, s32, 0xffff
    v_add_u32 v3, s32, v6
    v_add_u32 v4, s32, v7
    ds_read_b128 v[32:35], v4 offset:4096
    s_mov_b32 s92, s29
    s_mov_b32 s93, s25
    s_add_u32 s29, s29, 16384
    s_cmp_eq_u32 s29, s41
    s_cselect_b32 s29, s56, s29
    s_add_u32 s25, s25, 16384
    s_cmp_eq_u32 s25, s27
    s_cselect_b32 s25, s40, s25
    v_cvt_pk_bf16_f32 v221, v22, v23
    v_mfma_f32_16x16x32_bf16 v[104:107], v[36:39], v[208:211], v[104:107]
    v_cndmask_b32 v206, v9, v206, s[50:51]
    v_exp_f32 v25, v205
    v_mfma_f32_16x16x32_bf16 v[108:111], v[36:39], v[212:215], v[108:111]
    ds_read_b128 v[36:39], v4 offset:5120
    v_cndmask_b32 v207, v9, v207, s[52:53]
    v_exp_f32 v26, v206
    v_mfma_f32_16x16x32_bf16 v[112:115], v[40:43], v[208:211], v[112:115]
    v_cvt_pk_bf16_f32 v222, v24, v25
    v_or3_b32 v28, v28, v221, v222
    v_mfma_f32_16x16x32_bf16 v[116:119], v[40:43], v[212:215], v[116:119]
    ds_read_b128 v[40:43], v4 offset:6144
    v_exp_f32 v27, v207
    s_nop 0
    v_mfma_f32_16x16x32_bf16 v[120:123], v[44:47], v[208:211], v[120:123]
    v_cvt_pk_bf16_f32 v223, v26, v27
    v_or_b32 v28, v28, v223
    v_mfma_f32_16x16x32_bf16 v[124:127], v[44:47], v[212:215], v[124:127]
    ds_read_b128 v[44:47], v4 offset:7168
    v_and_b32 v28, s37, v28
    v_cmp_ne_u32 vcc, 0, v28
    s_sub_u32 s34, s34, 64
    s_cbranch_vccnz L_rare_57
L_rareback_58:
    v_mov_b32 v52, v10
    v_mov_b32 v53, v11
    v_mov_b32 v10, 20.0
    v_mov_b32 v11, 20.0
    s_lshl_b32 s90, s35, 20
    s_add_u32 s90, s90, s44
    s_add_u32 s91, s90, 131072
    s_mov_b32 s36, 1
    s_mov_b32 s35, s21
    s_lshl_b32 s34, s35, 2
    s_add_u32 s34, s34, s23
    s_sub_u32 s34, s34, s24
    s_lshl_b32 s34, s34, 5
    s_mov_b32 s33, s35
    s_cmp_lt_i32 s34, 32
    s_cbranch_scc1 L_mask_59
L_maskback_60:
    v_mfma_f32_16x16x32_bf16 v[168:171], v[12:15], v[216:219], v[168:171]
    v_exp_f32 v20, v176
    s_add_u32 s38, s32, 49152
    s_and_b32 s38, s38, 0xffff
    s_add_u32 s38, s38, 0
    s_cmp_ge_u32 s22, 6
    s_cselect_b32 s42, s38, 114688
    v_mfma_f32_16x16x32_bf16 v[172:175], v[12:15], v[220:223], v[172:175]
    s_lshl_b32 s39, s22, 13
    s_add_u32 s42, s42, s39
    s_xor_b32 s39, s22, 4
    s_cmp_ge_u32 s39, 6
    s_waitcnt lgkmcnt(3)
    v_mfma_f32_16x16x32_bf16 v[96:99], v[32:35], v[216:219], v[96:99]
    v_exp_f32 v21, v177
    s_cselect_b32 s43, s38, 114688
    s_lshl_b32 s39, s39, 13
    s_add_u32 s43, s43, s39
    v_add_u32 v29, s42, v1
    v_mfma_f32_16x16x32_bf16 v[100:103], v[32:35], v[220:223], v[100:103]
    ds_read_b128 v[32:35], v3 offset:0
    v_cvt_pk_bf16_f32 v208, v20, v21
    v_add_u32 v30, s43, v1
    v_add_u32 v48, s92, v1
    s_xor_b32 s38, s92, 8192
    v_add_u32 v49, s38, v1
    s_waitcnt lgkmcnt(3)
    v_mfma_f32_16x16x32_bf16 v[104:107], v[36:39], v[216:219], v[104:107]
    v_exp_f32 v22, v178
    v_mov_b32 v54, v168
    v_mfma_f32_16x16x32_bf16 v[108:111], v[36:39], v[220:223], v[108:111]
    ds_read_b128 v[36:39], v3 offset:1024
    v_mov_b32 v55, v172
    s_waitcnt lgkmcnt(3)
    v_mfma_f32_16x16x32_bf16 v[112:115], v[40:43], v[216:219], v[112:115]
    v_exp_f32 v23, v179
    v_mfma_f32_16x16x32_bf16 v[116:119], v[40:43], v[220:223], v[116:119]
    ds_read_b128 v[40:43], v3 offset:2048
    v_cvt_pk_bf16_f32 v209, v22, v23
    ds_write_b128 v48, v[52:55]
    s_waitcnt lgkmcnt(4)
    v_mfma_f32_16x16x32_bf16 v[120:123], v[44:47], v[216:219], v[120:123]
    v_exp_f32 v24, v184
    v_mfma_f32_16x16x32_bf16 v[124:127], v[44:47], v[220:223], v[124:127]
    ds_read_b128 v[44:47], v3 offset:3072
    ds_write_b128 v29, v[96:99] offset:0
    s_waitcnt lgkmcnt(5)
    v_mfma_f32_16x16x32_bf16 v[64:67], v[32:35], v[216:219], v[64:67]
    v_exp_f32 v25, v185
    v_mfma_f32_16x16x32_bf16 v[68:71], v[32:35], v[220:223], v[68:71]
    s_add_u32 s31, s31, 16384
    s_cmp_eq_u32 s31, 49152
    s_cselect_b32 s31, 0, s31
    v_add_u32 v2, s31, v5
    ds_read_b128 v[32:35], v2 offset:0
    v_cvt_pk_bf16_f32 v210, v24, v25
    v_or3_b32 v16, v208, v209, v210
    ds_write_b128 v29, v[100:103] offset:1024
    s_waitcnt lgkmcnt(6)
    v_mfma_f32_16x16x32_bf16 v[72:75], v[36:39], v[216:219], v[72:75]
    v_exp_f32 v26, v186
    v_mfma_f32_16x16x32_bf16 v[76:79], v[36:39], v[220:223], v[76:79]
    ds_read_b128 v[36:39], v2 offset:1024
    s_add_u32 m0, s30, s57
    s_add_u32 s30, s30, 16384
    buffer_load_dwordx4 v1, s[8:11], s26 offen sc1 lds
    ds_write_b128 v29, v[104:107] offset:2048
    s_waitcnt lgkmcnt(7)
    v_mfma_f32_16x16x32_bf16 v[80:83], v[40:43], v[216:219], v[80:83]
    v_exp_f32 v27, v187
    v_mfma_f32_16x16x32_bf16 v[84:87], v[40:43], v[220:223], v[84:87]
    ds_read_b128 v[40:43], v2 offset:2048
    v_cvt_pk_bf16_f32 v211, v26, v27
    v_or_b32 v16, v16, v211
    ds_write_b128 v29, v[108:111] offset:3072
    s_waitcnt lgkmcnt(7)
    v_mfma_f32_16x16x32_bf16 v[88:91], v[44:47], v[216:219], v[88:91]
    v_exp_f32 v20, v180
    v_mfma_f32_16x16x32_bf16 v[92:95], v[44:47], v[220:223], v[92:95]
    ds_read_b128 v[44:47], v2 offset:3072
    ds_write_b128 v29, v[112:115] offset:4096
    s_waitcnt lgkmcnt(7)
    v_mfma_f32_16x16x32_bf16 v[192:195], v[32:35], v[224:227], v[160:163]
    v_exp_f32 v21, v181
    v_mfma_f32_16x16x32_bf16 v[196:199], v[32:35], v[240:243], v[164:167]
    ds_read_b128 v[32:35], v2 offset:4096
    v_cvt_pk_bf16_f32 v212, v20, v21
    ds_write_b128 v29, v[116:119] offset:5120
    s_waitcnt lgkmcnt(7)
    v_mfma_f32_16x16x32_bf16 v[192:195], v[36:39], v[228:231], v[192:195]
    v_exp_f32 v22, v182
    v_mfma_f32_16x16x32_bf16 v[196:199], v[36:39], v[244:247], v[196:199]
    ds_read_b128 v[36:39], v2 offset:5120
    buffer_load_dwordx4 v1, s[8:11], s26 offen offset:1024 sc1 lds
    s_and_b32 s30, s30, 0xffff
    s_add_u32 s26, s26, 16384
    s_cmp_eq_u32 s26, s28
    s_cselect_b32 s26, s40, s26
    ds_write_b128 v29, v[120:123] offset:6144
    s_waitcnt lgkmcnt(7)
    v_mfma_f32_16x16x32_bf16 v[192:195], v[40:43], v[232:235], v[192:195]
    v_exp_f32 v23, v183
    v_mfma_f32_16x16x32_bf16 v[196:199], v[40:43], v[248:251], v[196:199]
    ds_read_b128 v[40:43], v2 offset:6144
    v_cvt_pk_bf16_f32 v213, v22, v23
    ds_write_b128 v29, v[124:127] offset:7168
    s_waitcnt lgkmcnt(7)
    v_mfma_f32_16x16x32_bf16 v[192:195], v[44:47], v[236:239], v[192:195]
    v_exp_f32 v24, v188
    v_mfma_f32_16x16x32_bf16 v[196:199], v[44:47], v[252:255], v[196:199]
    ds_read_b128 v[44:47], v2 offset:7168
    s_waitcnt lgkmcnt(0)
    s_waitcnt vmcnt(2)
    s_barrier
    v_mfma_f32_16x16x32_bf16 v[200:203], v[32:35], v[224:227], v[160:163]
    v_exp_f32 v25, v189
    v_mfma_f32_16x16x32_bf16 v[204:207], v[32:35], v[240:243], v[164:167]
    s_add_u32 s31, s31, 16384
    s_cmp_eq_u32 s31, 49152
    s_cselect_b32 s31, 0, s31
    v_add_u32 v2, s31, v5
    ds_read_b128 v[32:35], v2 offset:0
    s_mov_b32 m0, s29
    s_add_u32 s29, s29, 16384
    buffer_load_dwordx4 v1, s[4:7], s25 offen sc1 lds
    v_cvt_pk_bf16_f32 v214, v24, v25
    v_or3_b32 v17, v212, v213, v214
    ds_read_b128 v[56:59], v49
    ds_read_b128 v[128:131], v30 offset:0
    v_mfma_f32_16x16x32_bf16 v[200:203], v[36:39], v[228:231], v[200:203]
    v_exp_f32 v26, v190
    ds_read_b128 v[132:135], v30 offset:1024
    s_lshl_b32 s45, s22, 7
    s_add_u32 s45, s45, 73400192
    v_mfma_f32_16x16x32_bf16 v[204:207], v[36:39], v[244:247], v[204:207]
    ds_read_b128 v[36:39], v2 offset:1024
    ds_read_b128 v[136:139], v30 offset:2048
    s_sub_u32 s45, s45, s69
    v_mfma_f32_16x16x32_bf16 v[200:203], v[40:43], v[232:235], v[200:203]
    v_exp_f32 v27, v191
    ds_read_b128 v[140:143], v30 offset:3072
    ds_read_b128 v[144:147], v30 offset:4096
    v_lshrrev_b32 v18, 9, v1
    v_mfma_f32_16x16x32_bf16 v[204:207], v[40:43], v[248:251], v[204:207]
    ds_read_b128 v[40:43], v2 offset:2048
    v_cvt_pk_bf16_f32 v215, v26, v27
    v_or_b32 v17, v17, v215
    ds_read_b128 v[148:151], v30 offset:5120
    v_mul_lo_u32 v18, v18, s45
    v_lshrrev_b32 v31, 2, v1
    v_mfma_f32_16x16x32_bf16 v[200:203], v[44:47], v[236:239], v[200:203]
    v_or_b32 v28, v16, v17
    v_and_b32 v16, 0x60006000, v16
    ds_read_b128 v[152:155], v30 offset:6144
    v_add3_u32 v31, v31, v18, s69
    v_mfma_f32_16x16x32_bf16 v[204:207], v[44:47], v[252:255], v[204:207]
    ds_read_b128 v[44:47], v2 offset:3072
    v_and_b32 v17, 0x60006000, v17
    v_and_b32 v28, s37, v28
    v_min_u32 v16, v16, v17
    ds_read_b128 v[156:159], v30 offset:7168
    buffer_load_dword v31, v31, s[12:15], 0 offen sc1
    v_cmp_eq_u32 s[46:47], 0, v16
    v_cmp_ne_u32 vcc, 0, v28
    s_sub_u32 s34, s34, 64
    s_nop 1
    s_or_b64 vcc, vcc, s[46:47]
    s_cbranch_scc1 L_rare_61
L_rareback_62:
    s_cmp_eq_u32 s33, 0
    s_cbranch_scc1 L_x1s_56
    s_cmp_lt_i32 s34, 32
    s_cbranch_scc1 L_mask_63
L_maskback_64:
    s_waitcnt lgkmcnt(12)
    v_mfma_f32_16x16x32_bf16 v[176:179], v[32:35], v[224:227], v[160:163]
    v_exp_f32 v20, v192
    v_mfma_f32_16x16x32_bf16 v[180:183], v[32:35], v[240:243], v[164:167]
    ds_read_b128 v[32:35], v2 offset:4096
    s_waitcnt lgkmcnt(1)
    v_max_f32 v18, v52, v56
    v_max_f32 v19, v53, v57
    v_sub_f32 v60, v52, v18
    v_sub_f32 v62, v56, v18
    v_mfma_f32_16x16x32_bf16 v[176:179], v[36:39], v[228:231], v[176:179]
    v_exp_f32 v21, v193
    v_sub_f32 v61, v53, v19
    v_sub_f32 v63, v57, v19
    v_exp_f32 v60, v60
    v_exp_f32 v62, v62
    v_exp_f32 v61, v61
    v_mfma_f32_16x16x32_bf16 v[180:183], v[36:39], v[244:247], v[180:183]
    ds_read_b128 v[36:39], v2 offset:5120
    buffer_load_dwordx4 v1, s[4:7], s25 offen offset:1024 sc1 lds
    s_cmp_eq_u32 s29, s41
    s_cselect_b32 s29, s56, s29
    s_add_u32 s25, s25, 16384
    s_cmp_eq_u32 s25, s27
    s_cselect_b32 s25, s40, s25
    v_cvt_pk_bf16_f32 v216, v20, v21
    v_exp_f32 v63, v63
    s_nop 0
    v_mul_f32 v18, v54, v60
    v_mul_f32 v19, v55, v61
    v_mfma_f32_16x16x32_bf16 v[176:179], v[40:43], v[232:235], v[176:179]
    v_exp_f32 v22, v194
    v_fmac_f32 v18, v58, v62
    v_fmac_f32 v19, v59, v63
    v_rcp_f32 v18, v18
    v_rcp_f32 v19, v19
    s_nop 0
    v_mfma_f32_16x16x32_bf16 v[180:183], v[40:43], v[248:251], v[180:183]
    ds_read_b128 v[40:43], v2 offset:6144
    s_barrier
    s_mov_b32 m0, s92
    s_nop 0
    buffer_load_dwordx4 v1, s[4:7], s93 offen sc1 lds
    buffer_load_dwordx4 v1, s[4:7], s93 offen offset:1024 sc1 lds
    v_mul_f32 v60, v60, v18
    v_mul_f32 v62, v62, v18
    v_mul_f32 v61, v61, v19
    v_mul_f32 v63, v63, v19
    v_mfma_f32_16x16x32_bf16 v[176:179], v[44:47], v[236:239], v[176:179]
    v_exp_f32 v23, v195
    v_mul_f32 v128, v128, v62
    v_mul_f32 v129, v129, v62
    v_mul_f32 v130, v130, v62
    v_mul_f32 v131, v131, v62
    v_mfma_f32_16x16x32_bf16 v[180:183], v[44:47], v[252:255], v[180:183]
    ds_read_b128 v[44:47], v2 offset:7168
    v_cvt_pk_bf16_f32 v217, v22, v23
    v_mul_f32 v136, v136, v62
    v_mul_f32 v137, v137, v62
    v_mul_f32 v138, v138, v62
    s_waitcnt lgkmcnt(3)
    v_mfma_f32_16x16x32_bf16 v[184:187], v[32:35], v[224:227], v[160:163]
    v_exp_f32 v24, v200
    v_mul_f32 v139, v139, v62
    v_fmac_f32 v128, v64, v60
    v_fmac_f32 v129, v65, v60
    v_mfma_f32_16x16x32_bf16 v[188:191], v[32:35], v[240:243], v[164:167]
    s_add_u32 s32, s32, 16384
    s_and_b32 s32, s32, 0xffff
    v_add_u32 v3, s32, v6
    v_add_u32 v4, s32, v7
    ds_read_b128 v[32:35], v4 offset:4096
    v_fmac_f32 v130, v66, v60
    v_fmac_f32 v131, v67, v60
    v_fmac_f32 v136, v72, v60
    s_waitcnt lgkmcnt(3)
    v_mfma_f32_16x16x32_bf16 v[184:187], v[36:39], v[228:231], v[184:187]
    v_exp_f32 v25, v201
    v_fmac_f32 v137, v73, v60
    v_fmac_f32 v138, v74, v60
    v_fmac_f32 v139, v75, v60
    v_mfma_f32_16x16x32_bf16 v[188:191], v[36:39], v[244:247], v[188:191]
    ds_read_b128 v[36:39], v4 offset:5120
    s_add_u32 m0, s30, s57
    s_add_u32 s30, s30, 16384
    buffer_load_dwordx4 v1, s[8:11], s26 offen sc1 lds
    v_cvt_pk_bf16_f32 v218, v24, v25
    v_or3_b32 v28, v216, v217, v218
    v_mul_f32 v132, v132, v63
    v_mul_f32 v133, v133, v63
    v_mul_f32 v134, v134, v63
    v_mul_f32 v135, v135, v63
    s_waitcnt lgkmcnt(3)
    v_mfma_f32_16x16x32_bf16 v[184:187], v[40:43], v[232:235], v[184:187]
    v_exp_f32 v26, v202
    v_mul_f32 v140, v140, v63
    v_mul_f32 v141, v141, v63
    v_mul_f32 v142, v142, v63
    v_mfma_f32_16x16x32_bf16 v[188:191], v[40:43], v[248:251], v[188:191]
    ds_read_b128 v[40:43], v4 offset:6144
    v_mul_f32 v143, v143, v63
    v_fmac_f32 v132, v68, v61
    v_fmac_f32 v133, v69, v61
    s_waitcnt lgkmcnt(3)
    v_mfma_f32_16x16x32_bf16 v[184:187], v[44:47], v[236:239], v[184:187]
    v_exp_f32 v27, v203
    v_fmac_f32 v134, v70, v61
    v_fmac_f32 v135, v71, v61
    v_fmac_f32 v140, v76, v61
    v_cvt_pk_bf16_f32 v128, v128, v129
    v_mfma_f32_16x16x32_bf16 v[188:191], v[44:47], v[252:255], v[188:191]
    ds_read_b128 v[44:47], v4 offset:7168
    v_cvt_pk_bf16_f32 v219, v26, v27
    v_fmac_f32 v141, v77, v61
    v_fmac_f32 v142, v78, v61
    v_fmac_f32 v143, v79, v61
    v_cvt_pk_bf16_f32 v129, v130, v131
    v_mfma_f32_16x16x32_bf16 v[168:171], v[12:15], v[208:211], 0
    v_exp_f32 v20, v196
    v_mul_f32 v144, v144, v62
    v_mul_f32 v145, v145, v62
    v_mul_f32 v146, v146, v62
    v_mul_f32 v147, v147, v62
    v_cvt_pk_bf16_f32 v130, v136, v137
    v_mfma_f32_16x16x32_bf16 v[172:175], v[12:15], v[212:215], 0
    v_mul_f32 v152, v152, v62
    v_mul_f32 v153, v153, v62
    v_mul_f32 v154, v154, v62
    v_cvt_pk_bf16_f32 v131, v138, v139
    s_waitcnt lgkmcnt(3)
    v_mfma_f32_16x16x32_bf16 v[96:99], v[32:35], v[208:211], 0
    v_exp_f32 v21, v197
    v_mul_f32 v155, v155, v62
    v_fmac_f32 v144, v80, v60
    v_fmac_f32 v145, v81, v60
    buffer_store_dwordx4 v[128:131], v1, s[12:15], s90 offen offset:0 sc1
    v_mfma_f32_16x16x32_bf16 v[100:103], v[32:35], v[212:215], 0
    ds_read_b128 v[32:35], v3 offset:0
    v_cvt_pk_bf16_f32 v220, v20, v21
    v_or3_b32 v28, v28, v219, v220
    v_fmac_f32 v146, v82, v60
    v_fmac_f32 v147, v83, v60
    v_fmac_f32 v152, v88, v60
    v_cvt_pk_bf16_f32 v132, v132, v133
    s_waitcnt lgkmcnt(3)
    v_mfma_f32_16x16x32_bf16 v[104:107], v[36:39], v[208:211], 0
    v_exp_f32 v22, v198
    v_fmac_f32 v153, v89, v60
    v_fmac_f32 v154, v90, v60
    v_fmac_f32 v155, v91, v60
    v_cvt_pk_bf16_f32 v133, v134, v135
    v_mfma_f32_16x16x32_bf16 v[108:111], v[36:39], v[212:215], 0
    ds_read_b128 v[36:39], v3 offset:1024
    buffer_load_dwordx4 v1, s[8:11], s26 offen offset:1024 sc1 lds
    s_and_b32 s30, s30, 0xffff
    s_add_u32 s26, s26, 16384
    s_cmp_eq_u32 s26, s28
    s_cselect_b32 s26, s40, s26
    v_mul_f32 v148, v148, v63
    v_mul_f32 v149, v149, v63
    v_mul_f32 v150, v150, v63
    v_mul_f32 v151, v151, v63
    v_cvt_pk_bf16_f32 v134, v140, v141
    s_waitcnt lgkmcnt(3)
    v_mfma_f32_16x16x32_bf16 v[112:115], v[40:43], v[208:211], 0
    v_exp_f32 v23, v199
    v_mul_f32 v156, v156, v63
    v_mul_f32 v157, v157, v63
    v_mul_f32 v158, v158, v63
    v_cvt_pk_bf16_f32 v135, v142, v143
    v_mfma_f32_16x16x32_bf16 v[116:119], v[40:43], v[212:215], 0
    ds_read_b128 v[40:43], v3 offset:2048
    v_cvt_pk_bf16_f32 v221, v22, v23
    v_mul_f32 v159, v159, v63
    v_fmac_f32 v148, v84, v61
    v_fmac_f32 v149, v85, v61
    buffer_store_dwordx4 v[132:135], v1, s[12:15], s91 offen offset:0 sc1
    s_waitcnt lgkmcnt(3)
    v_mfma_f32_16x16x32_bf16 v[120:123], v[44:47], v[208:211], 0
    v_exp_f32 v24, v204
    v_fmac_f32 v150, v86, v61
    v_fmac_f32 v151, v87, v61
    v_fmac_f32 v156, v92, v61
    v_cvt_pk_bf16_f32 v144, v144, v145
    v_mfma_f32_16x16x32_bf16 v[124:127], v[44:47], v[212:215], 0
    ds_read_b128 v[44:47], v3 offset:3072
    v_fmac_f32 v157, v93, v61
    v_fmac_f32 v158, v94, v61
    v_fmac_f32 v159, v95, v61
    v_cvt_pk_bf16_f32 v145, v146, v147
    s_waitcnt vmcnt(4)
    s_barrier
    s_waitcnt lgkmcnt(3)
    v_mfma_f32_16x16x32_bf16 v[64:67], v[32:35], v[208:211], 0
    v_exp_f32 v25, v205
    v_cvt_pk_bf16_f32 v146, v152, v153
    v_mfma_f32_16x16x32_bf16 v[68:71], v[32:35], v[212:215], 0
    s_add_u32 s31, s31, 16384
    s_cmp_eq_u32 s31, 49152
    s_cselect_b32 s31, 0, s31
    v_add_u32 v2, s31, v5
    ds_read_b128 v[32:35], v2 offset:0
    s_mov_b32 m0, s29
    s_add_u32 s29, s29, 16384
    buffer_load_dwordx4 v1, s[4:7], s25 offen sc1 lds
    v_cvt_pk_bf16_f32 v222, v24, v25
    v_or3_b32 v28, v28, v221, v222
    v_cvt_pk_bf16_f32 v147, v154, v155
    s_waitcnt lgkmcnt(3)
    v_mfma_f32_16x16x32_bf16 v[72:75], v[36:39], v[208:211], 0
    v_exp_f32 v26, v206
    buffer_store_dwordx4 v[144:147], v1, s[12:15], s90 offen offset:1024 sc1
    v_mfma_f32_16x16x32_bf16 v[76:79], v[36:39], v[212:215], 0
    ds_read_b128 v[36:39], v2 offset:1024
    v_and_b32 v17, 7, v31
    v_cmp_gt_u32 vcc, 4, v17
    s_nop 0
    s_cbranch_vccnz L_spin_65
L_spinback_66:
    v_cvt_pk_bf16_f32 v148, v148, v149
    s_waitcnt lgkmcnt(3)
    v_mfma_f32_16x16x32_bf16 v[80:83], v[40:43], v[208:211], 0
    v_exp_f32 v27, v207
    v_cvt_pk_bf16_f32 v149, v150, v151
    v_mfma_f32_16x16x32_bf16 v[84:87], v[40:43], v[212:215], 0
    ds_read_b128 v[40:43], v2 offset:2048
    v_cvt_pk_bf16_f32 v223, v26, v27
    v_or_b32 v28, v28, v223
    v_cvt_pk_bf16_f32 v150, v156, v157
    s_waitcnt lgkmcnt(3)
    v_mfma_f32_16x16x32_bf16 v[88:91], v[44:47], v[208:211], 0
    v_and_b32 v28, s37, v28
    v_cvt_pk_bf16_f32 v151, v158, v159
    v_mfma_f32_16x16x32_bf16 v[92:95], v[44:47], v[212:215], 0
    ds_read_b128 v[44:47], v2 offset:3072
    buffer_store_dwordx4 v[148:151], v1, s[12:15], s91 offen offset:1024 sc1
    v_cmp_ne_u32 vcc, 0, v28
    s_sub_u32 s34, s34, 64
    s_cbranch_vccnz L_rare_67
L_rareback_68:
    s_cmp_lt_i32 s34, 32
    s_cbranch_scc1 L_mask_69
L_maskback_70:
    s_waitcnt lgkmcnt(3)
    v_mfma_f32_16x16x32_bf16 v[192:195], v[32:35], v[224:227], v[160:163]
    v_exp_f32 v20, v176
    v_mfma_f32_16x16x32_bf16 v[196:199], v[32:35], v[240:243], v[164:167]
    ds_read_b128 v[32:35], v2 offset:4096
    s_waitcnt lgkmcnt(3)
    v_mfma_f32_16x16x32_bf16 v[192:195], v[36:39], v[228:231], v[192:195]
    v_exp_f32 v21, v177
    v_mfma_f32_16x16x32_bf16 v[196:199], v[36:39], v[244:247], v[196:199]
    ds_read_b128 v[36:39], v2 offset:5120
    buffer_load_dwordx4 v1, s[4:7], s25 offen offset:1024 sc1 lds
    s_cmp_eq_u32 s29, s41
    s_cselect_b32 s29, s56, s29
    s_add_u32 s25, s25, 16384
    s_cmp_eq_u32 s25, s27
    s_cselect_b32 s25, s40, s25
    v_cvt_pk_bf16_f32 v208, v20, v21
    s_waitcnt lgkmcnt(3)
    v_mfma_f32_16x16x32_bf16 v[192:195], v[40:43], v[232:235], v[192:195]
    v_exp_f32 v22, v178
    v_mfma_f32_16x16x32_bf16 v[196:199], v[40:43], v[248:251], v[196:199]
    ds_read_b128 v[40:43], v2 offset:6144
    s_waitcnt lgkmcnt(3)
    v_mfma_f32_16x16x32_bf16 v[192:195], v[44:47], v[236:239], v[192:195]
    v_exp_f32 v23, v179
    v_mfma_f32_16x16x32_bf16 v[196:199], v[44:47], v[252:255], v[196:199]
    ds_read_b128 v[44:47], v2 offset:7168
    v_cvt_pk_bf16_f32 v209, v22, v23
    s_waitcnt lgkmcnt(3)
    v_mfma_f32_16x16x32_bf16 v[200:203], v[32:35], v[224:227], v[160:163]
    v_exp_f32 v24, v184
    v_mfma_f32_16x16x32_bf16 v[204:207], v[32:35], v[240:243], v[164:167]
    s_add_u32 s32, s32, 16384
    s_and_b32 s32, s32, 0xffff
    v_add_u32 v3, s32, v6
    v_add_u32 v4, s32, v7
    ds_read_b128 v[32:35], v3 offset:0
    s_waitcnt lgkmcnt(3)
    v_mfma_f32_16x16x32_bf16 v[200:203], v[36:39], v[228:231], v[200:203]
    v_exp_f32 v25, v185
    v_mfma_f32_16x16x32_bf16 v[204:207], v[36:39], v[244:247], v[204:207]
    ds_read_b128 v[36:39], v3 offset:1024
    s_add_u32 m0, s30, s57
    s_add_u32 s30, s30, 16384
    buffer_load_dwordx4 v1, s[8:11], s26 offen sc1 lds
    v_cvt_pk_bf16_f32 v210, v24, v25
    v_or3_b32 v28, v208, v209, v210
    s_waitcnt lgkmcnt(3)
    v_mfma_f32_16x16x32_bf16 v[200:203], v[40:43], v[232:235], v[200:203]
    v_exp_f32 v26, v186
    v_mfma_f32_16x16x32_bf16 v[204:207], v[40:43], v[248:251], v[204:207]
    ds_read_b128 v[40:43], v3 offset:2048
    s_waitcnt lgkmcnt(3)
    v_mfma_f32_16x16x32_bf16 v[200:203], v[44:47], v[236:239], v[200:203]
    v_exp_f32 v27, v187
    v_mfma_f32_16x16x32_bf16 v[204:207], v[44:47], v[252:255], v[204:207]
    ds_read_b128 v[44:47], v3 offset:3072
    v_cvt_pk_bf16_f32 v211, v26, v27
    v_mfma_f32_16x16x32_bf16 v[168:171], v[12:15], v[216:219], v[168:171]
    v_exp_f32 v20, v180
    v_mfma_f32_16x16x32_bf16 v[172:175], v[12:15], v[220:223], v[172:175]
    s_waitcnt lgkmcnt(3)
    v_mfma_f32_16x16x32_bf16 v[64:67], v[32:35], v[216:219], v[64:67]
    v_exp_f32 v21, v181
    v_mfma_f32_16x16x32_bf16 v[68:71], v[32:35], v[220:223], v[68:71]
    ds_read_b128 v[32:35], v4 offset:4096
    v_cvt_pk_bf16_f32 v212, v20, v21
    v_or3_b32 v28, v28, v211, v212
    s_waitcnt lgkmcnt(3)
    v_mfma_f32_16x16x32_bf16 v[72:75], v[36:39], v[216:219], v[72:75]
    v_exp_f32 v22, v182
    v_mfma_f32_16x16x32_bf16 v[76:79], v[36:39], v[220:223], v[76:79]
    ds_read_b128 v[36:39], v4 offset:5120
    buffer_load_dwordx4 v1, s[8:11], s26 offen offset:1024 sc1 lds
    s_and_b32 s30, s30, 0xffff
    s_add_u32 s26, s26, 16384
    s_cmp_eq_u32 s26, s28
    s_cselect_b32 s26, s40, s26
    s_waitcnt lgkmcnt(3)
    v_mfma_f32_16x16x32_bf16 v[80:83], v[40:43], v[216:219], v[80:83]
    v_exp_f32 v23, v183
    v_mfma_f32_16x16x32_bf16 v[84:87], v[40:43], v[220:223], v[84:87]
    ds_read_b128 v[40:43], v4 offset:6144
    v_cvt_pk_bf16_f32 v213, v22, v23
    s_waitcnt lgkmcnt(3)
    v_mfma_f32_16x16x32_bf16 v[88:91], v[44:47], v[216:219], v[88:91]
    v_exp_f32 v24, v188
    v_mfma_f32_16x16x32_bf16 v[92:95], v[44:47], v[220:223], v[92:95]
    ds_read_b128 v[44:47], v4 offset:7168
    s_waitcnt vmcnt(3)
    s_barrier
    s_waitcnt lgkmcnt(3)
    v_mfma_f32_16x16x32_bf16 v[96:99], v[32:35], v[216:219], v[96:99]
    v_exp_f32 v25, v189
    v_mfma_f32_16x16x32_bf16 v[100:103], v[32:35], v[220:223], v[100:103]
    s_add_u32 s31, s31, 16384
    s_cmp_eq_u32 s31, 49152
    s_cselect_b32 s31, 0, s31
    v_add_u32 v2, s31, v5
    ds_read_b128 v[32:35], v2 offset:0
    s_mov_b32 m0, s29
    s_add_u32 s29, s29, 16384
    buffer_load_dwordx4 v1, s[4:7], s25 offen sc1 lds
    s_cmp_eq_u32 s22, 0
    s_cbranch_scc0 L_fl_71
    s_add_u32 s45, s3, 5
    s_mov_b64 exec, 1
    v_mov_b32 v16, s45
    buffer_store_dword v16, off, s[12:15], s74 sc1
    s_mov_b64 exec, -1
L_fl_71:
    v_cvt_pk_bf16_f32 v214, v24, v25
    v_or3_b32 v28, v28, v213, v214
    s_waitcnt lgkmcnt(3)
    v_mfma_f32_16x16x32_bf16 v[104:107], v[36:39], v[216:219], v[104:107]
    v_exp_f32 v26, v190
    v_mfma_f32_16x16x32_bf16 v[108:111], v[36:39], v[220:223], v[108:111]
    ds_read_b128 v[36:39], v2 offset:1024
    s_waitcnt lgkmcnt(3)
    v_mfma_f32_16x16x32_bf16 v[112:115], v[40:43], v[216:219], v[112:115]
    v_exp_f32 v27, v191
    v_mfma_f32_16x16x32_bf16 v[116:119], v[40:43], v[220:223], v[116:119]
    ds_read_b128 v[40:43], v2 offset:2048
    v_cvt_pk_bf16_f32 v215, v26, v27
    v_or_b32 v28, v28, v215
    s_waitcnt lgkmcnt(3)
    v_mfma_f32_16x16x32_bf16 v[120:123], v[44:47], v[216:219], v[120:123]
    v_and_b32 v28, s37, v28
    v_mfma_f32_16x16x32_bf16 v[124:127], v[44:47], v[220:223], v[124:127]
    ds_read_b128 v[44:47], v2 offset:3072
    v_cmp_ne_u32 vcc, 0, v28
    s_sub_u32 s34, s34, 64
    s_cbranch_vccnz L_rare_72
L_rareback_73:
    s_sub_u32 s33, s33, 1
    s_cmp_eq_u32 s33, 0
    s_cbranch_scc1 L_loop2end_75
.p2align 3
L_loop2_74:
    s_cmp_lt_i32 s34, 32
    s_cbranch_scc1 L_mask_76
L_maskback_77:
    s_waitcnt lgkmcnt(3)
    v_mfma_f32_16x16x32_bf16 v[176:179], v[32:35], v[224:227], v[160:163]
    v_exp_f32 v20, v192
    v_mfma_f32_16x16x32_bf16 v[180:183], v[32:35], v[240:243], v[164:167]
    ds_read_b128 v[32:35], v2 offset:4096
    s_waitcnt lgkmcnt(3)
    v_mfma_f32_16x16x32_bf16 v[176:179], v[36:39], v[228:231], v[176:179]
    v_exp_f32 v21, v193
    v_mfma_f32_16x16x32_bf16 v[180:183], v[36:39], v[244:247], v[180:183]
    ds_read_b128 v[36:39], v2 offset:5120
    buffer_load_dwordx4 v1, s[4:7], s25 offen offset:1024 sc1 lds
    s_cmp_eq_u32 s29, s41
    s_cselect_b32 s29, s56, s29
    s_add_u32 s25, s25, 16384
    s_cmp_eq_u32 s25, s27
    s_cselect_b32 s25, s40, s25
    v_cvt_pk_bf16_f32 v216, v20, v21
    s_waitcnt lgkmcnt(3)
    v_mfma_f32_16x16x32_bf16 v[176:179], v[40:43], v[232:235], v[176:179]
    v_exp_f32 v22, v194
    v_mfma_f32_16x16x32_bf16 v[180:183], v[40:43], v[248:251], v[180:183]
    ds_read_b128 v[40:43], v2 offset:6144
    s_waitcnt lgkmcnt(3)
    v_mfma_f32_16x16x32_bf16 v[176:179], v[44:47], v[236:239], v[176:179]
    v_exp_f32 v23, v195
    v_mfma_f32_16x16x32_bf16 v[180:183], v[44:47], v[252:255], v[180:183]
    ds_read_b128 v[44:47], v2 offset:7168
    v_cvt_pk_bf16_f32 v217, v22, v23
    s_waitcnt lgkmcnt(3)
    v_mfma_f32_16x16x32_bf16 v[184:187], v[32:35], v[224:227], v[160:163]
    v_exp_f32 v24, v200
    v_mfma_f32_16x16x32_bf16 v[188:191], v[32:35], v[240:243], v[164:167]
    s_add_u32 s32, s32, 16384
    s_and_b32 s32, s32, 0xffff
    v_add_u32 v3, s32, v6
    v_add_u32 v4, s32, v7
    ds_read_b128 v[32:35], v3 offset:0
    s_waitcnt lgkmcnt(3)
    v_mfma_f32_16x16x32_bf16 v[184:187], v[36:39], v[228:231], v[184:187]
    v_exp_f32 v25, v201
    v_mfma_f32_16x16x32_bf16 v[188:191], v[36:39], v[244:247], v[188:191]
    ds_read_b128 v[36:39], v3 offset:1024
    s_add_u32 m0, s30, s57
    s_add_u32 s30, s30, 16384
    buffer_load_dwordx4 v1, s[8:11], s26 offen sc1 lds
    v_cvt_pk_bf16_f32 v218, v24, v25
    v_or3_b32 v28, v216, v217, v218
    s_waitcnt lgkmcnt(3)
    v_mfma_f32_16x16x32_bf16 v[184:187], v[40:43], v[232:235], v[184:187]
    v_exp_f32 v26, v202
    v_mfma_f32_16x16x32_bf16 v[188:191], v[40:43], v[248:251], v[188:191]
    ds_read_b128 v[40:43], v3 offset:2048
    s_waitcnt lgkmcnt(3)
    v_mfma_f32_16x16x32_bf16 v[184:187], v[44:47], v[236:239], v[184:187]
    v_exp_f32 v27, v203
    v_mfma_f32_16x16x32_bf16 v[188:191], v[44:47], v[252:255], v[188:191]
    ds_read_b128 v[44:47], v3 offset:3072
    v_cvt_pk_bf16_f32 v219, v26, v27
    v_mfma_f32_16x16x32_bf16 v[168:171], v[12:15], v[208:211], v[168:171]
    v_exp_f32 v20, v196
    v_mfma_f32_16x16x32_bf16 v[172:175], v[12:15], v[212:215], v[172:175]
    s_waitcnt lgkmcnt(3)
    v_mfma_f32_16x16x32_bf16 v[64:67], v[32:35], v[208:211], v[64:67]
    v_exp_f32 v21, v197
    v_mfma_f32_16x16x32_bf16 v[68:71], v[32:35], v[212:215], v[68:71]
    ds_read_b128 v[32:35], v4 offset:4096
    v_cvt_pk_bf16_f32 v220, v20, v21
    v_or3_b32 v28, v28, v219, v220
    s_waitcnt lgkmcnt(3)
    v_mfma_f32_16x16x32_bf16 v[72:75], v[36:39], v[208:211], v[72:75]
    v_exp_f32 v22, v198
    v_mfma_f32_16x16x32_bf16 v[76:79], v[36:39], v[212:215], v[76:79]
    ds_read_b128 v[36:39], v4 offset:5120
    buffer_load_dwordx4 v1, s[8:11], s26 offen offset:1024 sc1 lds
    s_and_b32 s30, s30, 0xffff
    s_add_u32 s26, s26, 16384
    s_cmp_eq_u32 s26, s28
    s_cselect_b32 s26, s40, s26
    s_waitcnt lgkmcnt(3)
    v_mfma_f32_16x16x32_bf16 v[80:83], v[40:43], v[208:211], v[80:83]
    v_exp_f32 v23, v199
    v_mfma_f32_16x16x32_bf16 v[84:87], v[40:43], v[212:215], v[84:87]
    ds_read_b128 v[40:43], v4 offset:6144
    v_cvt_pk_bf16_f32 v221, v22, v23
    s_waitcnt lgkmcnt(3)
    v_mfma_f32_16x16x32_bf16 v[88:91], v[44:47], v[208:211], v[88:91]
    v_exp_f32 v24, v204
    v_mfma_f32_16x16x32_bf16 v[92:95], v[44:47], v[212:215], v[92:95]
    ds_read_b128 v[44:47], v4 offset:7168
    s_waitcnt vmcnt(4)
    s_barrier
    s_waitcnt lgkmcnt(3)
    v_mfma_f32_16x16x32_bf16 v[96:99], v[32:35], v[208:211], v[96:99]
    v_exp_f32 v25, v205
    v_mfma_f32_16x16x32_bf16 v[100:103], v[32:35], v[212:215], v[100:103]
    s_add_u32 s31, s31, 16384
    s_cmp_eq_u32 s31, 49152
    s_cselect_b32 s31, 0, s31
    v_add_u32 v2, s31, v5
    ds_read_b128 v[32:35], v2 offset:0
    s_mov_b32 m0, s29
    s_add_u32 s29, s29, 16384
    buffer_load_dwordx4 v1, s[4:7], s25 offen sc1 lds
    v_cvt_pk_bf16_f32 v222, v24, v25
    v_or3_b32 v28, v28, v221, v222
    s_waitcnt lgkmcnt(3)
    v_mfma_f32_16x16x32_bf16 v[104:107], v[36:39], v[208:211], v[104:107]
    v_exp_f32 v26, v206
    v_mfma_f32_16x16x32_bf16 v[108:111], v[36:39], v[212:215], v[108:111]
    ds_read_b128 v[36:39], v2 offset:1024
    s_waitcnt lgkmcnt(3)
    v_mfma_f32_16x16x32_bf16 v[112:115], v[40:43], v[208:211], v[112:115]
    v_exp_f32 v27, v207
    v_mfma_f32_16x16x32_bf16 v[116:119], v[40:43], v[212:215], v[116:119]
    ds_read_b128 v[40:43], v2 offset:2048
    v_cvt_pk_bf16_f32 v223, v26, v27
    v_or_b32 v28, v28, v223
    s_waitcnt lgkmcnt(3)
    v_mfma_f32_16x16x32_bf16 v[120:123], v[44:47], v[208:211], v[120:123]
    v_and_b32 v28, s37, v28
    v_mfma_f32_16x16x32_bf16 v[124:127], v[44:47], v[212:215], v[124:127]
    ds_read_b128 v[44:47], v2 offset:3072
    v_cmp_ne_u32 vcc, 0, v28
    s_sub_u32 s34, s34, 64
    s_cbranch_vccnz L_rare_78
L_rareback_79:
    s_cmp_lt_i32 s34, 32
    s_cbranch_scc1 L_mask_80
L_maskback_81:
    s_waitcnt lgkmcnt(3)
    v_mfma_f32_16x16x32_bf16 v[192:195], v[32:35], v[224:227], v[160:163]
    v_exp_f32 v20, v176
    v_mfma_f32_16x16x32_bf16 v[196:199], v[32:35], v[240:243], v[164:167]
    ds_read_b128 v[32:35], v2 offset:4096
    s_waitcnt lgkmcnt(3)
    v_mfma_f32_16x16x32_bf16 v[192:195], v[36:39], v[228:231], v[192:195]
    v_exp_f32 v21, v177
    v_mfma_f32_16x16x32_bf16 v[196:199], v[36:39], v[244:247], v[196:199]
    ds_read_b128 v[36:39], v2 offset:5120
    buffer_load_dwordx4 v1, s[4:7], s25 offen offset:1024 sc1 lds
    s_cmp_eq_u32 s29, s41
    s_cselect_b32 s29, s56, s29
    s_add_u32 s25, s25, 16384
    s_cmp_eq_u32 s25, s27
    s_cselect_b32 s25, s40, s25
    v_cvt_pk_bf16_f32 v208, v20, v21
    s_waitcnt lgkmcnt(3)
    v_mfma_f32_16x16x32_bf16 v[192:195], v[40:43], v[232:235], v[192:195]
    v_exp_f32 v22, v178
    v_mfma_f32_16x16x32_bf16 v[196:199], v[40:43], v[248:251], v[196:199]
    ds_read_b128 v[40:43], v2 offset:6144
    s_waitcnt lgkmcnt(3)
    v_mfma_f32_16x16x32_bf16 v[192:195], v[44:47], v[236:239], v[192:195]
    v_exp_f32 v23, v179
    v_mfma_f32_16x16x32_bf16 v[196:199], v[44:47], v[252:255], v[196:199]
    ds_read_b128 v[44:47], v2 offset:7168
    v_cvt_pk_bf16_f32 v209, v22, v23
    s_waitcnt lgkmcnt(3)
    v_mfma_f32_16x16x32_bf16 v[200:203], v[32:35], v[224:227], v[160:163]
    v_exp_f32 v24, v184
    v_mfma_f32_16x16x32_bf16 v[204:207], v[32:35], v[240:243], v[164:167]
    s_add_u32 s32, s32, 16384
    s_and_b32 s32, s32, 0xffff
    v_add_u32 v3, s32, v6
    v_add_u32 v4, s32, v7
    ds_read_b128 v[32:35], v3 offset:0
    s_waitcnt lgkmcnt(3)
    v_mfma_f32_16x16x32_bf16 v[200:203], v[36:39], v[228:231], v[200:203]
    v_exp_f32 v25, v185
    v_mfma_f32_16x16x32_bf16 v[204:207], v[36:39], v[244:247], v[204:207]
    ds_read_b128 v[36:39], v3 offset:1024
    s_add_u32 m0, s30, s57
    s_add_u32 s30, s30, 16384
    buffer_load_dwordx4 v1, s[8:11], s26 offen sc1 lds
    v_cvt_pk_bf16_f32 v210, v24, v25
    v_or3_b32 v28, v208, v209, v210
    s_waitcnt lgkmcnt(3)
    v_mfma_f32_16x16x32_bf16 v[200:203], v[40:43], v[232:235], v[200:203]
    v_exp_f32 v26, v186
    v_mfma_f32_16x16x32_bf16 v[204:207], v[40:43], v[248:251], v[204:207]
    ds_read_b128 v[40:43], v3 offset:2048
    s_waitcnt lgkmcnt(3)
    v_mfma_f32_16x16x32_bf16 v[200:203], v[44:47], v[236:239], v[200:203]
    v_exp_f32 v27, v187
    v_mfma_f32_16x16x32_bf16 v[204:207], v[44:47], v[252:255], v[204:207]
    ds_read_b128 v[44:47], v3 offset:3072
    v_cvt_pk_bf16_f32 v211, v26, v27
    v_mfma_f32_16x16x32_bf16 v[168:171], v[12:15], v[216:219], v[168:171]
    v_exp_f32 v20, v180
    v_mfma_f32_16x16x32_bf16 v[172:175], v[12:15], v[220:223], v[172:175]
    s_waitcnt lgkmcnt(3)
    v_mfma_f32_16x16x32_bf16 v[64:67], v[32:35], v[216:219], v[64:67]
    v_exp_f32 v21, v181
    v_mfma_f32_16x16x32_bf16 v[68:71], v[32:35], v[220:223], v[68:71]
    ds_read_b128 v[32:35], v4 offset:4096
    v_cvt_pk_bf16_f32 v212, v20, v21
    v_or3_b32 v28, v28, v211, v212
    s_waitcnt lgkmcnt(3)
    v_mfma_f32_16x16x32_bf16 v[72:75], v[36:39], v[216:219], v[72:75]
    v_exp_f32 v22, v182
    v_mfma_f32_16x16x32_bf16 v[76:79], v[36:39], v[220:223], v[76:79]
    ds_read_b128 v[36:39], v4 offset:5120
    buffer_load_dwordx4 v1, s[8:11], s26 offen offset:1024 sc1 lds
    s_and_b32 s30, s30, 0xffff
    s_add_u32 s26, s26, 16384
    s_cmp_eq_u32 s26, s28
    s_cselect_b32 s26, s40, s26
    s_waitcnt lgkmcnt(3)
    v_mfma_f32_16x16x32_bf16 v[80:83], v[40:43], v[216:219], v[80:83]
    v_exp_f32 v23, v183
    v_mfma_f32_16x16x32_bf16 v[84:87], v[40:43], v[220:223], v[84:87]
    ds_read_b128 v[40:43], v4 offset:6144
    v_cvt_pk_bf16_f32 v213, v22, v23
    s_waitcnt lgkmcnt(3)
    v_mfma_f32_16x16x32_bf16 v[88:91], v[44:47], v[216:219], v[88:91]
    v_exp_f32 v24, v188
    v_mfma_f32_16x16x32_bf16 v[92:95], v[44:47], v[220:223], v[92:95]
    ds_read_b128 v[44:47], v4 offset:7168
    s_waitcnt vmcnt(4)
    s_barrier
    s_waitcnt lgkmcnt(3)
    v_mfma_f32_16x16x32_bf16 v[96:99], v[32:35], v[216:219], v[96:99]
    v_exp_f32 v25, v189
    v_mfma_f32_16x16x32_bf16 v[100:103], v[32:35], v[220:223], v[100:103]
    s_add_u32 s31, s31, 16384
    s_cmp_eq_u32 s31, 49152
    s_cselect_b32 s31, 0, s31
    v_add_u32 v2, s31, v5
    ds_read_b128 v[32:35], v2 offset:0
    s_mov_b32 m0, s29
    s_add_u32 s29, s29, 16384
    buffer_load_dwordx4 v1, s[4:7], s25 offen sc1 lds
    v_cvt_pk_bf16_f32 v214, v24, v25
    v_or3_b32 v28, v28, v213, v214
    s_waitcnt lgkmcnt(3)
    v_mfma_f32_16x16x32_bf16 v[104:107], v[36:39], v[216:219], v[104:107]
    v_exp_f32 v26, v190
    v_mfma_f32_16x16x32_bf16 v[108:111], v[36:39], v[220:223], v[108:111]
    ds_read_b128 v[36:39], v2 offset:1024
    s_waitcnt lgkmcnt(3)
    v_mfma_f32_16x16x32_bf16 v[112:115], v[40:43], v[216:219], v[112:115]
    v_exp_f32 v27, v191
    v_mfma_f32_16x16x32_bf16 v[116:119], v[40:43], v[220:223], v[116:119]
    ds_read_b128 v[40:43], v2 offset:2048
    v_cvt_pk_bf16_f32 v215, v26, v27
    v_or_b32 v28, v28, v215
    s_waitcnt lgkmcnt(3)
    v_mfma_f32_16x16x32_bf16 v[120:123], v[44:47], v[216:219], v[120:123]
    v_and_b32 v28, s37, v28
    v_mfma_f32_16x16x32_bf16 v[124:127], v[44:47], v[220:223], v[124:127]
    ds_read_b128 v[44:47], v2 offset:3072
    v_cmp_ne_u32 vcc, 0, v28
    s_sub_u32 s34, s34, 64
    s_cbranch_vccnz L_rare_82
L_rareback_83:
    s_sub_u32 s33, s33, 1
    s_cmp_lg_u32 s33, 0
    s_cbranch_scc1 L_loop2_74
L_loop2end_75:
    s_add_u32 s32, s32, 16384
    s_and_b32 s32, s32, 0xffff
    v_add_u32 v3, s32, v6
    v_add_u32 v4, s32, v7
    ds_read_b128 v[32:35], v3 offset:0
    ds_read_b128 v[36:39], v3 offset:1024
    ds_read_b128 v[40:43], v3 offset:2048
    ds_read_b128 v[44:47], v3 offset:3072
    v_mfma_f32_16x16x32_bf16 v[168:171], v[12:15], v[208:211], v[168:171]
    v_add_u32 v16, s34, v8
    v_cmp_le_i32 s[46:47], 0, v16
    v_cmp_le_i32 s[48:49], 1, v16
    v_cmp_le_i32 s[50:51], 2, v16
    v_mfma_f32_16x16x32_bf16 v[172:175], v[12:15], v[212:215], v[172:175]
    v_cmp_le_i32 s[52:53], 3, v16
    v_cndmask_b32 v192, v9, v192, s[46:47]
    v_cmp_le_i32 s[46:47], 16, v16
    s_waitcnt lgkmcnt(3)
    v_mfma_f32_16x16x32_bf16 v[64:67], v[32:35], v[208:211], v[64:67]
    v_cndmask_b32 v193, v9, v193, s[48:49]
    v_exp_f32 v20, v192
    v_cmp_le_i32 s[48:49], 17, v16
    v_cndmask_b32 v194, v9, v194, s[50:51]
    v_mfma_f32_16x16x32_bf16 v[68:71], v[32:35], v[212:215], v[68:71]
    ds_read_b128 v[32:35], v4 offset:4096
    v_exp_f32 v21, v193
    v_cmp_le_i32 s[50:51], 18, v16
    v_cndmask_b32 v195, v9, v195, s[52:53]
    s_waitcnt lgkmcnt(3)
    v_mfma_f32_16x16x32_bf16 v[72:75], v[36:39], v[208:211], v[72:75]
    v_exp_f32 v22, v194
    v_cvt_pk_bf16_f32 v216, v20, v21
    v_cmp_le_i32 s[52:53], 19, v16
    v_cndmask_b32 v200, v9, v200, s[46:47]
    v_mfma_f32_16x16x32_bf16 v[76:79], v[36:39], v[212:215], v[76:79]
    ds_read_b128 v[36:39], v4 offset:5120
    v_exp_f32 v23, v195
    v_cmp_le_i32 s[46:47], -16, v16
    v_cndmask_b32 v201, v9, v201, s[48:49]
    s_waitcnt lgkmcnt(3)
    v_mfma_f32_16x16x32_bf16 v[80:83], v[40:43], v[208:211], v[80:83]
    v_exp_f32 v24, v200
    v_cvt_pk_bf16_f32 v217, v22, v23
    v_cmp_le_i32 s[48:49], -15, v16
    v_cndmask_b32 v202, v9, v202, s[50:51]
    v_mfma_f32_16x16x32_bf16 v[84:87], v[40:43], v[212:215], v[84:87]
    ds_read_b128 v[40:43], v4 offset:6144
    v_exp_f32 v25, v201
    v_cmp_le_i32 s[50:51], -14, v16
    v_cndmask_b32 v203, v9, v203, s[52:53]
    s_waitcnt lgkmcnt(3)
    v_mfma_f32_16x16x32_bf16 v[88:91], v[44:47], v[208:211], v[88:91]
    v_exp_f32 v26, v202
    v_cvt_pk_bf16_f32 v218, v24, v25
    v_or3_b32 v28, v216, v217, v218
    v_cmp_le_i32 s[52:53], -13, v16
    v_mfma_f32_16x16x32_bf16 v[92:95], v[44:47], v[212:215], v[92:95]
    ds_read_b128 v[44:47], v4 offset:7168
    v_cndmask_b32 v196, v9, v196, s[46:47]
    v_exp_f32 v27, v203
    v_cmp_le_i32 s[46:47], 0, v16
    s_waitcnt vmcnt(0)
    s_barrier
    s_waitcnt lgkmcnt(3)
    v_mfma_f32_16x16x32_bf16 v[96:99], v[32:35], v[208:211], v[96:99]
    v_cndmask_b32 v197, v9, v197, s[48:49]
    v_exp_f32 v20, v196
    v_cvt_pk_bf16_f32 v219, v26, v27
    v_cmp_le_i32 s[48:49], 1, v16
    v_mfma_f32_16x16x32_bf16 v[100:103], v[32:35], v[212:215], v[100:103]
    s_add_u32 s32, s32, 16384
    s_and_b32 s32, s32, 0xffff
    v_add_u32 v3, s32, v6
    v_add_u32 v4, s32, v7
    ds_read_b128 v[32:35], v4 offset:4096
    s_cmp_eq_u32 s36, 0
    s_cbranch_scc1 L_tg_84
    v_mov_b32 v228, 0
    v_mov_b32 v229, 0
    v_mov_b32 v230, 0
    v_mov_b32 v231, 0
    s_add_u32 s85, s86, 4096
    buffer_store_dwordx4 v[228:231], v1, s[12:15], s86 offen offset:0 sc1
L_tg_84:
    v_cndmask_b32 v198, v9, v198, s[50:51]
    v_exp_f32 v21, v197
    v_cmp_le_i32 s[50:51], 2, v16
    s_waitcnt lgkmcnt(3)
    v_mfma_f32_16x16x32_bf16 v[104:107], v[36:39], v[208:211], v[104:107]
    v_cndmask_b32 v199, v9, v199, s[52:53]
    v_exp_f32 v22, v198
    v_cvt_pk_bf16_f32 v220, v20, v21
    v_or3_b32 v28, v28, v219, v220
    v_mfma_f32_16x16x32_bf16 v[108:111], v[36:39], v[212:215], v[108:111]
    ds_read_b128 v[36:39], v4 offset:5120
    s_cmp_eq_u32 s36, 0
    s_cbranch_scc1 L_tg_85
    buffer_store_dwordx4 v[228:231], v1, s[12:15], s86 offen offset:1024 sc1
    buffer_store_dwordx4 v[228:231], v1, s[12:15], s86 offen offset:2048 sc1
L_tg_85:
    v_cmp_le_i32 s[52:53], 3, v16
    v_cndmask_b32 v204, v9, v204, s[46:47]
    v_exp_f32 v23, v199
    s_waitcnt lgkmcnt(3)
    v_mfma_f32_16x16x32_bf16 v[112:115], v[40:43], v[208:211], v[112:115]
    v_cndmask_b32 v205, v9, v205, s[48:49]
    v_exp_f32 v24, v204
    v_cvt_pk_bf16_f32 v221, v22, v23
    v_cndmask_b32 v206, v9, v206, s[50:51]
    v_mfma_f32_16x16x32_bf16 v[116:119], v[40:43], v[212:215], v[116:119]
    ds_read_b128 v[40:43], v4 offset:6144
    s_cmp_eq_u32 s36, 0
    s_cbranch_scc1 L_tg_86
    buffer_store_dwordx4 v[228:231], v1, s[12:15], s86 offen offset:3072 sc1
    buffer_store_dwordx4 v[228:231], v1, s[12:15], s85 offen offset:0 sc1
L_tg_86:
    v_exp_f32 v25, v205
    v_cndmask_b32 v207, v9, v207, s[52:53]
    v_exp_f32 v26, v206
    s_waitcnt lgkmcnt(3)
    v_mfma_f32_16x16x32_bf16 v[120:123], v[44:47], v[208:211], v[120:123]
    v_cvt_pk_bf16_f32 v222, v24, v25
    v_or3_b32 v28, v28, v221, v222
    v_exp_f32 v27, v207
    s_nop 0
    v_mfma_f32_16x16x32_bf16 v[124:127], v[44:47], v[212:215], v[124:127]
    ds_read_b128 v[44:47], v4 offset:7168
    v_cvt_pk_bf16_f32 v223, v26, v27
    v_or_b32 v28, v28, v223
    v_and_b32 v28, s37, v28
    v_cmp_ne_u32 vcc, 0, v28
    s_sub_u32 s34, s34, 64
    s_cbranch_vccnz L_rare_87
L_rareback_88:
L_post_55:
    v_mfma_f32_16x16x32_bf16 v[168:171], v[12:15], v[216:219], v[168:171]
    v_mfma_f32_16x16x32_bf16 v[172:175], v[12:15], v[220:223], v[172:175]
    s_waitcnt lgkmcnt(3)
    v_mfma_f32_16x16x32_bf16 v[96:99], v[32:35], v[216:219], v[96:99]
    v_mfma_f32_16x16x32_bf16 v[100:103], v[32:35], v[220:223], v[100:103]
    ds_read_b128 v[32:35], v3 offset:0
    s_add_u32 s38, s32, 32768
    s_and_b32 s38, s38, 0xffff
    s_add_u32 s38, s38, 0
    s_cmp_ge_u32 s22, 6
    s_cselect_b32 s42, s38, 114688
    s_lshl_b32 s39, s22, 13
    s_add_u32 s42, s42, s39
    s_xor_b32 s39, s22, 4
    s_cmp_ge_u32 s39, 6
    s_cselect_b32 s43, s38, 114688
    s_lshl_b32 s39, s39, 13
    s_add_u32 s43, s43, s39
    v_add_u32 v29, s42, v1
    v_add_u32 v30, s43, v1
    s_add_u32 s38, s32, 49152
    s_and_b32 s38, s38, 0xffff
    s_lshl_b32 s39, s22, 10
    s_add_u32 s38, s38, s39
    s_add_u32 s38, s38, 49152
    s_xor_b32 s39, s38, 4096
    v_add_u32 v16, s38, v1
    v_add_u32 v17, s39, v1
    v_mov_b32 v20, v10
    v_mov_b32 v21, v11
    s_waitcnt lgkmcnt(3)
    v_mfma_f32_16x16x32_bf16 v[104:107], v[36:39], v[216:219], v[104:107]
    v_mfma_f32_16x16x32_bf16 v[108:111], v[36:39], v[220:223], v[108:111]
    ds_read_b128 v[36:39], v3 offset:1024
    s_barrier
    s_waitcnt lgkmcnt(3)
    v_mfma_f32_16x16x32_bf16 v[112:115], v[40:43], v[216:219], v[112:115]
    v_mfma_f32_16x16x32_bf16 v[116:119], v[40:43], v[220:223], v[116:119]
    ds_read_b128 v[40:43], v3 offset:2048
    s_waitcnt lgkmcnt(3)
    v_mfma_f32_16x16x32_bf16 v[120:123], v[44:47], v[216:219], v[120:123]
    v_mfma_f32_16x16x32_bf16 v[124:127], v[44:47], v[220:223], v[124:127]
    ds_read_b128 v[44:47], v3 offset:3072
    v_mov_b32 v22, v168
    v_mov_b32 v23, v172
    ds_write_b128 v16, v[20:23]
    s_add_u32 m0, s64, 0
    s_nop 0
    buffer_load_dwordx4 v1, s[12:15], s58 offen sc1 lds
    s_waitcnt lgkmcnt(4)
    v_mfma_f32_16x16x32_bf16 v[64:67], v[32:35], v[216:219], v[64:67]
    v_mfma_f32_16x16x32_bf16 v[68:71], v[32:35], v[220:223], v[68:71]
    ds_write_b128 v29, v[96:99] offset:0
    ds_write_b128 v29, v[100:103] offset:1024
    buffer_load_dwordx4 v1, s[12:15], s58 offen offset:1024 sc1 lds
    s_waitcnt lgkmcnt(5)
    v_mfma_f32_16x16x32_bf16 v[72:75], v[36:39], v[216:219], v[72:75]
    v_mfma_f32_16x16x32_bf16 v[76:79], v[36:39], v[220:223], v[76:79]
    ds_write_b128 v29, v[104:107] offset:2048
    ds_write_b128 v29, v[108:111] offset:3072
    s_add_u32 m0, s64, 16384
    s_nop 0
    buffer_load_dwordx4 v1, s[12:15], s59 offen sc1 lds
    s_waitcnt lgkmcnt(6)
    v_mfma_f32_16x16x32_bf16 v[80:83], v[40:43], v[216:219], v[80:83]
    v_mfma_f32_16x16x32_bf16 v[84:87], v[40:43], v[220:223], v[84:87]
    ds_write_b128 v29, v[112:115] offset:4096
    ds_write_b128 v29, v[116:119] offset:5120
    buffer_load_dwordx4 v1, s[12:15], s59 offen offset:1024 sc1 lds
    s_waitcnt lgkmcnt(7)
    v_mfma_f32_16x16x32_bf16 v[88:91], v[44:47], v[216:219], v[88:91]
    v_mfma_f32_16x16x32_bf16 v[92:95], v[44:47], v[220:223], v[92:95]
    ds_write_b128 v29, v[120:123] offset:6144
    ds_write_b128 v29, v[124:127] offset:7168
    s_add_u32 m0, s65, 32768
    s_nop 0
    buffer_load_dwordx4 v1, s[12:15], s60 offen sc1 lds
    s_lshl_b32 s38, s35, 20
    s_add_u32 s38, s38, s44
    s_waitcnt vmcnt(10) lgkmcnt(0)
    s_barrier
    ds_read_b128 v[20:23], v17
    ds_read_b128 v[48:51], v30 offset:0
    ds_read_b128 v[52:55], v30 offset:1024
    ds_read_b128 v[56:59], v30 offset:2048
    ds_read_b128 v[60:63], v30 offset:3072
    ds_read_b128 v[208:211], v30 offset:4096
    ds_read_b128 v[212:215], v30 offset:5120
    ds_read_b128 v[216:219], v30 offset:6144
    ds_read_b128 v[220:223], v30 offset:7168
    s_add_u32 s39, s38, 131072
    s_cmp_eq_u32 s22, 0
    s_cbranch_scc0 L_fl_89
    s_add_u32 s45, s3, 5
    s_mov_b64 exec, 1
    v_mov_b32 v18, s45
    buffer_store_dword v18, off, s[12:15], s74 sc1
    s_mov_b64 exec, -1
L_fl_89:
    s_setprio 3
    s_waitcnt lgkmcnt(8)
    v_max_f32 v18, v10, v20
    v_max_f32 v19, v11, v21
    v_sub_f32 v24, v10, v18
    v_sub_f32 v26, v20, v18
    v_sub_f32 v25, v11, v19
    v_sub_f32 v27, v21, v19
    v_exp_f32 v24, v24
    v_exp_f32 v26, v26
    v_exp_f32 v25, v25
    v_exp_f32 v27, v27
    s_nop 0
    v_mul_f32 v18, v168, v24
    v_mul_f32 v19, v172, v25
    v_fmac_f32 v18, v22, v26
    v_fmac_f32 v19, v23, v27
    v_rcp_f32 v18, v18
    v_rcp_f32 v19, v19
    s_nop 0
    v_mul_f32 v24, v24, v18
    v_mul_f32 v26, v26, v18
    v_mul_f32 v25, v25, v19
    v_mul_f32 v27, v27, v19
    s_waitcnt lgkmcnt(0)
    s_barrier
    s_add_u32 m0, s64, 57344
    s_add_u32 s85, s58, 2048
    buffer_load_dwordx4 v1, s[12:15], s85 offen sc1 lds
    buffer_load_dwordx4 v1, s[12:15], s85 offen offset:1024 sc1 lds
    s_add_u32 m0, s64, 73728
    s_add_u32 s85, s59, 2048
    buffer_load_dwordx4 v1, s[12:15], s85 offen sc1 lds
    buffer_load_dwordx4 v1, s[12:15], s85 offen offset:1024 sc1 lds
    v_mul_f32 v64, v64, v24
    v_mul_f32 v65, v65, v24
    v_mul_f32 v66, v66, v24
    v_mul_f32 v67, v67, v24
    v_mul_f32 v72, v72, v24
    v_mul_f32 v73, v73, v24
    v_mul_f32 v74, v74, v24
    v_mul_f32 v75, v75, v24
    v_fmac_f32 v64, v48, v26
    v_fmac_f32 v65, v49, v26
    v_fmac_f32 v66, v50, v26
    v_fmac_f32 v67, v51, v26
    v_fmac_f32 v72, v56, v26
    v_fmac_f32 v73, v57, v26
    v_fmac_f32 v74, v58, v26
    v_fmac_f32 v75, v59, v26
    v_cvt_pk_bf16_f32 v96, v64, v65
    v_cvt_pk_bf16_f32 v97, v66, v67
    v_cvt_pk_bf16_f32 v98, v72, v73
    v_cvt_pk_bf16_f32 v99, v74, v75
    buffer_store_dwordx4 v[96:99], v1, s[12:15], s38 offen offset:0 sc1
    v_mul_f32 v68, v68, v25
    v_mul_f32 v69, v69, v25
    v_mul_f32 v70, v70, v25
    v_mul_f32 v71, v71, v25
    v_mul_f32 v76, v76, v25
    v_mul_f32 v77, v77, v25
    v_mul_f32 v78, v78, v25
    v_mul_f32 v79, v79, v25
    v_fmac_f32 v68, v52, v27
    v_fmac_f32 v69, v53, v27
    v_fmac_f32 v70, v54, v27
    v_fmac_f32 v71, v55, v27
    v_fmac_f32 v76, v60, v27
    v_fmac_f32 v77, v61, v27
    v_fmac_f32 v78, v62, v27
    v_fmac_f32 v79, v63, v27
    v_cvt_pk_bf16_f32 v100, v68, v69
    v_cvt_pk_bf16_f32 v101, v70, v71
    v_cvt_pk_bf16_f32 v102, v76, v77
    v_cvt_pk_bf16_f32 v103, v78, v79
    buffer_store_dwordx4 v[100:103], v1, s[12:15], s39 offen offset:0 sc1
    v_mul_f32 v80, v80, v24
    v_mul_f32 v81, v81, v24
    v_mul_f32 v82, v82, v24
    v_mul_f32 v83, v83, v24
    v_mul_f32 v88, v88, v24
    v_mul_f32 v89, v89, v24
    v_mul_f32 v90, v90, v24
    v_mul_f32 v91, v91, v24
    v_fmac_f32 v80, v208, v26
    v_fmac_f32 v81, v209, v26
    v_fmac_f32 v82, v210, v26
    v_fmac_f32 v83, v211, v26
    v_fmac_f32 v88, v216, v26
    v_fmac_f32 v89, v217, v26
    v_fmac_f32 v90, v218, v26
    v_fmac_f32 v91, v219, v26
    v_cvt_pk_bf16_f32 v104, v80, v81
    v_cvt_pk_bf16_f32 v105, v82, v83
    v_cvt_pk_bf16_f32 v106, v88, v89
    v_cvt_pk_bf16_f32 v107, v90, v91
    buffer_store_dwordx4 v[104:107], v1, s[12:15], s38 offen offset:1024 sc1
    v_mul_f32 v84, v84, v25
    v_mul_f32 v85, v85, v25
    v_mul_f32 v86, v86, v25
    v_mul_f32 v87, v87, v25
    v_mul_f32 v92, v92, v25
    v_mul_f32 v93, v93, v25
    v_mul_f32 v94, v94, v25
    v_mul_f32 v95, v95, v25
    v_fmac_f32 v84, v212, v27
    v_fmac_f32 v85, v213, v27
    v_fmac_f32 v86, v214, v27
    v_fmac_f32 v87, v215, v27
    v_fmac_f32 v92, v220, v27
    v_fmac_f32 v93, v221, v27
    v_fmac_f32 v94, v222, v27
    v_fmac_f32 v95, v223, v27
    v_cvt_pk_bf16_f32 v108, v84, v85
    v_cvt_pk_bf16_f32 v109, v86, v87
    v_cvt_pk_bf16_f32 v110, v92, v93
    v_cvt_pk_bf16_f32 v111, v94, v95
    buffer_store_dwordx4 v[108:111], v1, s[12:15], s39 offen offset:1024 sc1
    s_setprio 0
    s_lshl_b32 s38, s23, 12
    v_add_u32 v2, s38, v1
    v_add_u32 v3, 90112, v2
    s_mul_i32 s38, s24, 10240
    s_add_u32 s38, s38, 16384
    v_add_u32 v4, s38, v1
    v_add_u32 v5, 90112, v4
    v_bfe_u32 v7, v1, 2, 7
    s_add_u32 m0, s64, 90112
    s_add_u32 s85, s58, 4096
    buffer_load_dwordx4 v1, s[12:15], s85 offen sc1 lds
    buffer_load_dwordx4 v1, s[12:15], s85 offen offset:1024 sc1 lds
    s_add_u32 m0, s64, 106496
    s_add_u32 s85, s59, 4096
    buffer_load_dwordx4 v1, s[12:15], s85 offen sc1 lds
    buffer_load_dwordx4 v1, s[12:15], s85 offen offset:1024 sc1 lds
    s_add_u32 m0, s65, 40960
    s_add_u32 s85, s60, 4096
    buffer_load_dwordx4 v1, s[12:15], s85 offen sc1 lds
    s_waitcnt vmcnt(13)
    s_barrier
    ds_read_b128 v[128:131], v2 offset:0
    ds_read_b128 v[136:139], v4 offset:0
    ds_read_b128 v[132:135], v2 offset:2048
    ds_read_b128 v[140:143], v4 offset:2048
    ds_read_b128 v[144:147], v4 offset:4096
    s_mul_i32 s39, s24, 10240
    s_add_u32 s39, s39, 22528
    v_add_u32 v6, s39, v1
    ds_read_b128 v[148:151], v6 offset:0
    ds_read_b128 v[152:155], v6 offset:2048
    s_waitcnt lgkmcnt(5)
    v_mfma_f32_16x16x32_bf16 v[184:187], v[136:139], v[128:131], 0
    ds_read_b128 v[156:159], v2 offset:1024
    v_lshrrev_b32 v20, 6, v1
    s_waitcnt lgkmcnt(5)
    v_mfma_f32_16x16x32_bf16 v[204:207], v[136:139], v[132:135], 0
    ds_read_b128 v[164:167], v4 offset:1024
    v_mul_u32_u24 v8, 1280, v20
    s_waitcnt lgkmcnt(5)
    v_mfma_f32_16x16x32_bf16 v[188:191], v[140:143], v[128:131], 0
    ds_read_b128 v[160:163], v2 offset:3072
    v_bfe_u32 v21, v1, 4, 2
    v_mfma_f32_16x16x32_bf16 v[208:211], v[140:143], v[132:135], 0
    ds_read_b128 v[168:171], v4 offset:3072
    v_lshl_add_u32 v16, v21, 4, v8
    s_waitcnt lgkmcnt(6)
    v_mfma_f32_16x16x32_bf16 v[192:195], v[144:147], v[128:131], 0
    ds_read_b128 v[172:175], v4 offset:5120
    v_lshl_add_u32 v8, v21, 3, v8
    v_mfma_f32_16x16x32_bf16 v[212:215], v[144:147], v[132:135], 0
    ds_read_b128 v[176:179], v6 offset:1024
    s_mul_i32 s40, s22, 1280
    s_waitcnt lgkmcnt(7)
    v_mfma_f32_16x16x32_bf16 v[196:199], v[148:151], v[128:131], 0
    ds_read_b128 v[180:183], v6 offset:3072
    v_mul_u32_u24 v20, 80, v20
    v_mfma_f32_16x16x32_bf16 v[216:219], v[148:151], v[132:135], 0
    v_add_u32 v20, s40, v20
    s_waitcnt lgkmcnt(7)
    v_mfma_f32_16x16x32_bf16 v[200:203], v[152:155], v[128:131], 0
    v_lshl_add_u32 v15, v21, 4, v20
    v_mfma_f32_16x16x32_bf16 v[220:223], v[152:155], v[132:135], 0
    v_lshl_add_u32 v17, v21, 2, v20
    s_waitcnt lgkmcnt(5)
    v_mfma_f32_16x16x32_bf16 v[184:187], v[164:167], v[156:159], v[184:187]
    v_bfe_u32 v20, v1, 4, 4
    s_waitcnt vmcnt(5)
    s_barrier
    s_cmp_eq_u32 s22, 0
    s_cbranch_scc0 L_fl_90
    s_add_u32 s45, s3, 6
    s_mov_b64 exec, 1
    v_mov_b32 v13, s45
    buffer_store_dword v13, off, s[12:15], s74 sc1
    s_mov_b64 exec, -1
L_fl_90:
    s_waitcnt lgkmcnt(4)
    v_mfma_f32_16x16x32_bf16 v[204:207], v[164:167], v[160:163], v[204:207]
    ds_read_b128 v[128:131], v2 offset:57344
    v_mul_u32_u24 v20, 80, v20
    s_waitcnt lgkmcnt(4)
    v_mfma_f32_16x16x32_bf16 v[188:191], v[168:171], v[156:159], v[188:191]
    ds_read_b128 v[136:139], v4 offset:57344
    s_add_u32 m0, s64, 122880
    s_add_u32 s85, s58, 6144
    buffer_load_dwordx4 v1, s[12:15], s85 offen sc1 lds
    v_add_u32 v20, s40, v20
    v_mfma_f32_16x16x32_bf16 v[208:211], v[168:171], v[160:163], v[208:211]
    ds_read_b128 v[132:135], v2 offset:59392
    v_lshrrev_b32 v21, 8, v1
    s_waitcnt lgkmcnt(5)
    v_mfma_f32_16x16x32_bf16 v[192:195], v[172:175], v[156:159], v[192:195]
    ds_read_b128 v[140:143], v4 offset:59392
    v_lshl_add_u32 v14, v21, 3, v20
    v_mfma_f32_16x16x32_bf16 v[212:215], v[172:175], v[160:163], v[212:215]
    ds_read_b128 v[144:147], v4 offset:61440
    buffer_load_dwordx4 v1, s[12:15], s85 offen offset:1024 sc1 lds
    v_lshl_add_u32 v18, v21, 2, v20
    s_waitcnt lgkmcnt(6)
    v_mfma_f32_16x16x32_bf16 v[196:199], v[176:179], v[156:159], v[196:199]
    s_mul_i32 s39, s24, -43008
    s_add_u32 s39, s39, 79872
    v_add_u32 v6, s39, v1
    ds_read_b128 v[148:151], v6 offset:0
    s_lshl_b32 s40, s23, 10
    v_mfma_f32_16x16x32_bf16 v[216:219], v[176:179], v[160:163], v[216:219]
    ds_read_b128 v[152:155], v6 offset:2048
    v_add_u32 v9, s40, v1
    s_waitcnt lgkmcnt(7)
    v_mfma_f32_16x16x32_bf16 v[200:203], v[180:183], v[156:159], v[200:203]
    s_add_u32 m0, s64, 139264
    s_add_u32 s85, s59, 6144
    buffer_load_dwordx4 v1, s[12:15], s85 offen sc1 lds
    s_lshl_b32 s40, s23, 2
    v_mfma_f32_16x16x32_bf16 v[220:223], v[180:183], v[160:163], v[220:223]
    s_add_u32 s40, s40, 4096
    s_waitcnt lgkmcnt(5)
    v_mfma_f32_16x16x32_bf16 v[184:187], v[136:139], v[128:131], v[184:187]
    ds_read_b128 v[156:159], v2 offset:58368
    v_add_u32 v12, s40, v1
    s_waitcnt lgkmcnt(5)
    v_mfma_f32_16x16x32_bf16 v[204:207], v[136:139], v[132:135], v[204:207]
    ds_read_b128 v[164:167], v4 offset:58368
    s_mul_i32 s40, s24, 5120
    s_waitcnt lgkmcnt(5)
    v_mfma_f32_16x16x32_bf16 v[188:191], v[140:143], v[128:131], v[188:191]
    ds_read_b128 v[160:163], v2 offset:60416
    s_add_u32 s40, s40, 122880
    v_mfma_f32_16x16x32_bf16 v[208:211], v[140:143], v[132:135], v[208:211]
    ds_read_b128 v[168:171], v4 offset:60416
    buffer_load_dwordx4 v1, s[12:15], s85 offen offset:1024 sc1 lds
    v_add_u32 v10, s40, v9
    s_waitcnt lgkmcnt(6)
    v_mfma_f32_16x16x32_bf16 v[192:195], v[144:147], v[128:131], v[192:195]
    ds_read_b128 v[172:175], v4 offset:62464
    v_add_u32 v11, s40, v12
    v_mfma_f32_16x16x32_bf16 v[212:215], v[144:147], v[132:135], v[212:215]
    ds_read_b128 v[176:179], v6 offset:1024
    s_mov_b32 s4, s70
    s_mov_b32 s5, s71
    s_and_b32 s5, s5, 0xffff
    s_mov_b32 s6, 2621440
    s_mov_b32 s7, 0x20000
    s_waitcnt lgkmcnt(7)
    v_mfma_f32_16x16x32_bf16 v[196:199], v[148:151], v[128:131], v[196:199]
    ds_read_b128 v[180:183], v6 offset:3072
    s_mov_b32 s8, s72
    s_mov_b32 s9, s73
    s_and_b32 s9, s9, 0xffff
    s_mov_b32 s10, 2621440
    s_mov_b32 s11, 0x20000
    v_mfma_f32_16x16x32_bf16 v[216:219], v[148:151], v[132:135], v[216:219]
    s_waitcnt lgkmcnt(7)
    v_mfma_f32_16x16x32_bf16 v[200:203], v[152:155], v[128:131], v[200:203]
    v_mfma_f32_16x16x32_bf16 v[220:223], v[152:155], v[132:135], v[220:223]
    s_waitcnt lgkmcnt(5)
    v_mfma_f32_16x16x32_bf16 v[184:187], v[164:167], v[156:159], v[184:187]
    s_waitcnt vmcnt(4)
    s_barrier
    s_waitcnt lgkmcnt(4)
    v_mfma_f32_16x16x32_bf16 v[204:207], v[164:167], v[160:163], v[204:207]
    ds_read_b128 v[128:131], v3 offset:0
    s_waitcnt lgkmcnt(4)
    v_mfma_f32_16x16x32_bf16 v[188:191], v[168:171], v[156:159], v[188:191]
    ds_read_b128 v[136:139], v5 offset:0
    s_add_u32 m0, s64, 0
    s_add_u32 s85, s58, 8192
    buffer_load_dwordx4 v1, s[12:15], s85 offen sc1 lds
    v_mfma_f32_16x16x32_bf16 v[208:211], v[168:171], v[160:163], v[208:211]
    ds_read_b128 v[132:135], v3 offset:2048
    s_waitcnt lgkmcnt(5)
    v_mfma_f32_16x16x32_bf16 v[192:195], v[172:175], v[156:159], v[192:195]
    ds_read_b128 v[140:143], v5 offset:2048
    v_mfma_f32_16x16x32_bf16 v[212:215], v[172:175], v[160:163], v[212:215]
    ds_read_b128 v[144:147], v5 offset:4096
    buffer_load_dwordx4 v1, s[12:15], s85 offen offset:1024 sc1 lds
    s_waitcnt lgkmcnt(6)
    v_mfma_f32_16x16x32_bf16 v[196:199], v[176:179], v[156:159], v[196:199]
    s_mul_i32 s39, s24, -71680
    s_add_u32 s39, s39, 112640
    v_add_u32 v6, s39, v1
    ds_read_b128 v[148:151], v6 offset:0
    v_mfma_f32_16x16x32_bf16 v[216:219], v[176:179], v[160:163], v[216:219]
    ds_read_b128 v[152:155], v6 offset:2048
    s_waitcnt lgkmcnt(7)
    v_mfma_f32_16x16x32_bf16 v[200:203], v[180:183], v[156:159], v[200:203]
    s_add_u32 m0, s64, 16384
    s_add_u32 s85, s59, 8192
    buffer_load_dwordx4 v1, s[12:15], s85 offen sc1 lds
    v_mfma_f32_16x16x32_bf16 v[220:223], v[180:183], v[160:163], v[220:223]
    s_waitcnt lgkmcnt(5)
    v_mfma_f32_16x16x32_bf16 v[184:187], v[136:139], v[128:131], v[184:187]
    ds_read_b128 v[156:159], v3 offset:1024
    s_waitcnt lgkmcnt(5)
    v_mfma_f32_16x16x32_bf16 v[204:207], v[136:139], v[132:135], v[204:207]
    ds_read_b128 v[164:167], v5 offset:1024
    s_waitcnt lgkmcnt(5)
    v_mfma_f32_16x16x32_bf16 v[188:191], v[140:143], v[128:131], v[188:191]
    ds_read_b128 v[160:163], v3 offset:3072
    v_mfma_f32_16x16x32_bf16 v[208:211], v[140:143], v[132:135], v[208:211]
    ds_read_b128 v[168:171], v5 offset:3072
    buffer_load_dwordx4 v1, s[12:15], s85 offen offset:1024 sc1 lds
    s_waitcnt lgkmcnt(6)
    v_mfma_f32_16x16x32_bf16 v[192:195], v[144:147], v[128:131], v[192:195]
    ds_read_b128 v[172:175], v5 offset:5120
    v_mfma_f32_16x16x32_bf16 v[212:215], v[144:147], v[132:135], v[212:215]
    ds_read_b128 v[176:179], v6 offset:1024
    s_waitcnt lgkmcnt(7)
    v_mfma_f32_16x16x32_bf16 v[196:199], v[148:151], v[128:131], v[196:199]
    ds_read_b128 v[180:183], v6 offset:3072
    s_add_u32 m0, s65, 49152
    s_add_u32 s85, s60, 8192
    buffer_load_dwordx4 v1, s[12:15], s85 offen sc1 lds
    v_mfma_f32_16x16x32_bf16 v[216:219], v[148:151], v[132:135], v[216:219]
    s_waitcnt lgkmcnt(7)
    v_mfma_f32_16x16x32_bf16 v[200:203], v[152:155], v[128:131], v[200:203]
    v_mfma_f32_16x16x32_bf16 v[220:223], v[152:155], v[132:135], v[220:223]
    s_waitcnt lgkmcnt(5)
    v_mfma_f32_16x16x32_bf16 v[184:187], v[164:167], v[156:159], v[184:187]
    s_waitcnt vmcnt(5)
    s_barrier
    s_waitcnt lgkmcnt(4)
    v_mfma_f32_16x16x32_bf16 v[204:207], v[164:167], v[160:163], v[204:207]
    ds_read_b128 v[128:131], v3 offset:32768
    s_waitcnt lgkmcnt(4)
    v_mfma_f32_16x16x32_bf16 v[188:191], v[168:171], v[156:159], v[188:191]
    ds_read_b128 v[136:139], v5 offset:32768
    s_add_u32 m0, s64, 57344
    s_add_u32 s85, s58, 10240
    buffer_load_dwordx4 v1, s[12:15], s85 offen sc1 lds
    v_mfma_f32_16x16x32_bf16 v[208:211], v[168:171], v[160:163], v[208:211]
    ds_read_b128 v[132:135], v3 offset:34816
    s_waitcnt lgkmcnt(5)
    v_mfma_f32_16x16x32_bf16 v[192:195], v[172:175], v[156:159], v[192:195]
    ds_read_b128 v[140:143], v5 offset:34816
    v_mfma_f32_16x16x32_bf16 v[212:215], v[172:175], v[160:163], v[212:215]
    ds_read_b128 v[144:147], v5 offset:36864
    buffer_load_dwordx4 v1, s[12:15], s85 offen offset:1024 sc1 lds
    s_waitcnt lgkmcnt(6)
    v_mfma_f32_16x16x32_bf16 v[196:199], v[176:179], v[156:159], v[196:199]
    s_mul_i32 s39, s24, -100352
    s_add_u32 s39, s39, 145408
    v_add_u32 v6, s39, v1
    ds_read_b128 v[148:151], v6 offset:0
    v_mfma_f32_16x16x32_bf16 v[216:219], v[176:179], v[160:163], v[216:219]
    ds_read_b128 v[152:155], v6 offset:2048
    s_waitcnt lgkmcnt(7)
    v_mfma_f32_16x16x32_bf16 v[200:203], v[180:183], v[156:159], v[200:203]
    s_add_u32 m0, s64, 73728
    s_add_u32 s85, s59, 10240
    buffer_load_dwordx4 v1, s[12:15], s85 offen sc1 lds
    v_mfma_f32_16x16x32_bf16 v[220:223], v[180:183], v[160:163], v[220:223]
    s_waitcnt lgkmcnt(5)
    v_mfma_f32_16x16x32_bf16 v[184:187], v[136:139], v[128:131], v[184:187]
    ds_read_b128 v[156:159], v3 offset:33792
    s_waitcnt lgkmcnt(5)
    v_mfma_f32_16x16x32_bf16 v[204:207], v[136:139], v[132:135], v[204:207]
    ds_read_b128 v[164:167], v5 offset:33792
    s_waitcnt lgkmcnt(5)
    v_mfma_f32_16x16x32_bf16 v[188:191], v[140:143], v[128:131], v[188:191]
    ds_read_b128 v[160:163], v3 offset:35840
    v_mfma_f32_16x16x32_bf16 v[208:211], v[140:143], v[132:135], v[208:211]
    ds_read_b128 v[168:171], v5 offset:35840
    buffer_load_dwordx4 v1, s[12:15], s85 offen offset:1024 sc1 lds
    s_waitcnt lgkmcnt(6)
    v_mfma_f32_16x16x32_bf16 v[192:195], v[144:147], v[128:131], v[192:195]
    ds_read_b128 v[172:175], v5 offset:37888
    v_mfma_f32_16x16x32_bf16 v[212:215], v[144:147], v[132:135], v[212:215]
    ds_read_b128 v[176:179], v6 offset:1024
    s_waitcnt lgkmcnt(7)
    v_mfma_f32_16x16x32_bf16 v[196:199], v[148:151], v[128:131], v[196:199]
    ds_read_b128 v[180:183], v6 offset:3072
    buffer_load_dword v31, v7, s[12:15], s69 offen sc1
    v_mfma_f32_16x16x32_bf16 v[216:219], v[148:151], v[132:135], v[216:219]
    s_waitcnt lgkmcnt(7)
    v_mfma_f32_16x16x32_bf16 v[200:203], v[152:155], v[128:131], v[200:203]
    v_mfma_f32_16x16x32_bf16 v[220:223], v[152:155], v[132:135], v[220:223]
    s_waitcnt lgkmcnt(5)
    v_mfma_f32_16x16x32_bf16 v[184:187], v[164:167], v[156:159], v[184:187]
    s_waitcnt vmcnt(5)
    s_barrier
    s_waitcnt lgkmcnt(4)
    v_mfma_f32_16x16x32_bf16 v[204:207], v[164:167], v[160:163], v[204:207]
    ds_read_b128 v[128:131], v2 offset:0
    s_waitcnt lgkmcnt(4)
    v_mfma_f32_16x16x32_bf16 v[188:191], v[168:171], v[156:159], v[188:191]
    ds_read_b128 v[136:139], v4 offset:0
    s_add_u32 m0, s64, 90112
    s_add_u32 s85, s58, 12288
    s_add_u32 s85, s85, s82
    buffer_load_dwordx4 v1, s[12:15], s85 offen sc1 lds
    v_mfma_f32_16x16x32_bf16 v[208:211], v[168:171], v[160:163], v[208:211]
    ds_read_b128 v[132:135], v2 offset:2048
    s_waitcnt lgkmcnt(5)
    v_mfma_f32_16x16x32_bf16 v[192:195], v[172:175], v[156:159], v[192:195]
    ds_read_b128 v[140:143], v4 offset:2048
    v_mfma_f32_16x16x32_bf16 v[212:215], v[172:175], v[160:163], v[212:215]
    ds_read_b128 v[144:147], v4 offset:4096
    buffer_load_dwordx4 v1, s[12:15], s85 offen offset:1024 sc1 lds
    s_waitcnt lgkmcnt(6)
    v_mfma_f32_16x16x32_bf16 v[196:199], v[176:179], v[156:159], v[196:199]
    s_mul_i32 s39, s24, 26624
    s_add_u32 s39, s39, 22528
    v_add_u32 v6, s39, v1
    ds_read_b128 v[148:151], v6 offset:0
    v_mfma_f32_16x16x32_bf16 v[216:219], v[176:179], v[160:163], v[216:219]
    ds_read_b128 v[152:155], v6 offset:2048
    s_waitcnt lgkmcnt(7)
    v_mfma_f32_16x16x32_bf16 v[200:203], v[180:183], v[156:159], v[200:203]
    s_add_u32 m0, s64, 106496
    s_add_u32 s85, s59, 12288
    s_add_u32 s85, s85, s82
    buffer_load_dwordx4 v1, s[12:15], s85 offen sc1 lds
    v_mfma_f32_16x16x32_bf16 v[220:223], v[180:183], v[160:163], v[220:223]
    s_waitcnt lgkmcnt(5)
    v_mfma_f32_16x16x32_bf16 v[184:187], v[136:139], v[128:131], v[184:187]
    ds_read_b128 v[156:159], v2 offset:1024
    s_waitcnt lgkmcnt(5)
    v_mfma_f32_16x16x32_bf16 v[204:207], v[136:139], v[132:135], v[204:207]
    ds_read_b128 v[164:167], v4 offset:1024
    s_waitcnt lgkmcnt(5)
    v_mfma_f32_16x16x32_bf16 v[188:191], v[140:143], v[128:131], v[188:191]
    ds_read_b128 v[160:163], v2 offset:3072
    v_mfma_f32_16x16x32_bf16 v[208:211], v[140:143], v[132:135], v[208:211]
    ds_read_b128 v[168:171], v4 offset:3072
    buffer_load_dwordx4 v1, s[12:15], s85 offen offset:1024 sc1 lds
    s_waitcnt lgkmcnt(6)
    v_mfma_f32_16x16x32_bf16 v[192:195], v[144:147], v[128:131], v[192:195]
    ds_read_b128 v[172:175], v4 offset:5120
    v_mfma_f32_16x16x32_bf16 v[212:215], v[144:147], v[132:135], v[212:215]
    ds_read_b128 v[176:179], v6 offset:1024
    s_waitcnt lgkmcnt(7)
    v_mfma_f32_16x16x32_bf16 v[196:199], v[148:151], v[128:131], v[196:199]
    ds_read_b128 v[180:183], v6 offset:3072
    s_add_u32 m0, s65, 32768
    s_add_u32 s85, s60, 12288
    s_add_u32 s85, s85, s82
    buffer_load_dwordx4 v1, s[12:15], s85 offen sc1 lds
    v_mfma_f32_16x16x32_bf16 v[216:219], v[148:151], v[132:135], v[216:219]
    s_waitcnt lgkmcnt(7)
    v_mfma_f32_16x16x32_bf16 v[200:203], v[152:155], v[128:131], v[200:203]
    v_mfma_f32_16x16x32_bf16 v[220:223], v[152:155], v[132:135], v[220:223]
    s_waitcnt lgkmcnt(5)
    v_mfma_f32_16x16x32_bf16 v[184:187], v[164:167], v[156:159], v[184:187]
    s_waitcnt vmcnt(5)
    s_barrier
    v_and_b32 v13, 7, v31
    v_cmp_gt_u32 vcc, s100, v13
    s_nop 1
    s_and_b64 vcc, vcc, s[88:89]
    s_cselect_b32 s81, 0, 1
    buffer_load_dword v31, v7, s[12:15], s69 offen sc1
    s_waitcnt lgkmcnt(4)
    v_mfma_f32_16x16x32_bf16 v[204:207], v[164:167], v[160:163], v[204:207]
    ds_read_b128 v[128:131], v2 offset:57344
    s_waitcnt lgkmcnt(4)
    v_mfma_f32_16x16x32_bf16 v[188:191], v[168:171], v[156:159], v[188:191]
    ds_read_b128 v[136:139], v4 offset:57344
    s_add_u32 m0, s64, 139264
    s_add_u32 s85, s62, 0
    buffer_load_dwordx4 v1, s[12:15], s85 offen sc1 lds
    v_mfma_f32_16x16x32_bf16 v[208:211], v[168:171], v[160:163], v[208:211]
    ds_read_b128 v[132:135], v2 offset:59392
    s_waitcnt lgkmcnt(5)
    v_mfma_f32_16x16x32_bf16 v[192:195], v[172:175], v[156:159], v[192:195]
    ds_read_b128 v[140:143], v4 offset:59392
    v_mfma_f32_16x16x32_bf16 v[212:215], v[172:175], v[160:163], v[212:215]
    ds_read_b128 v[144:147], v4 offset:61440
    buffer_load_dwordx4 v1, s[12:15], s85 offen offset:1024 sc1 lds
    s_waitcnt lgkmcnt(6)
    v_mfma_f32_16x16x32_bf16 v[196:199], v[176:179], v[156:159], v[196:199]
    s_mul_i32 s39, s24, -26624
    s_add_u32 s39, s39, 79872
    v_add_u32 v6, s39, v1
    ds_read_b128 v[148:151], v6 offset:0
    v_mfma_f32_16x16x32_bf16 v[216:219], v[176:179], v[160:163], v[216:219]
    ds_read_b128 v[152:155], v6 offset:2048
    s_waitcnt lgkmcnt(7)
    v_mfma_f32_16x16x32_bf16 v[200:203], v[180:183], v[156:159], v[200:203]
    s_add_u32 m0, s65, 40960
    s_add_u32 s85, s63, 0
    buffer_load_dwordx4 v1, s[12:15], s85 offen sc1 lds
    v_mfma_f32_16x16x32_bf16 v[220:223], v[180:183], v[160:163], v[220:223]
    s_waitcnt lgkmcnt(5)
    v_mfma_f32_16x16x32_bf16 v[184:187], v[136:139], v[128:131], v[184:187]
    ds_read_b128 v[156:159], v2 offset:58368
    s_waitcnt lgkmcnt(5)
    v_mfma_f32_16x16x32_bf16 v[204:207], v[136:139], v[132:135], v[204:207]
    ds_read_b128 v[164:167], v4 offset:58368
    s_waitcnt lgkmcnt(5)
    v_mfma_f32_16x16x32_bf16 v[188:191], v[140:143], v[128:131], v[188:191]
    ds_read_b128 v[160:163], v2 offset:60416
    v_mfma_f32_16x16x32_bf16 v[208:211], v[140:143], v[132:135], v[208:211]
    ds_read_b128 v[168:171], v4 offset:60416
    s_cmp_eq_u32 s81, 0
    s_cbranch_scc1 L_c_91
    s_add_u32 m0, s64, 122880
    s_add_u32 s85, s61, 0
    buffer_load_dwordx4 v1, s[12:15], s85 offen sc1 lds
    buffer_load_dwordx4 v1, s[12:15], s85 offen offset:1024 sc1 lds
L_c_91:
    s_waitcnt lgkmcnt(6)
    v_mfma_f32_16x16x32_bf16 v[192:195], v[144:147], v[128:131], v[192:195]
    ds_read_b128 v[172:175], v4 offset:62464
    v_mfma_f32_16x16x32_bf16 v[212:215], v[144:147], v[132:135], v[212:215]
    ds_read_b128 v[176:179], v6 offset:1024
    s_waitcnt lgkmcnt(7)
    v_mfma_f32_16x16x32_bf16 v[196:199], v[148:151], v[128:131], v[196:199]
    ds_read_b128 v[180:183], v6 offset:3072
    v_mfma_f32_16x16x32_bf16 v[216:219], v[148:151], v[132:135], v[216:219]
    s_waitcnt lgkmcnt(7)
    v_mfma_f32_16x16x32_bf16 v[200:203], v[152:155], v[128:131], v[200:203]
    v_mfma_f32_16x16x32_bf16 v[220:223], v[152:155], v[132:135], v[220:223]
    s_waitcnt lgkmcnt(5)
    v_mfma_f32_16x16x32_bf16 v[184:187], v[164:167], v[156:159], v[184:187]
    s_cmp_eq_u32 s81, 1
    s_cbranch_scc1 L_w_92
    s_waitcnt vmcnt(3)
L_w_92:
    s_waitcnt vmcnt(6)
    s_barrier
    s_cmp_eq_u32 s81, 1
    s_cbranch_scc1 L_c_93
    v_and_b32 v13, 7, v31
    v_cmp_gt_u32 vcc, s100, v13
    s_nop 1
    s_and_b64 vcc, vcc, s[88:89]
    s_cbranch_scc1 L_c_93
    s_mov_b32 s81, 1
    s_add_u32 m0, s64, 122880
    s_add_u32 s85, s61, 0
    buffer_load_dwordx4 v1, s[12:15], s85 offen sc1 lds
    buffer_load_dwordx4 v1, s[12:15], s85 offen offset:1024 sc1 lds
L_c_93:
    s_waitcnt lgkmcnt(4)
    v_mfma_f32_16x16x32_bf16 v[204:207], v[164:167], v[160:163], v[204:207]
    ds_read_b128 v[128:131], v3 offset:0
    s_waitcnt lgkmcnt(4)
    v_mfma_f32_16x16x32_bf16 v[188:191], v[168:171], v[156:159], v[188:191]
    ds_read_b128 v[136:139], v5 offset:0
    s_add_u32 m0, s64, 16384
    s_add_u32 s85, s62, 2048
    buffer_load_dwordx4 v1, s[12:15], s85 offen sc1 lds
    v_mfma_f32_16x16x32_bf16 v[208:211], v[168:171], v[160:163], v[208:211]
    ds_read_b128 v[132:135], v3 offset:2048
    s_waitcnt lgkmcnt(5)
    v_mfma_f32_16x16x32_bf16 v[192:195], v[172:175], v[156:159], v[192:195]
    ds_read_b128 v[140:143], v5 offset:2048
    v_mfma_f32_16x16x32_bf16 v[212:215], v[172:175], v[160:163], v[212:215]
    ds_read_b128 v[144:147], v5 offset:4096
    buffer_load_dwordx4 v1, s[12:15], s85 offen offset:1024 sc1 lds
    s_waitcnt lgkmcnt(6)
    v_mfma_f32_16x16x32_bf16 v[196:199], v[176:179], v[156:159], v[196:199]
    s_mul_i32 s39, s24, -79872
    s_add_u32 s39, s39, 112640
    v_add_u32 v6, s39, v1
    ds_read_b128 v[148:151], v6 offset:0
    v_mfma_f32_16x16x32_bf16 v[216:219], v[176:179], v[160:163], v[216:219]
    ds_read_b128 v[152:155], v6 offset:2048
    s_waitcnt lgkmcnt(7)
    v_mfma_f32_16x16x32_bf16 v[200:203], v[180:183], v[156:159], v[200:203]
    s_cmp_eq_u32 s81, 0
    s_cbranch_scc1 L_c_94
    s_add_u32 m0, s64, 0
    s_add_u32 s85, s61, 2048
    buffer_load_dwordx4 v1, s[12:15], s85 offen sc1 lds
    buffer_load_dwordx4 v1, s[12:15], s85 offen offset:1024 sc1 lds
L_c_94:
    v_mfma_f32_16x16x32_bf16 v[220:223], v[180:183], v[160:163], v[220:223]
    s_waitcnt lgkmcnt(5)
    v_mfma_f32_16x16x32_bf16 v[184:187], v[136:139], v[128:131], v[184:187]
    ds_read_b128 v[156:159], v3 offset:1024
    s_waitcnt lgkmcnt(5)
    v_mfma_f32_16x16x32_bf16 v[204:207], v[136:139], v[132:135], v[204:207]
    ds_read_b128 v[164:167], v5 offset:1024
    s_waitcnt lgkmcnt(5)
    v_mfma_f32_16x16x32_bf16 v[188:191], v[140:143], v[128:131], v[188:191]
    ds_read_b128 v[160:163], v3 offset:3072
    v_mfma_f32_16x16x32_bf16 v[208:211], v[140:143], v[132:135], v[208:211]
    ds_read_b128 v[168:171], v5 offset:3072
    s_waitcnt lgkmcnt(6)
    v_mfma_f32_16x16x32_bf16 v[192:195], v[144:147], v[128:131], v[192:195]
    ds_read_b128 v[172:175], v5 offset:5120
    v_mfma_f32_16x16x32_bf16 v[212:215], v[144:147], v[132:135], v[212:215]
    ds_read_b128 v[176:179], v6 offset:1024
    s_waitcnt lgkmcnt(7)
    v_mfma_f32_16x16x32_bf16 v[196:199], v[148:151], v[128:131], v[196:199]
    ds_read_b128 v[180:183], v6 offset:3072
    v_mfma_f32_16x16x32_bf16 v[216:219], v[148:151], v[132:135], v[216:219]
    s_waitcnt lgkmcnt(7)
    v_mfma_f32_16x16x32_bf16 v[200:203], v[152:155], v[128:131], v[200:203]
    v_mfma_f32_16x16x32_bf16 v[220:223], v[152:155], v[132:135], v[220:223]
    s_waitcnt lgkmcnt(5)
    v_mfma_f32_16x16x32_bf16 v[184:187], v[164:167], v[156:159], v[184:187]
    s_cmp_eq_u32 s81, 0
    s_cbranch_scc1 L_slow_95
    s_waitcnt vmcnt(4)
L_slowback_96:
    s_barrier
    s_waitcnt lgkmcnt(4)
    v_mfma_f32_16x16x32_bf16 v[204:207], v[164:167], v[160:163], v[204:207]
    ds_read_b128 v[128:131], v3 offset:32768
    s_waitcnt lgkmcnt(4)
    v_mfma_f32_16x16x32_bf16 v[188:191], v[168:171], v[156:159], v[188:191]
    ds_read_b128 v[136:139], v5 offset:32768
    s_add_u32 m0, s64, 57344
    s_add_u32 s85, s61, 4096
    buffer_load_dwordx4 v1, s[12:15], s85 offen sc1 lds
    v_mfma_f32_16x16x32_bf16 v[208:211], v[168:171], v[160:163], v[208:211]
    ds_read_b128 v[132:135], v3 offset:34816
    s_waitcnt lgkmcnt(5)
    v_mfma_f32_16x16x32_bf16 v[192:195], v[172:175], v[156:159], v[192:195]
    ds_read_b128 v[140:143], v5 offset:34816
    v_mfma_f32_16x16x32_bf16 v[212:215], v[172:175], v[160:163], v[212:215]
    ds_read_b128 v[144:147], v5 offset:36864
    buffer_load_dwordx4 v1, s[12:15], s85 offen offset:1024 sc1 lds
    s_waitcnt lgkmcnt(6)
    v_mfma_f32_16x16x32_bf16 v[196:199], v[176:179], v[156:159], v[196:199]
    s_mul_i32 s39, s24, -104448
    s_add_u32 s39, s39, 145408
    v_add_u32 v6, s39, v1
    ds_read_b128 v[148:151], v6 offset:0
    v_mfma_f32_16x16x32_bf16 v[216:219], v[176:179], v[160:163], v[216:219]
    ds_read_b128 v[152:155], v6 offset:2048
    s_waitcnt lgkmcnt(7)
    v_mfma_f32_16x16x32_bf16 v[200:203], v[180:183], v[156:159], v[200:203]
    s_add_u32 m0, s64, 73728
    s_add_u32 s85, s62, 4096
    buffer_load_dwordx4 v1, s[12:15], s85 offen sc1 lds
    v_mfma_f32_16x16x32_bf16 v[220:223], v[180:183], v[160:163], v[220:223]
    s_waitcnt lgkmcnt(5)
    v_mfma_f32_16x16x32_bf16 v[48:51], v[136:139], v[128:131], 0
    ds_read_b128 v[156:159], v3 offset:33792
    s_waitcnt lgkmcnt(5)
    v_mfma_f32_16x16x32_bf16 v[68:71], v[136:139], v[132:135], 0
    ds_read_b128 v[164:167], v5 offset:33792
    s_waitcnt lgkmcnt(5)
    v_mfma_f32_16x16x32_bf16 v[52:55], v[140:143], v[128:131], 0
    ds_read_b128 v[160:163], v3 offset:35840
    v_mfma_f32_16x16x32_bf16 v[72:75], v[140:143], v[132:135], 0
    ds_read_b128 v[168:171], v5 offset:35840
    buffer_load_dwordx4 v1, s[12:15], s85 offen offset:1024 sc1 lds
    s_waitcnt lgkmcnt(6)
    v_mfma_f32_16x16x32_bf16 v[56:59], v[144:147], v[128:131], 0
    ds_read_b128 v[172:175], v5 offset:37888
    v_cvt_pk_bf16_f32 v224, v184, v185
    v_cvt_pk_bf16_f32 v225, v186, v187
    v_mfma_f32_16x16x32_bf16 v[76:79], v[144:147], v[132:135], 0
    ds_read_b128 v[176:179], v6 offset:1024
    v_cvt_pk_bf16_f32 v226, v188, v189
    v_cvt_pk_bf16_f32 v227, v190, v191
    s_waitcnt lgkmcnt(7)
    v_mfma_f32_16x16x32_bf16 v[60:63], v[148:151], v[128:131], 0
    ds_read_b128 v[180:183], v6 offset:3072
    s_add_u32 m0, s65, 49152
    s_add_u32 s85, s63, 4096
    buffer_load_dwordx4 v1, s[12:15], s85 offen sc1 lds
    buffer_store_dwordx4 v[224:227], v1, s[12:15], s66 offen offset:0 sc1
    v_cvt_pk_bf16_f32 v232, v204, v205
    v_mfma_f32_16x16x32_bf16 v[80:83], v[148:151], v[132:135], 0
    v_cvt_pk_bf16_f32 v233, v206, v207
    v_cvt_pk_bf16_f32 v234, v208, v209
    s_waitcnt lgkmcnt(7)
    v_mfma_f32_16x16x32_bf16 v[64:67], v[152:155], v[128:131], 0
    v_cvt_pk_bf16_f32 v235, v210, v211
    buffer_store_dwordx4 v[232:235], v1, s[12:15], s66 offen offset:2048 sc1
    v_mfma_f32_16x16x32_bf16 v[84:87], v[152:155], v[132:135], 0
    v_cvt_pk_bf16_f32 v228, v192, v193
    v_cvt_pk_bf16_f32 v229, v194, v195
    s_waitcnt lgkmcnt(5)
    v_mfma_f32_16x16x32_bf16 v[48:51], v[164:167], v[156:159], v[48:51]
    v_cvt_pk_bf16_f32 v230, v196, v197
    v_cvt_pk_bf16_f32 v231, v198, v199
    s_waitcnt vmcnt(7)
    s_barrier
    s_waitcnt lgkmcnt(4)
    v_mfma_f32_16x16x32_bf16 v[68:71], v[164:167], v[160:163], v[68:71]
    ds_read_b128 v[128:131], v2 offset:0
    buffer_store_dwordx4 v[228:231], v1, s[12:15], s66 offen offset:1024 sc1
    v_cvt_pk_bf16_f32 v236, v212, v213
    s_waitcnt lgkmcnt(4)
    v_mfma_f32_16x16x32_bf16 v[52:55], v[168:171], v[156:159], v[52:55]
    ds_read_b128 v[136:139], v4 offset:0
    s_add_u32 m0, s64, 90112
    s_add_u32 s85, s61, 6144
    buffer_load_dwordx4 v1, s[12:15], s85 offen sc1 lds
    v_cvt_pk_bf16_f32 v237, v214, v215
    v_cvt_pk_bf16_f32 v238, v216, v217
    v_mfma_f32_16x16x32_bf16 v[72:75], v[168:171], v[160:163], v[72:75]
    ds_read_b128 v[132:135], v2 offset:2048
    v_cvt_pk_bf16_f32 v239, v218, v219
    buffer_store_dwordx4 v[236:239], v1, s[12:15], s66 offen offset:3072 sc1
    s_waitcnt lgkmcnt(5)
    v_mfma_f32_16x16x32_bf16 v[56:59], v[172:175], v[156:159], v[56:59]
    ds_read_b128 v[140:143], v4 offset:2048
    v_cvt_pk_bf16_f32 v240, v200, v201
    v_cvt_pk_bf16_f32 v241, v202, v203
    v_mfma_f32_16x16x32_bf16 v[76:79], v[172:175], v[160:163], v[76:79]
    ds_read_b128 v[144:147], v4 offset:4096
    buffer_load_dwordx4 v1, s[12:15], s85 offen offset:1024 sc1 lds
    v_cvt_pk_bf16_f32 v242, v220, v221
    v_cvt_pk_bf16_f32 v243, v222, v223
    s_waitcnt lgkmcnt(6)
    v_mfma_f32_16x16x32_bf16 v[60:63], v[176:179], v[156:159], v[60:63]
    s_mul_i32 s39, s24, 22528
    s_add_u32 s39, s39, 22528
    v_add_u32 v6, s39, v1
    ds_read_b128 v[148:151], v6 offset:0
    s_add_u32 s40, s66, 4096
    buffer_store_dwordx4 v[240:243], v1, s[12:15], s40 offen sc1
    v_mfma_f32_16x16x32_bf16 v[80:83], v[176:179], v[160:163], v[80:83]
    ds_read_b128 v[152:155], v6 offset:2048
    s_waitcnt lgkmcnt(7)
    v_mfma_f32_16x16x32_bf16 v[64:67], v[180:183], v[156:159], v[64:67]
    s_add_u32 m0, s64, 106496
    s_add_u32 s85, s62, 6144
    buffer_load_dwordx4 v1, s[12:15], s85 offen sc1 lds
    v_mfma_f32_16x16x32_bf16 v[84:87], v[180:183], v[160:163], v[84:87]
    s_waitcnt lgkmcnt(5)
    v_mfma_f32_16x16x32_bf16 v[48:51], v[136:139], v[128:131], v[48:51]
    ds_read_b128 v[156:159], v2 offset:1024
    s_waitcnt lgkmcnt(5)
    v_mfma_f32_16x16x32_bf16 v[68:71], v[136:139], v[132:135], v[68:71]
    ds_read_b128 v[164:167], v4 offset:1024
    s_waitcnt lgkmcnt(5)
    v_mfma_f32_16x16x32_bf16 v[52:55], v[140:143], v[128:131], v[52:55]
    ds_read_b128 v[160:163], v2 offset:3072
    v_mfma_f32_16x16x32_bf16 v[72:75], v[140:143], v[132:135], v[72:75]
    ds_read_b128 v[168:171], v4 offset:3072
    buffer_load_dwordx4 v1, s[12:15], s85 offen offset:1024 sc1 lds
    s_waitcnt lgkmcnt(6)
    v_mfma_f32_16x16x32_bf16 v[56:59], v[144:147], v[128:131], v[56:59]
    ds_read_b128 v[172:175], v4 offset:5120
    v_mfma_f32_16x16x32_bf16 v[76:79], v[144:147], v[132:135], v[76:79]
    ds_read_b128 v[176:179], v6 offset:1024
    s_waitcnt lgkmcnt(7)
    v_mfma_f32_16x16x32_bf16 v[60:63], v[148:151], v[128:131], v[60:63]
    ds_read_b128 v[180:183], v6 offset:3072
    v_mfma_f32_16x16x32_bf16 v[80:83], v[148:151], v[132:135], v[80:83]
    s_waitcnt lgkmcnt(7)
    v_mfma_f32_16x16x32_bf16 v[64:67], v[152:155], v[128:131], v[64:67]
    v_mfma_f32_16x16x32_bf16 v[84:87], v[152:155], v[132:135], v[84:87]
    s_waitcnt lgkmcnt(5)
    v_mfma_f32_16x16x32_bf16 v[48:51], v[164:167], v[156:159], v[48:51]
    s_waitcnt vmcnt(9)
    s_barrier
    s_waitcnt lgkmcnt(4)
    v_mfma_f32_16x16x32_bf16 v[68:71], v[164:167], v[160:163], v[68:71]
    ds_read_b128 v[128:131], v2 offset:57344
    s_waitcnt lgkmcnt(4)
    v_mfma_f32_16x16x32_bf16 v[52:55], v[168:171], v[156:159], v[52:55]
    ds_read_b128 v[136:139], v4 offset:57344
    s_add_u32 m0, s64, 122880
    s_add_u32 s85, s61, 8192
    buffer_load_dwordx4 v1, s[12:15], s85 offen sc1 lds
    v_mfma_f32_16x16x32_bf16 v[72:75], v[168:171], v[160:163], v[72:75]
    ds_read_b128 v[132:135], v2 offset:59392
    s_waitcnt lgkmcnt(5)
    v_mfma_f32_16x16x32_bf16 v[56:59], v[172:175], v[156:159], v[56:59]
    ds_read_b128 v[140:143], v4 offset:59392
    v_mfma_f32_16x16x32_bf16 v[76:79], v[172:175], v[160:163], v[76:79]
    ds_read_b128 v[144:147], v4 offset:61440
    buffer_load_dwordx4 v1, s[12:15], s85 offen offset:1024 sc1 lds
    s_waitcnt lgkmcnt(6)
    v_mfma_f32_16x16x32_bf16 v[60:63], v[176:179], v[156:159], v[60:63]
    s_mul_i32 s39, s24, -30720
    s_add_u32 s39, s39, 79872
    v_add_u32 v6, s39, v1
    ds_read_b128 v[148:151], v6 offset:0
    v_mfma_f32_16x16x32_bf16 v[80:83], v[176:179], v[160:163], v[80:83]
    ds_read_b128 v[152:155], v6 offset:2048
    s_waitcnt lgkmcnt(7)
    v_mfma_f32_16x16x32_bf16 v[64:67], v[180:183], v[156:159], v[64:67]
    s_add_u32 m0, s64, 139264
    s_add_u32 s85, s62, 8192
    buffer_load_dwordx4 v1, s[12:15], s85 offen sc1 lds
    v_mfma_f32_16x16x32_bf16 v[84:87], v[180:183], v[160:163], v[84:87]
    s_waitcnt lgkmcnt(5)
    v_mfma_f32_16x16x32_bf16 v[48:51], v[136:139], v[128:131], v[48:51]
    ds_read_b128 v[156:159], v2 offset:58368
    s_waitcnt lgkmcnt(5)
    v_mfma_f32_16x16x32_bf16 v[68:71], v[136:139], v[132:135], v[68:71]
    ds_read_b128 v[164:167], v4 offset:58368
    s_waitcnt lgkmcnt(5)
    v_mfma_f32_16x16x32_bf16 v[52:55], v[140:143], v[128:131], v[52:55]
    ds_read_b128 v[160:163], v2 offset:60416
    v_mfma_f32_16x16x32_bf16 v[72:75], v[140:143], v[132:135], v[72:75]
    ds_read_b128 v[168:171], v4 offset:60416
    buffer_load_dwordx4 v1, s[12:15], s85 offen offset:1024 sc1 lds
    s_waitcnt lgkmcnt(6)
    v_mfma_f32_16x16x32_bf16 v[56:59], v[144:147], v[128:131], v[56:59]
    ds_read_b128 v[172:175], v4 offset:62464
    v_mfma_f32_16x16x32_bf16 v[76:79], v[144:147], v[132:135], v[76:79]
    ds_read_b128 v[176:179], v6 offset:1024
    s_waitcnt lgkmcnt(7)
    v_mfma_f32_16x16x32_bf16 v[60:63], v[148:151], v[128:131], v[60:63]
    ds_read_b128 v[180:183], v6 offset:3072
    s_add_u32 m0, s65, 32768
    s_add_u32 s85, s63, 8192
    buffer_load_dwordx4 v1, s[12:15], s85 offen sc1 lds
    v_mfma_f32_16x16x32_bf16 v[80:83], v[148:151], v[132:135], v[80:83]
    s_waitcnt lgkmcnt(7)
    v_mfma_f32_16x16x32_bf16 v[64:67], v[152:155], v[128:131], v[64:67]
    v_mfma_f32_16x16x32_bf16 v[84:87], v[152:155], v[132:135], v[84:87]
    s_waitcnt lgkmcnt(5)
    v_mfma_f32_16x16x32_bf16 v[48:51], v[164:167], v[156:159], v[48:51]
    s_waitcnt vmcnt(5)
    s_barrier
    s_cmp_eq_u32 s22, 0
    s_cbranch_scc0 L_fl_97
    s_add_u32 s45, s3, 7
    s_mov_b64 exec, 1
    v_mov_b32 v13, s45
    buffer_store_dword v13, off, s[12:15], s74 sc1
    s_mov_b64 exec, -1
L_fl_97:
    s_waitcnt lgkmcnt(4)
    v_mfma_f32_16x16x32_bf16 v[68:71], v[164:167], v[160:163], v[68:71]
    ds_read_b128 v[128:131], v3 offset:0
    v_bfe_u32 v7, v1, 4, 2
    s_waitcnt lgkmcnt(4)
    v_mfma_f32_16x16x32_bf16 v[52:55], v[168:171], v[156:159], v[52:55]
    ds_read_b128 v[136:139], v5 offset:0
    s_add_u32 m0, s64, 0
    s_add_u32 s85, s61, 10240
    buffer_load_dwordx4 v1, s[12:15], s85 offen sc1 lds
    v_lshlrev_b32 v7, 5, v7
    v_mfma_f32_16x16x32_bf16 v[72:75], v[168:171], v[160:163], v[72:75]
    ds_read_b128 v[132:135], v3 offset:2048
    s_andn2_b32 s69, s74, 96
    s_waitcnt lgkmcnt(5)
    v_mfma_f32_16x16x32_bf16 v[56:59], v[172:175], v[156:159], v[56:59]
    ds_read_b128 v[140:143], v5 offset:2048
    v_mfma_f32_16x16x32_bf16 v[76:79], v[172:175], v[160:163], v[76:79]
    ds_read_b128 v[144:147], v5 offset:4096
    buffer_load_dwordx4 v1, s[12:15], s85 offen offset:1024 sc1 lds
    s_waitcnt lgkmcnt(6)
    v_mfma_f32_16x16x32_bf16 v[60:63], v[176:179], v[156:159], v[60:63]
    s_mul_i32 s39, s24, -59392
    s_add_u32 s39, s39, 112640
    v_add_u32 v6, s39, v1
    ds_read_b128 v[148:151], v6 offset:0
    v_mfma_f32_16x16x32_bf16 v[80:83], v[176:179], v[160:163], v[80:83]
    ds_read_b128 v[152:155], v6 offset:2048
    s_waitcnt lgkmcnt(7)
    v_mfma_f32_16x16x32_bf16 v[64:67], v[180:183], v[156:159], v[64:67]
    s_add_u32 m0, s64, 16384
    s_add_u32 s85, s62, 10240
    buffer_load_dwordx4 v1, s[12:15], s85 offen sc1 lds
    v_mfma_f32_16x16x32_bf16 v[84:87], v[180:183], v[160:163], v[84:87]
    s_waitcnt lgkmcnt(5)
    v_mfma_f32_16x16x32_bf16 v[48:51], v[136:139], v[128:131], v[48:51]
    ds_read_b128 v[156:159], v3 offset:1024
    s_waitcnt lgkmcnt(5)
    v_mfma_f32_16x16x32_bf16 v[68:71], v[136:139], v[132:135], v[68:71]
    ds_read_b128 v[164:167], v5 offset:1024
    s_waitcnt lgkmcnt(5)
    v_mfma_f32_16x16x32_bf16 v[52:55], v[140:143], v[128:131], v[52:55]
    ds_read_b128 v[160:163], v3 offset:3072
    v_mfma_f32_16x16x32_bf16 v[72:75], v[140:143], v[132:135], v[72:75]
    ds_read_b128 v[168:171], v5 offset:3072
    buffer_load_dwordx4 v1, s[12:15], s85 offen offset:1024 sc1 lds
    s_waitcnt lgkmcnt(6)
    v_mfma_f32_16x16x32_bf16 v[56:59], v[144:147], v[128:131], v[56:59]
    ds_read_b128 v[172:175], v5 offset:5120
    v_mfma_f32_16x16x32_bf16 v[76:79], v[144:147], v[132:135], v[76:79]
    ds_read_b128 v[176:179], v6 offset:1024
    s_waitcnt lgkmcnt(7)
    v_mfma_f32_16x16x32_bf16 v[60:63], v[148:151], v[128:131], v[60:63]
    ds_read_b128 v[180:183], v6 offset:3072
    v_mfma_f32_16x16x32_bf16 v[80:83], v[148:151], v[132:135], v[80:83]
    s_waitcnt lgkmcnt(7)
    v_mfma_f32_16x16x32_bf16 v[64:67], v[152:155], v[128:131], v[64:67]
    v_mfma_f32_16x16x32_bf16 v[84:87], v[152:155], v[132:135], v[84:87]
    s_waitcnt lgkmcnt(5)
    v_mfma_f32_16x16x32_bf16 v[48:51], v[164:167], v[156:159], v[48:51]
    s_waitcnt vmcnt(4)
    s_barrier
    s_waitcnt lgkmcnt(4)
    v_mfma_f32_16x16x32_bf16 v[68:71], v[164:167], v[160:163], v[68:71]
    ds_read_b128 v[128:131], v3 offset:32768
    s_waitcnt lgkmcnt(4)
    v_mfma_f32_16x16x32_bf16 v[52:55], v[168:171], v[156:159], v[52:55]
    ds_read_b128 v[136:139], v5 offset:32768
    s_add_u32 m0, s64, 57344
    s_add_u32 s85, s61, 12288
    buffer_load_dwordx4 v1, s[12:15], s85 offen sc1 lds
    v_mfma_f32_16x16x32_bf16 v[72:75], v[168:171], v[160:163], v[72:75]
    ds_read_b128 v[132:135], v3 offset:34816
    s_waitcnt lgkmcnt(5)
    v_mfma_f32_16x16x32_bf16 v[56:59], v[172:175], v[156:159], v[56:59]
    ds_read_b128 v[140:143], v5 offset:34816
    v_mfma_f32_16x16x32_bf16 v[76:79], v[172:175], v[160:163], v[76:79]
    ds_read_b128 v[144:147], v5 offset:36864
    buffer_load_dwordx4 v1, s[12:15], s85 offen offset:1024 sc1 lds
    s_waitcnt lgkmcnt(6)
    v_mfma_f32_16x16x32_bf16 v[60:63], v[176:179], v[156:159], v[60:63]
    s_mul_i32 s39, s24, -112640
    s_add_u32 s39, s39, 145408
    v_add_u32 v6, s39, v1
    ds_read_b128 v[148:151], v6 offset:0
    v_mfma_f32_16x16x32_bf16 v[80:83], v[176:179], v[160:163], v[80:83]
    ds_read_b128 v[152:155], v6 offset:2048
    s_waitcnt lgkmcnt(7)
    v_mfma_f32_16x16x32_bf16 v[64:67], v[180:183], v[156:159], v[64:67]
    s_add_u32 m0, s64, 73728
    s_add_u32 s85, s62, 12288
    buffer_load_dwordx4 v1, s[12:15], s85 offen sc1 lds
    v_mfma_f32_16x16x32_bf16 v[84:87], v[180:183], v[160:163], v[84:87]
    s_waitcnt lgkmcnt(5)
    v_mfma_f32_16x16x32_bf16 v[48:51], v[136:139], v[128:131], v[48:51]
    ds_read_b128 v[156:159], v3 offset:33792
    s_waitcnt lgkmcnt(5)
    v_mfma_f32_16x16x32_bf16 v[68:71], v[136:139], v[132:135], v[68:71]
    ds_read_b128 v[164:167], v5 offset:33792
    s_waitcnt lgkmcnt(5)
    v_mfma_f32_16x16x32_bf16 v[52:55], v[140:143], v[128:131], v[52:55]
    ds_read_b128 v[160:163], v3 offset:35840
    v_mfma_f32_16x16x32_bf16 v[72:75], v[140:143], v[132:135], v[72:75]
    ds_read_b128 v[168:171], v5 offset:35840
    buffer_load_dwordx4 v1, s[12:15], s85 offen offset:1024 sc1 lds
    s_waitcnt lgkmcnt(6)
    v_mfma_f32_16x16x32_bf16 v[56:59], v[144:147], v[128:131], v[56:59]
    ds_read_b128 v[172:175], v5 offset:37888
    v_mfma_f32_16x16x32_bf16 v[76:79], v[144:147], v[132:135], v[76:79]
    ds_read_b128 v[176:179], v6 offset:1024
    s_waitcnt lgkmcnt(7)
    v_mfma_f32_16x16x32_bf16 v[60:63], v[148:151], v[128:131], v[60:63]
    ds_read_b128 v[180:183], v6 offset:3072
    s_add_u32 m0, s65, 40960
    s_add_u32 s85, s63, 12288
    buffer_load_dwordx4 v1, s[12:15], s85 offen sc1 lds
    v_mfma_f32_16x16x32_bf16 v[80:83], v[148:151], v[132:135], v[80:83]
    s_waitcnt lgkmcnt(7)
    v_mfma_f32_16x16x32_bf16 v[64:67], v[152:155], v[128:131], v[64:67]
    v_mfma_f32_16x16x32_bf16 v[84:87], v[152:155], v[132:135], v[84:87]
    s_waitcnt lgkmcnt(5)
    v_mfma_f32_16x16x32_bf16 v[48:51], v[164:167], v[156:159], v[48:51]
    s_waitcnt vmcnt(5)
    s_barrier
    s_waitcnt lgkmcnt(4)
    v_mfma_f32_16x16x32_bf16 v[68:71], v[164:167], v[160:163], v[68:71]
    ds_read_b128 v[128:131], v2 offset:0
    s_waitcnt lgkmcnt(4)
    v_mfma_f32_16x16x32_bf16 v[52:55], v[168:171], v[156:159], v[52:55]
    ds_read_b128 v[136:139], v4 offset:0
    s_add_u32 m0, s64, 90112
    s_add_u32 s85, s61, 14336
    buffer_load_dwordx4 v1, s[12:15], s85 offen sc1 lds
    v_mfma_f32_16x16x32_bf16 v[72:75], v[168:171], v[160:163], v[72:75]
    ds_read_b128 v[132:135], v2 offset:2048
    s_waitcnt lgkmcnt(5)
    v_mfma_f32_16x16x32_bf16 v[56:59], v[172:175], v[156:159], v[56:59]
    ds_read_b128 v[140:143], v4 offset:2048
    v_mfma_f32_16x16x32_bf16 v[76:79], v[172:175], v[160:163], v[76:79]
    ds_read_b128 v[144:147], v4 offset:4096
    buffer_load_dwordx4 v1, s[12:15], s85 offen offset:1024 sc1 lds
    s_waitcnt lgkmcnt(6)
    v_mfma_f32_16x16x32_bf16 v[60:63], v[176:179], v[156:159], v[60:63]
    s_mul_i32 s39, s24, 14336
    s_add_u32 s39, s39, 22528
    v_add_u32 v6, s39, v1
    ds_read_b128 v[148:151], v6 offset:0
    v_mfma_f32_16x16x32_bf16 v[80:83], v[176:179], v[160:163], v[80:83]
    ds_read_b128 v[152:155], v6 offset:2048
    s_waitcnt lgkmcnt(7)
    v_mfma_f32_16x16x32_bf16 v[64:67], v[180:183], v[156:159], v[64:67]
    s_add_u32 m0, s64, 106496
    s_add_u32 s85, s62, 14336
    buffer_load_dwordx4 v1, s[12:15], s85 offen sc1 lds
    v_mfma_f32_16x16x32_bf16 v[84:87], v[180:183], v[160:163], v[84:87]
    s_waitcnt lgkmcnt(5)
    v_mfma_f32_16x16x32_bf16 v[48:51], v[136:139], v[128:131], v[48:51]
    ds_read_b128 v[156:159], v2 offset:1024
    s_waitcnt lgkmcnt(5)
    v_mfma_f32_16x16x32_bf16 v[68:71], v[136:139], v[132:135], v[68:71]
    ds_read_b128 v[164:167], v4 offset:1024
    s_waitcnt lgkmcnt(5)
    v_mfma_f32_16x16x32_bf16 v[52:55], v[140:143], v[128:131], v[52:55]
    ds_read_b128 v[160:163], v2 offset:3072
    v_mfma_f32_16x16x32_bf16 v[72:75], v[140:143], v[132:135], v[72:75]
    ds_read_b128 v[168:171], v4 offset:3072
    buffer_load_dwordx4 v1, s[12:15], s85 offen offset:1024 sc1 lds
    s_waitcnt lgkmcnt(6)
    v_mfma_f32_16x16x32_bf16 v[56:59], v[144:147], v[128:131], v[56:59]
    ds_read_b128 v[172:175], v4 offset:5120
    v_mfma_f32_16x16x32_bf16 v[76:79], v[144:147], v[132:135], v[76:79]
    ds_read_b128 v[176:179], v6 offset:1024
    s_waitcnt lgkmcnt(7)
    v_mfma_f32_16x16x32_bf16 v[60:63], v[148:151], v[128:131], v[60:63]
    ds_read_b128 v[180:183], v6 offset:3072
    buffer_load_dwordx4 v[20:23], v16, s[4:7], s67 offen
    v_mfma_f32_16x16x32_bf16 v[80:83], v[148:151], v[132:135], v[80:83]
    s_waitcnt lgkmcnt(7)
    v_mfma_f32_16x16x32_bf16 v[64:67], v[152:155], v[128:131], v[64:67]
    v_mfma_f32_16x16x32_bf16 v[84:87], v[152:155], v[132:135], v[84:87]
    s_waitcnt lgkmcnt(5)
    v_mfma_f32_16x16x32_bf16 v[48:51], v[164:167], v[156:159], v[48:51]
    s_waitcnt vmcnt(5)
    s_barrier
    s_waitcnt lgkmcnt(4)
    v_mfma_f32_16x16x32_bf16 v[68:71], v[164:167], v[160:163], v[68:71]
    ds_read_b128 v[128:131], v2 offset:57344
    s_waitcnt lgkmcnt(4)
    v_mfma_f32_16x16x32_bf16 v[52:55], v[168:171], v[156:159], v[52:55]
    ds_read_b128 v[136:139], v4 offset:57344
    s_add_u32 m0, s64, 122880
    s_add_u32 s85, s61, 16384
    buffer_load_dwordx4 v1, s[12:15], s85 offen sc1 lds
    v_mfma_f32_16x16x32_bf16 v[72:75], v[168:171], v[160:163], v[72:75]
    ds_read_b128 v[132:135], v2 offset:59392
    s_waitcnt lgkmcnt(5)
    v_mfma_f32_16x16x32_bf16 v[56:59], v[172:175], v[156:159], v[56:59]
    ds_read_b128 v[140:143], v4 offset:59392
    v_mfma_f32_16x16x32_bf16 v[76:79], v[172:175], v[160:163], v[76:79]
    ds_read_b128 v[144:147], v4 offset:61440
    buffer_load_dwordx4 v1, s[12:15], s85 offen offset:1024 sc1 lds
    s_waitcnt lgkmcnt(6)
    v_mfma_f32_16x16x32_bf16 v[60:63], v[176:179], v[156:159], v[60:63]
    s_mul_i32 s39, s24, -38912
    s_add_u32 s39, s39, 79872
    v_add_u32 v6, s39, v1
    ds_read_b128 v[148:151], v6 offset:0
    v_mfma_f32_16x16x32_bf16 v[80:83], v[176:179], v[160:163], v[80:83]
    ds_read_b128 v[152:155], v6 offset:2048
    s_waitcnt lgkmcnt(7)
    v_mfma_f32_16x16x32_bf16 v[64:67], v[180:183], v[156:159], v[64:67]
    s_add_u32 m0, s64, 139264
    s_add_u32 s85, s62, 16384
    buffer_load_dwordx4 v1, s[12:15], s85 offen sc1 lds
    v_mfma_f32_16x16x32_bf16 v[84:87], v[180:183], v[160:163], v[84:87]
    s_waitcnt lgkmcnt(5)
    v_mfma_f32_16x16x32_bf16 v[48:51], v[136:139], v[128:131], v[48:51]
    ds_read_b128 v[156:159], v2 offset:58368
    s_waitcnt lgkmcnt(5)
    v_mfma_f32_16x16x32_bf16 v[68:71], v[136:139], v[132:135], v[68:71]
    ds_read_b128 v[164:167], v4 offset:58368
    s_waitcnt lgkmcnt(5)
    v_mfma_f32_16x16x32_bf16 v[52:55], v[140:143], v[128:131], v[52:55]
    ds_read_b128 v[160:163], v2 offset:60416
    v_mfma_f32_16x16x32_bf16 v[72:75], v[140:143], v[132:135], v[72:75]
    ds_read_b128 v[168:171], v4 offset:60416
    buffer_load_dwordx4 v1, s[12:15], s85 offen offset:1024 sc1 lds
    s_waitcnt lgkmcnt(6)
    v_mfma_f32_16x16x32_bf16 v[56:59], v[144:147], v[128:131], v[56:59]
    ds_read_b128 v[172:175], v4 offset:62464
    v_mfma_f32_16x16x32_bf16 v[76:79], v[144:147], v[132:135], v[76:79]
    ds_read_b128 v[176:179], v6 offset:1024
    s_waitcnt lgkmcnt(7)
    v_mfma_f32_16x16x32_bf16 v[60:63], v[148:151], v[128:131], v[60:63]
    ds_read_b128 v[180:183], v6 offset:3072
    s_add_u32 m0, s65, 49152
    s_add_u32 s85, s63, 16384
    buffer_load_dwordx4 v1, s[12:15], s85 offen sc1 lds
    v_mfma_f32_16x16x32_bf16 v[80:83], v[148:151], v[132:135], v[80:83]
    s_waitcnt lgkmcnt(7)
    v_mfma_f32_16x16x32_bf16 v[64:67], v[152:155], v[128:131], v[64:67]
    v_mfma_f32_16x16x32_bf16 v[84:87], v[152:155], v[132:135], v[84:87]
    buffer_load_dword v24, v8, s[4:7], s68 offen
    s_waitcnt lgkmcnt(5)
    v_mfma_f32_16x16x32_bf16 v[48:51], v[164:167], v[156:159], v[48:51]
    s_waitcnt vmcnt(7)
    s_barrier
    s_waitcnt lgkmcnt(4)
    v_mfma_f32_16x16x32_bf16 v[68:71], v[164:167], v[160:163], v[68:71]
    ds_read_b128 v[128:131], v3 offset:0
    s_waitcnt lgkmcnt(4)
    v_mfma_f32_16x16x32_bf16 v[52:55], v[168:171], v[156:159], v[52:55]
    ds_read_b128 v[136:139], v5 offset:0
    s_add_u32 m0, s64, 0
    s_add_u32 s85, s61, 18432
    buffer_load_dwordx4 v1, s[12:15], s85 offen sc1 lds
    v_mfma_f32_16x16x32_bf16 v[72:75], v[168:171], v[160:163], v[72:75]
    ds_read_b128 v[132:135], v3 offset:2048
    s_waitcnt lgkmcnt(5)
    v_mfma_f32_16x16x32_bf16 v[56:59], v[172:175], v[156:159], v[56:59]
    ds_read_b128 v[140:143], v5 offset:2048
    v_mfma_f32_16x16x32_bf16 v[76:79], v[172:175], v[160:163], v[76:79]
    ds_read_b128 v[144:147], v5 offset:4096
    buffer_load_dwordx4 v1, s[12:15], s85 offen offset:1024 sc1 lds
    s_waitcnt lgkmcnt(6)
    v_mfma_f32_16x16x32_bf16 v[60:63], v[176:179], v[156:159], v[60:63]
    s_mul_i32 s39, s24, -67584
    s_add_u32 s39, s39, 112640
    v_add_u32 v6, s39, v1
    ds_read_b128 v[148:151], v6 offset:0
    v_mfma_f32_16x16x32_bf16 v[80:83], v[176:179], v[160:163], v[80:83]
    ds_read_b128 v[152:155], v6 offset:2048
    s_waitcnt lgkmcnt(7)
    v_mfma_f32_16x16x32_bf16 v[64:67], v[180:183], v[156:159], v[64:67]
    s_add_u32 m0, s64, 16384
    s_add_u32 s85, s62, 18432
    buffer_load_dwordx4 v1, s[12:15], s85 offen sc1 lds
    v_mfma_f32_16x16x32_bf16 v[84:87], v[180:183], v[160:163], v[84:87]
    s_waitcnt lgkmcnt(5)
    v_mfma_f32_16x16x32_bf16 v[48:51], v[136:139], v[128:131], v[48:51]
    ds_read_b128 v[156:159], v3 offset:1024
    s_waitcnt lgkmcnt(5)
    v_mfma_f32_16x16x32_bf16 v[68:71], v[136:139], v[132:135], v[68:71]
    ds_read_b128 v[164:167], v5 offset:1024
    s_waitcnt lgkmcnt(5)
    v_mfma_f32_16x16x32_bf16 v[52:55], v[140:143], v[128:131], v[52:55]
    ds_read_b128 v[160:163], v3 offset:3072
    v_mfma_f32_16x16x32_bf16 v[72:75], v[140:143], v[132:135], v[72:75]
    ds_read_b128 v[168:171], v5 offset:3072
    buffer_load_dwordx4 v1, s[12:15], s85 offen offset:1024 sc1 lds
    s_waitcnt lgkmcnt(6)
    v_mfma_f32_16x16x32_bf16 v[56:59], v[144:147], v[128:131], v[56:59]
    ds_read_b128 v[172:175], v5 offset:5120
    v_mfma_f32_16x16x32_bf16 v[76:79], v[144:147], v[132:135], v[76:79]
    ds_read_b128 v[176:179], v6 offset:1024
    s_waitcnt lgkmcnt(7)
    v_mfma_f32_16x16x32_bf16 v[60:63], v[148:151], v[128:131], v[60:63]
    ds_read_b128 v[180:183], v6 offset:3072
    v_mfma_f32_16x16x32_bf16 v[80:83], v[148:151], v[132:135], v[80:83]
    s_waitcnt lgkmcnt(7)
    v_mfma_f32_16x16x32_bf16 v[64:67], v[152:155], v[128:131], v[64:67]
    v_mfma_f32_16x16x32_bf16 v[84:87], v[152:155], v[132:135], v[84:87]
    s_waitcnt lgkmcnt(5)
    v_mfma_f32_16x16x32_bf16 v[48:51], v[164:167], v[156:159], v[48:51]
    s_waitcnt vmcnt(5)
    s_barrier
    s_waitcnt lgkmcnt(4)
    v_mfma_f32_16x16x32_bf16 v[68:71], v[164:167], v[160:163], v[68:71]
    ds_read_b128 v[128:131], v3 offset:32768
    s_waitcnt lgkmcnt(4)
    v_mfma_f32_16x16x32_bf16 v[52:55], v[168:171], v[156:159], v[52:55]
    ds_read_b128 v[136:139], v5 offset:32768
    s_add_u32 m0, s64, 57344
    s_add_u32 s85, s61, 20480
    buffer_load_dwordx4 v1, s[12:15], s85 offen sc1 lds
    v_mfma_f32_16x16x32_bf16 v[72:75], v[168:171], v[160:163], v[72:75]
    ds_read_b128 v[132:135], v3 offset:34816
    s_waitcnt lgkmcnt(5)
    v_mfma_f32_16x16x32_bf16 v[56:59], v[172:175], v[156:159], v[56:59]
    ds_read_b128 v[140:143], v5 offset:34816
    v_mfma_f32_16x16x32_bf16 v[76:79], v[172:175], v[160:163], v[76:79]
    ds_read_b128 v[144:147], v5 offset:36864
    buffer_load_dwordx4 v1, s[12:15], s85 offen offset:1024 sc1 lds
    s_waitcnt lgkmcnt(6)
    v_mfma_f32_16x16x32_bf16 v[60:63], v[176:179], v[156:159], v[60:63]
    s_mul_i32 s39, s24, -96256
    s_add_u32 s39, s39, 145408
    v_add_u32 v6, s39, v1
    ds_read_b128 v[148:151], v6 offset:0
    v_mfma_f32_16x16x32_bf16 v[80:83], v[176:179], v[160:163], v[80:83]
    ds_read_b128 v[152:155], v6 offset:2048
    s_waitcnt lgkmcnt(7)
    v_mfma_f32_16x16x32_bf16 v[64:67], v[180:183], v[156:159], v[64:67]
    s_add_u32 m0, s64, 73728
    s_add_u32 s85, s62, 20480
    buffer_load_dwordx4 v1, s[12:15], s85 offen sc1 lds
    v_mfma_f32_16x16x32_bf16 v[84:87], v[180:183], v[160:163], v[84:87]
    s_waitcnt lgkmcnt(5)
    v_mfma_f32_16x16x32_bf16 v[48:51], v[136:139], v[128:131], v[48:51]
    ds_read_b128 v[156:159], v3 offset:33792
    s_waitcnt lgkmcnt(5)
    v_mfma_f32_16x16x32_bf16 v[68:71], v[136:139], v[132:135], v[68:71]
    ds_read_b128 v[164:167], v5 offset:33792
    s_waitcnt lgkmcnt(5)
    v_mfma_f32_16x16x32_bf16 v[52:55], v[140:143], v[128:131], v[52:55]
    ds_read_b128 v[160:163], v3 offset:35840
    v_mfma_f32_16x16x32_bf16 v[72:75], v[140:143], v[132:135], v[72:75]
    ds_read_b128 v[168:171], v5 offset:35840
    buffer_load_dwordx4 v1, s[12:15], s85 offen offset:1024 sc1 lds
    s_waitcnt lgkmcnt(6)
    v_mfma_f32_16x16x32_bf16 v[56:59], v[144:147], v[128:131], v[56:59]
    ds_read_b128 v[172:175], v5 offset:37888
    v_mfma_f32_16x16x32_bf16 v[76:79], v[144:147], v[132:135], v[76:79]
    ds_read_b128 v[176:179], v6 offset:1024
    s_waitcnt lgkmcnt(7)
    v_mfma_f32_16x16x32_bf16 v[60:63], v[148:151], v[128:131], v[60:63]
    ds_read_b128 v[180:183], v6 offset:3072
    s_add_u32 m0, s65, 32768
    s_add_u32 s85, s63, 20480
    buffer_load_dwordx4 v1, s[12:15], s85 offen sc1 lds
    v_mfma_f32_16x16x32_bf16 v[80:83], v[148:151], v[132:135], v[80:83]
    s_waitcnt lgkmcnt(7)
    v_mfma_f32_16x16x32_bf16 v[64:67], v[152:155], v[128:131], v[64:67]
    v_mfma_f32_16x16x32_bf16 v[84:87], v[152:155], v[132:135], v[84:87]
    s_waitcnt lgkmcnt(5)
    v_mfma_f32_16x16x32_bf16 v[48:51], v[164:167], v[156:159], v[48:51]
    s_waitcnt vmcnt(5)
    s_barrier
    s_waitcnt lgkmcnt(4)
    v_mfma_f32_16x16x32_bf16 v[68:71], v[164:167], v[160:163], v[68:71]
    ds_read_b128 v[128:131], v2 offset:0
    s_waitcnt lgkmcnt(4)
    v_mfma_f32_16x16x32_bf16 v[52:55], v[168:171], v[156:159], v[52:55]
    ds_read_b128 v[136:139], v4 offset:0
    s_add_u32 m0, s64, 90112
    s_add_u32 s85, s61, 22528
    buffer_load_dwordx4 v1, s[12:15], s85 offen sc1 lds
    v_mfma_f32_16x16x32_bf16 v[72:75], v[168:171], v[160:163], v[72:75]
    ds_read_b128 v[132:135], v2 offset:2048
    s_waitcnt lgkmcnt(5)
    v_mfma_f32_16x16x32_bf16 v[56:59], v[172:175], v[156:159], v[56:59]
    ds_read_b128 v[140:143], v4 offset:2048
    v_mfma_f32_16x16x32_bf16 v[76:79], v[172:175], v[160:163], v[76:79]
    ds_read_b128 v[144:147], v4 offset:4096
    buffer_load_dwordx4 v1, s[12:15], s85 offen offset:1024 sc1 lds
    s_waitcnt lgkmcnt(6)
    v_mfma_f32_16x16x32_bf16 v[60:63], v[176:179], v[156:159], v[60:63]
    s_mul_i32 s39, s24, 30720
    s_add_u32 s39, s39, 22528
    v_add_u32 v6, s39, v1
    ds_read_b128 v[148:151], v6 offset:0
    v_mfma_f32_16x16x32_bf16 v[80:83], v[176:179], v[160:163], v[80:83]
    ds_read_b128 v[152:155], v6 offset:2048
    s_waitcnt lgkmcnt(7)
    v_mfma_f32_16x16x32_bf16 v[64:67], v[180:183], v[156:159], v[64:67]
    s_add_u32 m0, s64, 106496
    s_add_u32 s85, s62, 22528
    buffer_load_dwordx4 v1, s[12:15], s85 offen sc1 lds
    v_mfma_f32_16x16x32_bf16 v[84:87], v[180:183], v[160:163], v[84:87]
    s_waitcnt lgkmcnt(5)
    v_mfma_f32_16x16x32_bf16 v[48:51], v[136:139], v[128:131], v[48:51]
    ds_read_b128 v[156:159], v2 offset:1024
    s_waitcnt lgkmcnt(5)
    v_mfma_f32_16x16x32_bf16 v[68:71], v[136:139], v[132:135], v[68:71]
    ds_read_b128 v[164:167], v4 offset:1024
    s_waitcnt lgkmcnt(5)
    v_mfma_f32_16x16x32_bf16 v[52:55], v[140:143], v[128:131], v[52:55]
    ds_read_b128 v[160:163], v2 offset:3072
    v_mfma_f32_16x16x32_bf16 v[72:75], v[140:143], v[132:135], v[72:75]
    ds_read_b128 v[168:171], v4 offset:3072
    buffer_load_dwordx4 v1, s[12:15], s85 offen offset:1024 sc1 lds
    s_waitcnt lgkmcnt(6)
    v_mfma_f32_16x16x32_bf16 v[56:59], v[144:147], v[128:131], v[56:59]
    ds_read_b128 v[172:175], v4 offset:5120
    v_mfma_f32_16x16x32_bf16 v[76:79], v[144:147], v[132:135], v[76:79]
    ds_read_b128 v[176:179], v6 offset:1024
    s_waitcnt lgkmcnt(7)
    v_mfma_f32_16x16x32_bf16 v[60:63], v[148:151], v[128:131], v[60:63]
    ds_read_b128 v[180:183], v6 offset:3072
    v_mfma_f32_16x16x32_bf16 v[80:83], v[148:151], v[132:135], v[80:83]
    s_waitcnt lgkmcnt(7)
    v_mfma_f32_16x16x32_bf16 v[64:67], v[152:155], v[128:131], v[64:67]
    v_mfma_f32_16x16x32_bf16 v[84:87], v[152:155], v[132:135], v[84:87]
    s_waitcnt lgkmcnt(5)
    v_mfma_f32_16x16x32_bf16 v[48:51], v[164:167], v[156:159], v[48:51]
    s_waitcnt vmcnt(4)
    s_barrier
    s_waitcnt lgkmcnt(4)
    v_mfma_f32_16x16x32_bf16 v[68:71], v[164:167], v[160:163], v[68:71]
    ds_read_b128 v[128:131], v2 offset:57344
    s_waitcnt lgkmcnt(4)
    v_mfma_f32_16x16x32_bf16 v[52:55], v[168:171], v[156:159], v[52:55]
    ds_read_b128 v[136:139], v4 offset:57344
    s_add_u32 m0, s64, 122880
    s_add_u32 s85, s61, 24576
    buffer_load_dwordx4 v1, s[12:15], s85 offen sc1 lds
    v_mfma_f32_16x16x32_bf16 v[72:75], v[168:171], v[160:163], v[72:75]
    ds_read_b128 v[132:135], v2 offset:59392
    s_waitcnt lgkmcnt(5)
    v_mfma_f32_16x16x32_bf16 v[56:59], v[172:175], v[156:159], v[56:59]
    ds_read_b128 v[140:143], v4 offset:59392
    v_mfma_f32_16x16x32_bf16 v[76:79], v[172:175], v[160:163], v[76:79]
    ds_read_b128 v[144:147], v4 offset:61440
    buffer_load_dwordx4 v1, s[12:15], s85 offen offset:1024 sc1 lds
    s_waitcnt lgkmcnt(6)
    v_mfma_f32_16x16x32_bf16 v[60:63], v[176:179], v[156:159], v[60:63]
    s_mul_i32 s39, s24, -47104
    s_add_u32 s39, s39, 79872
    v_add_u32 v6, s39, v1
    ds_read_b128 v[148:151], v6 offset:0
    v_mfma_f32_16x16x32_bf16 v[80:83], v[176:179], v[160:163], v[80:83]
    ds_read_b128 v[152:155], v6 offset:2048
    s_waitcnt lgkmcnt(7)
    v_mfma_f32_16x16x32_bf16 v[64:67], v[180:183], v[156:159], v[64:67]
    s_add_u32 m0, s64, 139264
    s_add_u32 s85, s62, 24576
    buffer_load_dwordx4 v1, s[12:15], s85 offen sc1 lds
    v_mfma_f32_16x16x32_bf16 v[84:87], v[180:183], v[160:163], v[84:87]
    s_waitcnt lgkmcnt(5)
    v_mfma_f32_16x16x32_bf16 v[48:51], v[136:139], v[128:131], v[48:51]
    ds_read_b128 v[156:159], v2 offset:58368
    s_waitcnt lgkmcnt(5)
    v_mfma_f32_16x16x32_bf16 v[68:71], v[136:139], v[132:135], v[68:71]
    ds_read_b128 v[164:167], v4 offset:58368
    s_waitcnt lgkmcnt(5)
    v_mfma_f32_16x16x32_bf16 v[52:55], v[140:143], v[128:131], v[52:55]
    ds_read_b128 v[160:163], v2 offset:60416
    v_mfma_f32_16x16x32_bf16 v[72:75], v[140:143], v[132:135], v[72:75]
    ds_read_b128 v[168:171], v4 offset:60416
    buffer_load_dwordx4 v1, s[12:15], s85 offen offset:1024 sc1 lds
    s_waitcnt lgkmcnt(6)
    v_mfma_f32_16x16x32_bf16 v[56:59], v[144:147], v[128:131], v[56:59]
    ds_read_b128 v[172:175], v4 offset:62464
    v_mfma_f32_16x16x32_bf16 v[76:79], v[144:147], v[132:135], v[76:79]
    ds_read_b128 v[176:179], v6 offset:1024
    s_waitcnt lgkmcnt(7)
    v_mfma_f32_16x16x32_bf16 v[60:63], v[148:151], v[128:131], v[60:63]
    ds_read_b128 v[180:183], v6 offset:3072
    s_add_u32 m0, s65, 40960
    s_add_u32 s85, s63, 24576
    buffer_load_dwordx4 v1, s[12:15], s85 offen sc1 lds
    v_mfma_f32_16x16x32_bf16 v[80:83], v[148:151], v[132:135], v[80:83]
    s_waitcnt lgkmcnt(7)
    v_mfma_f32_16x16x32_bf16 v[64:67], v[152:155], v[128:131], v[64:67]
    v_mfma_f32_16x16x32_bf16 v[84:87], v[152:155], v[132:135], v[84:87]
    s_waitcnt lgkmcnt(5)
    v_mfma_f32_16x16x32_bf16 v[48:51], v[164:167], v[156:159], v[48:51]
    s_waitcnt vmcnt(5)
    s_barrier
    s_waitcnt lgkmcnt(4)
    v_mfma_f32_16x16x32_bf16 v[68:71], v[164:167], v[160:163], v[68:71]
    ds_read_b128 v[128:131], v3 offset:0
    s_waitcnt lgkmcnt(4)
    v_mfma_f32_16x16x32_bf16 v[52:55], v[168:171], v[156:159], v[52:55]
    ds_read_b128 v[136:139], v5 offset:0
    s_add_u32 m0, s64, 0
    s_add_u32 s85, s61, 26624
    buffer_load_dwordx4 v1, s[12:15], s85 offen sc1 lds
    v_mfma_f32_16x16x32_bf16 v[72:75], v[168:171], v[160:163], v[72:75]
    ds_read_b128 v[132:135], v3 offset:2048
    s_waitcnt lgkmcnt(5)
    v_mfma_f32_16x16x32_bf16 v[56:59], v[172:175], v[156:159], v[56:59]
    ds_read_b128 v[140:143], v5 offset:2048
    v_mfma_f32_16x16x32_bf16 v[76:79], v[172:175], v[160:163], v[76:79]
    ds_read_b128 v[144:147], v5 offset:4096
    buffer_load_dwordx4 v1, s[12:15], s85 offen offset:1024 sc1 lds
    s_waitcnt lgkmcnt(6)
    v_mfma_f32_16x16x32_bf16 v[60:63], v[176:179], v[156:159], v[60:63]
    s_mul_i32 s39, s24, -75776
    s_add_u32 s39, s39, 112640
    v_add_u32 v6, s39, v1
    ds_read_b128 v[148:151], v6 offset:0
    v_mfma_f32_16x16x32_bf16 v[80:83], v[176:179], v[160:163], v[80:83]
    ds_read_b128 v[152:155], v6 offset:2048
    s_waitcnt lgkmcnt(7)
    v_mfma_f32_16x16x32_bf16 v[64:67], v[180:183], v[156:159], v[64:67]
    s_add_u32 m0, s64, 16384
    s_add_u32 s85, s62, 26624
    buffer_load_dwordx4 v1, s[12:15], s85 offen sc1 lds
    v_mfma_f32_16x16x32_bf16 v[84:87], v[180:183], v[160:163], v[84:87]
    s_waitcnt lgkmcnt(5)
    v_mfma_f32_16x16x32_bf16 v[48:51], v[136:139], v[128:131], v[48:51]
    ds_read_b128 v[156:159], v3 offset:1024
    s_waitcnt lgkmcnt(5)
    v_mfma_f32_16x16x32_bf16 v[68:71], v[136:139], v[132:135], v[68:71]
    ds_read_b128 v[164:167], v5 offset:1024
    s_waitcnt lgkmcnt(5)
    v_mfma_f32_16x16x32_bf16 v[52:55], v[140:143], v[128:131], v[52:55]
    ds_read_b128 v[160:163], v3 offset:3072
    v_mfma_f32_16x16x32_bf16 v[72:75], v[140:143], v[132:135], v[72:75]
    ds_read_b128 v[168:171], v5 offset:3072
    buffer_load_dwordx4 v1, s[12:15], s85 offen offset:1024 sc1 lds
    s_waitcnt lgkmcnt(6)
    v_mfma_f32_16x16x32_bf16 v[56:59], v[144:147], v[128:131], v[56:59]
    ds_read_b128 v[172:175], v5 offset:5120
    v_mfma_f32_16x16x32_bf16 v[76:79], v[144:147], v[132:135], v[76:79]
    ds_read_b128 v[176:179], v6 offset:1024
    s_waitcnt lgkmcnt(7)
    v_mfma_f32_16x16x32_bf16 v[60:63], v[148:151], v[128:131], v[60:63]
    ds_read_b128 v[180:183], v6 offset:3072
    buffer_load_dword v31, v7, s[12:15], s69 offen sc1
    v_mfma_f32_16x16x32_bf16 v[80:83], v[148:151], v[132:135], v[80:83]
    s_waitcnt lgkmcnt(7)
    v_mfma_f32_16x16x32_bf16 v[64:67], v[152:155], v[128:131], v[64:67]
    v_mfma_f32_16x16x32_bf16 v[84:87], v[152:155], v[132:135], v[84:87]
    s_waitcnt lgkmcnt(5)
    v_mfma_f32_16x16x32_bf16 v[48:51], v[164:167], v[156:159], v[48:51]
    s_waitcnt vmcnt(5)
    s_barrier
    s_waitcnt lgkmcnt(4)
    v_mfma_f32_16x16x32_bf16 v[68:71], v[164:167], v[160:163], v[68:71]
    ds_read_b128 v[128:131], v3 offset:32768
    s_waitcnt lgkmcnt(4)
    v_mfma_f32_16x16x32_bf16 v[52:55], v[168:171], v[156:159], v[52:55]
    ds_read_b128 v[136:139], v5 offset:32768
    s_add_u32 m0, s64, 57344
    s_add_u32 s85, s61, 28672
    buffer_load_dwordx4 v1, s[12:15], s85 offen sc1 lds
    v_mfma_f32_16x16x32_bf16 v[72:75], v[168:171], v[160:163], v[72:75]
    ds_read_b128 v[132:135], v3 offset:34816
    s_waitcnt lgkmcnt(5)
    v_mfma_f32_16x16x32_bf16 v[56:59], v[172:175], v[156:159], v[56:59]
    ds_read_b128 v[140:143], v5 offset:34816
    v_mfma_f32_16x16x32_bf16 v[76:79], v[172:175], v[160:163], v[76:79]
    ds_read_b128 v[144:147], v5 offset:36864
    buffer_load_dwordx4 v1, s[12:15], s85 offen offset:1024 sc1 lds
    s_waitcnt lgkmcnt(6)
    v_mfma_f32_16x16x32_bf16 v[60:63], v[176:179], v[156:159], v[60:63]
    s_mul_i32 s39, s24, -104448
    s_add_u32 s39, s39, 145408
    v_add_u32 v6, s39, v1
    ds_read_b128 v[148:151], v6 offset:0
    v_mfma_f32_16x16x32_bf16 v[80:83], v[176:179], v[160:163], v[80:83]
    ds_read_b128 v[152:155], v6 offset:2048
    s_waitcnt lgkmcnt(7)
    v_mfma_f32_16x16x32_bf16 v[64:67], v[180:183], v[156:159], v[64:67]
    s_add_u32 m0, s64, 73728
    s_add_u32 s85, s62, 28672
    buffer_load_dwordx4 v1, s[12:15], s85 offen sc1 lds
    v_mfma_f32_16x16x32_bf16 v[84:87], v[180:183], v[160:163], v[84:87]
    s_waitcnt lgkmcnt(5)
    v_mfma_f32_16x16x32_bf16 v[48:51], v[136:139], v[128:131], v[48:51]
    ds_read_b128 v[156:159], v3 offset:33792
    s_waitcnt lgkmcnt(5)
    v_mfma_f32_16x16x32_bf16 v[68:71], v[136:139], v[132:135], v[68:71]
    ds_read_b128 v[164:167], v5 offset:33792
    s_waitcnt lgkmcnt(5)
    v_mfma_f32_16x16x32_bf16 v[52:55], v[140:143], v[128:131], v[52:55]
    ds_read_b128 v[160:163], v3 offset:35840
    v_mfma_f32_16x16x32_bf16 v[72:75], v[140:143], v[132:135], v[72:75]
    ds_read_b128 v[168:171], v5 offset:35840
    buffer_load_dwordx4 v1, s[12:15], s85 offen offset:1024 sc1 lds
    s_waitcnt lgkmcnt(6)
    v_mfma_f32_16x16x32_bf16 v[56:59], v[144:147], v[128:131], v[56:59]
    ds_read_b128 v[172:175], v5 offset:37888
    v_mfma_f32_16x16x32_bf16 v[76:79], v[144:147], v[132:135], v[76:79]
    ds_read_b128 v[176:179], v6 offset:1024
    s_waitcnt lgkmcnt(7)
    v_mfma_f32_16x16x32_bf16 v[60:63], v[148:151], v[128:131], v[60:63]
    ds_read_b128 v[180:183], v6 offset:3072
    s_add_u32 m0, s65, 49152
    s_add_u32 s85, s63, 28672
    buffer_load_dwordx4 v1, s[12:15], s85 offen sc1 lds
    v_mfma_f32_16x16x32_bf16 v[80:83], v[148:151], v[132:135], v[80:83]
    s_waitcnt lgkmcnt(7)
    v_mfma_f32_16x16x32_bf16 v[64:67], v[152:155], v[128:131], v[64:67]
    v_mfma_f32_16x16x32_bf16 v[84:87], v[152:155], v[132:135], v[84:87]
    s_waitcnt lgkmcnt(5)
    v_mfma_f32_16x16x32_bf16 v[48:51], v[164:167], v[156:159], v[48:51]
    s_waitcnt vmcnt(5)
    s_barrier
    v_and_b32 v13, 7, v31
    v_cmp_gt_u32 vcc, 7, v13
    s_nop 1
    s_cmp_lg_u64 vcc, 0
    s_cbranch_scc1 L_spin_98
L_spinback_99:
    s_waitcnt lgkmcnt(4)
    v_mfma_f32_16x16x32_bf16 v[68:71], v[164:167], v[160:163], v[68:71]
    ds_read_b128 v[128:131], v2 offset:0
    s_waitcnt lgkmcnt(4)
    v_mfma_f32_16x16x32_bf16 v[52:55], v[168:171], v[156:159], v[52:55]
    ds_read_b128 v[136:139], v4 offset:0
    s_add_u32 m0, s64, 90112
    s_add_u32 s85, s61, 30720
    buffer_load_dwordx4 v1, s[12:15], s85 offen sc1 lds
    v_mfma_f32_16x16x32_bf16 v[72:75], v[168:171], v[160:163], v[72:75]
    ds_read_b128 v[132:135], v2 offset:2048
    s_waitcnt lgkmcnt(5)
    v_mfma_f32_16x16x32_bf16 v[56:59], v[172:175], v[156:159], v[56:59]
    ds_read_b128 v[140:143], v4 offset:2048
    v_mfma_f32_16x16x32_bf16 v[76:79], v[172:175], v[160:163], v[76:79]
    ds_read_b128 v[144:147], v4 offset:4096
    buffer_load_dwordx4 v1, s[12:15], s85 offen offset:1024 sc1 lds
    s_waitcnt lgkmcnt(6)
    v_mfma_f32_16x16x32_bf16 v[60:63], v[176:179], v[156:159], v[60:63]
    s_mul_i32 s39, s24, 22528
    s_add_u32 s39, s39, 22528
    v_add_u32 v6, s39, v1
    ds_read_b128 v[148:151], v6 offset:0
    v_mfma_f32_16x16x32_bf16 v[80:83], v[176:179], v[160:163], v[80:83]
    ds_read_b128 v[152:155], v6 offset:2048
    s_waitcnt lgkmcnt(7)
    v_mfma_f32_16x16x32_bf16 v[64:67], v[180:183], v[156:159], v[64:67]
    s_add_u32 m0, s64, 106496
    s_add_u32 s85, s62, 30720
    buffer_load_dwordx4 v1, s[12:15], s85 offen sc1 lds
    v_mfma_f32_16x16x32_bf16 v[84:87], v[180:183], v[160:163], v[84:87]
    s_waitcnt lgkmcnt(5)
    v_mfma_f32_16x16x32_bf16 v[48:51], v[136:139], v[128:131], v[48:51]
    ds_read_b128 v[156:159], v2 offset:1024
    s_waitcnt lgkmcnt(5)
    v_mfma_f32_16x16x32_bf16 v[68:71], v[136:139], v[132:135], v[68:71]
    ds_read_b128 v[164:167], v4 offset:1024
    s_waitcnt lgkmcnt(5)
    v_mfma_f32_16x16x32_bf16 v[52:55], v[140:143], v[128:131], v[52:55]
    ds_read_b128 v[160:163], v2 offset:3072
    v_mfma_f32_16x16x32_bf16 v[72:75], v[140:143], v[132:135], v[72:75]
    ds_read_b128 v[168:171], v4 offset:3072
    buffer_load_dwordx4 v1, s[12:15], s85 offen offset:1024 sc1 lds
    s_waitcnt lgkmcnt(6)
    v_mfma_f32_16x16x32_bf16 v[56:59], v[144:147], v[128:131], v[56:59]
    ds_read_b128 v[172:175], v4 offset:5120
    v_mfma_f32_16x16x32_bf16 v[76:79], v[144:147], v[132:135], v[76:79]
    ds_read_b128 v[176:179], v6 offset:1024
    s_waitcnt lgkmcnt(7)
    v_mfma_f32_16x16x32_bf16 v[60:63], v[148:151], v[128:131], v[60:63]
    ds_read_b128 v[180:183], v6 offset:3072
    s_add_u32 s40, s80, 0
    buffer_load_dwordx4 v[100:103], v9, s[12:15], s40 offen sc1
    v_mfma_f32_16x16x32_bf16 v[80:83], v[148:151], v[132:135], v[80:83]
    s_waitcnt lgkmcnt(7)
    v_mfma_f32_16x16x32_bf16 v[64:67], v[152:155], v[128:131], v[64:67]
    v_mfma_f32_16x16x32_bf16 v[84:87], v[152:155], v[132:135], v[84:87]
    buffer_load_dword v116, v12, s[12:15], s40 offen sc1
    s_waitcnt lgkmcnt(5)
    v_mfma_f32_16x16x32_bf16 v[48:51], v[164:167], v[156:159], v[48:51]
    s_waitcnt vmcnt(6)
    s_barrier
    s_bitcmp1_b32 s86, 30
    s_cbranch_scc0 L_own_100
    s_and_b32 s39, s23, 1
    s_mul_i32 s39, s39, 5120
    s_add_u32 s39, s39, 122880
    v_add_u32 v13, s39, v1
    ds_write_b128 v13, v[224:227] offset:0
    ds_write_b128 v13, v[228:231] offset:1024
    ds_write_b128 v13, v[232:235] offset:2048
    ds_write_b128 v13, v[236:239] offset:3072
    ds_write_b128 v13, v[240:243] offset:4096
L_own_100:
    s_waitcnt lgkmcnt(4)
    v_mfma_f32_16x16x32_bf16 v[68:71], v[164:167], v[160:163], v[68:71]
    ds_read_b128 v[128:131], v2 offset:57344
    s_waitcnt lgkmcnt(4)
    v_mfma_f32_16x16x32_bf16 v[52:55], v[168:171], v[156:159], v[52:55]
    ds_read_b128 v[136:139], v4 offset:57344
    s_add_u32 s40, s80, 20480
    buffer_load_dwordx4 v[104:107], v9, s[12:15], s40 offen sc1
    v_mfma_f32_16x16x32_bf16 v[72:75], v[168:171], v[160:163], v[72:75]
    ds_read_b128 v[132:135], v2 offset:59392
    s_waitcnt lgkmcnt(5)
    v_mfma_f32_16x16x32_bf16 v[56:59], v[172:175], v[156:159], v[56:59]
    ds_read_b128 v[140:143], v4 offset:59392
    v_mfma_f32_16x16x32_bf16 v[76:79], v[172:175], v[160:163], v[76:79]
    ds_read_b128 v[144:147], v4 offset:61440
    buffer_load_dword v117, v12, s[12:15], s40 offen sc1
    s_waitcnt lgkmcnt(6)
    v_mfma_f32_16x16x32_bf16 v[60:63], v[176:179], v[156:159], v[60:63]
    s_mul_i32 s39, s24, -30720
    s_add_u32 s39, s39, 79872
    v_add_u32 v6, s39, v1
    ds_read_b128 v[148:151], v6 offset:0
    v_mfma_f32_16x16x32_bf16 v[80:83], v[176:179], v[160:163], v[80:83]
    ds_read_b128 v[152:155], v6 offset:2048
    s_waitcnt lgkmcnt(7)
    v_mfma_f32_16x16x32_bf16 v[64:67], v[180:183], v[156:159], v[64:67]
    s_add_u32 s40, s80, 40960
    buffer_load_dwordx4 v[108:111], v9, s[12:15], s40 offen sc1
    v_mfma_f32_16x16x32_bf16 v[84:87], v[180:183], v[160:163], v[84:87]
    s_waitcnt lgkmcnt(5)
    v_mfma_f32_16x16x32_bf16 v[48:51], v[136:139], v[128:131], v[48:51]
    ds_read_b128 v[156:159], v2 offset:58368
    s_waitcnt lgkmcnt(5)
    v_mfma_f32_16x16x32_bf16 v[68:71], v[136:139], v[132:135], v[68:71]
    ds_read_b128 v[164:167], v4 offset:58368
    s_waitcnt lgkmcnt(5)
    v_mfma_f32_16x16x32_bf16 v[52:55], v[140:143], v[128:131], v[52:55]
    ds_read_b128 v[160:163], v2 offset:60416
    v_mfma_f32_16x16x32_bf16 v[72:75], v[140:143], v[132:135], v[72:75]
    ds_read_b128 v[168:171], v4 offset:60416
    buffer_load_dword v118, v12, s[12:15], s40 offen sc1
    s_waitcnt lgkmcnt(6)
    v_mfma_f32_16x16x32_bf16 v[56:59], v[144:147], v[128:131], v[56:59]
    ds_read_b128 v[172:175], v4 offset:62464
    v_mfma_f32_16x16x32_bf16 v[76:79], v[144:147], v[132:135], v[76:79]
    ds_read_b128 v[176:179], v6 offset:1024
    s_waitcnt lgkmcnt(7)
    v_mfma_f32_16x16x32_bf16 v[60:63], v[148:151], v[128:131], v[60:63]
    ds_read_b128 v[180:183], v6 offset:3072
    v_mfma_f32_16x16x32_bf16 v[80:83], v[148:151], v[132:135], v[80:83]
    s_waitcnt lgkmcnt(7)
    v_mfma_f32_16x16x32_bf16 v[64:67], v[152:155], v[128:131], v[64:67]
    v_mfma_f32_16x16x32_bf16 v[84:87], v[152:155], v[132:135], v[84:87]
    s_waitcnt lgkmcnt(5)
    v_mfma_f32_16x16x32_bf16 v[48:51], v[164:167], v[156:159], v[48:51]
    s_waitcnt vmcnt(6)
    s_barrier
    s_waitcnt lgkmcnt(4)
    v_mfma_f32_16x16x32_bf16 v[68:71], v[164:167], v[160:163], v[68:71]
    ds_read_b128 v[128:131], v3 offset:0
    ds_write_b128 v15, v[20:23]
    s_waitcnt lgkmcnt(5)
    v_mfma_f32_16x16x32_bf16 v[52:55], v[168:171], v[156:159], v[52:55]
    ds_read_b128 v[136:139], v5 offset:0
    ds_write_b32 v17, v24 offset:64
    v_mfma_f32_16x16x32_bf16 v[72:75], v[168:171], v[160:163], v[72:75]
    ds_read_b128 v[132:135], v3 offset:2048
    ds_read_b64 v[26:27], v14
    s_waitcnt lgkmcnt(8)
    v_mfma_f32_16x16x32_bf16 v[56:59], v[172:175], v[156:159], v[56:59]
    ds_read_b128 v[140:143], v5 offset:2048
    ds_read_b64 v[28:29], v14 offset:32
    v_mfma_f32_16x16x32_bf16 v[76:79], v[172:175], v[160:163], v[76:79]
    ds_read_b128 v[144:147], v5 offset:4096
    ds_read_b32 v30, v18 offset:64
    s_waitcnt lgkmcnt(11)
    v_mfma_f32_16x16x32_bf16 v[60:63], v[176:179], v[156:159], v[60:63]
    s_mul_i32 s39, s24, -59392
    s_add_u32 s39, s39, 112640
    v_add_u32 v6, s39, v1
    ds_read_b128 v[148:151], v6 offset:0
    v_mfma_f32_16x16x32_bf16 v[80:83], v[176:179], v[160:163], v[80:83]
    ds_read_b128 v[152:155], v6 offset:2048
    ds_read_b128 v[112:115], v10
    s_waitcnt lgkmcnt(13)
    v_mfma_f32_16x16x32_bf16 v[64:67], v[180:183], v[156:159], v[64:67]
    ds_read_b32 v119, v11
    v_mfma_f32_16x16x32_bf16 v[84:87], v[180:183], v[160:163], v[84:87]
    s_waitcnt lgkmcnt(4)
    v_mfma_f32_16x16x32_bf16 v[48:51], v[136:139], v[128:131], v[48:51]
    ds_read_b128 v[156:159], v3 offset:1024
    v_lshlrev_b32 v248, 16, v26
    v_mfma_f32_16x16x32_bf16 v[68:71], v[136:139], v[132:135], v[68:71]
    ds_read_b128 v[180:183], v6 offset:3072
    v_and_b32 v249, 0xffff0000, v26
    v_mfma_f32_16x16x32_bf16 v[52:55], v[140:143], v[128:131], v[52:55]
    ds_read_b128 v[160:163], v3 offset:3072
    v_lshlrev_b32 v250, 16, v27
    v_mfma_f32_16x16x32_bf16 v[72:75], v[140:143], v[132:135], v[72:75]
    ds_read_b128 v[164:167], v5 offset:1024
    v_and_b32 v251, 0xffff0000, v27
    v_mfma_f32_16x16x32_bf16 v[56:59], v[144:147], v[128:131], v[56:59]
    ds_read_b128 v[168:171], v5 offset:3072
    v_lshlrev_b32 v252, 16, v28
    v_mfma_f32_16x16x32_bf16 v[76:79], v[144:147], v[132:135], v[76:79]
    ds_read_b128 v[172:175], v5 offset:5120
    v_and_b32 v253, 0xffff0000, v28
    s_waitcnt lgkmcnt(9)
    v_mfma_f32_16x16x32_bf16 v[60:63], v[148:151], v[128:131], v[60:63]
    ds_read_b128 v[176:179], v6 offset:1024
    v_lshlrev_b32 v254, 16, v29
    v_mfma_f32_16x16x32_bf16 v[80:83], v[148:151], v[132:135], v[80:83]
    v_and_b32 v255, 0xffff0000, v29
    s_waitcnt lgkmcnt(9)
    v_mfma_f32_16x16x32_bf16 v[64:67], v[152:155], v[128:131], v[64:67]
    v_lshlrev_b32 v98, 16, v30
    v_mfma_f32_16x16x32_bf16 v[84:87], v[152:155], v[132:135], v[84:87]
    v_and_b32 v99, 0xffff0000, v30
    s_add_u32 s40, s86, 4096
    s_waitcnt lgkmcnt(5)
    v_mfma_f32_16x16x32_bf16 v[64:67], v[180:183], v[156:159], v[64:67]
    s_waitcnt lgkmcnt(4)
    v_mfma_f32_16x16x32_bf16 v[84:87], v[180:183], v[160:163], v[84:87]
    s_waitcnt lgkmcnt(3)
    v_mfma_f32_16x16x32_bf16 v[48:51], v[164:167], v[156:159], v[48:51]
    v_mfma_f32_16x16x32_bf16 v[68:71], v[164:167], v[160:163], v[68:71]
    s_waitcnt lgkmcnt(2)
    v_mfma_f32_16x16x32_bf16 v[52:55], v[168:171], v[156:159], v[52:55]
    v_cvt_pk_bf16_f32 v200, v64, v65
    v_cvt_pk_bf16_f32 v201, v66, v67
    v_mfma_f32_16x16x32_bf16 v[72:75], v[168:171], v[160:163], v[72:75]
    v_cvt_pk_bf16_f32 v202, v84, v85
    v_cvt_pk_bf16_f32 v203, v86, v87
    v_or_b32 v200, 1, v200
    s_waitcnt lgkmcnt(1)
    v_mfma_f32_16x16x32_bf16 v[56:59], v[172:175], v[156:159], v[56:59]
    v_or_b32 v201, 1, v201
    v_or_b32 v202, 1, v202
    v_or_b32 v203, 1, v203
    v_mfma_f32_16x16x32_bf16 v[76:79], v[172:175], v[160:163], v[76:79]
    buffer_store_dwordx4 v[200:203], v1, s[12:15], s40 offen sc1
    v_cvt_pk_bf16_f32 v184, v48, v49
    v_cvt_pk_bf16_f32 v185, v50, v51
    s_waitcnt lgkmcnt(0)
    v_mfma_f32_16x16x32_bf16 v[60:63], v[176:179], v[156:159], v[60:63]
    v_or_b32 v184, 1, v184
    v_cvt_pk_bf16_f32 v192, v68, v69
    v_cvt_pk_bf16_f32 v193, v70, v71
    v_mfma_f32_16x16x32_bf16 v[80:83], v[176:179], v[160:163], v[80:83]
    v_or_b32 v192, 1, v192
    v_cvt_pk_bf16_f32 v186, v52, v53
    v_cvt_pk_bf16_f32 v187, v54, v55
    s_nop 7
    buffer_store_dwordx4 v[184:187], v1, s[12:15], s86 offen offset:0 sc1
    v_cvt_pk_bf16_f32 v194, v72, v73
    v_cvt_pk_bf16_f32 v195, v74, v75
    buffer_store_dwordx4 v[192:195], v1, s[12:15], s86 offen offset:2048 sc1
    v_cvt_pk_bf16_f32 v188, v56, v57
    v_cvt_pk_bf16_f32 v189, v58, v59
    v_or_b32 v188, 1, v188
    v_cvt_pk_bf16_f32 v196, v76, v77
    v_cvt_pk_bf16_f32 v197, v78, v79
    v_or_b32 v196, 1, v196
    v_cvt_pk_bf16_f32 v190, v60, v61
    v_cvt_pk_bf16_f32 v191, v62, v63
    buffer_store_dwordx4 v[188:191], v1, s[12:15], s86 offen offset:1024 sc1
    v_cvt_pk_bf16_f32 v198, v80, v81
    v_cvt_pk_bf16_f32 v199, v82, v83
    buffer_store_dwordx4 v[196:199], v1, s[12:15], s86 offen offset:3072 sc1
    s_bitcmp1_b32 s86, 30
    s_cbranch_scc0 L_own_101
    s_and_b32 s39, s23, 1
    s_mul_i32 s39, s39, 5120
    s_add_u32 s39, s39, 122880
    v_add_u32 v13, s39, v1
    ds_write_b128 v13, v[184:187] offset:10240
    ds_write_b128 v13, v[188:191] offset:11264
    ds_write_b128 v13, v[192:195] offset:12288
    ds_write_b128 v13, v[196:199] offset:13312
    ds_write_b128 v13, v[200:203] offset:14336
L_own_101:
    s_waitcnt vmcnt(9)
    v_lshlrev_b32 v88, 16, v100
    v_and_b32 v89, 0xffff0000, v100
    v_lshlrev_b32 v90, 16, v101
    v_and_b32 v91, 0xffff0000, v101
    v_lshlrev_b32 v92, 16, v102
    v_and_b32 v93, 0xffff0000, v102
    v_lshlrev_b32 v94, 16, v103
    v_and_b32 v95, 0xffff0000, v103
    v_lshlrev_b32 v96, 16, v116
    v_and_b32 v97, 0xffff0000, v116
    s_waitcnt vmcnt(7)
    v_dot2c_f32_bf16 v88, s83, v104
    v_dot2c_f32_bf16 v89, s84, v104
    v_dot2c_f32_bf16 v90, s83, v105
    v_dot2c_f32_bf16 v91, s84, v105
    v_dot2c_f32_bf16 v92, s83, v106
    v_dot2c_f32_bf16 v93, s84, v106
    v_dot2c_f32_bf16 v94, s83, v107
    v_dot2c_f32_bf16 v95, s84, v107
    v_dot2c_f32_bf16 v96, s83, v117
    v_dot2c_f32_bf16 v97, s84, v117
    s_waitcnt vmcnt(5)
    v_dot2c_f32_bf16 v88, s83, v108
    v_dot2c_f32_bf16 v89, s84, v108
    v_dot2c_f32_bf16 v90, s83, v109
    v_dot2c_f32_bf16 v91, s84, v109
    v_dot2c_f32_bf16 v92, s83, v110
    v_dot2c_f32_bf16 v93, s84, v110
    v_dot2c_f32_bf16 v94, s83, v111
    v_dot2c_f32_bf16 v95, s84, v111
    v_dot2c_f32_bf16 v96, s83, v118
    v_dot2c_f32_bf16 v97, s84, v118
    v_dot2c_f32_bf16 v88, s83, v112
    v_dot2c_f32_bf16 v89, s84, v112
    v_dot2c_f32_bf16 v90, s83, v113
    v_dot2c_f32_bf16 v91, s84, v113
    v_dot2c_f32_bf16 v92, s83, v114
    v_dot2c_f32_bf16 v93, s84, v114
    v_dot2c_f32_bf16 v94, s83, v115
    v_dot2c_f32_bf16 v95, s84, v115
    v_dot2c_f32_bf16 v96, s83, v119
    v_dot2c_f32_bf16 v97, s84, v119
    s_nop 2
    v_mul_f32 v32, -1.4426950408889634, v88
    v_mul_f32 v33, -1.4426950408889634, v89
    v_mul_f32 v34, -1.4426950408889634, v90
    v_mul_f32 v35, -1.4426950408889634, v91
    v_mul_f32 v36, -1.4426950408889634, v92
    v_mul_f32 v37, -1.4426950408889634, v93
    v_mul_f32 v38, -1.4426950408889634, v94
    v_mul_f32 v39, -1.4426950408889634, v95
    v_mul_f32 v40, -1.4426950408889634, v96
    v_mul_f32 v41, -1.4426950408889634, v97
    v_exp_f32 v32, v32
    v_exp_f32 v33, v33
    v_exp_f32 v34, v34
    v_exp_f32 v35, v35
    v_exp_f32 v36, v36
    v_exp_f32 v37, v37
    v_exp_f32 v38, v38
    v_exp_f32 v39, v39
    v_exp_f32 v40, v40
    v_exp_f32 v41, v41
    v_add_f32 v32, 1.0, v32
    v_add_f32 v33, 1.0, v33
    v_add_f32 v34, 1.0, v34
    v_add_f32 v35, 1.0, v35
    v_add_f32 v36, 1.0, v36
    v_add_f32 v37, 1.0, v37
    v_add_f32 v38, 1.0, v38
    v_add_f32 v39, 1.0, v39
    v_add_f32 v40, 1.0, v40
    v_add_f32 v41, 1.0, v41
    v_rcp_f32 v32, v32
    v_rcp_f32 v33, v33
    v_rcp_f32 v34, v34
    v_rcp_f32 v35, v35
    v_rcp_f32 v36, v36
    v_rcp_f32 v37, v37
    v_rcp_f32 v38, v38
    v_rcp_f32 v39, v39
    v_rcp_f32 v40, v40
    v_rcp_f32 v41, v41
    v_mul_f32 v88, v88, v32
    v_mul_f32 v89, v89, v33
    v_mul_f32 v90, v90, v34
    v_mul_f32 v91, v91, v35
    v_mul_f32 v92, v92, v36
    v_mul_f32 v93, v93, v37
    v_mul_f32 v94, v94, v38
    v_mul_f32 v95, v95, v39
    v_mul_f32 v96, v96, v40
    v_mul_f32 v97, v97, v41
    s_waitcnt lgkmcnt(0)
    s_barrier
    ds_read_b128 v[216:219], v10 offset:10240
    ds_read_b32 v223, v11 offset:10240
    s_add_u32 s40, s80, 10240
    buffer_load_dwordx4 v[204:207], v9, s[12:15], s40 offen sc1
    buffer_load_dword v220, v12, s[12:15], s40 offen sc1
    s_add_u32 s40, s80, 30720
    buffer_load_dwordx4 v[208:211], v9, s[12:15], s40 offen sc1
    buffer_load_dword v221, v12, s[12:15], s40 offen sc1
    s_add_u32 s40, s80, 51200
    buffer_load_dwordx4 v[212:215], v9, s[12:15], s40 offen sc1
    buffer_load_dword v222, v12, s[12:15], s40 offen sc1
    s_mov_b32 s46, 0x20000
L_tagloop_102:
    s_waitcnt vmcnt(0)
    s_mov_b32 s81, 0
    v_and_b32 v13, v204, v220
    v_and_b32 v13, 1, v13
    v_cmp_ne_u32 vcc, 1, v13
    s_nop 0
    s_cbranch_vccz L_tag_104
    s_cmp_eq_u32 s81, 0
    s_cbranch_scc0 L_tag_104_ns
    s_sleep 4
L_tag_104_ns:
    s_mov_b32 s81, 1
    s_add_u32 s40, s80, 10240
    buffer_load_dwordx4 v[204:207], v9, s[12:15], s40 offen sc1
    buffer_load_dword v220, v12, s[12:15], s40 offen sc1
L_tag_104:
    v_and_b32 v13, v208, v221
    v_and_b32 v13, 1, v13
    v_cmp_ne_u32 vcc, 1, v13
    s_nop 0
    s_cbranch_vccz L_tag_105
    s_cmp_eq_u32 s81, 0
    s_cbranch_scc0 L_tag_105_ns
    s_sleep 4
L_tag_105_ns:
    s_mov_b32 s81, 1
    s_add_u32 s40, s80, 30720
    buffer_load_dwordx4 v[208:211], v9, s[12:15], s40 offen sc1
    buffer_load_dword v221, v12, s[12:15], s40 offen sc1
L_tag_105:
    v_and_b32 v13, v212, v222
    v_and_b32 v13, 1, v13
    v_cmp_ne_u32 vcc, 1, v13
    s_nop 0
    s_cbranch_vccz L_tag_106
    s_cmp_eq_u32 s81, 0
    s_cbranch_scc0 L_tag_106_ns
    s_sleep 4
L_tag_106_ns:
    s_mov_b32 s81, 1
    s_add_u32 s40, s80, 51200
    buffer_load_dwordx4 v[212:215], v9, s[12:15], s40 offen sc1
    buffer_load_dword v222, v12, s[12:15], s40 offen sc1
L_tag_106:
    s_sub_u32 s46, s46, 1
    s_cbranch_scc1 L_tagout_103
    s_cmp_eq_u32 s81, 1
    s_cbranch_scc1 L_tagloop_102
L_tagout_103:
    s_waitcnt lgkmcnt(0)
    v_lshlrev_b32 v32, 16, v204
    v_and_b32 v33, 0xffff0000, v204
    v_lshlrev_b32 v34, 16, v205
    v_and_b32 v35, 0xffff0000, v205
    v_lshlrev_b32 v36, 16, v206
    v_and_b32 v37, 0xffff0000, v206
    v_lshlrev_b32 v38, 16, v207
    v_and_b32 v39, 0xffff0000, v207
    v_lshlrev_b32 v40, 16, v220
    v_and_b32 v41, 0xffff0000, v220
    v_dot2c_f32_bf16 v32, s83, v208
    v_dot2c_f32_bf16 v33, s84, v208
    v_dot2c_f32_bf16 v34, s83, v209
    v_dot2c_f32_bf16 v35, s84, v209
    v_dot2c_f32_bf16 v36, s83, v210
    v_dot2c_f32_bf16 v37, s84, v210
    v_dot2c_f32_bf16 v38, s83, v211
    v_dot2c_f32_bf16 v39, s84, v211
    v_dot2c_f32_bf16 v40, s83, v221
    v_dot2c_f32_bf16 v41, s84, v221
    v_dot2c_f32_bf16 v32, s83, v212
    v_dot2c_f32_bf16 v33, s84, v212
    v_dot2c_f32_bf16 v34, s83, v213
    v_dot2c_f32_bf16 v35, s84, v213
    v_dot2c_f32_bf16 v36, s83, v214
    v_dot2c_f32_bf16 v37, s84, v214
    v_dot2c_f32_bf16 v38, s83, v215
    v_dot2c_f32_bf16 v39, s84, v215
    v_dot2c_f32_bf16 v40, s83, v222
    v_dot2c_f32_bf16 v41, s84, v222
    v_dot2c_f32_bf16 v32, s83, v216
    v_dot2c_f32_bf16 v33, s84, v216
    v_dot2c_f32_bf16 v34, s83, v217
    v_dot2c_f32_bf16 v35, s84, v217
    v_dot2c_f32_bf16 v36, s83, v218
    v_dot2c_f32_bf16 v37, s84, v218
    v_dot2c_f32_bf16 v38, s83, v219
    v_dot2c_f32_bf16 v39, s84, v219
    v_dot2c_f32_bf16 v40, s83, v223
    v_dot2c_f32_bf16 v41, s84, v223
    s_nop 2
    v_fmac_f32 v248, v32, v88
    v_fmac_f32 v249, v33, v89
    v_fmac_f32 v250, v34, v90
    v_fmac_f32 v251, v35, v91
    v_fmac_f32 v252, v36, v92
    v_fmac_f32 v253, v37, v93
    v_fmac_f32 v254, v38, v94
    v_fmac_f32 v255, v39, v95
    v_fmac_f32 v98, v40, v96
    v_fmac_f32 v99, v41, v97
    v_cvt_pk_bf16_f32 v26, v248, v249
    v_cvt_pk_bf16_f32 v27, v250, v251
    v_cvt_pk_bf16_f32 v28, v252, v253
    v_cvt_pk_bf16_f32 v29, v254, v255
    v_cvt_pk_bf16_f32 v30, v98, v99
    ds_write_b64 v14, v[26:27]
    ds_write_b64 v14, v[28:29] offset:32
    ds_write_b32 v18, v30 offset:64
    ds_read_b128 v[20:23], v15
    ds_read_b32 v24, v17 offset:64
    s_waitcnt lgkmcnt(1)
    buffer_store_dwordx4 v[20:23], v16, s[8:11], s67 offen
    s_waitcnt lgkmcnt(0)
    buffer_store_dword v24, v8, s[8:11], s68 offen
recurrent_scan__compressed_kv_cla__dense_activation_mish__prompt_kernel_ool:
    s_branch recurrent_scan__compressed_kv_cla__dense_activation_mish__prompt_kernel_end
L_spin_2:
    s_mov_b32 s48, 0x20000
L_spinloop_107:
    buffer_load_dword v3, v2, s[12:15], 0 offen sc1
    s_sub_u32 s48, s48, 1
    s_cbranch_scc1 L_spinback_3
    s_waitcnt vmcnt(0)
    v_cmp_eq_u32 s[46:47], v3, v13
    v_and_b32 v19, 7, v3
    v_cmp_gt_u32 vcc, 1, v19
    s_nop 1
    s_or_b64 vcc, vcc, s[46:47]
    s_cmp_lg_u32 vcc_lo, 0
    s_cbranch_scc0 L_spinback_3
    s_sleep 2
    s_branch L_spinloop_107
L_spin_5:
    s_mov_b32 s48, 0x20000
L_spinloop_108:
    buffer_load_dword v3, v2, s[12:15], 0 offen sc1
    s_sub_u32 s48, s48, 1
    s_cbranch_scc1 L_spinback_6
    s_waitcnt vmcnt(0)
    v_cmp_eq_u32 s[46:47], v3, v13
    v_and_b32 v19, 7, v3
    v_cmp_gt_u32 vcc, v18, v19
    s_nop 1
    s_or_b64 vcc, vcc, s[46:47]
    s_cmp_lg_u32 vcc_hi, 0
    s_cbranch_scc0 L_spinback_6
    s_sleep 2
    s_branch L_spinloop_108
L_spin_8:
    s_mov_b32 s48, 0x20000
L_spinloop_109:
    buffer_load_dword v3, v2, s[12:15], 0 offen sc1
    s_sub_u32 s48, s48, 1
    s_cbranch_scc1 L_spinback_9
    s_waitcnt vmcnt(0)
    v_cmp_eq_u32 s[46:47], v3, v13
    v_and_b32 v19, 7, v3
    v_cmp_gt_u32 vcc, 1, v19
    s_nop 1
    s_or_b64 vcc, vcc, s[46:47]
    s_cmp_lg_u32 vcc_lo, 0
    s_cbranch_scc0 L_spinback_9
    s_sleep 2
    s_branch L_spinloop_109
L_spin_11:
    s_mov_b32 s48, 0x20000
L_spinloop_110:
    buffer_load_dword v3, v2, s[12:15], 0 offen sc1
    s_sub_u32 s48, s48, 1
    s_cbranch_scc1 L_spinback_12
    s_waitcnt vmcnt(0)
    v_cmp_eq_u32 s[46:47], v3, v13
    v_and_b32 v19, 7, v3
    v_cmp_gt_u32 vcc, v18, v19
    s_nop 1
    s_or_b64 vcc, vcc, s[46:47]
    s_cmp_lg_u32 vcc_hi, 0
    s_cbranch_scc0 L_spinback_12
    s_sleep 2
    s_branch L_spinloop_110
L_rare_13:
    s_nop 7
    v_max3_f32 v16, v176, v177, v178
    v_max3_f32 v17, v180, v181, v182
    v_max3_f32 v16, v16, v179, v184
    v_max3_f32 v17, v17, v183, v188
    v_max3_f32 v16, v16, v185, v186
    v_max3_f32 v17, v17, v189, v190
    v_max_f32 v16, v16, v187
    v_max_f32 v17, v17, v191
    v_mov_b32 v18, v16
    v_mov_b32 v19, v17
    s_nop 1
    v_permlane16_swap_b32 v16, v18
    v_permlane16_swap_b32 v17, v19
    s_nop 1
    v_max_f32 v16, v16, v18
    v_max_f32 v17, v17, v19
    v_mov_b32 v18, v16
    v_mov_b32 v19, v17
    s_nop 1
    v_permlane32_swap_b32 v16, v18
    v_permlane32_swap_b32 v17, v19
    s_nop 1
    v_max_f32 v16, v16, v18
    v_max_f32 v17, v17, v19
    v_add_f32 v16, 16.0, v16
    v_add_f32 v17, 16.0, v17
    v_max_f32 v16, 0xf1800000, v16
    v_add_f32 v10, v10, v16
    v_max_f32 v17, 0xf1800000, v17
    v_add_f32 v11, v11, v17
    v_sub_f32 v176, v176, v16
    v_sub_f32 v177, v177, v16
    v_sub_f32 v178, v178, v16
    v_sub_f32 v179, v179, v16
    v_sub_f32 v184, v184, v16
    v_sub_f32 v185, v185, v16
    v_sub_f32 v186, v186, v16
    v_sub_f32 v187, v187, v16
    v_sub_f32 v180, v180, v17
    v_sub_f32 v181, v181, v17
    v_sub_f32 v182, v182, v17
    v_sub_f32 v183, v183, v17
    v_sub_f32 v188, v188, v17
    v_sub_f32 v189, v189, v17
    v_sub_f32 v190, v190, v17
    v_sub_f32 v191, v191, v17
    v_sub_f32 v160, 0, v10
    v_sub_f32 v161, 0, v10
    v_sub_f32 v162, 0, v10
    v_sub_f32 v163, 0, v10
    v_sub_f32 v192, v192, v16
    v_sub_f32 v193, v193, v16
    v_sub_f32 v194, v194, v16
    v_sub_f32 v195, v195, v16
    v_sub_f32 v200, v200, v16
    v_sub_f32 v201, v201, v16
    v_sub_f32 v202, v202, v16
    v_sub_f32 v203, v203, v16
    v_sub_f32 v164, 0, v11
    v_sub_f32 v165, 0, v11
    v_sub_f32 v166, 0, v11
    v_sub_f32 v167, 0, v11
    v_sub_f32 v196, v196, v17
    v_sub_f32 v197, v197, v17
    v_sub_f32 v198, v198, v17
    v_sub_f32 v199, v199, v17
    v_sub_f32 v204, v204, v17
    v_sub_f32 v205, v205, v17
    v_sub_f32 v206, v206, v17
    v_sub_f32 v207, v207, v17
    v_exp_f32 v20, v176
    v_exp_f32 v21, v177
    v_exp_f32 v22, v178
    v_cvt_pk_bf16_f32 v208, v20, v21
    v_exp_f32 v23, v179
    v_exp_f32 v24, v184
    v_cvt_pk_bf16_f32 v209, v22, v23
    v_exp_f32 v25, v185
    v_exp_f32 v26, v186
    v_cvt_pk_bf16_f32 v210, v24, v25
    v_exp_f32 v27, v187
    v_exp_f32 v20, v180
    v_cvt_pk_bf16_f32 v211, v26, v27
    v_exp_f32 v21, v181
    v_exp_f32 v22, v182
    v_cvt_pk_bf16_f32 v212, v20, v21
    v_exp_f32 v23, v183
    v_exp_f32 v24, v188
    v_cvt_pk_bf16_f32 v213, v22, v23
    v_exp_f32 v25, v189
    v_exp_f32 v26, v190
    v_cvt_pk_bf16_f32 v214, v24, v25
    v_exp_f32 v27, v191
    s_nop 0
    v_cvt_pk_bf16_f32 v215, v26, v27
    s_nop 1
    s_branch L_rareback_14
L_rare_17:
    s_nop 7
    v_max3_f32 v16, v192, v193, v194
    v_max3_f32 v17, v196, v197, v198
    v_max3_f32 v16, v16, v195, v200
    v_max3_f32 v17, v17, v199, v204
    v_max3_f32 v16, v16, v201, v202
    v_max3_f32 v17, v17, v205, v206
    v_max_f32 v16, v16, v203
    v_max_f32 v17, v17, v207
    v_mov_b32 v18, v16
    v_mov_b32 v19, v17
    s_nop 1
    v_permlane16_swap_b32 v16, v18
    v_permlane16_swap_b32 v17, v19
    s_nop 1
    v_max_f32 v16, v16, v18
    v_max_f32 v17, v17, v19
    v_mov_b32 v18, v16
    v_mov_b32 v19, v17
    s_nop 1
    v_permlane32_swap_b32 v16, v18
    v_permlane32_swap_b32 v17, v19
    s_nop 1
    v_max_f32 v16, v16, v18
    v_max_f32 v17, v17, v19
    v_add_f32 v16, 16.0, v16
    v_add_f32 v17, 16.0, v17
    v_max_f32 v16, 0, v16
    v_add_f32 v10, v10, v16
    v_exp_f32 v18, -v16
    v_max_f32 v17, 0, v17
    v_add_f32 v11, v11, v17
    v_exp_f32 v19, -v17
    v_sub_f32 v192, v192, v16
    v_sub_f32 v193, v193, v16
    v_sub_f32 v194, v194, v16
    v_sub_f32 v195, v195, v16
    v_sub_f32 v200, v200, v16
    v_sub_f32 v201, v201, v16
    v_sub_f32 v202, v202, v16
    v_sub_f32 v203, v203, v16
    v_sub_f32 v196, v196, v17
    v_sub_f32 v197, v197, v17
    v_sub_f32 v198, v198, v17
    v_sub_f32 v199, v199, v17
    v_sub_f32 v204, v204, v17
    v_sub_f32 v205, v205, v17
    v_sub_f32 v206, v206, v17
    v_sub_f32 v207, v207, v17
    v_sub_f32 v160, 0, v10
    v_sub_f32 v161, 0, v10
    v_sub_f32 v162, 0, v10
    v_sub_f32 v163, 0, v10
    v_sub_f32 v176, v176, v16
    v_sub_f32 v177, v177, v16
    v_sub_f32 v178, v178, v16
    v_sub_f32 v179, v179, v16
    v_sub_f32 v184, v184, v16
    v_sub_f32 v185, v185, v16
    v_sub_f32 v186, v186, v16
    v_sub_f32 v187, v187, v16
    v_sub_f32 v164, 0, v11
    v_sub_f32 v165, 0, v11
    v_sub_f32 v166, 0, v11
    v_sub_f32 v167, 0, v11
    v_sub_f32 v180, v180, v17
    v_sub_f32 v181, v181, v17
    v_sub_f32 v182, v182, v17
    v_sub_f32 v183, v183, v17
    v_sub_f32 v188, v188, v17
    v_sub_f32 v189, v189, v17
    v_sub_f32 v190, v190, v17
    v_sub_f32 v191, v191, v17
    v_mul_f32 v168, v168, v18
    v_mul_f32 v169, v169, v18
    v_mul_f32 v170, v170, v18
    v_mul_f32 v171, v171, v18
    v_mul_f32 v172, v172, v19
    v_mul_f32 v173, v173, v19
    v_mul_f32 v174, v174, v19
    v_mul_f32 v175, v175, v19
    v_mul_f32 v64, v64, v18
    v_mul_f32 v65, v65, v18
    v_mul_f32 v66, v66, v18
    v_mul_f32 v67, v67, v18
    v_mul_f32 v68, v68, v19
    v_mul_f32 v69, v69, v19
    v_mul_f32 v70, v70, v19
    v_mul_f32 v71, v71, v19
    v_mul_f32 v72, v72, v18
    v_mul_f32 v73, v73, v18
    v_mul_f32 v74, v74, v18
    v_mul_f32 v75, v75, v18
    v_mul_f32 v76, v76, v19
    v_mul_f32 v77, v77, v19
    v_mul_f32 v78, v78, v19
    v_mul_f32 v79, v79, v19
    v_mul_f32 v80, v80, v18
    v_mul_f32 v81, v81, v18
    v_mul_f32 v82, v82, v18
    v_mul_f32 v83, v83, v18
    v_mul_f32 v84, v84, v19
    v_mul_f32 v85, v85, v19
    v_mul_f32 v86, v86, v19
    v_mul_f32 v87, v87, v19
    v_mul_f32 v88, v88, v18
    v_mul_f32 v89, v89, v18
    v_mul_f32 v90, v90, v18
    v_mul_f32 v91, v91, v18
    v_mul_f32 v92, v92, v19
    v_mul_f32 v93, v93, v19
    v_mul_f32 v94, v94, v19
    v_mul_f32 v95, v95, v19
    v_mul_f32 v96, v96, v18
    v_mul_f32 v97, v97, v18
    v_mul_f32 v98, v98, v18
    v_mul_f32 v99, v99, v18
    v_mul_f32 v100, v100, v19
    v_mul_f32 v101, v101, v19
    v_mul_f32 v102, v102, v19
    v_mul_f32 v103, v103, v19
    v_mul_f32 v104, v104, v18
    v_mul_f32 v105, v105, v18
    v_mul_f32 v106, v106, v18
    v_mul_f32 v107, v107, v18
    v_mul_f32 v108, v108, v19
    v_mul_f32 v109, v109, v19
    v_mul_f32 v110, v110, v19
    v_mul_f32 v111, v111, v19
    v_mul_f32 v112, v112, v18
    v_mul_f32 v113, v113, v18
    v_mul_f32 v114, v114, v18
    v_mul_f32 v115, v115, v18
    v_mul_f32 v116, v116, v19
    v_mul_f32 v117, v117, v19
    v_mul_f32 v118, v118, v19
    v_mul_f32 v119, v119, v19
    v_mul_f32 v120, v120, v18
    v_mul_f32 v121, v121, v18
    v_mul_f32 v122, v122, v18
    v_mul_f32 v123, v123, v18
    v_mul_f32 v124, v124, v19
    v_mul_f32 v125, v125, v19
    v_mul_f32 v126, v126, v19
    v_mul_f32 v127, v127, v19
    v_exp_f32 v20, v192
    v_exp_f32 v21, v193
    v_exp_f32 v22, v194
    v_cvt_pk_bf16_f32 v216, v20, v21
    v_exp_f32 v23, v195
    v_exp_f32 v24, v200
    v_cvt_pk_bf16_f32 v217, v22, v23
    v_exp_f32 v25, v201
    v_exp_f32 v26, v202
    v_cvt_pk_bf16_f32 v218, v24, v25
    v_exp_f32 v27, v203
    v_exp_f32 v20, v196
    v_cvt_pk_bf16_f32 v219, v26, v27
    v_exp_f32 v21, v197
    v_exp_f32 v22, v198
    v_cvt_pk_bf16_f32 v220, v20, v21
    v_exp_f32 v23, v199
    v_exp_f32 v24, v204
    v_cvt_pk_bf16_f32 v221, v22, v23
    v_exp_f32 v25, v205
    v_exp_f32 v26, v206
    v_cvt_pk_bf16_f32 v222, v24, v25
    v_exp_f32 v27, v207
    s_nop 0
    v_cvt_pk_bf16_f32 v223, v26, v27
    s_nop 1
    s_branch L_rareback_18
L_rare_19:
    s_nop 7
    v_max3_f32 v16, v176, v177, v178
    v_max3_f32 v17, v180, v181, v182
    v_max3_f32 v16, v16, v179, v184
    v_max3_f32 v17, v17, v183, v188
    v_max3_f32 v16, v16, v185, v186
    v_max3_f32 v17, v17, v189, v190
    v_max_f32 v16, v16, v187
    v_max_f32 v17, v17, v191
    v_mov_b32 v18, v16
    v_mov_b32 v19, v17
    s_nop 1
    v_permlane16_swap_b32 v16, v18
    v_permlane16_swap_b32 v17, v19
    s_nop 1
    v_max_f32 v16, v16, v18
    v_max_f32 v17, v17, v19
    v_mov_b32 v18, v16
    v_mov_b32 v19, v17
    s_nop 1
    v_permlane32_swap_b32 v16, v18
    v_permlane32_swap_b32 v17, v19
    s_nop 1
    v_max_f32 v16, v16, v18
    v_max_f32 v17, v17, v19
    v_add_f32 v16, 16.0, v16
    v_add_f32 v17, 16.0, v17
    v_max_f32 v16, 0, v16
    v_add_f32 v10, v10, v16
    v_exp_f32 v18, -v16
    v_max_f32 v17, 0, v17
    v_add_f32 v11, v11, v17
    v_exp_f32 v19, -v17
    v_sub_f32 v176, v176, v16
    v_sub_f32 v177, v177, v16
    v_sub_f32 v178, v178, v16
    v_sub_f32 v179, v179, v16
    v_sub_f32 v184, v184, v16
    v_sub_f32 v185, v185, v16
    v_sub_f32 v186, v186, v16
    v_sub_f32 v187, v187, v16
    v_sub_f32 v180, v180, v17
    v_sub_f32 v181, v181, v17
    v_sub_f32 v182, v182, v17
    v_sub_f32 v183, v183, v17
    v_sub_f32 v188, v188, v17
    v_sub_f32 v189, v189, v17
    v_sub_f32 v190, v190, v17
    v_sub_f32 v191, v191, v17
    v_sub_f32 v160, 0, v10
    v_sub_f32 v161, 0, v10
    v_sub_f32 v162, 0, v10
    v_sub_f32 v163, 0, v10
    v_sub_f32 v192, v192, v16
    v_sub_f32 v193, v193, v16
    v_sub_f32 v194, v194, v16
    v_sub_f32 v195, v195, v16
    v_sub_f32 v200, v200, v16
    v_sub_f32 v201, v201, v16
    v_sub_f32 v202, v202, v16
    v_sub_f32 v203, v203, v16
    v_sub_f32 v164, 0, v11
    v_sub_f32 v165, 0, v11
    v_sub_f32 v166, 0, v11
    v_sub_f32 v167, 0, v11
    v_sub_f32 v196, v196, v17
    v_sub_f32 v197, v197, v17
    v_sub_f32 v198, v198, v17
    v_sub_f32 v199, v199, v17
    v_sub_f32 v204, v204, v17
    v_sub_f32 v205, v205, v17
    v_sub_f32 v206, v206, v17
    v_sub_f32 v207, v207, v17
    v_mul_f32 v168, v168, v18
    v_mul_f32 v169, v169, v18
    v_mul_f32 v170, v170, v18
    v_mul_f32 v171, v171, v18
    v_mul_f32 v172, v172, v19
    v_mul_f32 v173, v173, v19
    v_mul_f32 v174, v174, v19
    v_mul_f32 v175, v175, v19
    v_mul_f32 v64, v64, v18
    v_mul_f32 v65, v65, v18
    v_mul_f32 v66, v66, v18
    v_mul_f32 v67, v67, v18
    v_mul_f32 v68, v68, v19
    v_mul_f32 v69, v69, v19
    v_mul_f32 v70, v70, v19
    v_mul_f32 v71, v71, v19
    v_mul_f32 v72, v72, v18
    v_mul_f32 v73, v73, v18
    v_mul_f32 v74, v74, v18
    v_mul_f32 v75, v75, v18
    v_mul_f32 v76, v76, v19
    v_mul_f32 v77, v77, v19
    v_mul_f32 v78, v78, v19
    v_mul_f32 v79, v79, v19
    v_mul_f32 v80, v80, v18
    v_mul_f32 v81, v81, v18
    v_mul_f32 v82, v82, v18
    v_mul_f32 v83, v83, v18
    v_mul_f32 v84, v84, v19
    v_mul_f32 v85, v85, v19
    v_mul_f32 v86, v86, v19
    v_mul_f32 v87, v87, v19
    v_mul_f32 v88, v88, v18
    v_mul_f32 v89, v89, v18
    v_mul_f32 v90, v90, v18
    v_mul_f32 v91, v91, v18
    v_mul_f32 v92, v92, v19
    v_mul_f32 v93, v93, v19
    v_mul_f32 v94, v94, v19
    v_mul_f32 v95, v95, v19
    v_mul_f32 v96, v96, v18
    v_mul_f32 v97, v97, v18
    v_mul_f32 v98, v98, v18
    v_mul_f32 v99, v99, v18
    v_mul_f32 v100, v100, v19
    v_mul_f32 v101, v101, v19
    v_mul_f32 v102, v102, v19
    v_mul_f32 v103, v103, v19
    v_mul_f32 v104, v104, v18
    v_mul_f32 v105, v105, v18
    v_mul_f32 v106, v106, v18
    v_mul_f32 v107, v107, v18
    v_mul_f32 v108, v108, v19
    v_mul_f32 v109, v109, v19
    v_mul_f32 v110, v110, v19
    v_mul_f32 v111, v111, v19
    v_mul_f32 v112, v112, v18
    v_mul_f32 v113, v113, v18
    v_mul_f32 v114, v114, v18
    v_mul_f32 v115, v115, v18
    v_mul_f32 v116, v116, v19
    v_mul_f32 v117, v117, v19
    v_mul_f32 v118, v118, v19
    v_mul_f32 v119, v119, v19
    v_mul_f32 v120, v120, v18
    v_mul_f32 v121, v121, v18
    v_mul_f32 v122, v122, v18
    v_mul_f32 v123, v123, v18
    v_mul_f32 v124, v124, v19
    v_mul_f32 v125, v125, v19
    v_mul_f32 v126, v126, v19
    v_mul_f32 v127, v127, v19
    v_exp_f32 v20, v176
    v_exp_f32 v21, v177
    v_exp_f32 v22, v178
    v_cvt_pk_bf16_f32 v208, v20, v21
    v_exp_f32 v23, v179
    v_exp_f32 v24, v184
    v_cvt_pk_bf16_f32 v209, v22, v23
    v_exp_f32 v25, v185
    v_exp_f32 v26, v186
    v_cvt_pk_bf16_f32 v210, v24, v25
    v_exp_f32 v27, v187
    v_exp_f32 v20, v180
    v_cvt_pk_bf16_f32 v211, v26, v27
    v_exp_f32 v21, v181
    v_exp_f32 v22, v182
    v_cvt_pk_bf16_f32 v212, v20, v21
    v_exp_f32 v23, v183
    v_exp_f32 v24, v188
    v_cvt_pk_bf16_f32 v213, v22, v23
    v_exp_f32 v25, v189
    v_exp_f32 v26, v190
    v_cvt_pk_bf16_f32 v214, v24, v25
    v_exp_f32 v27, v191
    s_nop 0
    v_cvt_pk_bf16_f32 v215, v26, v27
    s_nop 1
    s_branch L_rareback_20
L_rare_21:
    s_nop 7
    v_max3_f32 v16, v192, v193, v194
    v_max3_f32 v17, v196, v197, v198
    v_max3_f32 v16, v16, v195, v200
    v_max3_f32 v17, v17, v199, v204
    v_max3_f32 v16, v16, v201, v202
    v_max3_f32 v17, v17, v205, v206
    v_max_f32 v16, v16, v203
    v_max_f32 v17, v17, v207
    v_mov_b32 v18, v16
    v_mov_b32 v19, v17
    s_nop 1
    v_permlane16_swap_b32 v16, v18
    v_permlane16_swap_b32 v17, v19
    s_nop 1
    v_max_f32 v16, v16, v18
    v_max_f32 v17, v17, v19
    v_mov_b32 v18, v16
    v_mov_b32 v19, v17
    s_nop 1
    v_permlane32_swap_b32 v16, v18
    v_permlane32_swap_b32 v17, v19
    s_nop 1
    v_max_f32 v16, v16, v18
    v_max_f32 v17, v17, v19
    v_add_f32 v16, 16.0, v16
    v_add_f32 v17, 16.0, v17
    v_max_f32 v16, 0, v16
    v_add_f32 v10, v10, v16
    v_exp_f32 v18, -v16
    v_max_f32 v17, 0, v17
    v_add_f32 v11, v11, v17
    v_exp_f32 v19, -v17
    v_sub_f32 v192, v192, v16
    v_sub_f32 v193, v193, v16
    v_sub_f32 v194, v194, v16
    v_sub_f32 v195, v195, v16
    v_sub_f32 v200, v200, v16
    v_sub_f32 v201, v201, v16
    v_sub_f32 v202, v202, v16
    v_sub_f32 v203, v203, v16
    v_sub_f32 v196, v196, v17
    v_sub_f32 v197, v197, v17
    v_sub_f32 v198, v198, v17
    v_sub_f32 v199, v199, v17
    v_sub_f32 v204, v204, v17
    v_sub_f32 v205, v205, v17
    v_sub_f32 v206, v206, v17
    v_sub_f32 v207, v207, v17
    v_sub_f32 v160, 0, v10
    v_sub_f32 v161, 0, v10
    v_sub_f32 v162, 0, v10
    v_sub_f32 v163, 0, v10
    v_sub_f32 v176, v176, v16
    v_sub_f32 v177, v177, v16
    v_sub_f32 v178, v178, v16
    v_sub_f32 v179, v179, v16
    v_sub_f32 v184, v184, v16
    v_sub_f32 v185, v185, v16
    v_sub_f32 v186, v186, v16
    v_sub_f32 v187, v187, v16
    v_sub_f32 v164, 0, v11
    v_sub_f32 v165, 0, v11
    v_sub_f32 v166, 0, v11
    v_sub_f32 v167, 0, v11
    v_sub_f32 v180, v180, v17
    v_sub_f32 v181, v181, v17
    v_sub_f32 v182, v182, v17
    v_sub_f32 v183, v183, v17
    v_sub_f32 v188, v188, v17
    v_sub_f32 v189, v189, v17
    v_sub_f32 v190, v190, v17
    v_sub_f32 v191, v191, v17
    v_mul_f32 v168, v168, v18
    v_mul_f32 v169, v169, v18
    v_mul_f32 v170, v170, v18
    v_mul_f32 v171, v171, v18
    v_mul_f32 v172, v172, v19
    v_mul_f32 v173, v173, v19
    v_mul_f32 v174, v174, v19
    v_mul_f32 v175, v175, v19
    v_mul_f32 v64, v64, v18
    v_mul_f32 v65, v65, v18
    v_mul_f32 v66, v66, v18
    v_mul_f32 v67, v67, v18
    v_mul_f32 v68, v68, v19
    v_mul_f32 v69, v69, v19
    v_mul_f32 v70, v70, v19
    v_mul_f32 v71, v71, v19
    v_mul_f32 v72, v72, v18
    v_mul_f32 v73, v73, v18
    v_mul_f32 v74, v74, v18
    v_mul_f32 v75, v75, v18
    v_mul_f32 v76, v76, v19
    v_mul_f32 v77, v77, v19
    v_mul_f32 v78, v78, v19
    v_mul_f32 v79, v79, v19
    v_mul_f32 v80, v80, v18
    v_mul_f32 v81, v81, v18
    v_mul_f32 v82, v82, v18
    v_mul_f32 v83, v83, v18
    v_mul_f32 v84, v84, v19
    v_mul_f32 v85, v85, v19
    v_mul_f32 v86, v86, v19
    v_mul_f32 v87, v87, v19
    v_mul_f32 v88, v88, v18
    v_mul_f32 v89, v89, v18
    v_mul_f32 v90, v90, v18
    v_mul_f32 v91, v91, v18
    v_mul_f32 v92, v92, v19
    v_mul_f32 v93, v93, v19
    v_mul_f32 v94, v94, v19
    v_mul_f32 v95, v95, v19
    v_mul_f32 v96, v96, v18
    v_mul_f32 v97, v97, v18
    v_mul_f32 v98, v98, v18
    v_mul_f32 v99, v99, v18
    v_mul_f32 v100, v100, v19
    v_mul_f32 v101, v101, v19
    v_mul_f32 v102, v102, v19
    v_mul_f32 v103, v103, v19
    v_mul_f32 v104, v104, v18
    v_mul_f32 v105, v105, v18
    v_mul_f32 v106, v106, v18
    v_mul_f32 v107, v107, v18
    v_mul_f32 v108, v108, v19
    v_mul_f32 v109, v109, v19
    v_mul_f32 v110, v110, v19
    v_mul_f32 v111, v111, v19
    v_mul_f32 v112, v112, v18
    v_mul_f32 v113, v113, v18
    v_mul_f32 v114, v114, v18
    v_mul_f32 v115, v115, v18
    v_mul_f32 v116, v116, v19
    v_mul_f32 v117, v117, v19
    v_mul_f32 v118, v118, v19
    v_mul_f32 v119, v119, v19
    v_mul_f32 v120, v120, v18
    v_mul_f32 v121, v121, v18
    v_mul_f32 v122, v122, v18
    v_mul_f32 v123, v123, v18
    v_mul_f32 v124, v124, v19
    v_mul_f32 v125, v125, v19
    v_mul_f32 v126, v126, v19
    v_mul_f32 v127, v127, v19
    v_exp_f32 v20, v192
    v_exp_f32 v21, v193
    v_exp_f32 v22, v194
    v_cvt_pk_bf16_f32 v216, v20, v21
    v_exp_f32 v23, v195
    v_exp_f32 v24, v200
    v_cvt_pk_bf16_f32 v217, v22, v23
    v_exp_f32 v25, v201
    v_exp_f32 v26, v202
    v_cvt_pk_bf16_f32 v218, v24, v25
    v_exp_f32 v27, v203
    v_exp_f32 v20, v196
    v_cvt_pk_bf16_f32 v219, v26, v27
    v_exp_f32 v21, v197
    v_exp_f32 v22, v198
    v_cvt_pk_bf16_f32 v220, v20, v21
    v_exp_f32 v23, v199
    v_exp_f32 v24, v204
    v_cvt_pk_bf16_f32 v221, v22, v23
    v_exp_f32 v25, v205
    v_exp_f32 v26, v206
    v_cvt_pk_bf16_f32 v222, v24, v25
    v_exp_f32 v27, v207
    s_nop 0
    v_cvt_pk_bf16_f32 v223, v26, v27
    s_nop 1
    s_branch L_rareback_22
L_rare_23:
    s_nop 7
    v_max3_f32 v16, v176, v177, v178
    v_max3_f32 v17, v180, v181, v182
    v_max3_f32 v16, v16, v179, v184
    v_max3_f32 v17, v17, v183, v188
    v_max3_f32 v16, v16, v185, v186
    v_max3_f32 v17, v17, v189, v190
    v_max_f32 v16, v16, v187
    v_max_f32 v17, v17, v191
    v_mov_b32 v18, v16
    v_mov_b32 v19, v17
    s_nop 1
    v_permlane16_swap_b32 v16, v18
    v_permlane16_swap_b32 v17, v19
    s_nop 1
    v_max_f32 v16, v16, v18
    v_max_f32 v17, v17, v19
    v_mov_b32 v18, v16
    v_mov_b32 v19, v17
    s_nop 1
    v_permlane32_swap_b32 v16, v18
    v_permlane32_swap_b32 v17, v19
    s_nop 1
    v_max_f32 v16, v16, v18
    v_max_f32 v17, v17, v19
    v_add_f32 v16, 16.0, v16
    v_add_f32 v17, 16.0, v17
    v_max_f32 v16, 0, v16
    v_add_f32 v10, v10, v16
    v_exp_f32 v18, -v16
    v_max_f32 v17, 0, v17
    v_add_f32 v11, v11, v17
    v_exp_f32 v19, -v17
    v_sub_f32 v176, v176, v16
    v_sub_f32 v177, v177, v16
    v_sub_f32 v178, v178, v16
    v_sub_f32 v179, v179, v16
    v_sub_f32 v184, v184, v16
    v_sub_f32 v185, v185, v16
    v_sub_f32 v186, v186, v16
    v_sub_f32 v187, v187, v16
    v_sub_f32 v180, v180, v17
    v_sub_f32 v181, v181, v17
    v_sub_f32 v182, v182, v17
    v_sub_f32 v183, v183, v17
    v_sub_f32 v188, v188, v17
    v_sub_f32 v189, v189, v17
    v_sub_f32 v190, v190, v17
    v_sub_f32 v191, v191, v17
    v_sub_f32 v160, 0, v10
    v_sub_f32 v161, 0, v10
    v_sub_f32 v162, 0, v10
    v_sub_f32 v163, 0, v10
    v_sub_f32 v192, v192, v16
    v_sub_f32 v193, v193, v16
    v_sub_f32 v194, v194, v16
    v_sub_f32 v195, v195, v16
    v_sub_f32 v200, v200, v16
    v_sub_f32 v201, v201, v16
    v_sub_f32 v202, v202, v16
    v_sub_f32 v203, v203, v16
    v_sub_f32 v164, 0, v11
    v_sub_f32 v165, 0, v11
    v_sub_f32 v166, 0, v11
    v_sub_f32 v167, 0, v11
    v_sub_f32 v196, v196, v17
    v_sub_f32 v197, v197, v17
    v_sub_f32 v198, v198, v17
    v_sub_f32 v199, v199, v17
    v_sub_f32 v204, v204, v17
    v_sub_f32 v205, v205, v17
    v_sub_f32 v206, v206, v17
    v_sub_f32 v207, v207, v17
    v_mul_f32 v168, v168, v18
    v_mul_f32 v169, v169, v18
    v_mul_f32 v170, v170, v18
    v_mul_f32 v171, v171, v18
    v_mul_f32 v172, v172, v19
    v_mul_f32 v173, v173, v19
    v_mul_f32 v174, v174, v19
    v_mul_f32 v175, v175, v19
    v_mul_f32 v64, v64, v18
    v_mul_f32 v65, v65, v18
    v_mul_f32 v66, v66, v18
    v_mul_f32 v67, v67, v18
    v_mul_f32 v68, v68, v19
    v_mul_f32 v69, v69, v19
    v_mul_f32 v70, v70, v19
    v_mul_f32 v71, v71, v19
    v_mul_f32 v72, v72, v18
    v_mul_f32 v73, v73, v18
    v_mul_f32 v74, v74, v18
    v_mul_f32 v75, v75, v18
    v_mul_f32 v76, v76, v19
    v_mul_f32 v77, v77, v19
    v_mul_f32 v78, v78, v19
    v_mul_f32 v79, v79, v19
    v_mul_f32 v80, v80, v18
    v_mul_f32 v81, v81, v18
    v_mul_f32 v82, v82, v18
    v_mul_f32 v83, v83, v18
    v_mul_f32 v84, v84, v19
    v_mul_f32 v85, v85, v19
    v_mul_f32 v86, v86, v19
    v_mul_f32 v87, v87, v19
    v_mul_f32 v88, v88, v18
    v_mul_f32 v89, v89, v18
    v_mul_f32 v90, v90, v18
    v_mul_f32 v91, v91, v18
    v_mul_f32 v92, v92, v19
    v_mul_f32 v93, v93, v19
    v_mul_f32 v94, v94, v19
    v_mul_f32 v95, v95, v19
    v_mul_f32 v96, v96, v18
    v_mul_f32 v97, v97, v18
    v_mul_f32 v98, v98, v18
    v_mul_f32 v99, v99, v18
    v_mul_f32 v100, v100, v19
    v_mul_f32 v101, v101, v19
    v_mul_f32 v102, v102, v19
    v_mul_f32 v103, v103, v19
    v_mul_f32 v104, v104, v18
    v_mul_f32 v105, v105, v18
    v_mul_f32 v106, v106, v18
    v_mul_f32 v107, v107, v18
    v_mul_f32 v108, v108, v19
    v_mul_f32 v109, v109, v19
    v_mul_f32 v110, v110, v19
    v_mul_f32 v111, v111, v19
    v_mul_f32 v112, v112, v18
    v_mul_f32 v113, v113, v18
    v_mul_f32 v114, v114, v18
    v_mul_f32 v115, v115, v18
    v_mul_f32 v116, v116, v19
    v_mul_f32 v117, v117, v19
    v_mul_f32 v118, v118, v19
    v_mul_f32 v119, v119, v19
    v_mul_f32 v120, v120, v18
    v_mul_f32 v121, v121, v18
    v_mul_f32 v122, v122, v18
    v_mul_f32 v123, v123, v18
    v_mul_f32 v124, v124, v19
    v_mul_f32 v125, v125, v19
    v_mul_f32 v126, v126, v19
    v_mul_f32 v127, v127, v19
    v_exp_f32 v20, v176
    v_exp_f32 v21, v177
    v_exp_f32 v22, v178
    v_cvt_pk_bf16_f32 v208, v20, v21
    v_exp_f32 v23, v179
    v_exp_f32 v24, v184
    v_cvt_pk_bf16_f32 v209, v22, v23
    v_exp_f32 v25, v185
    v_exp_f32 v26, v186
    v_cvt_pk_bf16_f32 v210, v24, v25
    v_exp_f32 v27, v187
    v_exp_f32 v20, v180
    v_cvt_pk_bf16_f32 v211, v26, v27
    v_exp_f32 v21, v181
    v_exp_f32 v22, v182
    v_cvt_pk_bf16_f32 v212, v20, v21
    v_exp_f32 v23, v183
    v_exp_f32 v24, v188
    v_cvt_pk_bf16_f32 v213, v22, v23
    v_exp_f32 v25, v189
    v_exp_f32 v26, v190
    v_cvt_pk_bf16_f32 v214, v24, v25
    v_exp_f32 v27, v191
    s_nop 0
    v_cvt_pk_bf16_f32 v215, v26, v27
    s_nop 1
    s_branch L_rareback_24
L_rare_25:
    s_nop 7
    v_max3_f32 v16, v192, v193, v194
    v_max3_f32 v17, v196, v197, v198
    v_max3_f32 v16, v16, v195, v200
    v_max3_f32 v17, v17, v199, v204
    v_max3_f32 v16, v16, v201, v202
    v_max3_f32 v17, v17, v205, v206
    v_max_f32 v16, v16, v203
    v_max_f32 v17, v17, v207
    v_mov_b32 v18, v16
    v_mov_b32 v19, v17
    s_nop 1
    v_permlane16_swap_b32 v16, v18
    v_permlane16_swap_b32 v17, v19
    s_nop 1
    v_max_f32 v16, v16, v18
    v_max_f32 v17, v17, v19
    v_mov_b32 v18, v16
    v_mov_b32 v19, v17
    s_nop 1
    v_permlane32_swap_b32 v16, v18
    v_permlane32_swap_b32 v17, v19
    s_nop 1
    v_max_f32 v16, v16, v18
    v_max_f32 v17, v17, v19
    v_add_f32 v16, 16.0, v16
    v_add_f32 v17, 16.0, v17
    v_max_f32 v16, 0, v16
    v_add_f32 v10, v10, v16
    v_exp_f32 v18, -v16
    v_max_f32 v17, 0, v17
    v_add_f32 v11, v11, v17
    v_exp_f32 v19, -v17
    v_sub_f32 v192, v192, v16
    v_sub_f32 v193, v193, v16
    v_sub_f32 v194, v194, v16
    v_sub_f32 v195, v195, v16
    v_sub_f32 v200, v200, v16
    v_sub_f32 v201, v201, v16
    v_sub_f32 v202, v202, v16
    v_sub_f32 v203, v203, v16
    v_sub_f32 v196, v196, v17
    v_sub_f32 v197, v197, v17
    v_sub_f32 v198, v198, v17
    v_sub_f32 v199, v199, v17
    v_sub_f32 v204, v204, v17
    v_sub_f32 v205, v205, v17
    v_sub_f32 v206, v206, v17
    v_sub_f32 v207, v207, v17
    v_sub_f32 v160, 0, v10
    v_sub_f32 v161, 0, v10
    v_sub_f32 v162, 0, v10
    v_sub_f32 v163, 0, v10
    v_sub_f32 v176, v176, v16
    v_sub_f32 v177, v177, v16
    v_sub_f32 v178, v178, v16
    v_sub_f32 v179, v179, v16
    v_sub_f32 v184, v184, v16
    v_sub_f32 v185, v185, v16
    v_sub_f32 v186, v186, v16
    v_sub_f32 v187, v187, v16
    v_sub_f32 v164, 0, v11
    v_sub_f32 v165, 0, v11
    v_sub_f32 v166, 0, v11
    v_sub_f32 v167, 0, v11
    v_sub_f32 v180, v180, v17
    v_sub_f32 v181, v181, v17
    v_sub_f32 v182, v182, v17
    v_sub_f32 v183, v183, v17
    v_sub_f32 v188, v188, v17
    v_sub_f32 v189, v189, v17
    v_sub_f32 v190, v190, v17
    v_sub_f32 v191, v191, v17
    v_mul_f32 v168, v168, v18
    v_mul_f32 v169, v169, v18
    v_mul_f32 v170, v170, v18
    v_mul_f32 v171, v171, v18
    v_mul_f32 v172, v172, v19
    v_mul_f32 v173, v173, v19
    v_mul_f32 v174, v174, v19
    v_mul_f32 v175, v175, v19
    v_mul_f32 v64, v64, v18
    v_mul_f32 v65, v65, v18
    v_mul_f32 v66, v66, v18
    v_mul_f32 v67, v67, v18
    v_mul_f32 v68, v68, v19
    v_mul_f32 v69, v69, v19
    v_mul_f32 v70, v70, v19
    v_mul_f32 v71, v71, v19
    v_mul_f32 v72, v72, v18
    v_mul_f32 v73, v73, v18
    v_mul_f32 v74, v74, v18
    v_mul_f32 v75, v75, v18
    v_mul_f32 v76, v76, v19
    v_mul_f32 v77, v77, v19
    v_mul_f32 v78, v78, v19
    v_mul_f32 v79, v79, v19
    v_mul_f32 v80, v80, v18
    v_mul_f32 v81, v81, v18
    v_mul_f32 v82, v82, v18
    v_mul_f32 v83, v83, v18
    v_mul_f32 v84, v84, v19
    v_mul_f32 v85, v85, v19
    v_mul_f32 v86, v86, v19
    v_mul_f32 v87, v87, v19
    v_mul_f32 v88, v88, v18
    v_mul_f32 v89, v89, v18
    v_mul_f32 v90, v90, v18
    v_mul_f32 v91, v91, v18
    v_mul_f32 v92, v92, v19
    v_mul_f32 v93, v93, v19
    v_mul_f32 v94, v94, v19
    v_mul_f32 v95, v95, v19
    v_mul_f32 v96, v96, v18
    v_mul_f32 v97, v97, v18
    v_mul_f32 v98, v98, v18
    v_mul_f32 v99, v99, v18
    v_mul_f32 v100, v100, v19
    v_mul_f32 v101, v101, v19
    v_mul_f32 v102, v102, v19
    v_mul_f32 v103, v103, v19
    v_mul_f32 v104, v104, v18
    v_mul_f32 v105, v105, v18
    v_mul_f32 v106, v106, v18
    v_mul_f32 v107, v107, v18
    v_mul_f32 v108, v108, v19
    v_mul_f32 v109, v109, v19
    v_mul_f32 v110, v110, v19
    v_mul_f32 v111, v111, v19
    v_mul_f32 v112, v112, v18
    v_mul_f32 v113, v113, v18
    v_mul_f32 v114, v114, v18
    v_mul_f32 v115, v115, v18
    v_mul_f32 v116, v116, v19
    v_mul_f32 v117, v117, v19
    v_mul_f32 v118, v118, v19
    v_mul_f32 v119, v119, v19
    v_mul_f32 v120, v120, v18
    v_mul_f32 v121, v121, v18
    v_mul_f32 v122, v122, v18
    v_mul_f32 v123, v123, v18
    v_mul_f32 v124, v124, v19
    v_mul_f32 v125, v125, v19
    v_mul_f32 v126, v126, v19
    v_mul_f32 v127, v127, v19
    v_exp_f32 v20, v192
    v_exp_f32 v21, v193
    v_exp_f32 v22, v194
    v_cvt_pk_bf16_f32 v216, v20, v21
    v_exp_f32 v23, v195
    v_exp_f32 v24, v200
    v_cvt_pk_bf16_f32 v217, v22, v23
    v_exp_f32 v25, v201
    v_exp_f32 v26, v202
    v_cvt_pk_bf16_f32 v218, v24, v25
    v_exp_f32 v27, v203
    v_exp_f32 v20, v196
    v_cvt_pk_bf16_f32 v219, v26, v27
    v_exp_f32 v21, v197
    v_exp_f32 v22, v198
    v_cvt_pk_bf16_f32 v220, v20, v21
    v_exp_f32 v23, v199
    v_exp_f32 v24, v204
    v_cvt_pk_bf16_f32 v221, v22, v23
    v_exp_f32 v25, v205
    v_exp_f32 v26, v206
    v_cvt_pk_bf16_f32 v222, v24, v25
    v_exp_f32 v27, v207
    s_nop 0
    v_cvt_pk_bf16_f32 v223, v26, v27
    s_nop 1
    s_branch L_rareback_26
L_rare_27:
    s_nop 7
    v_max3_f32 v16, v176, v177, v178
    v_max3_f32 v17, v180, v181, v182
    v_max3_f32 v16, v16, v179, v184
    v_max3_f32 v17, v17, v183, v188
    v_max3_f32 v16, v16, v185, v186
    v_max3_f32 v17, v17, v189, v190
    v_max_f32 v16, v16, v187
    v_max_f32 v17, v17, v191
    v_mov_b32 v18, v16
    v_mov_b32 v19, v17
    s_nop 1
    v_permlane16_swap_b32 v16, v18
    v_permlane16_swap_b32 v17, v19
    s_nop 1
    v_max_f32 v16, v16, v18
    v_max_f32 v17, v17, v19
    v_mov_b32 v18, v16
    v_mov_b32 v19, v17
    s_nop 1
    v_permlane32_swap_b32 v16, v18
    v_permlane32_swap_b32 v17, v19
    s_nop 1
    v_max_f32 v16, v16, v18
    v_max_f32 v17, v17, v19
    v_add_f32 v16, 16.0, v16
    v_add_f32 v17, 16.0, v17
    v_max_f32 v16, 0, v16
    v_add_f32 v10, v10, v16
    v_exp_f32 v18, -v16
    v_max_f32 v17, 0, v17
    v_add_f32 v11, v11, v17
    v_exp_f32 v19, -v17
    v_sub_f32 v176, v176, v16
    v_sub_f32 v177, v177, v16
    v_sub_f32 v178, v178, v16
    v_sub_f32 v179, v179, v16
    v_sub_f32 v184, v184, v16
    v_sub_f32 v185, v185, v16
    v_sub_f32 v186, v186, v16
    v_sub_f32 v187, v187, v16
    v_sub_f32 v180, v180, v17
    v_sub_f32 v181, v181, v17
    v_sub_f32 v182, v182, v17
    v_sub_f32 v183, v183, v17
    v_sub_f32 v188, v188, v17
    v_sub_f32 v189, v189, v17
    v_sub_f32 v190, v190, v17
    v_sub_f32 v191, v191, v17
    v_sub_f32 v160, 0, v10
    v_sub_f32 v161, 0, v10
    v_sub_f32 v162, 0, v10
    v_sub_f32 v163, 0, v10
    v_sub_f32 v192, v192, v16
    v_sub_f32 v193, v193, v16
    v_sub_f32 v194, v194, v16
    v_sub_f32 v195, v195, v16
    v_sub_f32 v200, v200, v16
    v_sub_f32 v201, v201, v16
    v_sub_f32 v202, v202, v16
    v_sub_f32 v203, v203, v16
    v_sub_f32 v164, 0, v11
    v_sub_f32 v165, 0, v11
    v_sub_f32 v166, 0, v11
    v_sub_f32 v167, 0, v11
    v_sub_f32 v196, v196, v17
    v_sub_f32 v197, v197, v17
    v_sub_f32 v198, v198, v17
    v_sub_f32 v199, v199, v17
    v_sub_f32 v204, v204, v17
    v_sub_f32 v205, v205, v17
    v_sub_f32 v206, v206, v17
    v_sub_f32 v207, v207, v17
    v_mul_f32 v168, v168, v18
    v_mul_f32 v169, v169, v18
    v_mul_f32 v170, v170, v18
    v_mul_f32 v171, v171, v18
    v_mul_f32 v172, v172, v19
    v_mul_f32 v173, v173, v19
    v_mul_f32 v174, v174, v19
    v_mul_f32 v175, v175, v19
    v_mul_f32 v64, v64, v18
    v_mul_f32 v65, v65, v18
    v_mul_f32 v66, v66, v18
    v_mul_f32 v67, v67, v18
    v_mul_f32 v68, v68, v19
    v_mul_f32 v69, v69, v19
    v_mul_f32 v70, v70, v19
    v_mul_f32 v71, v71, v19
    v_mul_f32 v72, v72, v18
    v_mul_f32 v73, v73, v18
    v_mul_f32 v74, v74, v18
    v_mul_f32 v75, v75, v18
    v_mul_f32 v76, v76, v19
    v_mul_f32 v77, v77, v19
    v_mul_f32 v78, v78, v19
    v_mul_f32 v79, v79, v19
    v_mul_f32 v80, v80, v18
    v_mul_f32 v81, v81, v18
    v_mul_f32 v82, v82, v18
    v_mul_f32 v83, v83, v18
    v_mul_f32 v84, v84, v19
    v_mul_f32 v85, v85, v19
    v_mul_f32 v86, v86, v19
    v_mul_f32 v87, v87, v19
    v_mul_f32 v88, v88, v18
    v_mul_f32 v89, v89, v18
    v_mul_f32 v90, v90, v18
    v_mul_f32 v91, v91, v18
    v_mul_f32 v92, v92, v19
    v_mul_f32 v93, v93, v19
    v_mul_f32 v94, v94, v19
    v_mul_f32 v95, v95, v19
    v_mul_f32 v96, v96, v18
    v_mul_f32 v97, v97, v18
    v_mul_f32 v98, v98, v18
    v_mul_f32 v99, v99, v18
    v_mul_f32 v100, v100, v19
    v_mul_f32 v101, v101, v19
    v_mul_f32 v102, v102, v19
    v_mul_f32 v103, v103, v19
    v_mul_f32 v104, v104, v18
    v_mul_f32 v105, v105, v18
    v_mul_f32 v106, v106, v18
    v_mul_f32 v107, v107, v18
    v_mul_f32 v108, v108, v19
    v_mul_f32 v109, v109, v19
    v_mul_f32 v110, v110, v19
    v_mul_f32 v111, v111, v19
    v_mul_f32 v112, v112, v18
    v_mul_f32 v113, v113, v18
    v_mul_f32 v114, v114, v18
    v_mul_f32 v115, v115, v18
    v_mul_f32 v116, v116, v19
    v_mul_f32 v117, v117, v19
    v_mul_f32 v118, v118, v19
    v_mul_f32 v119, v119, v19
    v_mul_f32 v120, v120, v18
    v_mul_f32 v121, v121, v18
    v_mul_f32 v122, v122, v18
    v_mul_f32 v123, v123, v18
    v_mul_f32 v124, v124, v19
    v_mul_f32 v125, v125, v19
    v_mul_f32 v126, v126, v19
    v_mul_f32 v127, v127, v19
    v_exp_f32 v20, v176
    v_exp_f32 v21, v177
    v_exp_f32 v22, v178
    v_cvt_pk_bf16_f32 v208, v20, v21
    v_exp_f32 v23, v179
    v_exp_f32 v24, v184
    v_cvt_pk_bf16_f32 v209, v22, v23
    v_exp_f32 v25, v185
    v_exp_f32 v26, v186
    v_cvt_pk_bf16_f32 v210, v24, v25
    v_exp_f32 v27, v187
    v_exp_f32 v20, v180
    v_cvt_pk_bf16_f32 v211, v26, v27
    v_exp_f32 v21, v181
    v_exp_f32 v22, v182
    v_cvt_pk_bf16_f32 v212, v20, v21
    v_exp_f32 v23, v183
    v_exp_f32 v24, v188
    v_cvt_pk_bf16_f32 v213, v22, v23
    v_exp_f32 v25, v189
    v_exp_f32 v26, v190
    v_cvt_pk_bf16_f32 v214, v24, v25
    v_exp_f32 v27, v191
    s_nop 0
    v_cvt_pk_bf16_f32 v215, v26, v27
    s_nop 1
    s_branch L_rareback_28
L_rare_29:
    s_nop 7
    v_max3_f32 v16, v192, v193, v194
    v_max3_f32 v17, v196, v197, v198
    v_max3_f32 v16, v16, v195, v200
    v_max3_f32 v17, v17, v199, v204
    v_max3_f32 v16, v16, v201, v202
    v_max3_f32 v17, v17, v205, v206
    v_max_f32 v16, v16, v203
    v_max_f32 v17, v17, v207
    v_mov_b32 v18, v16
    v_mov_b32 v19, v17
    s_nop 1
    v_permlane16_swap_b32 v16, v18
    v_permlane16_swap_b32 v17, v19
    s_nop 1
    v_max_f32 v16, v16, v18
    v_max_f32 v17, v17, v19
    v_mov_b32 v18, v16
    v_mov_b32 v19, v17
    s_nop 1
    v_permlane32_swap_b32 v16, v18
    v_permlane32_swap_b32 v17, v19
    s_nop 1
    v_max_f32 v16, v16, v18
    v_max_f32 v17, v17, v19
    v_add_f32 v16, 16.0, v16
    v_add_f32 v17, 16.0, v17
    v_max_f32 v16, 0, v16
    v_add_f32 v10, v10, v16
    v_exp_f32 v18, -v16
    v_max_f32 v17, 0, v17
    v_add_f32 v11, v11, v17
    v_exp_f32 v19, -v17
    v_sub_f32 v192, v192, v16
    v_sub_f32 v193, v193, v16
    v_sub_f32 v194, v194, v16
    v_sub_f32 v195, v195, v16
    v_sub_f32 v200, v200, v16
    v_sub_f32 v201, v201, v16
    v_sub_f32 v202, v202, v16
    v_sub_f32 v203, v203, v16
    v_sub_f32 v196, v196, v17
    v_sub_f32 v197, v197, v17
    v_sub_f32 v198, v198, v17
    v_sub_f32 v199, v199, v17
    v_sub_f32 v204, v204, v17
    v_sub_f32 v205, v205, v17
    v_sub_f32 v206, v206, v17
    v_sub_f32 v207, v207, v17
    v_sub_f32 v160, 0, v10
    v_sub_f32 v161, 0, v10
    v_sub_f32 v162, 0, v10
    v_sub_f32 v163, 0, v10
    v_sub_f32 v176, v176, v16
    v_sub_f32 v177, v177, v16
    v_sub_f32 v178, v178, v16
    v_sub_f32 v179, v179, v16
    v_sub_f32 v184, v184, v16
    v_sub_f32 v185, v185, v16
    v_sub_f32 v186, v186, v16
    v_sub_f32 v187, v187, v16
    v_sub_f32 v164, 0, v11
    v_sub_f32 v165, 0, v11
    v_sub_f32 v166, 0, v11
    v_sub_f32 v167, 0, v11
    v_sub_f32 v180, v180, v17
    v_sub_f32 v181, v181, v17
    v_sub_f32 v182, v182, v17
    v_sub_f32 v183, v183, v17
    v_sub_f32 v188, v188, v17
    v_sub_f32 v189, v189, v17
    v_sub_f32 v190, v190, v17
    v_sub_f32 v191, v191, v17
    v_mul_f32 v168, v168, v18
    v_mul_f32 v169, v169, v18
    v_mul_f32 v170, v170, v18
    v_mul_f32 v171, v171, v18
    v_mul_f32 v172, v172, v19
    v_mul_f32 v173, v173, v19
    v_mul_f32 v174, v174, v19
    v_mul_f32 v175, v175, v19
    v_mul_f32 v64, v64, v18
    v_mul_f32 v65, v65, v18
    v_mul_f32 v66, v66, v18
    v_mul_f32 v67, v67, v18
    v_mul_f32 v68, v68, v19
    v_mul_f32 v69, v69, v19
    v_mul_f32 v70, v70, v19
    v_mul_f32 v71, v71, v19
    v_mul_f32 v72, v72, v18
    v_mul_f32 v73, v73, v18
    v_mul_f32 v74, v74, v18
    v_mul_f32 v75, v75, v18
    v_mul_f32 v76, v76, v19
    v_mul_f32 v77, v77, v19
    v_mul_f32 v78, v78, v19
    v_mul_f32 v79, v79, v19
    v_mul_f32 v80, v80, v18
    v_mul_f32 v81, v81, v18
    v_mul_f32 v82, v82, v18
    v_mul_f32 v83, v83, v18
    v_mul_f32 v84, v84, v19
    v_mul_f32 v85, v85, v19
    v_mul_f32 v86, v86, v19
    v_mul_f32 v87, v87, v19
    v_mul_f32 v88, v88, v18
    v_mul_f32 v89, v89, v18
    v_mul_f32 v90, v90, v18
    v_mul_f32 v91, v91, v18
    v_mul_f32 v92, v92, v19
    v_mul_f32 v93, v93, v19
    v_mul_f32 v94, v94, v19
    v_mul_f32 v95, v95, v19
    v_mul_f32 v96, v96, v18
    v_mul_f32 v97, v97, v18
    v_mul_f32 v98, v98, v18
    v_mul_f32 v99, v99, v18
    v_mul_f32 v100, v100, v19
    v_mul_f32 v101, v101, v19
    v_mul_f32 v102, v102, v19
    v_mul_f32 v103, v103, v19
    v_mul_f32 v104, v104, v18
    v_mul_f32 v105, v105, v18
    v_mul_f32 v106, v106, v18
    v_mul_f32 v107, v107, v18
    v_mul_f32 v108, v108, v19
    v_mul_f32 v109, v109, v19
    v_mul_f32 v110, v110, v19
    v_mul_f32 v111, v111, v19
    v_mul_f32 v112, v112, v18
    v_mul_f32 v113, v113, v18
    v_mul_f32 v114, v114, v18
    v_mul_f32 v115, v115, v18
    v_mul_f32 v116, v116, v19
    v_mul_f32 v117, v117, v19
    v_mul_f32 v118, v118, v19
    v_mul_f32 v119, v119, v19
    v_mul_f32 v120, v120, v18
    v_mul_f32 v121, v121, v18
    v_mul_f32 v122, v122, v18
    v_mul_f32 v123, v123, v18
    v_mul_f32 v124, v124, v19
    v_mul_f32 v125, v125, v19
    v_mul_f32 v126, v126, v19
    v_mul_f32 v127, v127, v19
    v_exp_f32 v20, v192
    v_exp_f32 v21, v193
    v_exp_f32 v22, v194
    v_cvt_pk_bf16_f32 v216, v20, v21
    v_exp_f32 v23, v195
    v_exp_f32 v24, v200
    v_cvt_pk_bf16_f32 v217, v22, v23
    v_exp_f32 v25, v201
    v_exp_f32 v26, v202
    v_cvt_pk_bf16_f32 v218, v24, v25
    v_exp_f32 v27, v203
    v_exp_f32 v20, v196
    v_cvt_pk_bf16_f32 v219, v26, v27
    v_exp_f32 v21, v197
    v_exp_f32 v22, v198
    v_cvt_pk_bf16_f32 v220, v20, v21
    v_exp_f32 v23, v199
    v_exp_f32 v24, v204
    v_cvt_pk_bf16_f32 v221, v22, v23
    v_exp_f32 v25, v205
    v_exp_f32 v26, v206
    v_cvt_pk_bf16_f32 v222, v24, v25
    v_exp_f32 v27, v207
    s_nop 0
    v_cvt_pk_bf16_f32 v223, v26, v27
    s_nop 1
    s_branch L_rareback_30
L_rare_31:
    s_nop 7
    v_max3_f32 v16, v176, v177, v178
    v_max3_f32 v17, v180, v181, v182
    v_max3_f32 v16, v16, v179, v184
    v_max3_f32 v17, v17, v183, v188
    v_max3_f32 v16, v16, v185, v186
    v_max3_f32 v17, v17, v189, v190
    v_max_f32 v16, v16, v187
    v_max_f32 v17, v17, v191
    v_mov_b32 v18, v16
    v_mov_b32 v19, v17
    s_nop 1
    v_permlane16_swap_b32 v16, v18
    v_permlane16_swap_b32 v17, v19
    s_nop 1
    v_max_f32 v16, v16, v18
    v_max_f32 v17, v17, v19
    v_mov_b32 v18, v16
    v_mov_b32 v19, v17
    s_nop 1
    v_permlane32_swap_b32 v16, v18
    v_permlane32_swap_b32 v17, v19
    s_nop 1
    v_max_f32 v16, v16, v18
    v_max_f32 v17, v17, v19
    v_add_f32 v16, 16.0, v16
    v_add_f32 v17, 16.0, v17
    v_max_f32 v16, 0, v16
    v_add_f32 v10, v10, v16
    v_exp_f32 v18, -v16
    v_max_f32 v17, 0, v17
    v_add_f32 v11, v11, v17
    v_exp_f32 v19, -v17
    v_sub_f32 v176, v176, v16
    v_sub_f32 v177, v177, v16
    v_sub_f32 v178, v178, v16
    v_sub_f32 v179, v179, v16
    v_sub_f32 v184, v184, v16
    v_sub_f32 v185, v185, v16
    v_sub_f32 v186, v186, v16
    v_sub_f32 v187, v187, v16
    v_sub_f32 v180, v180, v17
    v_sub_f32 v181, v181, v17
    v_sub_f32 v182, v182, v17
    v_sub_f32 v183, v183, v17
    v_sub_f32 v188, v188, v17
    v_sub_f32 v189, v189, v17
    v_sub_f32 v190, v190, v17
    v_sub_f32 v191, v191, v17
    v_sub_f32 v160, 0, v10
    v_sub_f32 v161, 0, v10
    v_sub_f32 v162, 0, v10
    v_sub_f32 v163, 0, v10
    v_sub_f32 v192, v192, v16
    v_sub_f32 v193, v193, v16
    v_sub_f32 v194, v194, v16
    v_sub_f32 v195, v195, v16
    v_sub_f32 v200, v200, v16
    v_sub_f32 v201, v201, v16
    v_sub_f32 v202, v202, v16
    v_sub_f32 v203, v203, v16
    v_sub_f32 v164, 0, v11
    v_sub_f32 v165, 0, v11
    v_sub_f32 v166, 0, v11
    v_sub_f32 v167, 0, v11
    v_sub_f32 v196, v196, v17
    v_sub_f32 v197, v197, v17
    v_sub_f32 v198, v198, v17
    v_sub_f32 v199, v199, v17
    v_sub_f32 v204, v204, v17
    v_sub_f32 v205, v205, v17
    v_sub_f32 v206, v206, v17
    v_sub_f32 v207, v207, v17
    v_mul_f32 v168, v168, v18
    v_mul_f32 v169, v169, v18
    v_mul_f32 v170, v170, v18
    v_mul_f32 v171, v171, v18
    v_mul_f32 v172, v172, v19
    v_mul_f32 v173, v173, v19
    v_mul_f32 v174, v174, v19
    v_mul_f32 v175, v175, v19
    v_mul_f32 v64, v64, v18
    v_mul_f32 v65, v65, v18
    v_mul_f32 v66, v66, v18
    v_mul_f32 v67, v67, v18
    v_mul_f32 v68, v68, v19
    v_mul_f32 v69, v69, v19
    v_mul_f32 v70, v70, v19
    v_mul_f32 v71, v71, v19
    v_mul_f32 v72, v72, v18
    v_mul_f32 v73, v73, v18
    v_mul_f32 v74, v74, v18
    v_mul_f32 v75, v75, v18
    v_mul_f32 v76, v76, v19
    v_mul_f32 v77, v77, v19
    v_mul_f32 v78, v78, v19
    v_mul_f32 v79, v79, v19
    v_mul_f32 v80, v80, v18
    v_mul_f32 v81, v81, v18
    v_mul_f32 v82, v82, v18
    v_mul_f32 v83, v83, v18
    v_mul_f32 v84, v84, v19
    v_mul_f32 v85, v85, v19
    v_mul_f32 v86, v86, v19
    v_mul_f32 v87, v87, v19
    v_mul_f32 v88, v88, v18
    v_mul_f32 v89, v89, v18
    v_mul_f32 v90, v90, v18
    v_mul_f32 v91, v91, v18
    v_mul_f32 v92, v92, v19
    v_mul_f32 v93, v93, v19
    v_mul_f32 v94, v94, v19
    v_mul_f32 v95, v95, v19
    v_mul_f32 v96, v96, v18
    v_mul_f32 v97, v97, v18
    v_mul_f32 v98, v98, v18
    v_mul_f32 v99, v99, v18
    v_mul_f32 v100, v100, v19
    v_mul_f32 v101, v101, v19
    v_mul_f32 v102, v102, v19
    v_mul_f32 v103, v103, v19
    v_mul_f32 v104, v104, v18
    v_mul_f32 v105, v105, v18
    v_mul_f32 v106, v106, v18
    v_mul_f32 v107, v107, v18
    v_mul_f32 v108, v108, v19
    v_mul_f32 v109, v109, v19
    v_mul_f32 v110, v110, v19
    v_mul_f32 v111, v111, v19
    v_mul_f32 v112, v112, v18
    v_mul_f32 v113, v113, v18
    v_mul_f32 v114, v114, v18
    v_mul_f32 v115, v115, v18
    v_mul_f32 v116, v116, v19
    v_mul_f32 v117, v117, v19
    v_mul_f32 v118, v118, v19
    v_mul_f32 v119, v119, v19
    v_mul_f32 v120, v120, v18
    v_mul_f32 v121, v121, v18
    v_mul_f32 v122, v122, v18
    v_mul_f32 v123, v123, v18
    v_mul_f32 v124, v124, v19
    v_mul_f32 v125, v125, v19
    v_mul_f32 v126, v126, v19
    v_mul_f32 v127, v127, v19
    v_exp_f32 v20, v176
    v_exp_f32 v21, v177
    v_exp_f32 v22, v178
    v_cvt_pk_bf16_f32 v208, v20, v21
    v_exp_f32 v23, v179
    v_exp_f32 v24, v184
    v_cvt_pk_bf16_f32 v209, v22, v23
    v_exp_f32 v25, v185
    v_exp_f32 v26, v186
    v_cvt_pk_bf16_f32 v210, v24, v25
    v_exp_f32 v27, v187
    v_exp_f32 v20, v180
    v_cvt_pk_bf16_f32 v211, v26, v27
    v_exp_f32 v21, v181
    v_exp_f32 v22, v182
    v_cvt_pk_bf16_f32 v212, v20, v21
    v_exp_f32 v23, v183
    v_exp_f32 v24, v188
    v_cvt_pk_bf16_f32 v213, v22, v23
    v_exp_f32 v25, v189
    v_exp_f32 v26, v190
    v_cvt_pk_bf16_f32 v214, v24, v25
    v_exp_f32 v27, v191
    s_nop 0
    v_cvt_pk_bf16_f32 v215, v26, v27
    s_nop 1
    s_branch L_rareback_32
L_rare_33:
    s_nop 7
    v_max3_f32 v16, v192, v193, v194
    v_max3_f32 v17, v196, v197, v198
    v_max3_f32 v16, v16, v195, v200
    v_max3_f32 v17, v17, v199, v204
    v_max3_f32 v16, v16, v201, v202
    v_max3_f32 v17, v17, v205, v206
    v_max_f32 v16, v16, v203
    v_max_f32 v17, v17, v207
    v_mov_b32 v18, v16
    v_mov_b32 v19, v17
    s_nop 1
    v_permlane16_swap_b32 v16, v18
    v_permlane16_swap_b32 v17, v19
    s_nop 1
    v_max_f32 v16, v16, v18
    v_max_f32 v17, v17, v19
    v_mov_b32 v18, v16
    v_mov_b32 v19, v17
    s_nop 1
    v_permlane32_swap_b32 v16, v18
    v_permlane32_swap_b32 v17, v19
    s_nop 1
    v_max_f32 v16, v16, v18
    v_max_f32 v17, v17, v19
    v_add_f32 v16, 16.0, v16
    v_add_f32 v17, 16.0, v17
    v_max_f32 v16, 0, v16
    v_add_f32 v10, v10, v16
    v_exp_f32 v18, -v16
    v_max_f32 v17, 0, v17
    v_add_f32 v11, v11, v17
    v_exp_f32 v19, -v17
    v_sub_f32 v192, v192, v16
    v_sub_f32 v193, v193, v16
    v_sub_f32 v194, v194, v16
    v_sub_f32 v195, v195, v16
    v_sub_f32 v200, v200, v16
    v_sub_f32 v201, v201, v16
    v_sub_f32 v202, v202, v16
    v_sub_f32 v203, v203, v16
    v_sub_f32 v196, v196, v17
    v_sub_f32 v197, v197, v17
    v_sub_f32 v198, v198, v17
    v_sub_f32 v199, v199, v17
    v_sub_f32 v204, v204, v17
    v_sub_f32 v205, v205, v17
    v_sub_f32 v206, v206, v17
    v_sub_f32 v207, v207, v17
    v_sub_f32 v160, 0, v10
    v_sub_f32 v161, 0, v10
    v_sub_f32 v162, 0, v10
    v_sub_f32 v163, 0, v10
    v_sub_f32 v176, v176, v16
    v_sub_f32 v177, v177, v16
    v_sub_f32 v178, v178, v16
    v_sub_f32 v179, v179, v16
    v_sub_f32 v184, v184, v16
    v_sub_f32 v185, v185, v16
    v_sub_f32 v186, v186, v16
    v_sub_f32 v187, v187, v16
    v_sub_f32 v164, 0, v11
    v_sub_f32 v165, 0, v11
    v_sub_f32 v166, 0, v11
    v_sub_f32 v167, 0, v11
    v_sub_f32 v180, v180, v17
    v_sub_f32 v181, v181, v17
    v_sub_f32 v182, v182, v17
    v_sub_f32 v183, v183, v17
    v_sub_f32 v188, v188, v17
    v_sub_f32 v189, v189, v17
    v_sub_f32 v190, v190, v17
    v_sub_f32 v191, v191, v17
    v_mul_f32 v168, v168, v18
    v_mul_f32 v169, v169, v18
    v_mul_f32 v170, v170, v18
    v_mul_f32 v171, v171, v18
    v_mul_f32 v172, v172, v19
    v_mul_f32 v173, v173, v19
    v_mul_f32 v174, v174, v19
    v_mul_f32 v175, v175, v19
    v_mul_f32 v64, v64, v18
    v_mul_f32 v65, v65, v18
    v_mul_f32 v66, v66, v18
    v_mul_f32 v67, v67, v18
    v_mul_f32 v68, v68, v19
    v_mul_f32 v69, v69, v19
    v_mul_f32 v70, v70, v19
    v_mul_f32 v71, v71, v19
    v_mul_f32 v72, v72, v18
    v_mul_f32 v73, v73, v18
    v_mul_f32 v74, v74, v18
    v_mul_f32 v75, v75, v18
    v_mul_f32 v76, v76, v19
    v_mul_f32 v77, v77, v19
    v_mul_f32 v78, v78, v19
    v_mul_f32 v79, v79, v19
    v_mul_f32 v80, v80, v18
    v_mul_f32 v81, v81, v18
    v_mul_f32 v82, v82, v18
    v_mul_f32 v83, v83, v18
    v_mul_f32 v84, v84, v19
    v_mul_f32 v85, v85, v19
    v_mul_f32 v86, v86, v19
    v_mul_f32 v87, v87, v19
    v_mul_f32 v88, v88, v18
    v_mul_f32 v89, v89, v18
    v_mul_f32 v90, v90, v18
    v_mul_f32 v91, v91, v18
    v_mul_f32 v92, v92, v19
    v_mul_f32 v93, v93, v19
    v_mul_f32 v94, v94, v19
    v_mul_f32 v95, v95, v19
    v_mul_f32 v96, v96, v18
    v_mul_f32 v97, v97, v18
    v_mul_f32 v98, v98, v18
    v_mul_f32 v99, v99, v18
    v_mul_f32 v100, v100, v19
    v_mul_f32 v101, v101, v19
    v_mul_f32 v102, v102, v19
    v_mul_f32 v103, v103, v19
    v_mul_f32 v104, v104, v18
    v_mul_f32 v105, v105, v18
    v_mul_f32 v106, v106, v18
    v_mul_f32 v107, v107, v18
    v_mul_f32 v108, v108, v19
    v_mul_f32 v109, v109, v19
    v_mul_f32 v110, v110, v19
    v_mul_f32 v111, v111, v19
    v_mul_f32 v112, v112, v18
    v_mul_f32 v113, v113, v18
    v_mul_f32 v114, v114, v18
    v_mul_f32 v115, v115, v18
    v_mul_f32 v116, v116, v19
    v_mul_f32 v117, v117, v19
    v_mul_f32 v118, v118, v19
    v_mul_f32 v119, v119, v19
    v_mul_f32 v120, v120, v18
    v_mul_f32 v121, v121, v18
    v_mul_f32 v122, v122, v18
    v_mul_f32 v123, v123, v18
    v_mul_f32 v124, v124, v19
    v_mul_f32 v125, v125, v19
    v_mul_f32 v126, v126, v19
    v_mul_f32 v127, v127, v19
    v_exp_f32 v20, v192
    v_exp_f32 v21, v193
    v_exp_f32 v22, v194
    v_cvt_pk_bf16_f32 v216, v20, v21
    v_exp_f32 v23, v195
    v_exp_f32 v24, v200
    v_cvt_pk_bf16_f32 v217, v22, v23
    v_exp_f32 v25, v201
    v_exp_f32 v26, v202
    v_cvt_pk_bf16_f32 v218, v24, v25
    v_exp_f32 v27, v203
    v_exp_f32 v20, v196
    v_cvt_pk_bf16_f32 v219, v26, v27
    v_exp_f32 v21, v197
    v_exp_f32 v22, v198
    v_cvt_pk_bf16_f32 v220, v20, v21
    v_exp_f32 v23, v199
    v_exp_f32 v24, v204
    v_cvt_pk_bf16_f32 v221, v22, v23
    v_exp_f32 v25, v205
    v_exp_f32 v26, v206
    v_cvt_pk_bf16_f32 v222, v24, v25
    v_exp_f32 v27, v207
    s_nop 0
    v_cvt_pk_bf16_f32 v223, v26, v27
    s_nop 1
    s_branch L_rareback_34
L_rare_35:
    s_nop 7
    v_max3_f32 v16, v176, v177, v178
    v_max3_f32 v17, v180, v181, v182
    v_max3_f32 v16, v16, v179, v184
    v_max3_f32 v17, v17, v183, v188
    v_max3_f32 v16, v16, v185, v186
    v_max3_f32 v17, v17, v189, v190
    v_max_f32 v16, v16, v187
    v_max_f32 v17, v17, v191
    v_mov_b32 v18, v16
    v_mov_b32 v19, v17
    s_nop 1
    v_permlane16_swap_b32 v16, v18
    v_permlane16_swap_b32 v17, v19
    s_nop 1
    v_max_f32 v16, v16, v18
    v_max_f32 v17, v17, v19
    v_mov_b32 v18, v16
    v_mov_b32 v19, v17
    s_nop 1
    v_permlane32_swap_b32 v16, v18
    v_permlane32_swap_b32 v17, v19
    s_nop 1
    v_max_f32 v16, v16, v18
    v_max_f32 v17, v17, v19
    v_add_f32 v16, 16.0, v16
    v_add_f32 v17, 16.0, v17
    v_max_f32 v16, 0, v16
    v_add_f32 v10, v10, v16
    v_exp_f32 v18, -v16
    v_max_f32 v17, 0, v17
    v_add_f32 v11, v11, v17
    v_exp_f32 v19, -v17
    v_sub_f32 v176, v176, v16
    v_sub_f32 v177, v177, v16
    v_sub_f32 v178, v178, v16
    v_sub_f32 v179, v179, v16
    v_sub_f32 v184, v184, v16
    v_sub_f32 v185, v185, v16
    v_sub_f32 v186, v186, v16
    v_sub_f32 v187, v187, v16
    v_sub_f32 v180, v180, v17
    v_sub_f32 v181, v181, v17
    v_sub_f32 v182, v182, v17
    v_sub_f32 v183, v183, v17
    v_sub_f32 v188, v188, v17
    v_sub_f32 v189, v189, v17
    v_sub_f32 v190, v190, v17
    v_sub_f32 v191, v191, v17
    v_sub_f32 v160, 0, v10
    v_sub_f32 v161, 0, v10
    v_sub_f32 v162, 0, v10
    v_sub_f32 v163, 0, v10
    v_sub_f32 v192, v192, v16
    v_sub_f32 v193, v193, v16
    v_sub_f32 v194, v194, v16
    v_sub_f32 v195, v195, v16
    v_sub_f32 v200, v200, v16
    v_sub_f32 v201, v201, v16
    v_sub_f32 v202, v202, v16
    v_sub_f32 v203, v203, v16
    v_sub_f32 v164, 0, v11
    v_sub_f32 v165, 0, v11
    v_sub_f32 v166, 0, v11
    v_sub_f32 v167, 0, v11
    v_sub_f32 v196, v196, v17
    v_sub_f32 v197, v197, v17
    v_sub_f32 v198, v198, v17
    v_sub_f32 v199, v199, v17
    v_sub_f32 v204, v204, v17
    v_sub_f32 v205, v205, v17
    v_sub_f32 v206, v206, v17
    v_sub_f32 v207, v207, v17
    v_mul_f32 v168, v168, v18
    v_mul_f32 v169, v169, v18
    v_mul_f32 v170, v170, v18
    v_mul_f32 v171, v171, v18
    v_mul_f32 v172, v172, v19
    v_mul_f32 v173, v173, v19
    v_mul_f32 v174, v174, v19
    v_mul_f32 v175, v175, v19
    v_mul_f32 v64, v64, v18
    v_mul_f32 v65, v65, v18
    v_mul_f32 v66, v66, v18
    v_mul_f32 v67, v67, v18
    v_mul_f32 v68, v68, v19
    v_mul_f32 v69, v69, v19
    v_mul_f32 v70, v70, v19
    v_mul_f32 v71, v71, v19
    v_mul_f32 v72, v72, v18
    v_mul_f32 v73, v73, v18
    v_mul_f32 v74, v74, v18
    v_mul_f32 v75, v75, v18
    v_mul_f32 v76, v76, v19
    v_mul_f32 v77, v77, v19
    v_mul_f32 v78, v78, v19
    v_mul_f32 v79, v79, v19
    v_mul_f32 v80, v80, v18
    v_mul_f32 v81, v81, v18
    v_mul_f32 v82, v82, v18
    v_mul_f32 v83, v83, v18
    v_mul_f32 v84, v84, v19
    v_mul_f32 v85, v85, v19
    v_mul_f32 v86, v86, v19
    v_mul_f32 v87, v87, v19
    v_mul_f32 v88, v88, v18
    v_mul_f32 v89, v89, v18
    v_mul_f32 v90, v90, v18
    v_mul_f32 v91, v91, v18
    v_mul_f32 v92, v92, v19
    v_mul_f32 v93, v93, v19
    v_mul_f32 v94, v94, v19
    v_mul_f32 v95, v95, v19
    v_mul_f32 v96, v96, v18
    v_mul_f32 v97, v97, v18
    v_mul_f32 v98, v98, v18
    v_mul_f32 v99, v99, v18
    v_mul_f32 v100, v100, v19
    v_mul_f32 v101, v101, v19
    v_mul_f32 v102, v102, v19
    v_mul_f32 v103, v103, v19
    v_mul_f32 v104, v104, v18
    v_mul_f32 v105, v105, v18
    v_mul_f32 v106, v106, v18
    v_mul_f32 v107, v107, v18
    v_mul_f32 v108, v108, v19
    v_mul_f32 v109, v109, v19
    v_mul_f32 v110, v110, v19
    v_mul_f32 v111, v111, v19
    v_mul_f32 v112, v112, v18
    v_mul_f32 v113, v113, v18
    v_mul_f32 v114, v114, v18
    v_mul_f32 v115, v115, v18
    v_mul_f32 v116, v116, v19
    v_mul_f32 v117, v117, v19
    v_mul_f32 v118, v118, v19
    v_mul_f32 v119, v119, v19
    v_mul_f32 v120, v120, v18
    v_mul_f32 v121, v121, v18
    v_mul_f32 v122, v122, v18
    v_mul_f32 v123, v123, v18
    v_mul_f32 v124, v124, v19
    v_mul_f32 v125, v125, v19
    v_mul_f32 v126, v126, v19
    v_mul_f32 v127, v127, v19
    v_exp_f32 v20, v176
    v_exp_f32 v21, v177
    v_exp_f32 v22, v178
    v_cvt_pk_bf16_f32 v208, v20, v21
    v_exp_f32 v23, v179
    v_exp_f32 v24, v184
    v_cvt_pk_bf16_f32 v209, v22, v23
    v_exp_f32 v25, v185
    v_exp_f32 v26, v186
    v_cvt_pk_bf16_f32 v210, v24, v25
    v_exp_f32 v27, v187
    v_exp_f32 v20, v180
    v_cvt_pk_bf16_f32 v211, v26, v27
    v_exp_f32 v21, v181
    v_exp_f32 v22, v182
    v_cvt_pk_bf16_f32 v212, v20, v21
    v_exp_f32 v23, v183
    v_exp_f32 v24, v188
    v_cvt_pk_bf16_f32 v213, v22, v23
    v_exp_f32 v25, v189
    v_exp_f32 v26, v190
    v_cvt_pk_bf16_f32 v214, v24, v25
    v_exp_f32 v27, v191
    s_nop 0
    v_cvt_pk_bf16_f32 v215, v26, v27
    s_nop 1
    s_branch L_rareback_36
L_rare_37:
    s_nop 7
    v_max3_f32 v16, v192, v193, v194
    v_max3_f32 v17, v196, v197, v198
    v_max3_f32 v16, v16, v195, v200
    v_max3_f32 v17, v17, v199, v204
    v_max3_f32 v16, v16, v201, v202
    v_max3_f32 v17, v17, v205, v206
    v_max_f32 v16, v16, v203
    v_max_f32 v17, v17, v207
    v_mov_b32 v18, v16
    v_mov_b32 v19, v17
    s_nop 1
    v_permlane16_swap_b32 v16, v18
    v_permlane16_swap_b32 v17, v19
    s_nop 1
    v_max_f32 v16, v16, v18
    v_max_f32 v17, v17, v19
    v_mov_b32 v18, v16
    v_mov_b32 v19, v17
    s_nop 1
    v_permlane32_swap_b32 v16, v18
    v_permlane32_swap_b32 v17, v19
    s_nop 1
    v_max_f32 v16, v16, v18
    v_max_f32 v17, v17, v19
    v_add_f32 v16, 16.0, v16
    v_add_f32 v17, 16.0, v17
    v_max_f32 v16, 0, v16
    v_add_f32 v10, v10, v16
    v_exp_f32 v18, -v16
    v_max_f32 v17, 0, v17
    v_add_f32 v11, v11, v17
    v_exp_f32 v19, -v17
    v_sub_f32 v192, v192, v16
    v_sub_f32 v193, v193, v16
    v_sub_f32 v194, v194, v16
    v_sub_f32 v195, v195, v16
    v_sub_f32 v200, v200, v16
    v_sub_f32 v201, v201, v16
    v_sub_f32 v202, v202, v16
    v_sub_f32 v203, v203, v16
    v_sub_f32 v196, v196, v17
    v_sub_f32 v197, v197, v17
    v_sub_f32 v198, v198, v17
    v_sub_f32 v199, v199, v17
    v_sub_f32 v204, v204, v17
    v_sub_f32 v205, v205, v17
    v_sub_f32 v206, v206, v17
    v_sub_f32 v207, v207, v17
    v_sub_f32 v160, 0, v10
    v_sub_f32 v161, 0, v10
    v_sub_f32 v162, 0, v10
    v_sub_f32 v163, 0, v10
    v_sub_f32 v176, v176, v16
    v_sub_f32 v177, v177, v16
    v_sub_f32 v178, v178, v16
    v_sub_f32 v179, v179, v16
    v_sub_f32 v184, v184, v16
    v_sub_f32 v185, v185, v16
    v_sub_f32 v186, v186, v16
    v_sub_f32 v187, v187, v16
    v_sub_f32 v164, 0, v11
    v_sub_f32 v165, 0, v11
    v_sub_f32 v166, 0, v11
    v_sub_f32 v167, 0, v11
    v_sub_f32 v180, v180, v17
    v_sub_f32 v181, v181, v17
    v_sub_f32 v182, v182, v17
    v_sub_f32 v183, v183, v17
    v_sub_f32 v188, v188, v17
    v_sub_f32 v189, v189, v17
    v_sub_f32 v190, v190, v17
    v_sub_f32 v191, v191, v17
    v_mul_f32 v168, v168, v18
    v_mul_f32 v169, v169, v18
    v_mul_f32 v170, v170, v18
    v_mul_f32 v171, v171, v18
    v_mul_f32 v172, v172, v19
    v_mul_f32 v173, v173, v19
    v_mul_f32 v174, v174, v19
    v_mul_f32 v175, v175, v19
    v_mul_f32 v64, v64, v18
    v_mul_f32 v65, v65, v18
    v_mul_f32 v66, v66, v18
    v_mul_f32 v67, v67, v18
    v_mul_f32 v68, v68, v19
    v_mul_f32 v69, v69, v19
    v_mul_f32 v70, v70, v19
    v_mul_f32 v71, v71, v19
    v_mul_f32 v72, v72, v18
    v_mul_f32 v73, v73, v18
    v_mul_f32 v74, v74, v18
    v_mul_f32 v75, v75, v18
    v_mul_f32 v76, v76, v19
    v_mul_f32 v77, v77, v19
    v_mul_f32 v78, v78, v19
    v_mul_f32 v79, v79, v19
    v_mul_f32 v80, v80, v18
    v_mul_f32 v81, v81, v18
    v_mul_f32 v82, v82, v18
    v_mul_f32 v83, v83, v18
    v_mul_f32 v84, v84, v19
    v_mul_f32 v85, v85, v19
    v_mul_f32 v86, v86, v19
    v_mul_f32 v87, v87, v19
    v_mul_f32 v88, v88, v18
    v_mul_f32 v89, v89, v18
    v_mul_f32 v90, v90, v18
    v_mul_f32 v91, v91, v18
    v_mul_f32 v92, v92, v19
    v_mul_f32 v93, v93, v19
    v_mul_f32 v94, v94, v19
    v_mul_f32 v95, v95, v19
    v_mul_f32 v96, v96, v18
    v_mul_f32 v97, v97, v18
    v_mul_f32 v98, v98, v18
    v_mul_f32 v99, v99, v18
    v_mul_f32 v100, v100, v19
    v_mul_f32 v101, v101, v19
    v_mul_f32 v102, v102, v19
    v_mul_f32 v103, v103, v19
    v_mul_f32 v104, v104, v18
    v_mul_f32 v105, v105, v18
    v_mul_f32 v106, v106, v18
    v_mul_f32 v107, v107, v18
    v_mul_f32 v108, v108, v19
    v_mul_f32 v109, v109, v19
    v_mul_f32 v110, v110, v19
    v_mul_f32 v111, v111, v19
    v_mul_f32 v112, v112, v18
    v_mul_f32 v113, v113, v18
    v_mul_f32 v114, v114, v18
    v_mul_f32 v115, v115, v18
    v_mul_f32 v116, v116, v19
    v_mul_f32 v117, v117, v19
    v_mul_f32 v118, v118, v19
    v_mul_f32 v119, v119, v19
    v_mul_f32 v120, v120, v18
    v_mul_f32 v121, v121, v18
    v_mul_f32 v122, v122, v18
    v_mul_f32 v123, v123, v18
    v_mul_f32 v124, v124, v19
    v_mul_f32 v125, v125, v19
    v_mul_f32 v126, v126, v19
    v_mul_f32 v127, v127, v19
    v_exp_f32 v20, v192
    v_exp_f32 v21, v193
    v_exp_f32 v22, v194
    v_cvt_pk_bf16_f32 v216, v20, v21
    v_exp_f32 v23, v195
    v_exp_f32 v24, v200
    v_cvt_pk_bf16_f32 v217, v22, v23
    v_exp_f32 v25, v201
    v_exp_f32 v26, v202
    v_cvt_pk_bf16_f32 v218, v24, v25
    v_exp_f32 v27, v203
    v_exp_f32 v20, v196
    v_cvt_pk_bf16_f32 v219, v26, v27
    v_exp_f32 v21, v197
    v_exp_f32 v22, v198
    v_cvt_pk_bf16_f32 v220, v20, v21
    v_exp_f32 v23, v199
    v_exp_f32 v24, v204
    v_cvt_pk_bf16_f32 v221, v22, v23
    v_exp_f32 v25, v205
    v_exp_f32 v26, v206
    v_cvt_pk_bf16_f32 v222, v24, v25
    v_exp_f32 v27, v207
    s_nop 0
    v_cvt_pk_bf16_f32 v223, v26, v27
    s_nop 1
    s_branch L_rareback_38
L_rare_39:
    s_nop 7
    v_max3_f32 v16, v176, v177, v178
    v_max3_f32 v17, v180, v181, v182
    v_max3_f32 v16, v16, v179, v184
    v_max3_f32 v17, v17, v183, v188
    v_max3_f32 v16, v16, v185, v186
    v_max3_f32 v17, v17, v189, v190
    v_max_f32 v16, v16, v187
    v_max_f32 v17, v17, v191
    v_mov_b32 v18, v16
    v_mov_b32 v19, v17
    s_nop 1
    v_permlane16_swap_b32 v16, v18
    v_permlane16_swap_b32 v17, v19
    s_nop 1
    v_max_f32 v16, v16, v18
    v_max_f32 v17, v17, v19
    v_mov_b32 v18, v16
    v_mov_b32 v19, v17
    s_nop 1
    v_permlane32_swap_b32 v16, v18
    v_permlane32_swap_b32 v17, v19
    s_nop 1
    v_max_f32 v16, v16, v18
    v_max_f32 v17, v17, v19
    v_add_f32 v16, 16.0, v16
    v_add_f32 v17, 16.0, v17
    v_max_f32 v16, 0, v16
    v_add_f32 v10, v10, v16
    v_exp_f32 v18, -v16
    v_max_f32 v17, 0, v17
    v_add_f32 v11, v11, v17
    v_exp_f32 v19, -v17
    v_sub_f32 v176, v176, v16
    v_sub_f32 v177, v177, v16
    v_sub_f32 v178, v178, v16
    v_sub_f32 v179, v179, v16
    v_sub_f32 v184, v184, v16
    v_sub_f32 v185, v185, v16
    v_sub_f32 v186, v186, v16
    v_sub_f32 v187, v187, v16
    v_sub_f32 v180, v180, v17
    v_sub_f32 v181, v181, v17
    v_sub_f32 v182, v182, v17
    v_sub_f32 v183, v183, v17
    v_sub_f32 v188, v188, v17
    v_sub_f32 v189, v189, v17
    v_sub_f32 v190, v190, v17
    v_sub_f32 v191, v191, v17
    v_sub_f32 v160, 0, v10
    v_sub_f32 v161, 0, v10
    v_sub_f32 v162, 0, v10
    v_sub_f32 v163, 0, v10
    v_sub_f32 v192, v192, v16
    v_sub_f32 v193, v193, v16
    v_sub_f32 v194, v194, v16
    v_sub_f32 v195, v195, v16
    v_sub_f32 v200, v200, v16
    v_sub_f32 v201, v201, v16
    v_sub_f32 v202, v202, v16
    v_sub_f32 v203, v203, v16
    v_sub_f32 v164, 0, v11
    v_sub_f32 v165, 0, v11
    v_sub_f32 v166, 0, v11
    v_sub_f32 v167, 0, v11
    v_sub_f32 v196, v196, v17
    v_sub_f32 v197, v197, v17
    v_sub_f32 v198, v198, v17
    v_sub_f32 v199, v199, v17
    v_sub_f32 v204, v204, v17
    v_sub_f32 v205, v205, v17
    v_sub_f32 v206, v206, v17
    v_sub_f32 v207, v207, v17
    v_mul_f32 v168, v168, v18
    v_mul_f32 v169, v169, v18
    v_mul_f32 v170, v170, v18
    v_mul_f32 v171, v171, v18
    v_mul_f32 v172, v172, v19
    v_mul_f32 v173, v173, v19
    v_mul_f32 v174, v174, v19
    v_mul_f32 v175, v175, v19
    v_mul_f32 v64, v64, v18
    v_mul_f32 v65, v65, v18
    v_mul_f32 v66, v66, v18
    v_mul_f32 v67, v67, v18
    v_mul_f32 v68, v68, v19
    v_mul_f32 v69, v69, v19
    v_mul_f32 v70, v70, v19
    v_mul_f32 v71, v71, v19
    v_mul_f32 v72, v72, v18
    v_mul_f32 v73, v73, v18
    v_mul_f32 v74, v74, v18
    v_mul_f32 v75, v75, v18
    v_mul_f32 v76, v76, v19
    v_mul_f32 v77, v77, v19
    v_mul_f32 v78, v78, v19
    v_mul_f32 v79, v79, v19
    v_mul_f32 v80, v80, v18
    v_mul_f32 v81, v81, v18
    v_mul_f32 v82, v82, v18
    v_mul_f32 v83, v83, v18
    v_mul_f32 v84, v84, v19
    v_mul_f32 v85, v85, v19
    v_mul_f32 v86, v86, v19
    v_mul_f32 v87, v87, v19
    v_mul_f32 v88, v88, v18
    v_mul_f32 v89, v89, v18
    v_mul_f32 v90, v90, v18
    v_mul_f32 v91, v91, v18
    v_mul_f32 v92, v92, v19
    v_mul_f32 v93, v93, v19
    v_mul_f32 v94, v94, v19
    v_mul_f32 v95, v95, v19
    v_mul_f32 v96, v96, v18
    v_mul_f32 v97, v97, v18
    v_mul_f32 v98, v98, v18
    v_mul_f32 v99, v99, v18
    v_mul_f32 v100, v100, v19
    v_mul_f32 v101, v101, v19
    v_mul_f32 v102, v102, v19
    v_mul_f32 v103, v103, v19
    v_mul_f32 v104, v104, v18
    v_mul_f32 v105, v105, v18
    v_mul_f32 v106, v106, v18
    v_mul_f32 v107, v107, v18
    v_mul_f32 v108, v108, v19
    v_mul_f32 v109, v109, v19
    v_mul_f32 v110, v110, v19
    v_mul_f32 v111, v111, v19
    v_mul_f32 v112, v112, v18
    v_mul_f32 v113, v113, v18
    v_mul_f32 v114, v114, v18
    v_mul_f32 v115, v115, v18
    v_mul_f32 v116, v116, v19
    v_mul_f32 v117, v117, v19
    v_mul_f32 v118, v118, v19
    v_mul_f32 v119, v119, v19
    v_mul_f32 v120, v120, v18
    v_mul_f32 v121, v121, v18
    v_mul_f32 v122, v122, v18
    v_mul_f32 v123, v123, v18
    v_mul_f32 v124, v124, v19
    v_mul_f32 v125, v125, v19
    v_mul_f32 v126, v126, v19
    v_mul_f32 v127, v127, v19
    v_exp_f32 v20, v176
    v_exp_f32 v21, v177
    v_exp_f32 v22, v178
    v_cvt_pk_bf16_f32 v208, v20, v21
    v_exp_f32 v23, v179
    v_exp_f32 v24, v184
    v_cvt_pk_bf16_f32 v209, v22, v23
    v_exp_f32 v25, v185
    v_exp_f32 v26, v186
    v_cvt_pk_bf16_f32 v210, v24, v25
    v_exp_f32 v27, v187
    v_exp_f32 v20, v180
    v_cvt_pk_bf16_f32 v211, v26, v27
    v_exp_f32 v21, v181
    v_exp_f32 v22, v182
    v_cvt_pk_bf16_f32 v212, v20, v21
    v_exp_f32 v23, v183
    v_exp_f32 v24, v188
    v_cvt_pk_bf16_f32 v213, v22, v23
    v_exp_f32 v25, v189
    v_exp_f32 v26, v190
    v_cvt_pk_bf16_f32 v214, v24, v25
    v_exp_f32 v27, v191
    s_nop 0
    v_cvt_pk_bf16_f32 v215, v26, v27
    s_nop 1
    s_branch L_rareback_40
L_rare_41:
    s_nop 7
    v_max3_f32 v16, v192, v193, v194
    v_max3_f32 v17, v196, v197, v198
    v_max3_f32 v16, v16, v195, v200
    v_max3_f32 v17, v17, v199, v204
    v_max3_f32 v16, v16, v201, v202
    v_max3_f32 v17, v17, v205, v206
    v_max_f32 v16, v16, v203
    v_max_f32 v17, v17, v207
    v_mov_b32 v18, v16
    v_mov_b32 v19, v17
    s_nop 1
    v_permlane16_swap_b32 v16, v18
    v_permlane16_swap_b32 v17, v19
    s_nop 1
    v_max_f32 v16, v16, v18
    v_max_f32 v17, v17, v19
    v_mov_b32 v18, v16
    v_mov_b32 v19, v17
    s_nop 1
    v_permlane32_swap_b32 v16, v18
    v_permlane32_swap_b32 v17, v19
    s_nop 1
    v_max_f32 v16, v16, v18
    v_max_f32 v17, v17, v19
    v_add_f32 v16, 16.0, v16
    v_add_f32 v17, 16.0, v17
    v_max_f32 v16, 0, v16
    v_add_f32 v10, v10, v16
    v_exp_f32 v18, -v16
    v_max_f32 v17, 0, v17
    v_add_f32 v11, v11, v17
    v_exp_f32 v19, -v17
    v_sub_f32 v192, v192, v16
    v_sub_f32 v193, v193, v16
    v_sub_f32 v194, v194, v16
    v_sub_f32 v195, v195, v16
    v_sub_f32 v200, v200, v16
    v_sub_f32 v201, v201, v16
    v_sub_f32 v202, v202, v16
    v_sub_f32 v203, v203, v16
    v_sub_f32 v196, v196, v17
    v_sub_f32 v197, v197, v17
    v_sub_f32 v198, v198, v17
    v_sub_f32 v199, v199, v17
    v_sub_f32 v204, v204, v17
    v_sub_f32 v205, v205, v17
    v_sub_f32 v206, v206, v17
    v_sub_f32 v207, v207, v17
    v_sub_f32 v160, 0, v10
    v_sub_f32 v161, 0, v10
    v_sub_f32 v162, 0, v10
    v_sub_f32 v163, 0, v10
    v_sub_f32 v176, v176, v16
    v_sub_f32 v177, v177, v16
    v_sub_f32 v178, v178, v16
    v_sub_f32 v179, v179, v16
    v_sub_f32 v184, v184, v16
    v_sub_f32 v185, v185, v16
    v_sub_f32 v186, v186, v16
    v_sub_f32 v187, v187, v16
    v_sub_f32 v164, 0, v11
    v_sub_f32 v165, 0, v11
    v_sub_f32 v166, 0, v11
    v_sub_f32 v167, 0, v11
    v_sub_f32 v180, v180, v17
    v_sub_f32 v181, v181, v17
    v_sub_f32 v182, v182, v17
    v_sub_f32 v183, v183, v17
    v_sub_f32 v188, v188, v17
    v_sub_f32 v189, v189, v17
    v_sub_f32 v190, v190, v17
    v_sub_f32 v191, v191, v17
    v_mul_f32 v168, v168, v18
    v_mul_f32 v169, v169, v18
    v_mul_f32 v170, v170, v18
    v_mul_f32 v171, v171, v18
    v_mul_f32 v172, v172, v19
    v_mul_f32 v173, v173, v19
    v_mul_f32 v174, v174, v19
    v_mul_f32 v175, v175, v19
    v_mul_f32 v64, v64, v18
    v_mul_f32 v65, v65, v18
    v_mul_f32 v66, v66, v18
    v_mul_f32 v67, v67, v18
    v_mul_f32 v68, v68, v19
    v_mul_f32 v69, v69, v19
    v_mul_f32 v70, v70, v19
    v_mul_f32 v71, v71, v19
    v_mul_f32 v72, v72, v18
    v_mul_f32 v73, v73, v18
    v_mul_f32 v74, v74, v18
    v_mul_f32 v75, v75, v18
    v_mul_f32 v76, v76, v19
    v_mul_f32 v77, v77, v19
    v_mul_f32 v78, v78, v19
    v_mul_f32 v79, v79, v19
    v_mul_f32 v80, v80, v18
    v_mul_f32 v81, v81, v18
    v_mul_f32 v82, v82, v18
    v_mul_f32 v83, v83, v18
    v_mul_f32 v84, v84, v19
    v_mul_f32 v85, v85, v19
    v_mul_f32 v86, v86, v19
    v_mul_f32 v87, v87, v19
    v_mul_f32 v88, v88, v18
    v_mul_f32 v89, v89, v18
    v_mul_f32 v90, v90, v18
    v_mul_f32 v91, v91, v18
    v_mul_f32 v92, v92, v19
    v_mul_f32 v93, v93, v19
    v_mul_f32 v94, v94, v19
    v_mul_f32 v95, v95, v19
    v_mul_f32 v96, v96, v18
    v_mul_f32 v97, v97, v18
    v_mul_f32 v98, v98, v18
    v_mul_f32 v99, v99, v18
    v_mul_f32 v100, v100, v19
    v_mul_f32 v101, v101, v19
    v_mul_f32 v102, v102, v19
    v_mul_f32 v103, v103, v19
    v_mul_f32 v104, v104, v18
    v_mul_f32 v105, v105, v18
    v_mul_f32 v106, v106, v18
    v_mul_f32 v107, v107, v18
    v_mul_f32 v108, v108, v19
    v_mul_f32 v109, v109, v19
    v_mul_f32 v110, v110, v19
    v_mul_f32 v111, v111, v19
    v_mul_f32 v112, v112, v18
    v_mul_f32 v113, v113, v18
    v_mul_f32 v114, v114, v18
    v_mul_f32 v115, v115, v18
    v_mul_f32 v116, v116, v19
    v_mul_f32 v117, v117, v19
    v_mul_f32 v118, v118, v19
    v_mul_f32 v119, v119, v19
    v_mul_f32 v120, v120, v18
    v_mul_f32 v121, v121, v18
    v_mul_f32 v122, v122, v18
    v_mul_f32 v123, v123, v18
    v_mul_f32 v124, v124, v19
    v_mul_f32 v125, v125, v19
    v_mul_f32 v126, v126, v19
    v_mul_f32 v127, v127, v19
    v_exp_f32 v20, v192
    v_exp_f32 v21, v193
    v_exp_f32 v22, v194
    v_cvt_pk_bf16_f32 v216, v20, v21
    v_exp_f32 v23, v195
    v_exp_f32 v24, v200
    v_cvt_pk_bf16_f32 v217, v22, v23
    v_exp_f32 v25, v201
    v_exp_f32 v26, v202
    v_cvt_pk_bf16_f32 v218, v24, v25
    v_exp_f32 v27, v203
    v_exp_f32 v20, v196
    v_cvt_pk_bf16_f32 v219, v26, v27
    v_exp_f32 v21, v197
    v_exp_f32 v22, v198
    v_cvt_pk_bf16_f32 v220, v20, v21
    v_exp_f32 v23, v199
    v_exp_f32 v24, v204
    v_cvt_pk_bf16_f32 v221, v22, v23
    v_exp_f32 v25, v205
    v_exp_f32 v26, v206
    v_cvt_pk_bf16_f32 v222, v24, v25
    v_exp_f32 v27, v207
    s_nop 0
    v_cvt_pk_bf16_f32 v223, v26, v27
    s_nop 1
    s_branch L_rareback_42
L_rare_44:
    s_nop 7
    v_max3_f32 v16, v176, v177, v178
    v_max3_f32 v17, v180, v181, v182
    v_max3_f32 v16, v16, v179, v184
    v_max3_f32 v17, v17, v183, v188
    v_max3_f32 v16, v16, v185, v186
    v_max3_f32 v17, v17, v189, v190
    v_max_f32 v16, v16, v187
    v_max_f32 v17, v17, v191
    v_mov_b32 v18, v16
    v_mov_b32 v19, v17
    s_nop 1
    v_permlane16_swap_b32 v16, v18
    v_permlane16_swap_b32 v17, v19
    s_nop 1
    v_max_f32 v16, v16, v18
    v_max_f32 v17, v17, v19
    v_mov_b32 v18, v16
    v_mov_b32 v19, v17
    s_nop 1
    v_permlane32_swap_b32 v16, v18
    v_permlane32_swap_b32 v17, v19
    s_nop 1
    v_max_f32 v16, v16, v18
    v_max_f32 v17, v17, v19
    v_add_f32 v16, 16.0, v16
    v_add_f32 v17, 16.0, v17
    v_max_f32 v16, 0, v16
    v_add_f32 v10, v10, v16
    v_exp_f32 v18, -v16
    v_max_f32 v17, 0, v17
    v_add_f32 v11, v11, v17
    v_exp_f32 v19, -v17
    v_sub_f32 v176, v176, v16
    v_sub_f32 v177, v177, v16
    v_sub_f32 v178, v178, v16
    v_sub_f32 v179, v179, v16
    v_sub_f32 v184, v184, v16
    v_sub_f32 v185, v185, v16
    v_sub_f32 v186, v186, v16
    v_sub_f32 v187, v187, v16
    v_sub_f32 v180, v180, v17
    v_sub_f32 v181, v181, v17
    v_sub_f32 v182, v182, v17
    v_sub_f32 v183, v183, v17
    v_sub_f32 v188, v188, v17
    v_sub_f32 v189, v189, v17
    v_sub_f32 v190, v190, v17
    v_sub_f32 v191, v191, v17
    v_sub_f32 v160, 0, v10
    v_sub_f32 v161, 0, v10
    v_sub_f32 v162, 0, v10
    v_sub_f32 v163, 0, v10
    v_sub_f32 v192, v192, v16
    v_sub_f32 v193, v193, v16
    v_sub_f32 v194, v194, v16
    v_sub_f32 v195, v195, v16
    v_sub_f32 v200, v200, v16
    v_sub_f32 v201, v201, v16
    v_sub_f32 v202, v202, v16
    v_sub_f32 v203, v203, v16
    v_sub_f32 v164, 0, v11
    v_sub_f32 v165, 0, v11
    v_sub_f32 v166, 0, v11
    v_sub_f32 v167, 0, v11
    v_sub_f32 v196, v196, v17
    v_sub_f32 v197, v197, v17
    v_sub_f32 v198, v198, v17
    v_sub_f32 v199, v199, v17
    v_sub_f32 v204, v204, v17
    v_sub_f32 v205, v205, v17
    v_sub_f32 v206, v206, v17
    v_sub_f32 v207, v207, v17
    v_mul_f32 v168, v168, v18
    v_mul_f32 v169, v169, v18
    v_mul_f32 v170, v170, v18
    v_mul_f32 v171, v171, v18
    v_mul_f32 v172, v172, v19
    v_mul_f32 v173, v173, v19
    v_mul_f32 v174, v174, v19
    v_mul_f32 v175, v175, v19
    v_mul_f32 v64, v64, v18
    v_mul_f32 v65, v65, v18
    v_mul_f32 v66, v66, v18
    v_mul_f32 v67, v67, v18
    v_mul_f32 v68, v68, v19
    v_mul_f32 v69, v69, v19
    v_mul_f32 v70, v70, v19
    v_mul_f32 v71, v71, v19
    v_mul_f32 v72, v72, v18
    v_mul_f32 v73, v73, v18
    v_mul_f32 v74, v74, v18
    v_mul_f32 v75, v75, v18
    v_mul_f32 v76, v76, v19
    v_mul_f32 v77, v77, v19
    v_mul_f32 v78, v78, v19
    v_mul_f32 v79, v79, v19
    v_mul_f32 v80, v80, v18
    v_mul_f32 v81, v81, v18
    v_mul_f32 v82, v82, v18
    v_mul_f32 v83, v83, v18
    v_mul_f32 v84, v84, v19
    v_mul_f32 v85, v85, v19
    v_mul_f32 v86, v86, v19
    v_mul_f32 v87, v87, v19
    v_mul_f32 v88, v88, v18
    v_mul_f32 v89, v89, v18
    v_mul_f32 v90, v90, v18
    v_mul_f32 v91, v91, v18
    v_mul_f32 v92, v92, v19
    v_mul_f32 v93, v93, v19
    v_mul_f32 v94, v94, v19
    v_mul_f32 v95, v95, v19
    v_mul_f32 v96, v96, v18
    v_mul_f32 v97, v97, v18
    v_mul_f32 v98, v98, v18
    v_mul_f32 v99, v99, v18
    v_mul_f32 v100, v100, v19
    v_mul_f32 v101, v101, v19
    v_mul_f32 v102, v102, v19
    v_mul_f32 v103, v103, v19
    v_mul_f32 v104, v104, v18
    v_mul_f32 v105, v105, v18
    v_mul_f32 v106, v106, v18
    v_mul_f32 v107, v107, v18
    v_mul_f32 v108, v108, v19
    v_mul_f32 v109, v109, v19
    v_mul_f32 v110, v110, v19
    v_mul_f32 v111, v111, v19
    v_mul_f32 v112, v112, v18
    v_mul_f32 v113, v113, v18
    v_mul_f32 v114, v114, v18
    v_mul_f32 v115, v115, v18
    v_mul_f32 v116, v116, v19
    v_mul_f32 v117, v117, v19
    v_mul_f32 v118, v118, v19
    v_mul_f32 v119, v119, v19
    v_mul_f32 v120, v120, v18
    v_mul_f32 v121, v121, v18
    v_mul_f32 v122, v122, v18
    v_mul_f32 v123, v123, v18
    v_mul_f32 v124, v124, v19
    v_mul_f32 v125, v125, v19
    v_mul_f32 v126, v126, v19
    v_mul_f32 v127, v127, v19
    v_exp_f32 v20, v176
    v_exp_f32 v21, v177
    v_exp_f32 v22, v178
    v_cvt_pk_bf16_f32 v208, v20, v21
    v_exp_f32 v23, v179
    v_exp_f32 v24, v184
    v_cvt_pk_bf16_f32 v209, v22, v23
    v_exp_f32 v25, v185
    v_exp_f32 v26, v186
    v_cvt_pk_bf16_f32 v210, v24, v25
    v_exp_f32 v27, v187
    v_exp_f32 v20, v180
    v_cvt_pk_bf16_f32 v211, v26, v27
    v_exp_f32 v21, v181
    v_exp_f32 v22, v182
    v_cvt_pk_bf16_f32 v212, v20, v21
    v_exp_f32 v23, v183
    v_exp_f32 v24, v188
    v_cvt_pk_bf16_f32 v213, v22, v23
    v_exp_f32 v25, v189
    v_exp_f32 v26, v190
    v_cvt_pk_bf16_f32 v214, v24, v25
    v_exp_f32 v27, v191
    s_nop 0
    v_cvt_pk_bf16_f32 v215, v26, v27
    s_nop 1
    s_branch L_rareback_45
L_mask_46:
    v_add_u32 v16, s34, v8
    v_cmp_le_i32 s[46:47], 0, v16
    v_cmp_le_i32 s[48:49], 1, v16
    v_cmp_le_i32 s[50:51], 2, v16
    v_cmp_le_i32 s[52:53], 3, v16
    v_cndmask_b32 v192, v9, v192, s[46:47]
    v_cmp_le_i32 s[46:47], -16, v16
    v_cndmask_b32 v193, v9, v193, s[48:49]
    v_cmp_le_i32 s[48:49], -15, v16
    v_cndmask_b32 v194, v9, v194, s[50:51]
    v_cmp_le_i32 s[50:51], -14, v16
    v_cndmask_b32 v195, v9, v195, s[52:53]
    v_cmp_le_i32 s[52:53], -13, v16
    v_cndmask_b32 v196, v9, v196, s[46:47]
    v_cmp_le_i32 s[46:47], 16, v16
    v_cndmask_b32 v197, v9, v197, s[48:49]
    v_cmp_le_i32 s[48:49], 17, v16
    v_cndmask_b32 v198, v9, v198, s[50:51]
    v_cmp_le_i32 s[50:51], 18, v16
    v_cndmask_b32 v199, v9, v199, s[52:53]
    v_cmp_le_i32 s[52:53], 19, v16
    v_cndmask_b32 v200, v9, v200, s[46:47]
    v_cmp_le_i32 s[46:47], 0, v16
    v_cndmask_b32 v201, v9, v201, s[48:49]
    v_cmp_le_i32 s[48:49], 1, v16
    v_cndmask_b32 v202, v9, v202, s[50:51]
    v_cmp_le_i32 s[50:51], 2, v16
    v_cndmask_b32 v203, v9, v203, s[52:53]
    v_cmp_le_i32 s[52:53], 3, v16
    v_cndmask_b32 v204, v9, v204, s[46:47]
    s_nop 0
    v_cndmask_b32 v205, v9, v205, s[48:49]
    s_nop 0
    v_cndmask_b32 v206, v9, v206, s[50:51]
    s_nop 0
    v_cndmask_b32 v207, v9, v207, s[52:53]
    s_branch L_maskback_47
L_rare_48:
    s_nop 7
    v_max3_f32 v16, v192, v193, v194
    v_max3_f32 v17, v196, v197, v198
    v_max3_f32 v16, v16, v195, v200
    v_max3_f32 v17, v17, v199, v204
    v_max3_f32 v16, v16, v201, v202
    v_max3_f32 v17, v17, v205, v206
    v_max_f32 v16, v16, v203
    v_max_f32 v17, v17, v207
    v_mov_b32 v18, v16
    v_mov_b32 v19, v17
    s_nop 1
    v_permlane16_swap_b32 v16, v18
    v_permlane16_swap_b32 v17, v19
    s_nop 1
    v_max_f32 v16, v16, v18
    v_max_f32 v17, v17, v19
    v_mov_b32 v18, v16
    v_mov_b32 v19, v17
    s_nop 1
    v_permlane32_swap_b32 v16, v18
    v_permlane32_swap_b32 v17, v19
    s_nop 1
    v_max_f32 v16, v16, v18
    v_max_f32 v17, v17, v19
    v_add_f32 v16, 16.0, v16
    v_add_f32 v17, 16.0, v17
    v_max_f32 v16, 0, v16
    v_add_f32 v10, v10, v16
    v_exp_f32 v18, -v16
    v_max_f32 v17, 0, v17
    v_add_f32 v11, v11, v17
    v_exp_f32 v19, -v17
    v_sub_f32 v192, v192, v16
    v_sub_f32 v193, v193, v16
    v_sub_f32 v194, v194, v16
    v_sub_f32 v195, v195, v16
    v_sub_f32 v200, v200, v16
    v_sub_f32 v201, v201, v16
    v_sub_f32 v202, v202, v16
    v_sub_f32 v203, v203, v16
    v_sub_f32 v196, v196, v17
    v_sub_f32 v197, v197, v17
    v_sub_f32 v198, v198, v17
    v_sub_f32 v199, v199, v17
    v_sub_f32 v204, v204, v17
    v_sub_f32 v205, v205, v17
    v_sub_f32 v206, v206, v17
    v_sub_f32 v207, v207, v17
    v_sub_f32 v160, 0, v10
    v_sub_f32 v161, 0, v10
    v_sub_f32 v162, 0, v10
    v_sub_f32 v163, 0, v10
    v_sub_f32 v176, v176, v16
    v_sub_f32 v177, v177, v16
    v_sub_f32 v178, v178, v16
    v_sub_f32 v179, v179, v16
    v_sub_f32 v184, v184, v16
    v_sub_f32 v185, v185, v16
    v_sub_f32 v186, v186, v16
    v_sub_f32 v187, v187, v16
    v_sub_f32 v164, 0, v11
    v_sub_f32 v165, 0, v11
    v_sub_f32 v166, 0, v11
    v_sub_f32 v167, 0, v11
    v_sub_f32 v180, v180, v17
    v_sub_f32 v181, v181, v17
    v_sub_f32 v182, v182, v17
    v_sub_f32 v183, v183, v17
    v_sub_f32 v188, v188, v17
    v_sub_f32 v189, v189, v17
    v_sub_f32 v190, v190, v17
    v_sub_f32 v191, v191, v17
    v_mul_f32 v168, v168, v18
    v_mul_f32 v169, v169, v18
    v_mul_f32 v170, v170, v18
    v_mul_f32 v171, v171, v18
    v_mul_f32 v172, v172, v19
    v_mul_f32 v173, v173, v19
    v_mul_f32 v174, v174, v19
    v_mul_f32 v175, v175, v19
    v_mul_f32 v64, v64, v18
    v_mul_f32 v65, v65, v18
    v_mul_f32 v66, v66, v18
    v_mul_f32 v67, v67, v18
    v_mul_f32 v68, v68, v19
    v_mul_f32 v69, v69, v19
    v_mul_f32 v70, v70, v19
    v_mul_f32 v71, v71, v19
    v_mul_f32 v72, v72, v18
    v_mul_f32 v73, v73, v18
    v_mul_f32 v74, v74, v18
    v_mul_f32 v75, v75, v18
    v_mul_f32 v76, v76, v19
    v_mul_f32 v77, v77, v19
    v_mul_f32 v78, v78, v19
    v_mul_f32 v79, v79, v19
    v_mul_f32 v80, v80, v18
    v_mul_f32 v81, v81, v18
    v_mul_f32 v82, v82, v18
    v_mul_f32 v83, v83, v18
    v_mul_f32 v84, v84, v19
    v_mul_f32 v85, v85, v19
    v_mul_f32 v86, v86, v19
    v_mul_f32 v87, v87, v19
    v_mul_f32 v88, v88, v18
    v_mul_f32 v89, v89, v18
    v_mul_f32 v90, v90, v18
    v_mul_f32 v91, v91, v18
    v_mul_f32 v92, v92, v19
    v_mul_f32 v93, v93, v19
    v_mul_f32 v94, v94, v19
    v_mul_f32 v95, v95, v19
    v_mul_f32 v96, v96, v18
    v_mul_f32 v97, v97, v18
    v_mul_f32 v98, v98, v18
    v_mul_f32 v99, v99, v18
    v_mul_f32 v100, v100, v19
    v_mul_f32 v101, v101, v19
    v_mul_f32 v102, v102, v19
    v_mul_f32 v103, v103, v19
    v_mul_f32 v104, v104, v18
    v_mul_f32 v105, v105, v18
    v_mul_f32 v106, v106, v18
    v_mul_f32 v107, v107, v18
    v_mul_f32 v108, v108, v19
    v_mul_f32 v109, v109, v19
    v_mul_f32 v110, v110, v19
    v_mul_f32 v111, v111, v19
    v_mul_f32 v112, v112, v18
    v_mul_f32 v113, v113, v18
    v_mul_f32 v114, v114, v18
    v_mul_f32 v115, v115, v18
    v_mul_f32 v116, v116, v19
    v_mul_f32 v117, v117, v19
    v_mul_f32 v118, v118, v19
    v_mul_f32 v119, v119, v19
    v_mul_f32 v120, v120, v18
    v_mul_f32 v121, v121, v18
    v_mul_f32 v122, v122, v18
    v_mul_f32 v123, v123, v18
    v_mul_f32 v124, v124, v19
    v_mul_f32 v125, v125, v19
    v_mul_f32 v126, v126, v19
    v_mul_f32 v127, v127, v19
    v_exp_f32 v20, v192
    v_exp_f32 v21, v193
    v_exp_f32 v22, v194
    v_cvt_pk_bf16_f32 v216, v20, v21
    v_exp_f32 v23, v195
    v_exp_f32 v24, v200
    v_cvt_pk_bf16_f32 v217, v22, v23
    v_exp_f32 v25, v201
    v_exp_f32 v26, v202
    v_cvt_pk_bf16_f32 v218, v24, v25
    v_exp_f32 v27, v203
    v_exp_f32 v20, v196
    v_cvt_pk_bf16_f32 v219, v26, v27
    v_exp_f32 v21, v197
    v_exp_f32 v22, v198
    v_cvt_pk_bf16_f32 v220, v20, v21
    v_exp_f32 v23, v199
    v_exp_f32 v24, v204
    v_cvt_pk_bf16_f32 v221, v22, v23
    v_exp_f32 v25, v205
    v_exp_f32 v26, v206
    v_cvt_pk_bf16_f32 v222, v24, v25
    v_exp_f32 v27, v207
    s_nop 0
    v_cvt_pk_bf16_f32 v223, v26, v27
    s_nop 1
    s_branch L_rareback_49
L_mask_50:
    v_add_u32 v16, s34, v8
    v_cmp_le_i32 s[46:47], 0, v16
    v_cmp_le_i32 s[48:49], 1, v16
    v_cmp_le_i32 s[50:51], 2, v16
    v_cmp_le_i32 s[52:53], 3, v16
    v_cndmask_b32 v176, v9, v176, s[46:47]
    v_cmp_le_i32 s[46:47], -16, v16
    v_cndmask_b32 v177, v9, v177, s[48:49]
    v_cmp_le_i32 s[48:49], -15, v16
    v_cndmask_b32 v178, v9, v178, s[50:51]
    v_cmp_le_i32 s[50:51], -14, v16
    v_cndmask_b32 v179, v9, v179, s[52:53]
    v_cmp_le_i32 s[52:53], -13, v16
    v_cndmask_b32 v180, v9, v180, s[46:47]
    v_cmp_le_i32 s[46:47], 16, v16
    v_cndmask_b32 v181, v9, v181, s[48:49]
    v_cmp_le_i32 s[48:49], 17, v16
    v_cndmask_b32 v182, v9, v182, s[50:51]
    v_cmp_le_i32 s[50:51], 18, v16
    v_cndmask_b32 v183, v9, v183, s[52:53]
    v_cmp_le_i32 s[52:53], 19, v16
    v_cndmask_b32 v184, v9, v184, s[46:47]
    v_cmp_le_i32 s[46:47], 0, v16
    v_cndmask_b32 v185, v9, v185, s[48:49]
    v_cmp_le_i32 s[48:49], 1, v16
    v_cndmask_b32 v186, v9, v186, s[50:51]
    v_cmp_le_i32 s[50:51], 2, v16
    v_cndmask_b32 v187, v9, v187, s[52:53]
    v_cmp_le_i32 s[52:53], 3, v16
    v_cndmask_b32 v188, v9, v188, s[46:47]
    s_nop 0
    v_cndmask_b32 v189, v9, v189, s[48:49]
    s_nop 0
    v_cndmask_b32 v190, v9, v190, s[50:51]
    s_nop 0
    v_cndmask_b32 v191, v9, v191, s[52:53]
    s_branch L_maskback_51
L_rare_52:
    s_nop 7
    v_max3_f32 v16, v176, v177, v178
    v_max3_f32 v17, v180, v181, v182
    v_max3_f32 v16, v16, v179, v184
    v_max3_f32 v17, v17, v183, v188
    v_max3_f32 v16, v16, v185, v186
    v_max3_f32 v17, v17, v189, v190
    v_max_f32 v16, v16, v187
    v_max_f32 v17, v17, v191
    v_mov_b32 v18, v16
    v_mov_b32 v19, v17
    s_nop 1
    v_permlane16_swap_b32 v16, v18
    v_permlane16_swap_b32 v17, v19
    s_nop 1
    v_max_f32 v16, v16, v18
    v_max_f32 v17, v17, v19
    v_mov_b32 v18, v16
    v_mov_b32 v19, v17
    s_nop 1
    v_permlane32_swap_b32 v16, v18
    v_permlane32_swap_b32 v17, v19
    s_nop 1
    v_max_f32 v16, v16, v18
    v_max_f32 v17, v17, v19
    v_add_f32 v16, 16.0, v16
    v_add_f32 v17, 16.0, v17
    v_max_f32 v16, 0, v16
    v_add_f32 v10, v10, v16
    v_exp_f32 v18, -v16
    v_max_f32 v17, 0, v17
    v_add_f32 v11, v11, v17
    v_exp_f32 v19, -v17
    v_sub_f32 v176, v176, v16
    v_sub_f32 v177, v177, v16
    v_sub_f32 v178, v178, v16
    v_sub_f32 v179, v179, v16
    v_sub_f32 v184, v184, v16
    v_sub_f32 v185, v185, v16
    v_sub_f32 v186, v186, v16
    v_sub_f32 v187, v187, v16
    v_sub_f32 v180, v180, v17
    v_sub_f32 v181, v181, v17
    v_sub_f32 v182, v182, v17
    v_sub_f32 v183, v183, v17
    v_sub_f32 v188, v188, v17
    v_sub_f32 v189, v189, v17
    v_sub_f32 v190, v190, v17
    v_sub_f32 v191, v191, v17
    v_sub_f32 v160, 0, v10
    v_sub_f32 v161, 0, v10
    v_sub_f32 v162, 0, v10
    v_sub_f32 v163, 0, v10
    v_sub_f32 v192, v192, v16
    v_sub_f32 v193, v193, v16
    v_sub_f32 v194, v194, v16
    v_sub_f32 v195, v195, v16
    v_sub_f32 v200, v200, v16
    v_sub_f32 v201, v201, v16
    v_sub_f32 v202, v202, v16
    v_sub_f32 v203, v203, v16
    v_sub_f32 v164, 0, v11
    v_sub_f32 v165, 0, v11
    v_sub_f32 v166, 0, v11
    v_sub_f32 v167, 0, v11
    v_sub_f32 v196, v196, v17
    v_sub_f32 v197, v197, v17
    v_sub_f32 v198, v198, v17
    v_sub_f32 v199, v199, v17
    v_sub_f32 v204, v204, v17
    v_sub_f32 v205, v205, v17
    v_sub_f32 v206, v206, v17
    v_sub_f32 v207, v207, v17
    v_mul_f32 v168, v168, v18
    v_mul_f32 v169, v169, v18
    v_mul_f32 v170, v170, v18
    v_mul_f32 v171, v171, v18
    v_mul_f32 v172, v172, v19
    v_mul_f32 v173, v173, v19
    v_mul_f32 v174, v174, v19
    v_mul_f32 v175, v175, v19
    v_mul_f32 v64, v64, v18
    v_mul_f32 v65, v65, v18
    v_mul_f32 v66, v66, v18
    v_mul_f32 v67, v67, v18
    v_mul_f32 v68, v68, v19
    v_mul_f32 v69, v69, v19
    v_mul_f32 v70, v70, v19
    v_mul_f32 v71, v71, v19
    v_mul_f32 v72, v72, v18
    v_mul_f32 v73, v73, v18
    v_mul_f32 v74, v74, v18
    v_mul_f32 v75, v75, v18
    v_mul_f32 v76, v76, v19
    v_mul_f32 v77, v77, v19
    v_mul_f32 v78, v78, v19
    v_mul_f32 v79, v79, v19
    v_mul_f32 v80, v80, v18
    v_mul_f32 v81, v81, v18
    v_mul_f32 v82, v82, v18
    v_mul_f32 v83, v83, v18
    v_mul_f32 v84, v84, v19
    v_mul_f32 v85, v85, v19
    v_mul_f32 v86, v86, v19
    v_mul_f32 v87, v87, v19
    v_mul_f32 v88, v88, v18
    v_mul_f32 v89, v89, v18
    v_mul_f32 v90, v90, v18
    v_mul_f32 v91, v91, v18
    v_mul_f32 v92, v92, v19
    v_mul_f32 v93, v93, v19
    v_mul_f32 v94, v94, v19
    v_mul_f32 v95, v95, v19
    v_mul_f32 v96, v96, v18
    v_mul_f32 v97, v97, v18
    v_mul_f32 v98, v98, v18
    v_mul_f32 v99, v99, v18
    v_mul_f32 v100, v100, v19
    v_mul_f32 v101, v101, v19
    v_mul_f32 v102, v102, v19
    v_mul_f32 v103, v103, v19
    v_mul_f32 v104, v104, v18
    v_mul_f32 v105, v105, v18
    v_mul_f32 v106, v106, v18
    v_mul_f32 v107, v107, v18
    v_mul_f32 v108, v108, v19
    v_mul_f32 v109, v109, v19
    v_mul_f32 v110, v110, v19
    v_mul_f32 v111, v111, v19
    v_mul_f32 v112, v112, v18
    v_mul_f32 v113, v113, v18
    v_mul_f32 v114, v114, v18
    v_mul_f32 v115, v115, v18
    v_mul_f32 v116, v116, v19
    v_mul_f32 v117, v117, v19
    v_mul_f32 v118, v118, v19
    v_mul_f32 v119, v119, v19
    v_mul_f32 v120, v120, v18
    v_mul_f32 v121, v121, v18
    v_mul_f32 v122, v122, v18
    v_mul_f32 v123, v123, v18
    v_mul_f32 v124, v124, v19
    v_mul_f32 v125, v125, v19
    v_mul_f32 v126, v126, v19
    v_mul_f32 v127, v127, v19
    v_exp_f32 v20, v176
    v_exp_f32 v21, v177
    v_exp_f32 v22, v178
    v_cvt_pk_bf16_f32 v208, v20, v21
    v_exp_f32 v23, v179
    v_exp_f32 v24, v184
    v_cvt_pk_bf16_f32 v209, v22, v23
    v_exp_f32 v25, v185
    v_exp_f32 v26, v186
    v_cvt_pk_bf16_f32 v210, v24, v25
    v_exp_f32 v27, v187
    v_exp_f32 v20, v180
    v_cvt_pk_bf16_f32 v211, v26, v27
    v_exp_f32 v21, v181
    v_exp_f32 v22, v182
    v_cvt_pk_bf16_f32 v212, v20, v21
    v_exp_f32 v23, v183
    v_exp_f32 v24, v188
    v_cvt_pk_bf16_f32 v213, v22, v23
    v_exp_f32 v25, v189
    v_exp_f32 v26, v190
    v_cvt_pk_bf16_f32 v214, v24, v25
    v_exp_f32 v27, v191
    s_nop 0
    v_cvt_pk_bf16_f32 v215, v26, v27
    s_nop 1
    s_branch L_rareback_53
L_rare_57:
    s_nop 7
    v_max3_f32 v16, v192, v193, v194
    v_max3_f32 v17, v196, v197, v198
    v_max3_f32 v16, v16, v195, v200
    v_max3_f32 v17, v17, v199, v204
    v_max3_f32 v16, v16, v201, v202
    v_max3_f32 v17, v17, v205, v206
    v_max_f32 v16, v16, v203
    v_max_f32 v17, v17, v207
    v_mov_b32 v18, v16
    v_mov_b32 v19, v17
    s_nop 1
    v_permlane16_swap_b32 v16, v18
    v_permlane16_swap_b32 v17, v19
    s_nop 1
    v_max_f32 v16, v16, v18
    v_max_f32 v17, v17, v19
    v_mov_b32 v18, v16
    v_mov_b32 v19, v17
    s_nop 1
    v_permlane32_swap_b32 v16, v18
    v_permlane32_swap_b32 v17, v19
    s_nop 1
    v_max_f32 v16, v16, v18
    v_max_f32 v17, v17, v19
    v_add_f32 v16, 16.0, v16
    v_add_f32 v17, 16.0, v17
    v_max_f32 v16, 0, v16
    v_add_f32 v10, v10, v16
    v_exp_f32 v18, -v16
    v_max_f32 v17, 0, v17
    v_add_f32 v11, v11, v17
    v_exp_f32 v19, -v17
    v_sub_f32 v192, v192, v16
    v_sub_f32 v193, v193, v16
    v_sub_f32 v194, v194, v16
    v_sub_f32 v195, v195, v16
    v_sub_f32 v200, v200, v16
    v_sub_f32 v201, v201, v16
    v_sub_f32 v202, v202, v16
    v_sub_f32 v203, v203, v16
    v_sub_f32 v196, v196, v17
    v_sub_f32 v197, v197, v17
    v_sub_f32 v198, v198, v17
    v_sub_f32 v199, v199, v17
    v_sub_f32 v204, v204, v17
    v_sub_f32 v205, v205, v17
    v_sub_f32 v206, v206, v17
    v_sub_f32 v207, v207, v17
    v_mul_f32 v168, v168, v18
    v_mul_f32 v169, v169, v18
    v_mul_f32 v170, v170, v18
    v_mul_f32 v171, v171, v18
    v_mul_f32 v172, v172, v19
    v_mul_f32 v173, v173, v19
    v_mul_f32 v174, v174, v19
    v_mul_f32 v175, v175, v19
    v_mul_f32 v64, v64, v18
    v_mul_f32 v65, v65, v18
    v_mul_f32 v66, v66, v18
    v_mul_f32 v67, v67, v18
    v_mul_f32 v68, v68, v19
    v_mul_f32 v69, v69, v19
    v_mul_f32 v70, v70, v19
    v_mul_f32 v71, v71, v19
    v_mul_f32 v72, v72, v18
    v_mul_f32 v73, v73, v18
    v_mul_f32 v74, v74, v18
    v_mul_f32 v75, v75, v18
    v_mul_f32 v76, v76, v19
    v_mul_f32 v77, v77, v19
    v_mul_f32 v78, v78, v19
    v_mul_f32 v79, v79, v19
    v_mul_f32 v80, v80, v18
    v_mul_f32 v81, v81, v18
    v_mul_f32 v82, v82, v18
    v_mul_f32 v83, v83, v18
    v_mul_f32 v84, v84, v19
    v_mul_f32 v85, v85, v19
    v_mul_f32 v86, v86, v19
    v_mul_f32 v87, v87, v19
    v_mul_f32 v88, v88, v18
    v_mul_f32 v89, v89, v18
    v_mul_f32 v90, v90, v18
    v_mul_f32 v91, v91, v18
    v_mul_f32 v92, v92, v19
    v_mul_f32 v93, v93, v19
    v_mul_f32 v94, v94, v19
    v_mul_f32 v95, v95, v19
    v_mul_f32 v96, v96, v18
    v_mul_f32 v97, v97, v18
    v_mul_f32 v98, v98, v18
    v_mul_f32 v99, v99, v18
    v_mul_f32 v100, v100, v19
    v_mul_f32 v101, v101, v19
    v_mul_f32 v102, v102, v19
    v_mul_f32 v103, v103, v19
    v_mul_f32 v104, v104, v18
    v_mul_f32 v105, v105, v18
    v_mul_f32 v106, v106, v18
    v_mul_f32 v107, v107, v18
    v_mul_f32 v108, v108, v19
    v_mul_f32 v109, v109, v19
    v_mul_f32 v110, v110, v19
    v_mul_f32 v111, v111, v19
    v_mul_f32 v112, v112, v18
    v_mul_f32 v113, v113, v18
    v_mul_f32 v114, v114, v18
    v_mul_f32 v115, v115, v18
    v_mul_f32 v116, v116, v19
    v_mul_f32 v117, v117, v19
    v_mul_f32 v118, v118, v19
    v_mul_f32 v119, v119, v19
    v_mul_f32 v120, v120, v18
    v_mul_f32 v121, v121, v18
    v_mul_f32 v122, v122, v18
    v_mul_f32 v123, v123, v18
    v_mul_f32 v124, v124, v19
    v_mul_f32 v125, v125, v19
    v_mul_f32 v126, v126, v19
    v_mul_f32 v127, v127, v19
    v_exp_f32 v20, v192
    v_exp_f32 v21, v193
    v_exp_f32 v22, v194
    v_cvt_pk_bf16_f32 v216, v20, v21
    v_exp_f32 v23, v195
    v_exp_f32 v24, v200
    v_cvt_pk_bf16_f32 v217, v22, v23
    v_exp_f32 v25, v201
    v_exp_f32 v26, v202
    v_cvt_pk_bf16_f32 v218, v24, v25
    v_exp_f32 v27, v203
    v_exp_f32 v20, v196
    v_cvt_pk_bf16_f32 v219, v26, v27
    v_exp_f32 v21, v197
    v_exp_f32 v22, v198
    v_cvt_pk_bf16_f32 v220, v20, v21
    v_exp_f32 v23, v199
    v_exp_f32 v24, v204
    v_cvt_pk_bf16_f32 v221, v22, v23
    v_exp_f32 v25, v205
    v_exp_f32 v26, v206
    v_cvt_pk_bf16_f32 v222, v24, v25
    v_exp_f32 v27, v207
    s_nop 0
    v_cvt_pk_bf16_f32 v223, v26, v27
    s_nop 1
    s_branch L_rareback_58
L_mask_59:
    v_add_u32 v16, s34, v8
    v_cmp_le_i32 s[46:47], 0, v16
    v_cmp_le_i32 s[48:49], 1, v16
    v_cmp_le_i32 s[50:51], 2, v16
    v_cmp_le_i32 s[52:53], 3, v16
    v_cndmask_b32 v176, v9, v176, s[46:47]
    v_cmp_le_i32 s[46:47], -16, v16
    v_cndmask_b32 v177, v9, v177, s[48:49]
    v_cmp_le_i32 s[48:49], -15, v16
    v_cndmask_b32 v178, v9, v178, s[50:51]
    v_cmp_le_i32 s[50:51], -14, v16
    v_cndmask_b32 v179, v9, v179, s[52:53]
    v_cmp_le_i32 s[52:53], -13, v16
    v_cndmask_b32 v180, v9, v180, s[46:47]
    v_cmp_le_i32 s[46:47], 16, v16
    v_cndmask_b32 v181, v9, v181, s[48:49]
    v_cmp_le_i32 s[48:49], 17, v16
    v_cndmask_b32 v182, v9, v182, s[50:51]
    v_cmp_le_i32 s[50:51], 18, v16
    v_cndmask_b32 v183, v9, v183, s[52:53]
    v_cmp_le_i32 s[52:53], 19, v16
    v_cndmask_b32 v184, v9, v184, s[46:47]
    v_cmp_le_i32 s[46:47], 0, v16
    v_cndmask_b32 v185, v9, v185, s[48:49]
    v_cmp_le_i32 s[48:49], 1, v16
    v_cndmask_b32 v186, v9, v186, s[50:51]
    v_cmp_le_i32 s[50:51], 2, v16
    v_cndmask_b32 v187, v9, v187, s[52:53]
    v_cmp_le_i32 s[52:53], 3, v16
    v_cndmask_b32 v188, v9, v188, s[46:47]
    s_nop 0
    v_cndmask_b32 v189, v9, v189, s[48:49]
    s_nop 0
    v_cndmask_b32 v190, v9, v190, s[50:51]
    s_nop 0
    v_cndmask_b32 v191, v9, v191, s[52:53]
    s_branch L_maskback_60
L_rare_61:
    s_nop 7
    v_max3_f32 v16, v176, v177, v178
    v_max3_f32 v17, v180, v181, v182
    v_max3_f32 v16, v16, v179, v184
    v_max3_f32 v17, v17, v183, v188
    v_max3_f32 v16, v16, v185, v186
    v_max3_f32 v17, v17, v189, v190
    v_max_f32 v16, v16, v187
    v_max_f32 v17, v17, v191
    v_mov_b32 v18, v16
    v_mov_b32 v19, v17
    s_nop 1
    v_permlane16_swap_b32 v16, v18
    v_permlane16_swap_b32 v17, v19
    s_nop 1
    v_max_f32 v16, v16, v18
    v_max_f32 v17, v17, v19
    v_mov_b32 v18, v16
    v_mov_b32 v19, v17
    s_nop 1
    v_permlane32_swap_b32 v16, v18
    v_permlane32_swap_b32 v17, v19
    s_nop 1
    v_max_f32 v16, v16, v18
    v_max_f32 v17, v17, v19
    v_add_f32 v16, 16.0, v16
    v_add_f32 v17, 16.0, v17
    v_max_f32 v16, 0xf1800000, v16
    v_add_f32 v10, v10, v16
    v_max_f32 v17, 0xf1800000, v17
    v_add_f32 v11, v11, v17
    v_sub_f32 v176, v176, v16
    v_sub_f32 v177, v177, v16
    v_sub_f32 v178, v178, v16
    v_sub_f32 v179, v179, v16
    v_sub_f32 v184, v184, v16
    v_sub_f32 v185, v185, v16
    v_sub_f32 v186, v186, v16
    v_sub_f32 v187, v187, v16
    v_sub_f32 v180, v180, v17
    v_sub_f32 v181, v181, v17
    v_sub_f32 v182, v182, v17
    v_sub_f32 v183, v183, v17
    v_sub_f32 v188, v188, v17
    v_sub_f32 v189, v189, v17
    v_sub_f32 v190, v190, v17
    v_sub_f32 v191, v191, v17
    v_sub_f32 v160, 0, v10
    v_sub_f32 v161, 0, v10
    v_sub_f32 v162, 0, v10
    v_sub_f32 v163, 0, v10
    v_sub_f32 v192, v192, v16
    v_sub_f32 v193, v193, v16
    v_sub_f32 v194, v194, v16
    v_sub_f32 v195, v195, v16
    v_sub_f32 v200, v200, v16
    v_sub_f32 v201, v201, v16
    v_sub_f32 v202, v202, v16
    v_sub_f32 v203, v203, v16
    v_sub_f32 v164, 0, v11
    v_sub_f32 v165, 0, v11
    v_sub_f32 v166, 0, v11
    v_sub_f32 v167, 0, v11
    v_sub_f32 v196, v196, v17
    v_sub_f32 v197, v197, v17
    v_sub_f32 v198, v198, v17
    v_sub_f32 v199, v199, v17
    v_sub_f32 v204, v204, v17
    v_sub_f32 v205, v205, v17
    v_sub_f32 v206, v206, v17
    v_sub_f32 v207, v207, v17
    v_exp_f32 v20, v176
    v_exp_f32 v21, v177
    v_exp_f32 v22, v178
    v_cvt_pk_bf16_f32 v208, v20, v21
    v_exp_f32 v23, v179
    v_exp_f32 v24, v184
    v_cvt_pk_bf16_f32 v209, v22, v23
    v_exp_f32 v25, v185
    v_exp_f32 v26, v186
    v_cvt_pk_bf16_f32 v210, v24, v25
    v_exp_f32 v27, v187
    v_exp_f32 v20, v180
    v_cvt_pk_bf16_f32 v211, v26, v27
    v_exp_f32 v21, v181
    v_exp_f32 v22, v182
    v_cvt_pk_bf16_f32 v212, v20, v21
    v_exp_f32 v23, v183
    v_exp_f32 v24, v188
    v_cvt_pk_bf16_f32 v213, v22, v23
    v_exp_f32 v25, v189
    v_exp_f32 v26, v190
    v_cvt_pk_bf16_f32 v214, v24, v25
    v_exp_f32 v27, v191
    s_nop 0
    v_cvt_pk_bf16_f32 v215, v26, v27
    s_nop 1
    s_branch L_rareback_62
L_mask_63:
    v_add_u32 v16, s34, v8
    v_cmp_le_i32 s[46:47], 0, v16
    v_cmp_le_i32 s[48:49], 1, v16
    v_cmp_le_i32 s[50:51], 2, v16
    v_cmp_le_i32 s[52:53], 3, v16
    v_cndmask_b32 v192, v9, v192, s[46:47]
    v_cmp_le_i32 s[46:47], -16, v16
    v_cndmask_b32 v193, v9, v193, s[48:49]
    v_cmp_le_i32 s[48:49], -15, v16
    v_cndmask_b32 v194, v9, v194, s[50:51]
    v_cmp_le_i32 s[50:51], -14, v16
    v_cndmask_b32 v195, v9, v195, s[52:53]
    v_cmp_le_i32 s[52:53], -13, v16
    v_cndmask_b32 v196, v9, v196, s[46:47]
    v_cmp_le_i32 s[46:47], 16, v16
    v_cndmask_b32 v197, v9, v197, s[48:49]
    v_cmp_le_i32 s[48:49], 17, v16
    v_cndmask_b32 v198, v9, v198, s[50:51]
    v_cmp_le_i32 s[50:51], 18, v16
    v_cndmask_b32 v199, v9, v199, s[52:53]
    v_cmp_le_i32 s[52:53], 19, v16
    v_cndmask_b32 v200, v9, v200, s[46:47]
    v_cmp_le_i32 s[46:47], 0, v16
    v_cndmask_b32 v201, v9, v201, s[48:49]
    v_cmp_le_i32 s[48:49], 1, v16
    v_cndmask_b32 v202, v9, v202, s[50:51]
    v_cmp_le_i32 s[50:51], 2, v16
    v_cndmask_b32 v203, v9, v203, s[52:53]
    v_cmp_le_i32 s[52:53], 3, v16
    v_cndmask_b32 v204, v9, v204, s[46:47]
    s_nop 0
    v_cndmask_b32 v205, v9, v205, s[48:49]
    s_nop 0
    v_cndmask_b32 v206, v9, v206, s[50:51]
    s_nop 0
    v_cndmask_b32 v207, v9, v207, s[52:53]
    s_branch L_maskback_64
L_spin_65:
    s_mov_b32 s46, 0x20000
L_spinloop_111:
    s_lshl_b32 s45, s22, 7
    s_add_u32 s45, s45, 73400192
    s_sub_u32 s45, s45, s69
    v_lshrrev_b32 v17, 9, v1
    v_mul_lo_u32 v17, v17, s45
    v_lshrrev_b32 v31, 2, v1
    v_add3_u32 v31, v31, v17, s69
    buffer_load_dword v31, v31, s[12:15], 0 offen sc1
    s_sub_u32 s46, s46, 1
    s_cbranch_scc1 L_spinback_66
    s_waitcnt vmcnt(0)
    v_and_b32 v17, 7, v31
    v_cmp_gt_u32 vcc, 4, v17
    s_nop 0
    s_cbranch_vccz L_spinback_66
    s_sleep 2
    s_branch L_spinloop_111
L_rare_67:
    s_nop 7
    v_max3_f32 v16, v192, v193, v194
    v_max3_f32 v17, v196, v197, v198
    v_max3_f32 v16, v16, v195, v200
    v_max3_f32 v17, v17, v199, v204
    v_max3_f32 v16, v16, v201, v202
    v_max3_f32 v17, v17, v205, v206
    v_max_f32 v16, v16, v203
    v_max_f32 v17, v17, v207
    v_mov_b32 v18, v16
    v_mov_b32 v19, v17
    s_nop 1
    v_permlane16_swap_b32 v16, v18
    v_permlane16_swap_b32 v17, v19
    s_nop 1
    v_max_f32 v16, v16, v18
    v_max_f32 v17, v17, v19
    v_mov_b32 v18, v16
    v_mov_b32 v19, v17
    s_nop 1
    v_permlane32_swap_b32 v16, v18
    v_permlane32_swap_b32 v17, v19
    s_nop 1
    v_max_f32 v16, v16, v18
    v_max_f32 v17, v17, v19
    v_add_f32 v16, 16.0, v16
    v_add_f32 v17, 16.0, v17
    v_max_f32 v16, 0, v16
    v_add_f32 v10, v10, v16
    v_exp_f32 v18, -v16
    v_max_f32 v17, 0, v17
    v_add_f32 v11, v11, v17
    v_exp_f32 v19, -v17
    v_sub_f32 v192, v192, v16
    v_sub_f32 v193, v193, v16
    v_sub_f32 v194, v194, v16
    v_sub_f32 v195, v195, v16
    v_sub_f32 v200, v200, v16
    v_sub_f32 v201, v201, v16
    v_sub_f32 v202, v202, v16
    v_sub_f32 v203, v203, v16
    v_sub_f32 v196, v196, v17
    v_sub_f32 v197, v197, v17
    v_sub_f32 v198, v198, v17
    v_sub_f32 v199, v199, v17
    v_sub_f32 v204, v204, v17
    v_sub_f32 v205, v205, v17
    v_sub_f32 v206, v206, v17
    v_sub_f32 v207, v207, v17
    v_sub_f32 v160, 0, v10
    v_sub_f32 v161, 0, v10
    v_sub_f32 v162, 0, v10
    v_sub_f32 v163, 0, v10
    v_sub_f32 v176, v176, v16
    v_sub_f32 v177, v177, v16
    v_sub_f32 v178, v178, v16
    v_sub_f32 v179, v179, v16
    v_sub_f32 v184, v184, v16
    v_sub_f32 v185, v185, v16
    v_sub_f32 v186, v186, v16
    v_sub_f32 v187, v187, v16
    v_sub_f32 v164, 0, v11
    v_sub_f32 v165, 0, v11
    v_sub_f32 v166, 0, v11
    v_sub_f32 v167, 0, v11
    v_sub_f32 v180, v180, v17
    v_sub_f32 v181, v181, v17
    v_sub_f32 v182, v182, v17
    v_sub_f32 v183, v183, v17
    v_sub_f32 v188, v188, v17
    v_sub_f32 v189, v189, v17
    v_sub_f32 v190, v190, v17
    v_sub_f32 v191, v191, v17
    v_mul_f32 v168, v168, v18
    v_mul_f32 v169, v169, v18
    v_mul_f32 v170, v170, v18
    v_mul_f32 v171, v171, v18
    v_mul_f32 v172, v172, v19
    v_mul_f32 v173, v173, v19
    v_mul_f32 v174, v174, v19
    v_mul_f32 v175, v175, v19
    v_mul_f32 v64, v64, v18
    v_mul_f32 v65, v65, v18
    v_mul_f32 v66, v66, v18
    v_mul_f32 v67, v67, v18
    v_mul_f32 v68, v68, v19
    v_mul_f32 v69, v69, v19
    v_mul_f32 v70, v70, v19
    v_mul_f32 v71, v71, v19
    v_mul_f32 v72, v72, v18
    v_mul_f32 v73, v73, v18
    v_mul_f32 v74, v74, v18
    v_mul_f32 v75, v75, v18
    v_mul_f32 v76, v76, v19
    v_mul_f32 v77, v77, v19
    v_mul_f32 v78, v78, v19
    v_mul_f32 v79, v79, v19
    v_mul_f32 v80, v80, v18
    v_mul_f32 v81, v81, v18
    v_mul_f32 v82, v82, v18
    v_mul_f32 v83, v83, v18
    v_mul_f32 v84, v84, v19
    v_mul_f32 v85, v85, v19
    v_mul_f32 v86, v86, v19
    v_mul_f32 v87, v87, v19
    v_mul_f32 v88, v88, v18
    v_mul_f32 v89, v89, v18
    v_mul_f32 v90, v90, v18
    v_mul_f32 v91, v91, v18
    v_mul_f32 v92, v92, v19
    v_mul_f32 v93, v93, v19
    v_mul_f32 v94, v94, v19
    v_mul_f32 v95, v95, v19
    v_mul_f32 v96, v96, v18
    v_mul_f32 v97, v97, v18
    v_mul_f32 v98, v98, v18
    v_mul_f32 v99, v99, v18
    v_mul_f32 v100, v100, v19
    v_mul_f32 v101, v101, v19
    v_mul_f32 v102, v102, v19
    v_mul_f32 v103, v103, v19
    v_mul_f32 v104, v104, v18
    v_mul_f32 v105, v105, v18
    v_mul_f32 v106, v106, v18
    v_mul_f32 v107, v107, v18
    v_mul_f32 v108, v108, v19
    v_mul_f32 v109, v109, v19
    v_mul_f32 v110, v110, v19
    v_mul_f32 v111, v111, v19
    v_mul_f32 v112, v112, v18
    v_mul_f32 v113, v113, v18
    v_mul_f32 v114, v114, v18
    v_mul_f32 v115, v115, v18
    v_mul_f32 v116, v116, v19
    v_mul_f32 v117, v117, v19
    v_mul_f32 v118, v118, v19
    v_mul_f32 v119, v119, v19
    v_mul_f32 v120, v120, v18
    v_mul_f32 v121, v121, v18
    v_mul_f32 v122, v122, v18
    v_mul_f32 v123, v123, v18
    v_mul_f32 v124, v124, v19
    v_mul_f32 v125, v125, v19
    v_mul_f32 v126, v126, v19
    v_mul_f32 v127, v127, v19
    v_exp_f32 v20, v192
    v_exp_f32 v21, v193
    v_exp_f32 v22, v194
    v_cvt_pk_bf16_f32 v216, v20, v21
    v_exp_f32 v23, v195
    v_exp_f32 v24, v200
    v_cvt_pk_bf16_f32 v217, v22, v23
    v_exp_f32 v25, v201
    v_exp_f32 v26, v202
    v_cvt_pk_bf16_f32 v218, v24, v25
    v_exp_f32 v27, v203
    v_exp_f32 v20, v196
    v_cvt_pk_bf16_f32 v219, v26, v27
    v_exp_f32 v21, v197
    v_exp_f32 v22, v198
    v_cvt_pk_bf16_f32 v220, v20, v21
    v_exp_f32 v23, v199
    v_exp_f32 v24, v204
    v_cvt_pk_bf16_f32 v221, v22, v23
    v_exp_f32 v25, v205
    v_exp_f32 v26, v206
    v_cvt_pk_bf16_f32 v222, v24, v25
    v_exp_f32 v27, v207
    s_nop 0
    v_cvt_pk_bf16_f32 v223, v26, v27
    s_nop 1
    s_branch L_rareback_68
L_mask_69:
    v_add_u32 v16, s34, v8
    v_cmp_le_i32 s[46:47], 0, v16
    v_cmp_le_i32 s[48:49], 1, v16
    v_cmp_le_i32 s[50:51], 2, v16
    v_cmp_le_i32 s[52:53], 3, v16
    v_cndmask_b32 v176, v9, v176, s[46:47]
    v_cmp_le_i32 s[46:47], -16, v16
    v_cndmask_b32 v177, v9, v177, s[48:49]
    v_cmp_le_i32 s[48:49], -15, v16
    v_cndmask_b32 v178, v9, v178, s[50:51]
    v_cmp_le_i32 s[50:51], -14, v16
    v_cndmask_b32 v179, v9, v179, s[52:53]
    v_cmp_le_i32 s[52:53], -13, v16
    v_cndmask_b32 v180, v9, v180, s[46:47]
    v_cmp_le_i32 s[46:47], 16, v16
    v_cndmask_b32 v181, v9, v181, s[48:49]
    v_cmp_le_i32 s[48:49], 17, v16
    v_cndmask_b32 v182, v9, v182, s[50:51]
    v_cmp_le_i32 s[50:51], 18, v16
    v_cndmask_b32 v183, v9, v183, s[52:53]
    v_cmp_le_i32 s[52:53], 19, v16
    v_cndmask_b32 v184, v9, v184, s[46:47]
    v_cmp_le_i32 s[46:47], 0, v16
    v_cndmask_b32 v185, v9, v185, s[48:49]
    v_cmp_le_i32 s[48:49], 1, v16
    v_cndmask_b32 v186, v9, v186, s[50:51]
    v_cmp_le_i32 s[50:51], 2, v16
    v_cndmask_b32 v187, v9, v187, s[52:53]
    v_cmp_le_i32 s[52:53], 3, v16
    v_cndmask_b32 v188, v9, v188, s[46:47]
    s_nop 0
    v_cndmask_b32 v189, v9, v189, s[48:49]
    s_nop 0
    v_cndmask_b32 v190, v9, v190, s[50:51]
    s_nop 0
    v_cndmask_b32 v191, v9, v191, s[52:53]
    s_branch L_maskback_70
L_rare_72:
    s_nop 7
    v_max3_f32 v16, v176, v177, v178
    v_max3_f32 v17, v180, v181, v182
    v_max3_f32 v16, v16, v179, v184
    v_max3_f32 v17, v17, v183, v188
    v_max3_f32 v16, v16, v185, v186
    v_max3_f32 v17, v17, v189, v190
    v_max_f32 v16, v16, v187
    v_max_f32 v17, v17, v191
    v_mov_b32 v18, v16
    v_mov_b32 v19, v17
    s_nop 1
    v_permlane16_swap_b32 v16, v18
    v_permlane16_swap_b32 v17, v19
    s_nop 1
    v_max_f32 v16, v16, v18
    v_max_f32 v17, v17, v19
    v_mov_b32 v18, v16
    v_mov_b32 v19, v17
    s_nop 1
    v_permlane32_swap_b32 v16, v18
    v_permlane32_swap_b32 v17, v19
    s_nop 1
    v_max_f32 v16, v16, v18
    v_max_f32 v17, v17, v19
    v_add_f32 v16, 16.0, v16
    v_add_f32 v17, 16.0, v17
    v_max_f32 v16, 0, v16
    v_add_f32 v10, v10, v16
    v_exp_f32 v18, -v16
    v_max_f32 v17, 0, v17
    v_add_f32 v11, v11, v17
    v_exp_f32 v19, -v17
    v_sub_f32 v176, v176, v16
    v_sub_f32 v177, v177, v16
    v_sub_f32 v178, v178, v16
    v_sub_f32 v179, v179, v16
    v_sub_f32 v184, v184, v16
    v_sub_f32 v185, v185, v16
    v_sub_f32 v186, v186, v16
    v_sub_f32 v187, v187, v16
    v_sub_f32 v180, v180, v17
    v_sub_f32 v181, v181, v17
    v_sub_f32 v182, v182, v17
    v_sub_f32 v183, v183, v17
    v_sub_f32 v188, v188, v17
    v_sub_f32 v189, v189, v17
    v_sub_f32 v190, v190, v17
    v_sub_f32 v191, v191, v17
    v_sub_f32 v160, 0, v10
    v_sub_f32 v161, 0, v10
    v_sub_f32 v162, 0, v10
    v_sub_f32 v163, 0, v10
    v_sub_f32 v192, v192, v16
    v_sub_f32 v193, v193, v16
    v_sub_f32 v194, v194, v16
    v_sub_f32 v195, v195, v16
    v_sub_f32 v200, v200, v16
    v_sub_f32 v201, v201, v16
    v_sub_f32 v202, v202, v16
    v_sub_f32 v203, v203, v16
    v_sub_f32 v164, 0, v11
    v_sub_f32 v165, 0, v11
    v_sub_f32 v166, 0, v11
    v_sub_f32 v167, 0, v11
    v_sub_f32 v196, v196, v17
    v_sub_f32 v197, v197, v17
    v_sub_f32 v198, v198, v17
    v_sub_f32 v199, v199, v17
    v_sub_f32 v204, v204, v17
    v_sub_f32 v205, v205, v17
    v_sub_f32 v206, v206, v17
    v_sub_f32 v207, v207, v17
    v_mul_f32 v168, v168, v18
    v_mul_f32 v169, v169, v18
    v_mul_f32 v170, v170, v18
    v_mul_f32 v171, v171, v18
    v_mul_f32 v172, v172, v19
    v_mul_f32 v173, v173, v19
    v_mul_f32 v174, v174, v19
    v_mul_f32 v175, v175, v19
    v_mul_f32 v64, v64, v18
    v_mul_f32 v65, v65, v18
    v_mul_f32 v66, v66, v18
    v_mul_f32 v67, v67, v18
    v_mul_f32 v68, v68, v19
    v_mul_f32 v69, v69, v19
    v_mul_f32 v70, v70, v19
    v_mul_f32 v71, v71, v19
    v_mul_f32 v72, v72, v18
    v_mul_f32 v73, v73, v18
    v_mul_f32 v74, v74, v18
    v_mul_f32 v75, v75, v18
    v_mul_f32 v76, v76, v19
    v_mul_f32 v77, v77, v19
    v_mul_f32 v78, v78, v19
    v_mul_f32 v79, v79, v19
    v_mul_f32 v80, v80, v18
    v_mul_f32 v81, v81, v18
    v_mul_f32 v82, v82, v18
    v_mul_f32 v83, v83, v18
    v_mul_f32 v84, v84, v19
    v_mul_f32 v85, v85, v19
    v_mul_f32 v86, v86, v19
    v_mul_f32 v87, v87, v19
    v_mul_f32 v88, v88, v18
    v_mul_f32 v89, v89, v18
    v_mul_f32 v90, v90, v18
    v_mul_f32 v91, v91, v18
    v_mul_f32 v92, v92, v19
    v_mul_f32 v93, v93, v19
    v_mul_f32 v94, v94, v19
    v_mul_f32 v95, v95, v19
    v_mul_f32 v96, v96, v18
    v_mul_f32 v97, v97, v18
    v_mul_f32 v98, v98, v18
    v_mul_f32 v99, v99, v18
    v_mul_f32 v100, v100, v19
    v_mul_f32 v101, v101, v19
    v_mul_f32 v102, v102, v19
    v_mul_f32 v103, v103, v19
    v_mul_f32 v104, v104, v18
    v_mul_f32 v105, v105, v18
    v_mul_f32 v106, v106, v18
    v_mul_f32 v107, v107, v18
    v_mul_f32 v108, v108, v19
    v_mul_f32 v109, v109, v19
    v_mul_f32 v110, v110, v19
    v_mul_f32 v111, v111, v19
    v_mul_f32 v112, v112, v18
    v_mul_f32 v113, v113, v18
    v_mul_f32 v114, v114, v18
    v_mul_f32 v115, v115, v18
    v_mul_f32 v116, v116, v19
    v_mul_f32 v117, v117, v19
    v_mul_f32 v118, v118, v19
    v_mul_f32 v119, v119, v19
    v_mul_f32 v120, v120, v18
    v_mul_f32 v121, v121, v18
    v_mul_f32 v122, v122, v18
    v_mul_f32 v123, v123, v18
    v_mul_f32 v124, v124, v19
    v_mul_f32 v125, v125, v19
    v_mul_f32 v126, v126, v19
    v_mul_f32 v127, v127, v19
    v_exp_f32 v20, v176
    v_exp_f32 v21, v177
    v_exp_f32 v22, v178
    v_cvt_pk_bf16_f32 v208, v20, v21
    v_exp_f32 v23, v179
    v_exp_f32 v24, v184
    v_cvt_pk_bf16_f32 v209, v22, v23
    v_exp_f32 v25, v185
    v_exp_f32 v26, v186
    v_cvt_pk_bf16_f32 v210, v24, v25
    v_exp_f32 v27, v187
    v_exp_f32 v20, v180
    v_cvt_pk_bf16_f32 v211, v26, v27
    v_exp_f32 v21, v181
    v_exp_f32 v22, v182
    v_cvt_pk_bf16_f32 v212, v20, v21
    v_exp_f32 v23, v183
    v_exp_f32 v24, v188
    v_cvt_pk_bf16_f32 v213, v22, v23
    v_exp_f32 v25, v189
    v_exp_f32 v26, v190
    v_cvt_pk_bf16_f32 v214, v24, v25
    v_exp_f32 v27, v191
    s_nop 0
    v_cvt_pk_bf16_f32 v215, v26, v27
    s_nop 1
    s_branch L_rareback_73
L_mask_76:
    v_add_u32 v16, s34, v8
    v_cmp_le_i32 s[46:47], 0, v16
    v_cmp_le_i32 s[48:49], 1, v16
    v_cmp_le_i32 s[50:51], 2, v16
    v_cmp_le_i32 s[52:53], 3, v16
    v_cndmask_b32 v192, v9, v192, s[46:47]
    v_cmp_le_i32 s[46:47], -16, v16
    v_cndmask_b32 v193, v9, v193, s[48:49]
    v_cmp_le_i32 s[48:49], -15, v16
    v_cndmask_b32 v194, v9, v194, s[50:51]
    v_cmp_le_i32 s[50:51], -14, v16
    v_cndmask_b32 v195, v9, v195, s[52:53]
    v_cmp_le_i32 s[52:53], -13, v16
    v_cndmask_b32 v196, v9, v196, s[46:47]
    v_cmp_le_i32 s[46:47], 16, v16
    v_cndmask_b32 v197, v9, v197, s[48:49]
    v_cmp_le_i32 s[48:49], 17, v16
    v_cndmask_b32 v198, v9, v198, s[50:51]
    v_cmp_le_i32 s[50:51], 18, v16
    v_cndmask_b32 v199, v9, v199, s[52:53]
    v_cmp_le_i32 s[52:53], 19, v16
    v_cndmask_b32 v200, v9, v200, s[46:47]
    v_cmp_le_i32 s[46:47], 0, v16
    v_cndmask_b32 v201, v9, v201, s[48:49]
    v_cmp_le_i32 s[48:49], 1, v16
    v_cndmask_b32 v202, v9, v202, s[50:51]
    v_cmp_le_i32 s[50:51], 2, v16
    v_cndmask_b32 v203, v9, v203, s[52:53]
    v_cmp_le_i32 s[52:53], 3, v16
    v_cndmask_b32 v204, v9, v204, s[46:47]
    s_nop 0
    v_cndmask_b32 v205, v9, v205, s[48:49]
    s_nop 0
    v_cndmask_b32 v206, v9, v206, s[50:51]
    s_nop 0
    v_cndmask_b32 v207, v9, v207, s[52:53]
    s_branch L_maskback_77
L_rare_78:
    s_nop 7
    v_max3_f32 v16, v192, v193, v194
    v_max3_f32 v17, v196, v197, v198
    v_max3_f32 v16, v16, v195, v200
    v_max3_f32 v17, v17, v199, v204
    v_max3_f32 v16, v16, v201, v202
    v_max3_f32 v17, v17, v205, v206
    v_max_f32 v16, v16, v203
    v_max_f32 v17, v17, v207
    v_mov_b32 v18, v16
    v_mov_b32 v19, v17
    s_nop 1
    v_permlane16_swap_b32 v16, v18
    v_permlane16_swap_b32 v17, v19
    s_nop 1
    v_max_f32 v16, v16, v18
    v_max_f32 v17, v17, v19
    v_mov_b32 v18, v16
    v_mov_b32 v19, v17
    s_nop 1
    v_permlane32_swap_b32 v16, v18
    v_permlane32_swap_b32 v17, v19
    s_nop 1
    v_max_f32 v16, v16, v18
    v_max_f32 v17, v17, v19
    v_add_f32 v16, 16.0, v16
    v_add_f32 v17, 16.0, v17
    v_max_f32 v16, 0, v16
    v_add_f32 v10, v10, v16
    v_exp_f32 v18, -v16
    v_max_f32 v17, 0, v17
    v_add_f32 v11, v11, v17
    v_exp_f32 v19, -v17
    v_sub_f32 v192, v192, v16
    v_sub_f32 v193, v193, v16
    v_sub_f32 v194, v194, v16
    v_sub_f32 v195, v195, v16
    v_sub_f32 v200, v200, v16
    v_sub_f32 v201, v201, v16
    v_sub_f32 v202, v202, v16
    v_sub_f32 v203, v203, v16
    v_sub_f32 v196, v196, v17
    v_sub_f32 v197, v197, v17
    v_sub_f32 v198, v198, v17
    v_sub_f32 v199, v199, v17
    v_sub_f32 v204, v204, v17
    v_sub_f32 v205, v205, v17
    v_sub_f32 v206, v206, v17
    v_sub_f32 v207, v207, v17
    v_sub_f32 v160, 0, v10
    v_sub_f32 v161, 0, v10
    v_sub_f32 v162, 0, v10
    v_sub_f32 v163, 0, v10
    v_sub_f32 v176, v176, v16
    v_sub_f32 v177, v177, v16
    v_sub_f32 v178, v178, v16
    v_sub_f32 v179, v179, v16
    v_sub_f32 v184, v184, v16
    v_sub_f32 v185, v185, v16
    v_sub_f32 v186, v186, v16
    v_sub_f32 v187, v187, v16
    v_sub_f32 v164, 0, v11
    v_sub_f32 v165, 0, v11
    v_sub_f32 v166, 0, v11
    v_sub_f32 v167, 0, v11
    v_sub_f32 v180, v180, v17
    v_sub_f32 v181, v181, v17
    v_sub_f32 v182, v182, v17
    v_sub_f32 v183, v183, v17
    v_sub_f32 v188, v188, v17
    v_sub_f32 v189, v189, v17
    v_sub_f32 v190, v190, v17
    v_sub_f32 v191, v191, v17
    v_mul_f32 v168, v168, v18
    v_mul_f32 v169, v169, v18
    v_mul_f32 v170, v170, v18
    v_mul_f32 v171, v171, v18
    v_mul_f32 v172, v172, v19
    v_mul_f32 v173, v173, v19
    v_mul_f32 v174, v174, v19
    v_mul_f32 v175, v175, v19
    v_mul_f32 v64, v64, v18
    v_mul_f32 v65, v65, v18
    v_mul_f32 v66, v66, v18
    v_mul_f32 v67, v67, v18
    v_mul_f32 v68, v68, v19
    v_mul_f32 v69, v69, v19
    v_mul_f32 v70, v70, v19
    v_mul_f32 v71, v71, v19
    v_mul_f32 v72, v72, v18
    v_mul_f32 v73, v73, v18
    v_mul_f32 v74, v74, v18
    v_mul_f32 v75, v75, v18
    v_mul_f32 v76, v76, v19
    v_mul_f32 v77, v77, v19
    v_mul_f32 v78, v78, v19
    v_mul_f32 v79, v79, v19
    v_mul_f32 v80, v80, v18
    v_mul_f32 v81, v81, v18
    v_mul_f32 v82, v82, v18
    v_mul_f32 v83, v83, v18
    v_mul_f32 v84, v84, v19
    v_mul_f32 v85, v85, v19
    v_mul_f32 v86, v86, v19
    v_mul_f32 v87, v87, v19
    v_mul_f32 v88, v88, v18
    v_mul_f32 v89, v89, v18
    v_mul_f32 v90, v90, v18
    v_mul_f32 v91, v91, v18
    v_mul_f32 v92, v92, v19
    v_mul_f32 v93, v93, v19
    v_mul_f32 v94, v94, v19
    v_mul_f32 v95, v95, v19
    v_mul_f32 v96, v96, v18
    v_mul_f32 v97, v97, v18
    v_mul_f32 v98, v98, v18
    v_mul_f32 v99, v99, v18
    v_mul_f32 v100, v100, v19
    v_mul_f32 v101, v101, v19
    v_mul_f32 v102, v102, v19
    v_mul_f32 v103, v103, v19
    v_mul_f32 v104, v104, v18
    v_mul_f32 v105, v105, v18
    v_mul_f32 v106, v106, v18
    v_mul_f32 v107, v107, v18
    v_mul_f32 v108, v108, v19
    v_mul_f32 v109, v109, v19
    v_mul_f32 v110, v110, v19
    v_mul_f32 v111, v111, v19
    v_mul_f32 v112, v112, v18
    v_mul_f32 v113, v113, v18
    v_mul_f32 v114, v114, v18
    v_mul_f32 v115, v115, v18
    v_mul_f32 v116, v116, v19
    v_mul_f32 v117, v117, v19
    v_mul_f32 v118, v118, v19
    v_mul_f32 v119, v119, v19
    v_mul_f32 v120, v120, v18
    v_mul_f32 v121, v121, v18
    v_mul_f32 v122, v122, v18
    v_mul_f32 v123, v123, v18
    v_mul_f32 v124, v124, v19
    v_mul_f32 v125, v125, v19
    v_mul_f32 v126, v126, v19
    v_mul_f32 v127, v127, v19
    v_exp_f32 v20, v192
    v_exp_f32 v21, v193
    v_exp_f32 v22, v194
    v_cvt_pk_bf16_f32 v216, v20, v21
    v_exp_f32 v23, v195
    v_exp_f32 v24, v200
    v_cvt_pk_bf16_f32 v217, v22, v23
    v_exp_f32 v25, v201
    v_exp_f32 v26, v202
    v_cvt_pk_bf16_f32 v218, v24, v25
    v_exp_f32 v27, v203
    v_exp_f32 v20, v196
    v_cvt_pk_bf16_f32 v219, v26, v27
    v_exp_f32 v21, v197
    v_exp_f32 v22, v198
    v_cvt_pk_bf16_f32 v220, v20, v21
    v_exp_f32 v23, v199
    v_exp_f32 v24, v204
    v_cvt_pk_bf16_f32 v221, v22, v23
    v_exp_f32 v25, v205
    v_exp_f32 v26, v206
    v_cvt_pk_bf16_f32 v222, v24, v25
    v_exp_f32 v27, v207
    s_nop 0
    v_cvt_pk_bf16_f32 v223, v26, v27
    s_nop 1
    s_branch L_rareback_79
L_mask_80:
    v_add_u32 v16, s34, v8
    v_cmp_le_i32 s[46:47], 0, v16
    v_cmp_le_i32 s[48:49], 1, v16
    v_cmp_le_i32 s[50:51], 2, v16
    v_cmp_le_i32 s[52:53], 3, v16
    v_cndmask_b32 v176, v9, v176, s[46:47]
    v_cmp_le_i32 s[46:47], -16, v16
    v_cndmask_b32 v177, v9, v177, s[48:49]
    v_cmp_le_i32 s[48:49], -15, v16
    v_cndmask_b32 v178, v9, v178, s[50:51]
    v_cmp_le_i32 s[50:51], -14, v16
    v_cndmask_b32 v179, v9, v179, s[52:53]
    v_cmp_le_i32 s[52:53], -13, v16
    v_cndmask_b32 v180, v9, v180, s[46:47]
    v_cmp_le_i32 s[46:47], 16, v16
    v_cndmask_b32 v181, v9, v181, s[48:49]
    v_cmp_le_i32 s[48:49], 17, v16
    v_cndmask_b32 v182, v9, v182, s[50:51]
    v_cmp_le_i32 s[50:51], 18, v16
    v_cndmask_b32 v183, v9, v183, s[52:53]
    v_cmp_le_i32 s[52:53], 19, v16
    v_cndmask_b32 v184, v9, v184, s[46:47]
    v_cmp_le_i32 s[46:47], 0, v16
    v_cndmask_b32 v185, v9, v185, s[48:49]
    v_cmp_le_i32 s[48:49], 1, v16
    v_cndmask_b32 v186, v9, v186, s[50:51]
    v_cmp_le_i32 s[50:51], 2, v16
    v_cndmask_b32 v187, v9, v187, s[52:53]
    v_cmp_le_i32 s[52:53], 3, v16
    v_cndmask_b32 v188, v9, v188, s[46:47]
    s_nop 0
    v_cndmask_b32 v189, v9, v189, s[48:49]
    s_nop 0
    v_cndmask_b32 v190, v9, v190, s[50:51]
    s_nop 0
    v_cndmask_b32 v191, v9, v191, s[52:53]
    s_branch L_maskback_81
L_rare_82:
    s_nop 7
    v_max3_f32 v16, v176, v177, v178
    v_max3_f32 v17, v180, v181, v182
    v_max3_f32 v16, v16, v179, v184
    v_max3_f32 v17, v17, v183, v188
    v_max3_f32 v16, v16, v185, v186
    v_max3_f32 v17, v17, v189, v190
    v_max_f32 v16, v16, v187
    v_max_f32 v17, v17, v191
    v_mov_b32 v18, v16
    v_mov_b32 v19, v17
    s_nop 1
    v_permlane16_swap_b32 v16, v18
    v_permlane16_swap_b32 v17, v19
    s_nop 1
    v_max_f32 v16, v16, v18
    v_max_f32 v17, v17, v19
    v_mov_b32 v18, v16
    v_mov_b32 v19, v17
    s_nop 1
    v_permlane32_swap_b32 v16, v18
    v_permlane32_swap_b32 v17, v19
    s_nop 1
    v_max_f32 v16, v16, v18
    v_max_f32 v17, v17, v19
    v_add_f32 v16, 16.0, v16
    v_add_f32 v17, 16.0, v17
    v_max_f32 v16, 0, v16
    v_add_f32 v10, v10, v16
    v_exp_f32 v18, -v16
    v_max_f32 v17, 0, v17
    v_add_f32 v11, v11, v17
    v_exp_f32 v19, -v17
    v_sub_f32 v176, v176, v16
    v_sub_f32 v177, v177, v16
    v_sub_f32 v178, v178, v16
    v_sub_f32 v179, v179, v16
    v_sub_f32 v184, v184, v16
    v_sub_f32 v185, v185, v16
    v_sub_f32 v186, v186, v16
    v_sub_f32 v187, v187, v16
    v_sub_f32 v180, v180, v17
    v_sub_f32 v181, v181, v17
    v_sub_f32 v182, v182, v17
    v_sub_f32 v183, v183, v17
    v_sub_f32 v188, v188, v17
    v_sub_f32 v189, v189, v17
    v_sub_f32 v190, v190, v17
    v_sub_f32 v191, v191, v17
    v_sub_f32 v160, 0, v10
    v_sub_f32 v161, 0, v10
    v_sub_f32 v162, 0, v10
    v_sub_f32 v163, 0, v10
    v_sub_f32 v192, v192, v16
    v_sub_f32 v193, v193, v16
    v_sub_f32 v194, v194, v16
    v_sub_f32 v195, v195, v16
    v_sub_f32 v200, v200, v16
    v_sub_f32 v201, v201, v16
    v_sub_f32 v202, v202, v16
    v_sub_f32 v203, v203, v16
    v_sub_f32 v164, 0, v11
    v_sub_f32 v165, 0, v11
    v_sub_f32 v166, 0, v11
    v_sub_f32 v167, 0, v11
    v_sub_f32 v196, v196, v17
    v_sub_f32 v197, v197, v17
    v_sub_f32 v198, v198, v17
    v_sub_f32 v199, v199, v17
    v_sub_f32 v204, v204, v17
    v_sub_f32 v205, v205, v17
    v_sub_f32 v206, v206, v17
    v_sub_f32 v207, v207, v17
    v_mul_f32 v168, v168, v18
    v_mul_f32 v169, v169, v18
    v_mul_f32 v170, v170, v18
    v_mul_f32 v171, v171, v18
    v_mul_f32 v172, v172, v19
    v_mul_f32 v173, v173, v19
    v_mul_f32 v174, v174, v19
    v_mul_f32 v175, v175, v19
    v_mul_f32 v64, v64, v18
    v_mul_f32 v65, v65, v18
    v_mul_f32 v66, v66, v18
    v_mul_f32 v67, v67, v18
    v_mul_f32 v68, v68, v19
    v_mul_f32 v69, v69, v19
    v_mul_f32 v70, v70, v19
    v_mul_f32 v71, v71, v19
    v_mul_f32 v72, v72, v18
    v_mul_f32 v73, v73, v18
    v_mul_f32 v74, v74, v18
    v_mul_f32 v75, v75, v18
    v_mul_f32 v76, v76, v19
    v_mul_f32 v77, v77, v19
    v_mul_f32 v78, v78, v19
    v_mul_f32 v79, v79, v19
    v_mul_f32 v80, v80, v18
    v_mul_f32 v81, v81, v18
    v_mul_f32 v82, v82, v18
    v_mul_f32 v83, v83, v18
    v_mul_f32 v84, v84, v19
    v_mul_f32 v85, v85, v19
    v_mul_f32 v86, v86, v19
    v_mul_f32 v87, v87, v19
    v_mul_f32 v88, v88, v18
    v_mul_f32 v89, v89, v18
    v_mul_f32 v90, v90, v18
    v_mul_f32 v91, v91, v18
    v_mul_f32 v92, v92, v19
    v_mul_f32 v93, v93, v19
    v_mul_f32 v94, v94, v19
    v_mul_f32 v95, v95, v19
    v_mul_f32 v96, v96, v18
    v_mul_f32 v97, v97, v18
    v_mul_f32 v98, v98, v18
    v_mul_f32 v99, v99, v18
    v_mul_f32 v100, v100, v19
    v_mul_f32 v101, v101, v19
    v_mul_f32 v102, v102, v19
    v_mul_f32 v103, v103, v19
    v_mul_f32 v104, v104, v18
    v_mul_f32 v105, v105, v18
    v_mul_f32 v106, v106, v18
    v_mul_f32 v107, v107, v18
    v_mul_f32 v108, v108, v19
    v_mul_f32 v109, v109, v19
    v_mul_f32 v110, v110, v19
    v_mul_f32 v111, v111, v19
    v_mul_f32 v112, v112, v18
    v_mul_f32 v113, v113, v18
    v_mul_f32 v114, v114, v18
    v_mul_f32 v115, v115, v18
    v_mul_f32 v116, v116, v19
    v_mul_f32 v117, v117, v19
    v_mul_f32 v118, v118, v19
    v_mul_f32 v119, v119, v19
    v_mul_f32 v120, v120, v18
    v_mul_f32 v121, v121, v18
    v_mul_f32 v122, v122, v18
    v_mul_f32 v123, v123, v18
    v_mul_f32 v124, v124, v19
    v_mul_f32 v125, v125, v19
    v_mul_f32 v126, v126, v19
    v_mul_f32 v127, v127, v19
    v_exp_f32 v20, v176
    v_exp_f32 v21, v177
    v_exp_f32 v22, v178
    v_cvt_pk_bf16_f32 v208, v20, v21
    v_exp_f32 v23, v179
    v_exp_f32 v24, v184
    v_cvt_pk_bf16_f32 v209, v22, v23
    v_exp_f32 v25, v185
    v_exp_f32 v26, v186
    v_cvt_pk_bf16_f32 v210, v24, v25
    v_exp_f32 v27, v187
    v_exp_f32 v20, v180
    v_cvt_pk_bf16_f32 v211, v26, v27
    v_exp_f32 v21, v181
    v_exp_f32 v22, v182
    v_cvt_pk_bf16_f32 v212, v20, v21
    v_exp_f32 v23, v183
    v_exp_f32 v24, v188
    v_cvt_pk_bf16_f32 v213, v22, v23
    v_exp_f32 v25, v189
    v_exp_f32 v26, v190
    v_cvt_pk_bf16_f32 v214, v24, v25
    v_exp_f32 v27, v191
    s_nop 0
    v_cvt_pk_bf16_f32 v215, v26, v27
    s_nop 1
    s_branch L_rareback_83
L_rare_87:
    s_nop 7
    v_max3_f32 v16, v192, v193, v194
    v_max3_f32 v17, v196, v197, v198
    v_max3_f32 v16, v16, v195, v200
    v_max3_f32 v17, v17, v199, v204
    v_max3_f32 v16, v16, v201, v202
    v_max3_f32 v17, v17, v205, v206
    v_max_f32 v16, v16, v203
    v_max_f32 v17, v17, v207
    v_mov_b32 v18, v16
    v_mov_b32 v19, v17
    s_nop 1
    v_permlane16_swap_b32 v16, v18
    v_permlane16_swap_b32 v17, v19
    s_nop 1
    v_max_f32 v16, v16, v18
    v_max_f32 v17, v17, v19
    v_mov_b32 v18, v16
    v_mov_b32 v19, v17
    s_nop 1
    v_permlane32_swap_b32 v16, v18
    v_permlane32_swap_b32 v17, v19
    s_nop 1
    v_max_f32 v16, v16, v18
    v_max_f32 v17, v17, v19
    v_add_f32 v16, 16.0, v16
    v_add_f32 v17, 16.0, v17
    v_max_f32 v16, 0, v16
    v_add_f32 v10, v10, v16
    v_exp_f32 v18, -v16
    v_max_f32 v17, 0, v17
    v_add_f32 v11, v11, v17
    v_exp_f32 v19, -v17
    v_sub_f32 v192, v192, v16
    v_sub_f32 v193, v193, v16
    v_sub_f32 v194, v194, v16
    v_sub_f32 v195, v195, v16
    v_sub_f32 v200, v200, v16
    v_sub_f32 v201, v201, v16
    v_sub_f32 v202, v202, v16
    v_sub_f32 v203, v203, v16
    v_sub_f32 v196, v196, v17
    v_sub_f32 v197, v197, v17
    v_sub_f32 v198, v198, v17
    v_sub_f32 v199, v199, v17
    v_sub_f32 v204, v204, v17
    v_sub_f32 v205, v205, v17
    v_sub_f32 v206, v206, v17
    v_sub_f32 v207, v207, v17
    v_sub_f32 v160, 0, v10
    v_sub_f32 v161, 0, v10
    v_sub_f32 v162, 0, v10
    v_sub_f32 v163, 0, v10
    v_sub_f32 v164, 0, v11
    v_sub_f32 v165, 0, v11
    v_sub_f32 v166, 0, v11
    v_sub_f32 v167, 0, v11
    v_mul_f32 v168, v168, v18
    v_mul_f32 v169, v169, v18
    v_mul_f32 v170, v170, v18
    v_mul_f32 v171, v171, v18
    v_mul_f32 v172, v172, v19
    v_mul_f32 v173, v173, v19
    v_mul_f32 v174, v174, v19
    v_mul_f32 v175, v175, v19
    v_mul_f32 v64, v64, v18
    v_mul_f32 v65, v65, v18
    v_mul_f32 v66, v66, v18
    v_mul_f32 v67, v67, v18
    v_mul_f32 v68, v68, v19
    v_mul_f32 v69, v69, v19
    v_mul_f32 v70, v70, v19
    v_mul_f32 v71, v71, v19
    v_mul_f32 v72, v72, v18
    v_mul_f32 v73, v73, v18
    v_mul_f32 v74, v74, v18
    v_mul_f32 v75, v75, v18
    v_mul_f32 v76, v76, v19
    v_mul_f32 v77, v77, v19
    v_mul_f32 v78, v78, v19
    v_mul_f32 v79, v79, v19
    v_mul_f32 v80, v80, v18
    v_mul_f32 v81, v81, v18
    v_mul_f32 v82, v82, v18
    v_mul_f32 v83, v83, v18
    v_mul_f32 v84, v84, v19
    v_mul_f32 v85, v85, v19
    v_mul_f32 v86, v86, v19
    v_mul_f32 v87, v87, v19
    v_mul_f32 v88, v88, v18
    v_mul_f32 v89, v89, v18
    v_mul_f32 v90, v90, v18
    v_mul_f32 v91, v91, v18
    v_mul_f32 v92, v92, v19
    v_mul_f32 v93, v93, v19
    v_mul_f32 v94, v94, v19
    v_mul_f32 v95, v95, v19
    v_mul_f32 v96, v96, v18
    v_mul_f32 v97, v97, v18
    v_mul_f32 v98, v98, v18
    v_mul_f32 v99, v99, v18
    v_mul_f32 v100, v100, v19
    v_mul_f32 v101, v101, v19
    v_mul_f32 v102, v102, v19
    v_mul_f32 v103, v103, v19
    v_mul_f32 v104, v104, v18
    v_mul_f32 v105, v105, v18
    v_mul_f32 v106, v106, v18
    v_mul_f32 v107, v107, v18
    v_mul_f32 v108, v108, v19
    v_mul_f32 v109, v109, v19
    v_mul_f32 v110, v110, v19
    v_mul_f32 v111, v111, v19
    v_mul_f32 v112, v112, v18
    v_mul_f32 v113, v113, v18
    v_mul_f32 v114, v114, v18
    v_mul_f32 v115, v115, v18
    v_mul_f32 v116, v116, v19
    v_mul_f32 v117, v117, v19
    v_mul_f32 v118, v118, v19
    v_mul_f32 v119, v119, v19
    v_mul_f32 v120, v120, v18
    v_mul_f32 v121, v121, v18
    v_mul_f32 v122, v122, v18
    v_mul_f32 v123, v123, v18
    v_mul_f32 v124, v124, v19
    v_mul_f32 v125, v125, v19
    v_mul_f32 v126, v126, v19
    v_mul_f32 v127, v127, v19
    v_exp_f32 v20, v192
    v_exp_f32 v21, v193
    v_exp_f32 v22, v194
    v_cvt_pk_bf16_f32 v216, v20, v21
    v_exp_f32 v23, v195
    v_exp_f32 v24, v200
    v_cvt_pk_bf16_f32 v217, v22, v23
    v_exp_f32 v25, v201
    v_exp_f32 v26, v202
    v_cvt_pk_bf16_f32 v218, v24, v25
    v_exp_f32 v27, v203
    v_exp_f32 v20, v196
    v_cvt_pk_bf16_f32 v219, v26, v27
    v_exp_f32 v21, v197
    v_exp_f32 v22, v198
    v_cvt_pk_bf16_f32 v220, v20, v21
    v_exp_f32 v23, v199
    v_exp_f32 v24, v204
    v_cvt_pk_bf16_f32 v221, v22, v23
    v_exp_f32 v25, v205
    v_exp_f32 v26, v206
    v_cvt_pk_bf16_f32 v222, v24, v25
    v_exp_f32 v27, v207
    s_nop 0
    v_cvt_pk_bf16_f32 v223, v26, v27
    s_nop 1
    s_branch L_rareback_88
L_x1s_56:
    s_add_u32 s32, s32, 16384
    s_and_b32 s32, s32, 0xffff
    v_add_u32 v3, s32, v6
    v_add_u32 v4, s32, v7
    ds_read_b128 v[32:35], v4 offset:4096
    ds_read_b128 v[36:39], v4 offset:5120
    ds_read_b128 v[40:43], v4 offset:6144
    ds_read_b128 v[44:47], v4 offset:7168
    v_mfma_f32_16x16x32_bf16 v[168:171], v[12:15], v[208:211], 0
    s_waitcnt lgkmcnt(4)
    v_max_f32 v18, v52, v56
    v_max_f32 v19, v53, v57
    v_sub_f32 v60, v52, v18
    v_sub_f32 v62, v56, v18
    v_sub_f32 v61, v53, v19
    v_sub_f32 v63, v57, v19
    v_exp_f32 v60, v60
    v_exp_f32 v62, v62
    v_exp_f32 v61, v61
    v_exp_f32 v63, v63
    s_nop 0
    v_mfma_f32_16x16x32_bf16 v[172:175], v[12:15], v[212:215], 0
    v_mul_f32 v18, v54, v60
    v_mul_f32 v19, v55, v61
    v_fmac_f32 v18, v58, v62
    v_fmac_f32 v19, v59, v63
    v_rcp_f32 v18, v18
    v_rcp_f32 v19, v19
    s_nop 0
    v_mul_f32 v60, v60, v18
    v_mul_f32 v62, v62, v18
    v_mul_f32 v61, v61, v19
    v_mul_f32 v63, v63, v19
    s_waitcnt lgkmcnt(3)
    v_mfma_f32_16x16x32_bf16 v[96:99], v[32:35], v[208:211], 0
    v_mul_f32 v128, v128, v62
    v_mul_f32 v129, v129, v62
    v_mul_f32 v130, v130, v62
    v_mul_f32 v131, v131, v62
    v_mul_f32 v136, v136, v62
    v_mul_f32 v137, v137, v62
    v_mul_f32 v138, v138, v62
    v_mul_f32 v139, v139, v62
    v_fmac_f32 v128, v64, v60
    v_fmac_f32 v129, v65, v60
    v_mfma_f32_16x16x32_bf16 v[100:103], v[32:35], v[212:215], 0
    ds_read_b128 v[32:35], v3 offset:0
    v_fmac_f32 v130, v66, v60
    v_fmac_f32 v131, v67, v60
    v_fmac_f32 v136, v72, v60
    v_fmac_f32 v137, v73, v60
    v_fmac_f32 v138, v74, v60
    v_fmac_f32 v139, v75, v60
    v_mul_f32 v132, v132, v63
    v_mul_f32 v133, v133, v63
    v_mul_f32 v134, v134, v63
    s_waitcnt lgkmcnt(3)
    v_mfma_f32_16x16x32_bf16 v[104:107], v[36:39], v[208:211], 0
    v_mul_f32 v135, v135, v63
    v_mul_f32 v140, v140, v63
    v_mul_f32 v141, v141, v63
    v_mul_f32 v142, v142, v63
    v_mul_f32 v143, v143, v63
    v_fmac_f32 v132, v68, v61
    v_fmac_f32 v133, v69, v61
    v_fmac_f32 v134, v70, v61
    v_fmac_f32 v135, v71, v61
    v_mfma_f32_16x16x32_bf16 v[108:111], v[36:39], v[212:215], 0
    ds_read_b128 v[36:39], v3 offset:1024
    v_fmac_f32 v140, v76, v61
    v_fmac_f32 v141, v77, v61
    v_fmac_f32 v142, v78, v61
    v_fmac_f32 v143, v79, v61
    v_mul_f32 v144, v144, v62
    v_mul_f32 v145, v145, v62
    v_mul_f32 v146, v146, v62
    v_mul_f32 v147, v147, v62
    v_mul_f32 v152, v152, v62
    v_cvt_pk_bf16_f32 v128, v128, v129
    v_cvt_pk_bf16_f32 v129, v130, v131
    v_cvt_pk_bf16_f32 v130, v136, v137
    v_cvt_pk_bf16_f32 v131, v138, v139
    s_waitcnt lgkmcnt(3)
    v_mfma_f32_16x16x32_bf16 v[112:115], v[40:43], v[208:211], 0
    v_add_u32 v16, s34, v8
    v_cmp_le_i32 s[46:47], 0, v16
    v_cmp_le_i32 s[48:49], 1, v16
    v_cmp_le_i32 s[50:51], 2, v16
    v_cmp_le_i32 s[52:53], 3, v16
    v_cndmask_b32 v192, v9, v192, s[46:47]
    v_mul_f32 v153, v153, v62
    v_mul_f32 v154, v154, v62
    v_mul_f32 v155, v155, v62
    v_fmac_f32 v144, v80, v60
    v_fmac_f32 v145, v81, v60
    v_fmac_f32 v146, v82, v60
    v_fmac_f32 v147, v83, v60
    v_fmac_f32 v152, v88, v60
    v_fmac_f32 v153, v89, v60
    buffer_store_dwordx4 v[128:131], v1, s[12:15], s90 offen offset:0 sc1
    v_cvt_pk_bf16_f32 v132, v132, v133
    v_cvt_pk_bf16_f32 v133, v134, v135
    v_mfma_f32_16x16x32_bf16 v[116:119], v[40:43], v[212:215], 0
    ds_read_b128 v[40:43], v3 offset:2048
    v_cmp_le_i32 s[46:47], 16, v16
    v_cndmask_b32 v193, v9, v193, s[48:49]
    v_exp_f32 v20, v192
    v_cmp_le_i32 s[48:49], 17, v16
    v_cndmask_b32 v194, v9, v194, s[50:51]
    v_fmac_f32 v154, v90, v60
    v_fmac_f32 v155, v91, v60
    v_mul_f32 v148, v148, v63
    v_mul_f32 v149, v149, v63
    v_mul_f32 v150, v150, v63
    v_mul_f32 v151, v151, v63
    v_mul_f32 v156, v156, v63
    v_mul_f32 v157, v157, v63
    v_mul_f32 v158, v158, v63
    v_cvt_pk_bf16_f32 v134, v140, v141
    v_cvt_pk_bf16_f32 v135, v142, v143
    buffer_store_dwordx4 v[132:135], v1, s[12:15], s91 offen offset:0 sc1
    s_waitcnt lgkmcnt(3)
    v_mfma_f32_16x16x32_bf16 v[120:123], v[44:47], v[208:211], 0
    v_exp_f32 v21, v193
    v_cmp_le_i32 s[50:51], 18, v16
    v_cndmask_b32 v195, v9, v195, s[52:53]
    v_exp_f32 v22, v194
    v_cvt_pk_bf16_f32 v216, v20, v21
    v_mul_f32 v159, v159, v63
    v_fmac_f32 v148, v84, v61
    v_fmac_f32 v149, v85, v61
    v_fmac_f32 v150, v86, v61
    v_fmac_f32 v151, v87, v61
    v_fmac_f32 v156, v92, v61
    v_fmac_f32 v157, v93, v61
    v_fmac_f32 v158, v94, v61
    v_fmac_f32 v159, v95, v61
    v_cvt_pk_bf16_f32 v144, v144, v145
    v_cvt_pk_bf16_f32 v145, v146, v147
    v_cvt_pk_bf16_f32 v146, v152, v153
    v_cvt_pk_bf16_f32 v147, v154, v155
    v_mfma_f32_16x16x32_bf16 v[124:127], v[44:47], v[212:215], 0
    ds_read_b128 v[44:47], v3 offset:3072
    v_cmp_le_i32 s[52:53], 19, v16
    v_cndmask_b32 v200, v9, v200, s[46:47]
    v_exp_f32 v23, v195
    v_cmp_le_i32 s[46:47], -16, v16
    v_cndmask_b32 v201, v9, v201, s[48:49]
    buffer_store_dwordx4 v[144:147], v1, s[12:15], s90 offen offset:1024 sc1
    v_cvt_pk_bf16_f32 v148, v148, v149
    v_cvt_pk_bf16_f32 v149, v150, v151
    s_waitcnt vmcnt(3)
    s_barrier
    s_waitcnt lgkmcnt(3)
    v_mfma_f32_16x16x32_bf16 v[64:67], v[32:35], v[208:211], 0
    v_exp_f32 v24, v200
    v_cvt_pk_bf16_f32 v217, v22, v23
    v_cmp_le_i32 s[48:49], -15, v16
    v_cndmask_b32 v202, v9, v202, s[50:51]
    v_exp_f32 v25, v201
    v_cmp_le_i32 s[50:51], -14, v16
    v_cvt_pk_bf16_f32 v150, v156, v157
    v_cvt_pk_bf16_f32 v151, v158, v159
    buffer_store_dwordx4 v[148:151], v1, s[12:15], s91 offen offset:1024 sc1
    v_mfma_f32_16x16x32_bf16 v[68:71], v[32:35], v[212:215], 0
    s_add_u32 s32, s32, 16384
    s_and_b32 s32, s32, 0xffff
    v_add_u32 v3, s32, v6
    v_add_u32 v4, s32, v7
    ds_read_b128 v[32:35], v4 offset:4096
    s_cmp_eq_u32 s36, 0
    s_cbranch_scc1 L_tg_112
    v_mov_b32 v228, 0
    v_mov_b32 v229, 0
    v_mov_b32 v230, 0
    v_mov_b32 v231, 0
    s_add_u32 s85, s86, 4096
    buffer_store_dwordx4 v[228:231], v1, s[12:15], s86 offen offset:0 sc1
L_tg_112:
    v_cndmask_b32 v203, v9, v203, s[52:53]
    v_exp_f32 v26, v202
    v_cvt_pk_bf16_f32 v218, v24, v25
    v_or3_b32 v28, v216, v217, v218
    v_cmp_le_i32 s[52:53], -13, v16
    s_waitcnt lgkmcnt(3)
    v_mfma_f32_16x16x32_bf16 v[72:75], v[36:39], v[208:211], 0
    v_cndmask_b32 v196, v9, v196, s[46:47]
    v_exp_f32 v27, v203
    v_cmp_le_i32 s[46:47], 0, v16
    v_cndmask_b32 v197, v9, v197, s[48:49]
    v_exp_f32 v20, v196
    v_mfma_f32_16x16x32_bf16 v[76:79], v[36:39], v[212:215], 0
    ds_read_b128 v[36:39], v4 offset:5120
    s_cmp_eq_u32 s36, 0
    s_cbranch_scc1 L_tg_113
    buffer_store_dwordx4 v[228:231], v1, s[12:15], s86 offen offset:1024 sc1
    buffer_store_dwordx4 v[228:231], v1, s[12:15], s86 offen offset:2048 sc1
L_tg_113:
    v_cvt_pk_bf16_f32 v219, v26, v27
    v_cmp_le_i32 s[48:49], 1, v16
    v_cndmask_b32 v198, v9, v198, s[50:51]
    v_exp_f32 v21, v197
    v_cmp_le_i32 s[50:51], 2, v16
    s_waitcnt lgkmcnt(3)
    v_mfma_f32_16x16x32_bf16 v[80:83], v[40:43], v[208:211], 0
    v_cndmask_b32 v199, v9, v199, s[52:53]
    v_exp_f32 v22, v198
    v_cvt_pk_bf16_f32 v220, v20, v21
    v_or3_b32 v28, v28, v219, v220
    v_cmp_le_i32 s[52:53], 3, v16
    v_cndmask_b32 v204, v9, v204, s[46:47]
    v_mfma_f32_16x16x32_bf16 v[84:87], v[40:43], v[212:215], 0
    ds_read_b128 v[40:43], v4 offset:6144
    s_cmp_eq_u32 s36, 0
    s_cbranch_scc1 L_tg_114
    buffer_store_dwordx4 v[228:231], v1, s[12:15], s86 offen offset:3072 sc1
    buffer_store_dwordx4 v[228:231], v1, s[12:15], s85 offen offset:0 sc1
L_tg_114:
    v_exp_f32 v23, v199
    v_cndmask_b32 v205, v9, v205, s[48:49]
    v_exp_f32 v24, v204
    v_cvt_pk_bf16_f32 v221, v22, v23
    v_cndmask_b32 v206, v9, v206, s[50:51]
    s_waitcnt lgkmcnt(3)
    v_mfma_f32_16x16x32_bf16 v[88:91], v[44:47], v[208:211], 0
    v_exp_f32 v25, v205
    v_cndmask_b32 v207, v9, v207, s[52:53]
    v_exp_f32 v26, v206
    v_cvt_pk_bf16_f32 v222, v24, v25
    v_or3_b32 v28, v28, v221, v222
    v_mfma_f32_16x16x32_bf16 v[92:95], v[44:47], v[212:215], 0
    ds_read_b128 v[44:47], v4 offset:7168
    v_exp_f32 v27, v207
    s_nop 0
    v_cvt_pk_bf16_f32 v223, v26, v27
    v_or_b32 v28, v28, v223
    v_and_b32 v28, s37, v28
    v_cmp_ne_u32 vcc, 0, v28
    s_sub_u32 s34, s34, 64
    s_cbranch_vccnz L_rare_115
L_rareback_116:
    v_and_b32 v17, 7, v31
    v_cmp_gt_u32 vcc, 4, v17
    s_nop 0
    s_cbranch_vccnz L_spin_117
L_spinback_118:
    s_branch L_post_55
L_slow_95:
    s_mov_b32 s46, 0x20000
L_spinloop_119:
    buffer_load_dword v31, v7, s[12:15], s69 offen sc1
    s_sub_u32 s46, s46, 1
    s_cbranch_scc1 L_spinout_120
    s_waitcnt vmcnt(0)
    v_and_b32 v13, 7, v31
    v_cmp_gt_u32 vcc, s100, v13
    s_nop 1
    s_and_b64 vcc, vcc, s[88:89]
    s_cbranch_scc0 L_spinout_120
    s_sleep 1
    s_branch L_spinloop_119
L_spinout_120:
    s_add_u32 m0, s64, 122880
    s_add_u32 s85, s61, 0
    buffer_load_dwordx4 v1, s[12:15], s85 offen sc1 lds
    buffer_load_dwordx4 v1, s[12:15], s85 offen offset:1024 sc1 lds
    s_add_u32 m0, s64, 0
    s_add_u32 s85, s61, 2048
    buffer_load_dwordx4 v1, s[12:15], s85 offen sc1 lds
    buffer_load_dwordx4 v1, s[12:15], s85 offen offset:1024 sc1 lds
    s_waitcnt vmcnt(2)
    s_branch L_slowback_96
L_spin_98:
    s_mov_b32 s46, 0x20000
L_spinloop_121:
    buffer_load_dword v31, v7, s[12:15], s69 offen sc1
    s_sub_u32 s46, s46, 1
    s_cbranch_scc1 L_spinback_99
    s_waitcnt vmcnt(0)
    v_and_b32 v13, 7, v31
    v_cmp_gt_u32 vcc, 7, v13
    s_nop 1
    s_cmp_lg_u64 vcc, 0
    s_cbranch_scc0 L_spinback_99
    s_sleep 1
    s_branch L_spinloop_121
L_rare_115:
    s_nop 7
    v_max3_f32 v16, v192, v193, v194
    v_max3_f32 v17, v196, v197, v198
    v_max3_f32 v16, v16, v195, v200
    v_max3_f32 v17, v17, v199, v204
    v_max3_f32 v16, v16, v201, v202
    v_max3_f32 v17, v17, v205, v206
    v_max_f32 v16, v16, v203
    v_max_f32 v17, v17, v207
    v_mov_b32 v18, v16
    v_mov_b32 v19, v17
    s_nop 1
    v_permlane16_swap_b32 v16, v18
    v_permlane16_swap_b32 v17, v19
    s_nop 1
    v_max_f32 v16, v16, v18
    v_max_f32 v17, v17, v19
    v_mov_b32 v18, v16
    v_mov_b32 v19, v17
    s_nop 1
    v_permlane32_swap_b32 v16, v18
    v_permlane32_swap_b32 v17, v19
    s_nop 1
    v_max_f32 v16, v16, v18
    v_max_f32 v17, v17, v19
    v_add_f32 v16, 16.0, v16
    v_add_f32 v17, 16.0, v17
    v_max_f32 v16, 0, v16
    v_add_f32 v10, v10, v16
    v_exp_f32 v18, -v16
    v_max_f32 v17, 0, v17
    v_add_f32 v11, v11, v17
    v_exp_f32 v19, -v17
    v_sub_f32 v192, v192, v16
    v_sub_f32 v193, v193, v16
    v_sub_f32 v194, v194, v16
    v_sub_f32 v195, v195, v16
    v_sub_f32 v200, v200, v16
    v_sub_f32 v201, v201, v16
    v_sub_f32 v202, v202, v16
    v_sub_f32 v203, v203, v16
    v_sub_f32 v196, v196, v17
    v_sub_f32 v197, v197, v17
    v_sub_f32 v198, v198, v17
    v_sub_f32 v199, v199, v17
    v_sub_f32 v204, v204, v17
    v_sub_f32 v205, v205, v17
    v_sub_f32 v206, v206, v17
    v_sub_f32 v207, v207, v17
    v_sub_f32 v160, 0, v10
    v_sub_f32 v161, 0, v10
    v_sub_f32 v162, 0, v10
    v_sub_f32 v163, 0, v10
    v_sub_f32 v164, 0, v11
    v_sub_f32 v165, 0, v11
    v_sub_f32 v166, 0, v11
    v_sub_f32 v167, 0, v11
    v_mul_f32 v168, v168, v18
    v_mul_f32 v169, v169, v18
    v_mul_f32 v170, v170, v18
    v_mul_f32 v171, v171, v18
    v_mul_f32 v172, v172, v19
    v_mul_f32 v173, v173, v19
    v_mul_f32 v174, v174, v19
    v_mul_f32 v175, v175, v19
    v_mul_f32 v64, v64, v18
    v_mul_f32 v65, v65, v18
    v_mul_f32 v66, v66, v18
    v_mul_f32 v67, v67, v18
    v_mul_f32 v68, v68, v19
    v_mul_f32 v69, v69, v19
    v_mul_f32 v70, v70, v19
    v_mul_f32 v71, v71, v19
    v_mul_f32 v72, v72, v18
    v_mul_f32 v73, v73, v18
    v_mul_f32 v74, v74, v18
    v_mul_f32 v75, v75, v18
    v_mul_f32 v76, v76, v19
    v_mul_f32 v77, v77, v19
    v_mul_f32 v78, v78, v19
    v_mul_f32 v79, v79, v19
    v_mul_f32 v80, v80, v18
    v_mul_f32 v81, v81, v18
    v_mul_f32 v82, v82, v18
    v_mul_f32 v83, v83, v18
    v_mul_f32 v84, v84, v19
    v_mul_f32 v85, v85, v19
    v_mul_f32 v86, v86, v19
    v_mul_f32 v87, v87, v19
    v_mul_f32 v88, v88, v18
    v_mul_f32 v89, v89, v18
    v_mul_f32 v90, v90, v18
    v_mul_f32 v91, v91, v18
    v_mul_f32 v92, v92, v19
    v_mul_f32 v93, v93, v19
    v_mul_f32 v94, v94, v19
    v_mul_f32 v95, v95, v19
    v_mul_f32 v96, v96, v18
    v_mul_f32 v97, v97, v18
    v_mul_f32 v98, v98, v18
    v_mul_f32 v99, v99, v18
    v_mul_f32 v100, v100, v19
    v_mul_f32 v101, v101, v19
    v_mul_f32 v102, v102, v19
    v_mul_f32 v103, v103, v19
    v_mul_f32 v104, v104, v18
    v_mul_f32 v105, v105, v18
    v_mul_f32 v106, v106, v18
    v_mul_f32 v107, v107, v18
    v_mul_f32 v108, v108, v19
    v_mul_f32 v109, v109, v19
    v_mul_f32 v110, v110, v19
    v_mul_f32 v111, v111, v19
    v_mul_f32 v112, v112, v18
    v_mul_f32 v113, v113, v18
    v_mul_f32 v114, v114, v18
    v_mul_f32 v115, v115, v18
    v_mul_f32 v116, v116, v19
    v_mul_f32 v117, v117, v19
    v_mul_f32 v118, v118, v19
    v_mul_f32 v119, v119, v19
    v_mul_f32 v120, v120, v18
    v_mul_f32 v121, v121, v18
    v_mul_f32 v122, v122, v18
    v_mul_f32 v123, v123, v18
    v_mul_f32 v124, v124, v19
    v_mul_f32 v125, v125, v19
    v_mul_f32 v126, v126, v19
    v_mul_f32 v127, v127, v19
    v_exp_f32 v20, v192
    v_exp_f32 v21, v193
    v_exp_f32 v22, v194
    v_cvt_pk_bf16_f32 v216, v20, v21
    v_exp_f32 v23, v195
    v_exp_f32 v24, v200
    v_cvt_pk_bf16_f32 v217, v22, v23
    v_exp_f32 v25, v201
    v_exp_f32 v26, v202
    v_cvt_pk_bf16_f32 v218, v24, v25
    v_exp_f32 v27, v203
    v_exp_f32 v20, v196
    v_cvt_pk_bf16_f32 v219, v26, v27
    v_exp_f32 v21, v197
    v_exp_f32 v22, v198
    v_cvt_pk_bf16_f32 v220, v20, v21
    v_exp_f32 v23, v199
    v_exp_f32 v24, v204
    v_cvt_pk_bf16_f32 v221, v22, v23
    v_exp_f32 v25, v205
    v_exp_f32 v26, v206
    v_cvt_pk_bf16_f32 v222, v24, v25
    v_exp_f32 v27, v207
    s_nop 0
    v_cvt_pk_bf16_f32 v223, v26, v27
    s_nop 1
    s_branch L_rareback_116
L_spin_117:
    s_mov_b32 s46, 0x20000
L_spinloop_122:
    s_lshl_b32 s45, s22, 7
    s_add_u32 s45, s45, 73400192
    s_sub_u32 s45, s45, s69
    v_lshrrev_b32 v17, 9, v1
    v_mul_lo_u32 v17, v17, s45
    v_lshrrev_b32 v31, 2, v1
    v_add3_u32 v31, v31, v17, s69
    buffer_load_dword v31, v31, s[12:15], 0 offen sc1
    s_sub_u32 s46, s46, 1
    s_cbranch_scc1 L_spinback_118
    s_waitcnt vmcnt(0)
    v_and_b32 v17, 7, v31
    v_cmp_gt_u32 vcc, 4, v17
    s_nop 0
    s_cbranch_vccz L_spinback_118
    s_sleep 2
    s_branch L_spinloop_122
recurrent_scan__compressed_kv_cla__dense_activation_mish__prompt_kernel_end:
    s_endpgm
recurrent_scan__compressed_kv_cla__dense_activation_mish__prompt_kernel_codeend:
.section .rodata,"a"
.p2align 6
.amdhsa_kernel recurrent_scan__compressed_kv_cla__dense_activation_mish__prompt_kernel
  .amdhsa_next_free_vgpr 256
  .amdhsa_next_free_sgpr 102
  .amdhsa_accum_offset 256
  .amdhsa_group_segment_fixed_size 0
  .amdhsa_kernarg_size 104
  .amdhsa_user_sgpr_count 2
  .amdhsa_user_sgpr_kernarg_segment_ptr 1
  .amdhsa_system_sgpr_workgroup_id_x 1
.end_amdhsa_kernel
```
